```python
import torch

def _softmax(x, axis=-1):
    return torch.softmax(x, dim=axis)
def _gelu(x):
    return torch.nn.functional.gelu(x, approximate="tanh")
def _silu(x):
    return torch.nn.functional.silu(x)
def _sigmoid(x):
    return torch.sigmoid(x)
def _layernorm(x, axis=-1, eps=1e-5):
    m = x.mean(dim=axis, keepdim=True)
    v = x.var(dim=axis, keepdim=True, unbiased=False)
    return (x - m) / torch.sqrt(v + eps)
def _scatter_add(tgt, idx, src, axis=0):
    return tgt.clone().index_add_(axis, idx, src)
def _segment_sum(src, seg, n):
    out = torch.zeros((n,) + src.shape[1:], dtype=src.dtype)
    return out.index_add_(0, seg, src)
def _pad(x, pw):
    flat = tuple(v for pair in reversed(pw) for v in pair)
    return torch.nn.functional.pad(x, flat)

kernel_name = 'sequential_preLN__sliding_block__glu_gated_glu__prompt'

def setup_inputs():

    _w = (lambda a: (lambda t: t.to(torch.bfloat16) if t.is_floating_point() else t)(torch.as_tensor(a)))
    def _A_setup():
        B, S, D = 1, 2048, 1024
        return {
            "x": _w((lambda *s: torch.randn(*s, dtype=torch.bfloat16) * 0.05)(B, S, D)),
            "wqkv": _w((lambda *s: torch.randn(*s, dtype=torch.bfloat16) * 0.05)(D, 3 * D)),
            "wo": _w((lambda *s: torch.randn(*s, dtype=torch.bfloat16) * 0.05)(D, D)),
        }
    _A_in = _A_setup()

    def _B_setup():
        B, S, D, F = 1, 2048, 1024, 3584
        return {
            "x": _w((lambda *s: torch.randn(*s, dtype=torch.bfloat16) * 0.05)(B, S, D)),
            "w_gate": _w((lambda *s: torch.randn(*s, dtype=torch.bfloat16) * 0.05)(D, F)),
            "w_up": _w((lambda *s: torch.randn(*s, dtype=torch.bfloat16) * 0.05)(D, F)),
            "w_down": _w((lambda *s: torch.randn(*s, dtype=torch.bfloat16) * 0.05)(F, D)),
        }
    _B_in = _B_setup()

    return {
        "A_x": _A_in["x"],
        "A_wqkv": _A_in["wqkv"],
        "A_wo": _A_in["wo"],
        "B_x": _B_in["x"],
        "B_w_gate": _B_in["w_gate"],
        "B_w_up": _B_in["w_up"],
        "B_w_down": _B_in["w_down"],
    }

def reference(A_x, A_wqkv, A_wo, B_x, B_w_gate, B_w_up, B_w_down):
    def _A_ref(x, wqkv, wo):
        B, S, D = x.shape
        H = 32; Dh = D // H; W = 256
        qkv = (lambda x, *d: x.permute(*d))((x @ wqkv).reshape(B, S, 3, H, Dh), 2, 0, 3, 1, 4)
        q, k, v = qkv[0], qkv[1], qkv[2]
        scores = torch.einsum("bhqd,bhkd->bhqk", q, k) * (Dh ** -0.5)
        idx = torch.arange(S)
        mask = (idx[:, None] - idx[None, :] >= 0) & (idx[:, None] - idx[None, :] < W)
        scores = torch.where(mask[None, None], scores, -1e9)
        p = _softmax(scores, axis=-1)
        o = torch.einsum("bhqk,bhkd->bhqd", p, v)
        return (lambda x, *d: x.permute(*d))(o, 0, 2, 1, 3).reshape(B, S, D) @ wo

    def _B_ref(x, w_gate, w_up, w_down):
        g = torch.einsum("bsd,df->bsf", x, w_gate)
        u = torch.einsum("bsd,df->bsf", x, w_up)
        h = _sigmoid(g) * u
        return torch.einsum("bsf,fd->bsd", h, w_down)

    x = A_x
    h = x + _A_ref(_layernorm(x, axis=-1), A_wqkv, A_wo)
    h2 = h + _B_ref(_layernorm(h, axis=-1), B_w_gate, B_w_up, B_w_down)
    return h2
```

```asm
; @launch grid=(256,1,1) block=(256,1,1) lds=163840
.amdgcn_target "amdgcn-amd-amdhsa--gfx950"
.text
.globl sequential_preLN__sliding_block__glu_gated_glu__prompt_kernel
.p2align 8
.type sequential_preLN__sliding_block__glu_gated_glu__prompt_kernel,@function
sequential_preLN__sliding_block__glu_gated_glu__prompt_kernel:

    s_load_dwordx16 s[64:79], s[0:1], 0
    s_load_dwordx4 s[80:83], s[0:1], 64
    s_cmp_ge_u32 s2, 256
    s_cbranch_scc1 L_done
    v_and_b32 v255, 63, v0
    v_lshrrev_b32 v1, 6, v0
    v_lshlrev_b32 v254, 4, v255
    v_readfirstlane_b32 s28, v1
    v_mov_b32 v253, 1
    v_mov_b32 v252, 0
    s_and_b32 s34, s2, 7
    s_lshr_b32 s35, s2, 3
    s_lshr_b32 s36, s34, 1
    s_and_b32 s37, s34, 1
    s_lshl_b32 s38, s36, 2
    s_and_b32 s39, s35, 3
    s_add_u32 s29, s38, s39
    s_lshl_b32 s38, s37, 3
    s_lshr_b32 s39, s35, 2
    s_add_u32 s30, s38, s39
    s_and_b32 s38, s34, 4
    s_and_b32 s39, s35, 3
    s_add_u32 s31, s38, s39
    s_and_b32 s38, s34, 3
    s_lshl_b32 s38, s38, 3
    s_lshr_b32 s39, s35, 2
    s_add_u32 s32, s38, s39
    s_and_b32 s38, s35, 3
    s_lshl_b32 s38, s38, 1
    s_lshr_b32 s39, s35, 2
    s_add_u32 s38, s38, s39
    s_and_b32 s40, s38, 7
    s_and_b32 s58, s36, 3
    s_lshl_b32 s34, s29, 4
    s_add_u32 s34, s34, s30
    s_lshl_b32 s45, s34, 3
    s_lshl_b32 s41, s34, 14
    v_and_b32 v76, 7, v255
    v_lshrrev_b32 v77, 3, v255
    v_lshlrev_b32 v3, 11, v76
    v_lshl_add_u32 v3, v77, 4, v3
    s_lshl_b32 s42, s28, 9
    s_waitcnt lgkmcnt(0)
    v_lshrrev_b32 v1, 5, v255
    v_lshlrev_b32 v1, 11, v1
    v_bfe_u32 v2, v255, 2, 3
    v_lshl_add_u32 v1, v2, 7, v1
    v_and_b32 v3, 3, v255
    v_lshl_add_u32 v1, v3, 3, v1
    v_bfe_u32 v2, v255, 3, 2
    v_xor_b32 v3, 0, v2
    v_lshl_add_u32 v248, v3, 5, v1
    v_xor_b32 v3, 1, v2
    v_lshl_add_u32 v249, v3, 5, v1
    v_xor_b32 v3, 2, v2
    v_lshl_add_u32 v250, v3, 5, v1
    v_xor_b32 v3, 3, v2
    v_lshl_add_u32 v251, v3, 5, v1
    s_mov_b32 s70, s40
    s_mov_b32 s36, 0xeeee44
    s_mov_b32 s37, s36
    s_lshl_b32 s38, s40, 2
    s_lshl_b64 s[36:37], s[36:37], s38
    s_mov_b32 s71, s37
    s_add_u32 s20, s82, 0x3400000
    s_addc_u32 s21, s83, 0
    s_mov_b32 s22, 0x2a8000
    s_mov_b32 s23, 0x20000
L_ph0:
    s_lshl_b32 s34, s28, 1
    s_add_u32 s100, s45, s34
    s_lshl_b32 s34, s100, 11
    s_add_u32 s4, s64, s34
    s_addc_u32 s5, s65, 0
    s_mov_b32 s6, 0x1000
    s_mov_b32 s7, 0x20000
    v_lshrrev_b32 v72, 5, v255
    v_and_b32 v73, 31, v255
    v_lshlrev_b32 v73, 4, v73
    v_lshl_add_u32 v73, v72, 11, v73
    buffer_load_dwordx4 v[128:131], v73, s[4:7], 0 offen offset:0
    buffer_load_dwordx4 v[132:135], v73, s[4:7], 0 offen offset:512
    buffer_load_dwordx4 v[136:139], v73, s[4:7], 0 offen offset:1024
    buffer_load_dwordx4 v[140:143], v73, s[4:7], 0 offen offset:1536
    s_lshr_b32 s34, s2, 3
    s_lshl2_add_u32 s34, s34, s28
    s_mov_b32 s96, s82
    s_mov_b32 s97, s83
    s_mov_b32 s35, s34
    s_cmp_ge_u32 s34, 28
    s_cselect_b32 s96, s72, s96
    s_cselect_b32 s97, s73, s97
    s_cselect_b32 s36, 28, 0
    s_mov_b32 s37, s36
    s_cmp_ge_u32 s34, 32
    s_cselect_b32 s96, s74, s96
    s_cselect_b32 s97, s75, s97
    s_cselect_b32 s36, 32, 0
    s_max_u32 s37, s37, s36
    s_cmp_ge_u32 s34, 36
    s_cselect_b32 s96, s76, s96
    s_cselect_b32 s97, s77, s97
    s_cselect_b32 s36, 36, 0
    s_max_u32 s37, s37, s36
    s_cmp_ge_u32 s34, 40
    s_cselect_b32 s96, s78, s96
    s_cselect_b32 s97, s79, s97
    s_cselect_b32 s36, 40, 0
    s_max_u32 s37, s37, s36
    s_cmp_ge_u32 s34, 42
    s_cselect_b32 s96, s68, s96
    s_cselect_b32 s97, s69, s97
    s_cselect_b32 s36, 42, 0
    s_max_u32 s37, s37, s36
    s_cmp_ge_u32 s34, 43
    s_cselect_b32 s96, s66, s96
    s_cselect_b32 s97, s67, s97
    s_cselect_b32 s36, 43, 0
    s_max_u32 s37, s37, s36
    s_cmp_ge_u32 s34, 46
    s_cselect_b32 s96, s64, s96
    s_cselect_b32 s97, s65, s97
    s_cselect_b32 s36, 46, 0
    s_max_u32 s37, s37, s36
    s_sub_u32 s35, s34, s37
    s_lshl_b32 s35, s35, 21
    s_add_u32 s96, s96, s35
    s_addc_u32 s97, s97, 0
    s_cmp_ge_u32 s34, 48
    s_cbranch_scc1 L_tw1
    s_load_dword s101, s[96:97], 0x0
L_tw1:
    v_lshrrev_b32 v72, 3, v255
    v_and_b32 v73, 4, v72
    v_add_u32 v72, v72, v73
    s_and_b32 s34, s28, 1
    s_lshl_b32 s34, s34, 4
    s_lshr_b32 s35, s28, 1
    s_lshl_b32 s35, s35, 2
    s_add_u32 s34, s34, s35
    v_add_u32 v72, s34, v72
    v_mul_u32_u24 v72, 6144, v72
    v_lshrrev_b32 v73, 4, v255
    v_lshlrev_b32 v73, 1, v73
    v_and_b32 v246, 7, v255
    v_xor_b32 v246, v246, v73
    v_lshl_add_u32 v246, v246, 4, v72
    v_add_u32 v247, 1024, v246
    v_add_u32 v245, 3072, v246
    v_add_u32 v244, 4096, v246
    s_lshl_b32 s35, s30, 7
    s_sub_u32 s36, 6292480, s35
    s_sub_u32 s38, s66, 1024
    s_subb_u32 s39, s67, 0
    s_add_u32 s12, s38, s35
    s_addc_u32 s13, s39, 0
    s_mov_b32 s14, s36
    s_mov_b32 s15, 0x20000
    s_lshl_b32 s40, s28, 11
    v_bfe_u32 v243, v255, 1, 4
    s_add_u32 s34, s29, s30
    s_and_b32 s34, s34, 3
    v_subrev_u32 v72, s34, v243
    v_and_b32 v72, 3, v72
    v_sub_u32 v73, v243, v72
    v_lshlrev_b32 v72, 2, v72
    s_mov_b32 s35, 0xf1
    v_bfe_i32 v72, s35, v72, 4
    v_cmp_ge_u32 s[36:37], 14, v73
    s_nop 0
    s_nop 0
    v_cndmask_b32_e64 v72, 0, v72, s[36:37]
    v_add_u32 v243, v243, v72
    s_and_b32 s35, s58, 3
    s_lshl_b32 s35, s35, 2
    v_add_u32 v243, s35, v243
    v_and_b32 v243, 15, v243
    v_lshlrev_b32 v88, 7, v243
    v_and_b32 v72, 1, v255
    v_lshl_add_u32 v243, v243, 1, v72
    v_mul_u32_u24 v243, 196608, v243
    s_nop 0
    v_readlane_b32 s50, v243, 0
    v_readlane_b32 s51, v243, 1
    v_readlane_b32 s52, v243, 2
    v_readlane_b32 s53, v243, 3
    v_readlane_b32 s54, v243, 4
    v_readlane_b32 s55, v243, 5
    v_readlane_b32 s56, v243, 6
    v_readlane_b32 s57, v243, 7
    s_add_u32 m0, s40, 81920
    s_nop 0
    buffer_load_dwordx4 v245, s[12:15], s50 offen offset:0 lds
    buffer_load_dwordx4 v244, s[12:15], s50 offen offset:1024 lds
    s_add_u32 m0, s40, 90112
    s_nop 0
    buffer_load_dwordx4 v245, s[12:15], s51 offen offset:0 lds
    buffer_load_dwordx4 v244, s[12:15], s51 offen offset:1024 lds
    s_lshl_b32 s34, s29, 2
    s_add_u32 s34, s34, s28
    s_lshl_b32 s34, s34, 16
    s_sub_u32 s86, s64, 3072
    s_subb_u32 s87, s65, 0
    s_add_u32 s8, s86, s34
    s_addc_u32 s9, s87, 0
    s_mov_b32 s10, 0x10c00
    s_mov_b32 s11, 0x20000
    v_lshrrev_b32 v72, 1, v77
    v_lshlrev_b32 v73, 11, v77
    v_add_u32 v74, 0, v72
    v_xor_b32 v74, v74, v76
    v_lshl_add_u32 v74, v74, 4, v73
    v_add_u32 v90, 3072, v74
    v_add_u32 v74, 4, v72
    v_xor_b32 v74, v74, v76
    v_lshl_add_u32 v74, v74, 4, v73
    v_add_u32 v91, 18432, v74
    v_add_u32 v74, 0, v72
    v_xor_b32 v74, v74, v76
    v_lshl_add_u32 v74, v74, 4, v73
    v_add_u32 v92, 33792, v74
    v_add_u32 v74, 4, v72
    v_xor_b32 v74, v74, v76
    v_lshl_add_u32 v74, v74, 4, v73
    v_add_u32 v93, 49152, v74
    s_lshl_b32 s41, s28, 12
    s_add_u32 s41, s41, 114688
    v_and_b32 v72, 15, v255
    v_lshrrev_b32 v73, 1, v72
    v_lshrrev_b32 v74, 4, v255
    v_xor_b32 v73, v73, v74
    v_lshlrev_b32 v73, 4, v73
    v_lshl_add_u32 v73, v72, 7, v73
    v_add_u32 v94, s41, v73
    v_xor_b32 v73, 64, v73
    v_add_u32 v95, s41, v73
    v_readlane_b32 s84, v88, 0
    v_readlane_b32 s85, v88, 2
    s_lshl_b32 s34, s28, 5
    v_xor_b32 v232, s34, v248
    v_add_u32 v236, 0x10000, v232
    v_xor_b32 v233, s34, v249
    v_add_u32 v237, 0x10000, v233
    v_xor_b32 v234, s34, v250
    v_add_u32 v238, 0x10000, v234
    v_xor_b32 v235, s34, v251
    v_add_u32 v239, 0x10000, v235
    v_mov_b32 v212, 0x3f803f80
    v_mov_b32 v213, 0x3f803f80
    v_mov_b32 v214, 0x3f803f80
    v_mov_b32 v215, 0x3f803f80
    s_mov_b32 s88, s80
    s_mov_b32 s89, s81
    s_mov_b32 s90, 0x100
    s_mov_b32 s91, 0x20000
    s_add_u32 m0, s41, 0
    s_nop 0
    buffer_load_dwordx4 v90, s[8:11], s84 offen offset:0 lds
    buffer_load_dwordx4 v91, s[8:11], s84 offen offset:1024 lds
    s_add_u32 m0, s41, 0
    s_nop 0
    buffer_load_dwordx4 v92, s[8:11], s84 offen offset:2048 lds
    buffer_load_dwordx4 v93, s[8:11], s84 offen offset:3072 lds
    v_readlane_b32 s84, v88, 4
    v_mov_b32 v80, 0
    v_mov_b32 v81, 0
    v_mov_b32 v82, 0
    v_mov_b32 v83, 0
    s_lshr_b32 s36, s45, 3
    s_add_u32 s36, s36, 128
    s_mul_i32 s36, s36, 4352
    s_mul_i32 s37, s28, 4194304
    s_add_u32 s36, s36, s37
    v_mul_u32_u24 v4, 1114112, v77
    v_lshl_add_u32 v4, v76, 4, v4
    buffer_store_dwordx4 v[80:83], v4, s[20:23], s36 offen sc1
    s_cmp_lg_u32 s2, 0
    s_cbranch_scc1 L_z2
    buffer_load_dword v84, v252, s[88:91], 0 offen sc1
    v_lshrrev_b32 v4, 3, v0
    v_mul_u32_u24 v4, 4352, v4
    v_lshl_add_u32 v4, v76, 4, v4
    s_mov_b32 s36, 0
    buffer_store_dwordx4 v[80:83], v4, s[20:23], s36 offen sc1
    s_add_u32 s36, s36, 139264
    buffer_store_dwordx4 v[80:83], v4, s[20:23], s36 offen sc1
    s_add_u32 s36, s36, 139264
    buffer_store_dwordx4 v[80:83], v4, s[20:23], s36 offen sc1
    s_add_u32 s36, s36, 139264
    buffer_store_dwordx4 v[80:83], v4, s[20:23], s36 offen sc1
    s_add_u32 s36, s36, 139264
L_z2:
    s_getpc_b64 s[34:35]
L_pc3:
    s_lshr_b32 s36, s2, 3
    s_lshl_b32 s36, s36, 13
    s_sub_u32 s16, s34, L_pc3-sequential_preLN__sliding_block__glu_gated_glu__prompt_kernel
    s_subb_u32 s17, s35, 0
    s_mov_b32 s18, L_end-sequential_preLN__sliding_block__glu_gated_glu__prompt_kernel
    s_mov_b32 s19, 0x20000
    v_lshlrev_b32 v7, 7, v255
    s_cmp_lg_u32 s28, 3
    s_cbranch_scc1 L_pf4
    buffer_load_dword v71, v7, s[16:19], s36 offen
L_pf4:
    s_mov_b32 s47, 0xffff0000
    s_waitcnt vmcnt(12)
    v_lshlrev_b32 v160, 16, v128
    v_and_b32 v161, s47, v128
    v_lshlrev_b32 v162, 16, v129
    v_and_b32 v163, s47, v129
    v_lshlrev_b32 v164, 16, v130
    v_and_b32 v165, s47, v130
    v_lshlrev_b32 v166, 16, v131
    v_and_b32 v167, s47, v131
    s_waitcnt vmcnt(11)
    v_lshlrev_b32 v168, 16, v132
    v_and_b32 v169, s47, v132
    v_lshlrev_b32 v170, 16, v133
    v_and_b32 v171, s47, v133
    v_lshlrev_b32 v172, 16, v134
    v_and_b32 v173, s47, v134
    v_lshlrev_b32 v174, 16, v135
    v_and_b32 v175, s47, v135
    s_waitcnt vmcnt(10)
    v_lshlrev_b32 v176, 16, v136
    v_and_b32 v177, s47, v136
    v_lshlrev_b32 v178, 16, v137
    v_and_b32 v179, s47, v137
    v_lshlrev_b32 v180, 16, v138
    v_and_b32 v181, s47, v138
    v_lshlrev_b32 v182, 16, v139
    v_and_b32 v183, s47, v139
    s_waitcnt vmcnt(9)
    v_lshlrev_b32 v184, 16, v140
    v_and_b32 v185, s47, v140
    v_lshlrev_b32 v186, 16, v141
    v_and_b32 v187, s47, v141
    v_lshlrev_b32 v188, 16, v142
    v_and_b32 v189, s47, v142
    v_lshlrev_b32 v190, 16, v143
    v_and_b32 v191, s47, v143
    v_pk_add_f32 v[192:193], v[160:161], v[164:165]
    v_pk_add_f32 v[194:195], v[162:163], v[166:167]
    v_pk_add_f32 v[192:193], v[192:193], v[168:169]
    v_pk_add_f32 v[194:195], v[194:195], v[170:171]
    v_pk_add_f32 v[192:193], v[192:193], v[172:173]
    v_pk_add_f32 v[194:195], v[194:195], v[174:175]
    v_pk_add_f32 v[192:193], v[192:193], v[176:177]
    v_pk_add_f32 v[194:195], v[194:195], v[178:179]
    v_pk_add_f32 v[192:193], v[192:193], v[180:181]
    v_pk_add_f32 v[194:195], v[194:195], v[182:183]
    v_pk_add_f32 v[192:193], v[192:193], v[184:185]
    v_pk_add_f32 v[194:195], v[194:195], v[186:187]
    v_pk_add_f32 v[192:193], v[192:193], v[188:189]
    v_pk_add_f32 v[194:195], v[194:195], v[190:191]
    v_add_f32 v192, v192, v193
    v_add_f32 v194, v194, v195
    v_add_f32 v192, v192, v194
    s_nop 1
    v_add_f32_dpp v192, v192, v192 row_ror:8 row_mask:0xf bank_mask:0xf
    s_nop 1
    v_add_f32_dpp v192, v192, v192 row_ror:4 row_mask:0xf bank_mask:0xf
    s_nop 1
    v_add_f32_dpp v192, v192, v192 row_ror:2 row_mask:0xf bank_mask:0xf
    s_nop 1
    v_add_f32_dpp v192, v192, v192 row_ror:1 row_mask:0xf bank_mask:0xf
    v_mov_b32 v193, v192
    s_nop 1
    v_permlane16_swap_b32 v192, v193
    v_add_f32 v192, v192, v193
    v_mul_f32 v198, 0x3a800000, v192
    v_pk_add_f32 v[160:161], v[160:161], v[198:199] op_sel_hi:[1,0] neg_lo:[0,1] neg_hi:[0,1]
    v_pk_add_f32 v[162:163], v[162:163], v[198:199] op_sel_hi:[1,0] neg_lo:[0,1] neg_hi:[0,1]
    v_pk_add_f32 v[164:165], v[164:165], v[198:199] op_sel_hi:[1,0] neg_lo:[0,1] neg_hi:[0,1]
    v_pk_add_f32 v[166:167], v[166:167], v[198:199] op_sel_hi:[1,0] neg_lo:[0,1] neg_hi:[0,1]
    v_pk_add_f32 v[168:169], v[168:169], v[198:199] op_sel_hi:[1,0] neg_lo:[0,1] neg_hi:[0,1]
    v_pk_add_f32 v[170:171], v[170:171], v[198:199] op_sel_hi:[1,0] neg_lo:[0,1] neg_hi:[0,1]
    v_pk_add_f32 v[172:173], v[172:173], v[198:199] op_sel_hi:[1,0] neg_lo:[0,1] neg_hi:[0,1]
    v_pk_add_f32 v[174:175], v[174:175], v[198:199] op_sel_hi:[1,0] neg_lo:[0,1] neg_hi:[0,1]
    v_pk_add_f32 v[176:177], v[176:177], v[198:199] op_sel_hi:[1,0] neg_lo:[0,1] neg_hi:[0,1]
    v_pk_add_f32 v[178:179], v[178:179], v[198:199] op_sel_hi:[1,0] neg_lo:[0,1] neg_hi:[0,1]
    v_pk_add_f32 v[180:181], v[180:181], v[198:199] op_sel_hi:[1,0] neg_lo:[0,1] neg_hi:[0,1]
    v_pk_add_f32 v[182:183], v[182:183], v[198:199] op_sel_hi:[1,0] neg_lo:[0,1] neg_hi:[0,1]
    v_pk_add_f32 v[184:185], v[184:185], v[198:199] op_sel_hi:[1,0] neg_lo:[0,1] neg_hi:[0,1]
    v_pk_add_f32 v[186:187], v[186:187], v[198:199] op_sel_hi:[1,0] neg_lo:[0,1] neg_hi:[0,1]
    v_pk_add_f32 v[188:189], v[188:189], v[198:199] op_sel_hi:[1,0] neg_lo:[0,1] neg_hi:[0,1]
    v_pk_add_f32 v[190:191], v[190:191], v[198:199] op_sel_hi:[1,0] neg_lo:[0,1] neg_hi:[0,1]
    v_pk_mul_f32 v[192:193], v[160:161], v[160:161]
    v_pk_mul_f32 v[194:195], v[162:163], v[162:163]
    v_pk_fma_f32 v[192:193], v[164:165], v[164:165], v[192:193]
    v_pk_fma_f32 v[194:195], v[166:167], v[166:167], v[194:195]
    v_pk_fma_f32 v[192:193], v[168:169], v[168:169], v[192:193]
    v_pk_fma_f32 v[194:195], v[170:171], v[170:171], v[194:195]
    v_pk_fma_f32 v[192:193], v[172:173], v[172:173], v[192:193]
    v_pk_fma_f32 v[194:195], v[174:175], v[174:175], v[194:195]
    v_pk_fma_f32 v[192:193], v[176:177], v[176:177], v[192:193]
    v_pk_fma_f32 v[194:195], v[178:179], v[178:179], v[194:195]
    v_pk_fma_f32 v[192:193], v[180:181], v[180:181], v[192:193]
    v_pk_fma_f32 v[194:195], v[182:183], v[182:183], v[194:195]
    v_pk_fma_f32 v[192:193], v[184:185], v[184:185], v[192:193]
    v_pk_fma_f32 v[194:195], v[186:187], v[186:187], v[194:195]
    v_pk_fma_f32 v[192:193], v[188:189], v[188:189], v[192:193]
    v_pk_fma_f32 v[194:195], v[190:191], v[190:191], v[194:195]
    v_add_f32 v192, v192, v193
    v_add_f32 v194, v194, v195
    v_add_f32 v192, v192, v194
    s_nop 1
    v_add_f32_dpp v192, v192, v192 row_ror:8 row_mask:0xf bank_mask:0xf
    s_nop 1
    v_add_f32_dpp v192, v192, v192 row_ror:4 row_mask:0xf bank_mask:0xf
    s_nop 1
    v_add_f32_dpp v192, v192, v192 row_ror:2 row_mask:0xf bank_mask:0xf
    s_nop 1
    v_add_f32_dpp v192, v192, v192 row_ror:1 row_mask:0xf bank_mask:0xf
    v_mov_b32 v193, v192
    s_nop 1
    v_permlane16_swap_b32 v192, v193
    v_add_f32 v192, v192, v193
    v_mov_b32 v197, 0x3727c5ac
    v_fmac_f32 v197, 0x3a800000, v192
    v_rsq_f32 v197, v197
    s_lshl_b32 s34, s100, 4
    s_add_u32 s34, s34, 0x18c0000
    s_add_u32 s4, s82, s34
    s_addc_u32 s5, s83, 0
    s_mov_b32 s6, 0x20
    s_mov_b32 s7, 0x20000
    v_mul_f32 v196, v198, v197
    v_mov_b32 v199, 0
    v_sub_f32 v196, 0, v196
    v_and_b32 v200, 31, v255
    v_lshlrev_b32 v200, 5, v200
    v_lshrrev_b32 v201, 5, v255
    v_lshl_add_u32 v200, v201, 4, v200
    buffer_store_dwordx4 v[196:199], v200, s[4:7], 0 offen sc1
    s_add_u32 m0, s40, 98304
    s_nop 0
    buffer_load_dwordx4 v245, s[12:15], s52 offen offset:0 lds
    buffer_load_dwordx4 v244, s[12:15], s52 offen offset:1024 lds
    s_add_u32 m0, s40, 106496
    s_nop 0
    buffer_load_dwordx4 v245, s[12:15], s53 offen offset:0 lds
    buffer_load_dwordx4 v244, s[12:15], s53 offen offset:1024 lds
    s_mov_b32 s34, 0x12492493
    s_mov_b32 s35, 7168
    v_add_u32 v218, 0, v255
    v_mul_hi_u32 v219, v218, s34
    v_mul_u32_u24 v220, 14, v219
    v_sub_u32 v220, v218, v220
    v_lshlrev_b32 v220, 4, v220
    v_mad_u32_u24 v224, v219, s35, v220
    v_add_u32 v218, 64, v255
    v_mul_hi_u32 v219, v218, s34
    v_mul_u32_u24 v220, 14, v219
    v_sub_u32 v220, v218, v220
    v_lshlrev_b32 v220, 4, v220
    v_mad_u32_u24 v225, v219, s35, v220
    v_subrev_u32 v225, 1024, v225
    v_add_u32 v218, 128, v255
    v_mul_hi_u32 v219, v218, s34
    v_mul_u32_u24 v220, 14, v219
    v_sub_u32 v220, v218, v220
    v_lshlrev_b32 v220, 4, v220
    v_mad_u32_u24 v226, v219, s35, v220
    v_subrev_u32 v226, 2048, v226
    v_add_u32 v218, 192, v255
    v_mul_hi_u32 v219, v218, s34
    v_mul_u32_u24 v220, 14, v219
    v_sub_u32 v220, v218, v220
    v_lshlrev_b32 v220, 4, v220
    v_mad_u32_u24 v227, v219, s35, v220
    v_subrev_u32 v227, 3072, v227
    v_add_u32 v218, 256, v255
    v_mul_hi_u32 v219, v218, s34
    v_mul_u32_u24 v220, 14, v219
    v_sub_u32 v220, v218, v220
    v_lshlrev_b32 v220, 4, v220
    v_mad_u32_u24 v228, v219, s35, v220
    v_add_u32 v218, 320, v255
    v_mul_hi_u32 v219, v218, s34
    v_mul_u32_u24 v220, 14, v219
    v_sub_u32 v220, v218, v220
    v_lshlrev_b32 v220, 4, v220
    v_mad_u32_u24 v229, v219, s35, v220
    v_subrev_u32 v229, 1024, v229
    v_add_u32 v218, 384, v255
    v_mul_hi_u32 v219, v218, s34
    v_mul_u32_u24 v220, 14, v219
    v_sub_u32 v220, v218, v220
    v_lshlrev_b32 v220, 4, v220
    v_mad_u32_u24 v230, v219, s35, v220
    v_subrev_u32 v230, 2048, v230
    v_and_b32 v219, 3, v255
    v_min_u32 v219, 2, v219
    s_sub_u32 s34, s29, 2
    v_add_u32 v219, s34, v219
    v_cmp_le_i32 vcc, 0, v219
    v_max_i32 v219, 0, v219
    v_mul_u32_u24 v219, 4352, v219
    v_cndmask_b32_e64 v220, 0, 16, vcc
    s_lshl_b32 s46, s2, 2
    s_add_u32 s46, s46, s28
    s_lshl_b32 s46, s46, 11
    s_lshl_b32 s34, s2, 2
    s_add_u32 s34, s34, s28
    s_mul_i32 s34, s34, 6144
    s_add_u32 s4, s66, s34
    s_addc_u32 s5, s67, 0
    s_mov_b32 s6, 0x800
    s_mov_b32 s7, 0x20000
    v_lshlrev_b32 v231, 7, v255
L_ph1:
    s_add_u32 m0, s41, 16384
    s_nop 0
    buffer_load_dwordx4 v90, s[8:11], s85 offen offset:0 lds
    buffer_load_dwordx4 v91, s[8:11], s85 offen offset:1024 lds
    s_add_u32 m0, s41, 16384
    s_nop 0
    buffer_load_dwordx4 v92, s[8:11], s85 offen offset:2048 lds
    buffer_load_dwordx4 v93, s[8:11], s85 offen offset:3072 lds
    v_readlane_b32 s85, v88, 6
    s_waitcnt vmcnt(14)
    s_barrier
    s_waitcnt vmcnt(10)
    ds_read_b128 a[0:3], v94 offset:0
    ds_read_b128 a[4:7], v94 offset:2048
    ds_read_b64_tr_b16 v[96:97], v236 offset:16384
    ds_read_b64_tr_b16 v[98:99], v236 offset:20480
    ds_read_b64_tr_b16 v[100:101], v237 offset:16384
    ds_read_b64_tr_b16 v[102:103], v237 offset:20480
    ds_read_b64_tr_b16 v[104:105], v238 offset:16384
    ds_read_b64_tr_b16 v[106:107], v238 offset:20480
    ds_read_b64_tr_b16 v[108:109], v239 offset:16384
    ds_read_b64_tr_b16 v[110:111], v239 offset:20480
    ds_read_b64_tr_b16 v[112:113], v236 offset:17408
    ds_read_b64_tr_b16 v[114:115], v236 offset:21504
    ds_read_b64_tr_b16 v[116:117], v237 offset:17408
    ds_read_b64_tr_b16 v[118:119], v237 offset:21504
    ds_read_b64_tr_b16 v[120:121], v238 offset:17408
    ds_read_b64_tr_b16 v[122:123], v238 offset:21504
    ds_read_b64_tr_b16 v[124:125], v239 offset:17408
    ds_read_b64_tr_b16 v[126:127], v239 offset:21504
    s_waitcnt lgkmcnt(8)
    v_mfma_f32_16x16x32_bf16 v[0:3], v[96:99], a[0:3], 0
    ds_read_b128 a[8:11], v95 offset:0
    s_add_u32 m0, s41, 32768
    v_mfma_f32_16x16x32_bf16 v[4:7], v[96:99], a[4:7], 0
    ds_read_b128 a[12:15], v95 offset:2048
    buffer_load_dwordx4 v90, s[8:11], s84 offen offset:0 lds
    v_mfma_f32_16x16x32_bf16 v[148:151], v[96:99], v[212:215], 0
    ds_read_b64_tr_b16 v[96:97], v236 offset:24576
    buffer_load_dwordx4 v91, s[8:11], s84 offen offset:1024 lds
    v_mfma_f32_16x16x32_bf16 v[8:11], v[100:103], a[0:3], 0
    ds_read_b64_tr_b16 v[98:99], v236 offset:28672
    s_add_u32 m0, s41, 32768
    v_mfma_f32_16x16x32_bf16 v[12:15], v[100:103], a[4:7], 0
    ds_read_b64_tr_b16 v[100:101], v237 offset:24576
    buffer_load_dwordx4 v92, s[8:11], s84 offen offset:2048 lds
    v_mfma_f32_16x16x32_bf16 v[16:19], v[104:107], a[0:3], 0
    ds_read_b64_tr_b16 v[102:103], v237 offset:28672
    buffer_load_dwordx4 v93, s[8:11], s84 offen offset:3072 lds
    v_mfma_f32_16x16x32_bf16 v[20:23], v[104:107], a[4:7], 0
    ds_read_b64_tr_b16 v[104:105], v238 offset:24576
    v_readlane_b32 s84, v88, 8
    v_mfma_f32_16x16x32_bf16 v[24:27], v[108:111], a[0:3], 0
    ds_read_b64_tr_b16 v[106:107], v238 offset:28672
    s_add_u32 m0, s40, 0
    v_mfma_f32_16x16x32_bf16 v[28:31], v[108:111], a[4:7], 0
    ds_read_b64_tr_b16 v[108:109], v239 offset:24576
    s_waitcnt lgkmcnt(9)
    v_mfma_f32_16x16x32_bf16 v[32:35], a[0:3], v[112:115], 0
    ds_read_b64_tr_b16 v[110:111], v239 offset:28672
    buffer_load_dwordx4 v245, s[12:15], s54 offen offset:0 lds
    v_mfma_f32_16x16x32_bf16 v[36:39], a[4:7], v[112:115], 0
    buffer_load_dwordx4 v244, s[12:15], s54 offen offset:1024 lds
    s_add_u32 m0, s40, 8192
    v_mfma_f32_16x16x32_bf16 v[152:155], v[212:215], v[112:115], 0
    ds_read_b64_tr_b16 v[112:113], v236 offset:25600
    buffer_load_dwordx4 v245, s[12:15], s55 offen offset:0 lds
    v_mfma_f32_16x16x32_bf16 v[40:43], a[0:3], v[116:119], 0
    ds_read_b64_tr_b16 v[114:115], v236 offset:29696
    buffer_load_dwordx4 v244, s[12:15], s55 offen offset:1024 lds
    v_mfma_f32_16x16x32_bf16 v[44:47], a[4:7], v[116:119], 0
    ds_read_b64_tr_b16 v[116:117], v237 offset:25600
    v_mfma_f32_16x16x32_bf16 v[48:51], a[0:3], v[120:123], 0
    ds_read_b64_tr_b16 v[118:119], v237 offset:29696
    v_mfma_f32_16x16x32_bf16 v[52:55], a[4:7], v[120:123], 0
    ds_read_b64_tr_b16 v[120:121], v238 offset:25600
    v_mfma_f32_16x16x32_bf16 v[56:59], a[0:3], v[124:127], 0
    ds_read_b64_tr_b16 v[122:123], v238 offset:29696
    v_mfma_f32_16x16x32_bf16 v[60:63], a[4:7], v[124:127], 0
    ds_read_b64_tr_b16 v[124:125], v239 offset:25600
    ds_read_b64_tr_b16 v[126:127], v239 offset:29696
    s_waitcnt lgkmcnt(8)
    v_mfma_f32_16x16x32_bf16 v[0:3], v[96:99], a[8:11], v[0:3]
    s_waitcnt vmcnt(8)
    ds_read_b128 a[16:19], v94 offset:16384
    v_mfma_f32_16x16x32_bf16 v[4:7], v[96:99], a[12:15], v[4:7]
    ds_read_b128 a[20:23], v94 offset:18432
    s_add_u32 m0, s40, 16384
    v_mfma_f32_16x16x32_bf16 v[148:151], v[96:99], v[212:215], v[148:151]
    buffer_load_dwordx4 v245, s[12:15], s56 offen offset:0 lds
    buffer_load_dwordx4 v244, s[12:15], s56 offen offset:1024 lds
    s_add_u32 m0, s40, 24576
    s_nop 0
    buffer_load_dwordx4 v245, s[12:15], s57 offen offset:0 lds
    buffer_load_dwordx4 v244, s[12:15], s57 offen offset:1024 lds
    v_readlane_b32 s59, v243, 8
    s_add_u32 m0, s41, 0
    s_nop 0
    buffer_load_dwordx4 v90, s[8:11], s85 offen offset:0 lds
    buffer_load_dwordx4 v91, s[8:11], s85 offen offset:1024 lds
    s_barrier
    s_or_b32 s3, s2, s28
    s_cbranch_scc1 L_zs5
    s_mov_b64 exec, 1
    buffer_store_dword v253, v252, s[88:91], 0 offen sc1
    s_mov_b64 exec, -1
L_zs5:
    ds_read_b64_tr_b16 v[96:97], v236 offset:32768
    v_mfma_f32_16x16x32_bf16 v[8:11], v[100:103], a[8:11], v[8:11]
    ds_read_b64_tr_b16 v[98:99], v236 offset:36864
    s_lshl_b32 s34, s29, 4
    v_mfma_f32_16x16x32_bf16 v[12:15], v[100:103], a[12:15], v[12:15]
    ds_read_b64_tr_b16 v[100:101], v237 offset:32768
    s_add_u32 s49, s34, s30
    v_mfma_f32_16x16x32_bf16 v[16:19], v[104:107], a[8:11], v[16:19]
    ds_read_b64_tr_b16 v[102:103], v237 offset:36864
    s_lshl_b32 s34, s49, 2
    v_mfma_f32_16x16x32_bf16 v[20:23], v[104:107], a[12:15], v[20:23]
    ds_read_b64_tr_b16 v[104:105], v238 offset:32768
    s_add_u32 s34, s34, s28
    v_mfma_f32_16x16x32_bf16 v[24:27], v[108:111], a[8:11], v[24:27]
    ds_read_b64_tr_b16 v[106:107], v238 offset:36864
    s_lshl_b32 s34, s34, 13
    v_mfma_f32_16x16x32_bf16 v[28:31], v[108:111], a[12:15], v[28:31]
    ds_read_b64_tr_b16 v[108:109], v239 offset:32768
    s_waitcnt lgkmcnt(9)
    v_mfma_f32_16x16x32_bf16 v[32:35], a[8:11], v[112:115], v[32:35]
    ds_read_b64_tr_b16 v[110:111], v239 offset:36864
    s_add_u32 s34, s34, 0x800000
    v_mfma_f32_16x16x32_bf16 v[36:39], a[12:15], v[112:115], v[36:39]
    s_add_u32 s16, s82, s34
    s_addc_u32 s17, s83, 0
    v_mfma_f32_16x16x32_bf16 v[152:155], v[212:215], v[112:115], v[152:155]
    ds_read_b64_tr_b16 v[112:113], v236 offset:33792
    s_mov_b32 s18, 0x2000
    v_mfma_f32_16x16x32_bf16 v[40:43], a[8:11], v[116:119], v[40:43]
    ds_read_b64_tr_b16 v[114:115], v236 offset:37888
    s_mov_b32 s19, 0x20000
    v_mfma_f32_16x16x32_bf16 v[44:47], a[12:15], v[116:119], v[44:47]
    ds_read_b64_tr_b16 v[116:117], v237 offset:33792
    v_and_b32 v216, 15, v255
    v_mfma_f32_16x16x32_bf16 v[48:51], a[8:11], v[120:123], v[48:51]
    ds_read_b64_tr_b16 v[118:119], v237 offset:37888
    v_lshrrev_b32 v217, 4, v255
    v_mfma_f32_16x16x32_bf16 v[52:55], a[12:15], v[120:123], v[52:55]
    ds_read_b64_tr_b16 v[120:121], v238 offset:33792
    v_lshlrev_b32 v217, 2, v217
    v_mfma_f32_16x16x32_bf16 v[56:59], a[8:11], v[124:127], v[56:59]
    ds_read_b64_tr_b16 v[122:123], v238 offset:37888
    v_sub_u32 v216, v216, v217
    v_mfma_f32_16x16x32_bf16 v[60:63], a[12:15], v[124:127], v[60:63]
    ds_read_b64_tr_b16 v[124:125], v239 offset:33792
    ds_read_b64_tr_b16 v[126:127], v239 offset:37888
    s_waitcnt lgkmcnt(8)
    v_mfma_f32_16x16x32_bf16 v[0:3], v[96:99], a[16:19], v[0:3]
    ds_read_b128 a[24:27], v95 offset:16384
    s_add_u32 m0, s40, 32768
    v_mfma_f32_16x16x32_bf16 v[4:7], v[96:99], a[20:23], v[4:7]
    ds_read_b128 a[28:31], v95 offset:18432
    buffer_load_dwordx4 v245, s[12:15], s59 offen offset:0 lds
    v_mfma_f32_16x16x32_bf16 v[148:151], v[96:99], v[212:215], v[148:151]
    ds_read_b64_tr_b16 v[96:97], v236 offset:40960
    buffer_load_dwordx4 v244, s[12:15], s59 offen offset:1024 lds
    v_mfma_f32_16x16x32_bf16 v[8:11], v[100:103], a[16:19], v[8:11]
    ds_read_b64_tr_b16 v[98:99], v236 offset:45056
    v_readlane_b32 s45, v243, 9
    v_mfma_f32_16x16x32_bf16 v[12:15], v[100:103], a[20:23], v[12:15]
    ds_read_b64_tr_b16 v[100:101], v237 offset:40960
    s_add_u32 m0, s41, 0
    v_mfma_f32_16x16x32_bf16 v[16:19], v[104:107], a[16:19], v[16:19]
    ds_read_b64_tr_b16 v[102:103], v237 offset:45056
    buffer_load_dwordx4 v92, s[8:11], s85 offen offset:2048 lds
    v_mfma_f32_16x16x32_bf16 v[20:23], v[104:107], a[20:23], v[20:23]
    ds_read_b64_tr_b16 v[104:105], v238 offset:40960
    buffer_load_dwordx4 v93, s[8:11], s85 offen offset:3072 lds
    v_mfma_f32_16x16x32_bf16 v[24:27], v[108:111], a[16:19], v[24:27]
    ds_read_b64_tr_b16 v[106:107], v238 offset:45056
    v_readlane_b32 s85, v88, 10
    v_mfma_f32_16x16x32_bf16 v[28:31], v[108:111], a[20:23], v[28:31]
    ds_read_b64_tr_b16 v[108:109], v239 offset:40960
    s_waitcnt lgkmcnt(9)
    v_mfma_f32_16x16x32_bf16 v[32:35], a[16:19], v[112:115], v[32:35]
    ds_read_b64_tr_b16 v[110:111], v239 offset:45056
    s_lshl_b32 s34, s29, 2
    v_mfma_f32_16x16x32_bf16 v[36:39], a[20:23], v[112:115], v[36:39]
    s_add_u32 s34, s34, s28
    v_mov_b32 v217, 0xf149f2ca
    v_mfma_f32_16x16x32_bf16 v[152:155], v[212:215], v[112:115], v[152:155]
    ds_read_b64_tr_b16 v[112:113], v236 offset:41984
    s_cmp_ge_u32 s34, 8
    s_cselect_b32 s35, 0, 0xf149f2ca
    v_mfma_f32_16x16x32_bf16 v[40:43], a[16:19], v[116:119], v[40:43]
    ds_read_b64_tr_b16 v[114:115], v236 offset:46080
    v_mov_b32 v160, s35
    v_mfma_f32_16x16x32_bf16 v[44:47], a[20:23], v[116:119], v[44:47]
    ds_read_b64_tr_b16 v[116:117], v237 offset:41984
    v_cmp_le_i32 vcc, 0, v216
    v_mfma_f32_16x16x32_bf16 v[48:51], a[16:19], v[120:123], v[48:51]
    ds_read_b64_tr_b16 v[118:119], v237 offset:46080
    v_cndmask_b32 v192, v217, v252, vcc
    v_mfma_f32_16x16x32_bf16 v[52:55], a[20:23], v[120:123], v[52:55]
    ds_read_b64_tr_b16 v[120:121], v238 offset:41984
    v_cndmask_b32 v196, v160, v217, vcc
    v_mfma_f32_16x16x32_bf16 v[56:59], a[16:19], v[124:127], v[56:59]
    ds_read_b64_tr_b16 v[122:123], v238 offset:46080
    v_cmp_le_i32 vcc, 1, v216
    v_mfma_f32_16x16x32_bf16 v[60:63], a[20:23], v[124:127], v[60:63]
    ds_read_b64_tr_b16 v[124:125], v239 offset:41984
    ds_read_b64_tr_b16 v[126:127], v239 offset:46080
    s_waitcnt lgkmcnt(8)
    v_mfma_f32_16x16x32_bf16 v[0:3], v[96:99], a[24:27], v[0:3]
    s_waitcnt vmcnt(14)
    ds_read_b128 a[32:35], v94 offset:32768
    v_mfma_f32_16x16x32_bf16 v[4:7], v[96:99], a[28:31], v[4:7]
    ds_read_b128 a[36:39], v94 offset:34816
    s_add_u32 m0, s40, 40960
    v_mfma_f32_16x16x32_bf16 v[148:151], v[96:99], v[212:215], v[148:151]
    s_waitcnt vmcnt(10)
    s_barrier
    ds_read_b64_tr_b16 v[96:97], v232 offset:0
    v_mfma_f32_16x16x32_bf16 v[8:11], v[100:103], a[24:27], v[8:11]
    ds_read_b64_tr_b16 v[98:99], v232 offset:4096
    buffer_load_dwordx4 v245, s[12:15], s45 offen offset:0 lds
    v_mfma_f32_16x16x32_bf16 v[12:15], v[100:103], a[28:31], v[12:15]
    ds_read_b64_tr_b16 v[100:101], v233 offset:0
    buffer_load_dwordx4 v244, s[12:15], s45 offen offset:1024 lds
    v_mfma_f32_16x16x32_bf16 v[16:19], v[104:107], a[24:27], v[16:19]
    ds_read_b64_tr_b16 v[102:103], v233 offset:4096
    v_readlane_b32 s50, v243, 10
    v_mfma_f32_16x16x32_bf16 v[20:23], v[104:107], a[28:31], v[20:23]
    ds_read_b64_tr_b16 v[104:105], v234 offset:0
    s_add_u32 m0, s41, 16384
    v_mfma_f32_16x16x32_bf16 v[24:27], v[108:111], a[24:27], v[24:27]
    ds_read_b64_tr_b16 v[106:107], v234 offset:4096
    buffer_load_dwordx4 v90, s[8:11], s84 offen offset:0 lds
    v_mfma_f32_16x16x32_bf16 v[28:31], v[108:111], a[28:31], v[28:31]
    ds_read_b64_tr_b16 v[108:109], v235 offset:0
    s_waitcnt lgkmcnt(9)
    v_mfma_f32_16x16x32_bf16 v[32:35], a[24:27], v[112:115], v[32:35]
    ds_read_b64_tr_b16 v[110:111], v235 offset:4096
    buffer_load_dwordx4 v91, s[8:11], s84 offen offset:1024 lds
    v_mfma_f32_16x16x32_bf16 v[36:39], a[28:31], v[112:115], v[36:39]
    v_cndmask_b32 v193, v217, v252, vcc
    v_cndmask_b32 v197, v160, v217, vcc
    v_mfma_f32_16x16x32_bf16 v[152:155], v[212:215], v[112:115], v[152:155]
    ds_read_b64_tr_b16 v[112:113], v232 offset:1024
    v_cmp_le_i32 vcc, 2, v216
    v_mfma_f32_16x16x32_bf16 v[40:43], a[24:27], v[116:119], v[40:43]
    ds_read_b64_tr_b16 v[114:115], v232 offset:5120
    v_cndmask_b32 v194, v217, v252, vcc
    v_mfma_f32_16x16x32_bf16 v[44:47], a[28:31], v[116:119], v[44:47]
    ds_read_b64_tr_b16 v[116:117], v233 offset:1024
    v_cndmask_b32 v198, v160, v217, vcc
    v_mfma_f32_16x16x32_bf16 v[48:51], a[24:27], v[120:123], v[48:51]
    ds_read_b64_tr_b16 v[118:119], v233 offset:5120
    v_cmp_le_i32 vcc, 3, v216
    v_mfma_f32_16x16x32_bf16 v[52:55], a[28:31], v[120:123], v[52:55]
    ds_read_b64_tr_b16 v[120:121], v234 offset:1024
    v_cndmask_b32 v195, v217, v252, vcc
    v_mfma_f32_16x16x32_bf16 v[56:59], a[24:27], v[124:127], v[56:59]
    ds_read_b64_tr_b16 v[122:123], v234 offset:5120
    v_cndmask_b32 v199, v160, v217, vcc
    v_mfma_f32_16x16x32_bf16 v[60:63], a[28:31], v[124:127], v[60:63]
    ds_read_b64_tr_b16 v[124:125], v235 offset:1024
    ds_read_b64_tr_b16 v[126:127], v235 offset:5120
    s_waitcnt lgkmcnt(8)
    v_mfma_f32_16x16x32_bf16 v[0:3], v[96:99], a[32:35], v[0:3]
    ds_read_b128 a[40:43], v95 offset:32768
    s_add_u32 m0, s40, 49152
    v_mfma_f32_16x16x32_bf16 v[4:7], v[96:99], a[36:39], v[4:7]
    ds_read_b128 a[44:47], v95 offset:34816
    buffer_load_dwordx4 v245, s[12:15], s50 offen offset:0 lds
    v_mfma_f32_16x16x32_bf16 v[148:151], v[96:99], v[212:215], v[148:151]
    ds_read_b64_tr_b16 v[96:97], v232 offset:8192
    buffer_load_dwordx4 v244, s[12:15], s50 offen offset:1024 lds
    v_mfma_f32_16x16x32_bf16 v[8:11], v[100:103], a[32:35], v[8:11]
    ds_read_b64_tr_b16 v[98:99], v232 offset:12288
    v_readlane_b32 s51, v243, 11
    v_mfma_f32_16x16x32_bf16 v[12:15], v[100:103], a[36:39], v[12:15]
    ds_read_b64_tr_b16 v[100:101], v233 offset:8192
    s_add_u32 m0, s41, 16384
    v_mfma_f32_16x16x32_bf16 v[16:19], v[104:107], a[32:35], v[16:19]
    ds_read_b64_tr_b16 v[102:103], v233 offset:12288
    buffer_load_dwordx4 v92, s[8:11], s84 offen offset:2048 lds
    v_mfma_f32_16x16x32_bf16 v[20:23], v[104:107], a[36:39], v[20:23]
    ds_read_b64_tr_b16 v[104:105], v234 offset:8192
    buffer_load_dwordx4 v93, s[8:11], s84 offen offset:3072 lds
    v_mfma_f32_16x16x32_bf16 v[24:27], v[108:111], a[32:35], v[24:27]
    ds_read_b64_tr_b16 v[106:107], v234 offset:12288
    v_readlane_b32 s84, v88, 12
    v_mfma_f32_16x16x32_bf16 v[28:31], v[108:111], a[36:39], v[28:31]
    ds_read_b64_tr_b16 v[108:109], v235 offset:8192
    s_waitcnt lgkmcnt(9)
    v_mfma_f32_16x16x32_bf16 v[32:35], a[32:35], v[112:115], v[32:35]
    ds_read_b64_tr_b16 v[110:111], v235 offset:12288
    buffer_load_dword v223, v252, s[88:91], 0 offen sc1
    v_mfma_f32_16x16x32_bf16 v[36:39], a[36:39], v[112:115], v[36:39]
    s_lshl_b32 s39, s28, 13
    s_lshl_b32 s38, s49, 15
    v_mfma_f32_16x16x32_bf16 v[152:155], v[212:215], v[112:115], v[152:155]
    ds_read_b64_tr_b16 v[112:113], v232 offset:9216
    s_add_u32 s38, s38, s39
    v_mfma_f32_16x16x32_bf16 v[40:43], a[32:35], v[116:119], v[40:43]
    ds_read_b64_tr_b16 v[114:115], v232 offset:13312
    s_sub_u32 s36, s38, 1048576
    s_cselect_b32 s36, 0x1000000, s36
    v_mfma_f32_16x16x32_bf16 v[44:47], a[36:39], v[116:119], v[44:47]
    ds_read_b64_tr_b16 v[116:117], v233 offset:9216
    s_sub_u32 s37, s38, 524288
    s_cselect_b32 s37, 0x1000000, s37
    v_mfma_f32_16x16x32_bf16 v[48:51], a[32:35], v[120:123], v[48:51]
    ds_read_b64_tr_b16 v[118:119], v233 offset:13312
    v_and_b32 v240, 1, v255
    v_mfma_f32_16x16x32_bf16 v[52:55], a[36:39], v[120:123], v[52:55]
    ds_read_b64_tr_b16 v[120:121], v234 offset:9216
    v_lshlrev_b32 v240, 4, v240
    v_mfma_f32_16x16x32_bf16 v[56:59], a[32:35], v[124:127], v[56:59]
    ds_read_b64_tr_b16 v[122:123], v234 offset:13312
    s_sub_u32 s34, s49, 32
    v_mfma_f32_16x16x32_bf16 v[60:63], a[36:39], v[124:127], v[60:63]
    ds_read_b64_tr_b16 v[124:125], v235 offset:9216
    ds_read_b64_tr_b16 v[126:127], v235 offset:13312
    s_waitcnt lgkmcnt(8)
    v_mfma_f32_16x16x32_bf16 v[0:3], v[96:99], a[40:43], v[0:3]
    s_waitcnt vmcnt(9)
    ds_read_b128 a[48:51], v94 offset:0
    v_mfma_f32_16x16x32_bf16 v[4:7], v[96:99], a[44:47], v[4:7]
    ds_read_b128 a[52:55], v94 offset:2048
    s_add_u32 m0, s40, 57344
    v_mfma_f32_16x16x32_bf16 v[148:151], v[96:99], v[212:215], v[148:151]
    s_barrier
    ds_read_b64_tr_b16 v[96:97], v232 offset:16384
    v_mfma_f32_16x16x32_bf16 v[8:11], v[100:103], a[40:43], v[8:11]
    ds_read_b64_tr_b16 v[98:99], v232 offset:20480
    buffer_load_dwordx4 v245, s[12:15], s51 offen offset:0 lds
    v_mfma_f32_16x16x32_bf16 v[12:15], v[100:103], a[44:47], v[12:15]
    ds_read_b64_tr_b16 v[100:101], v233 offset:16384
    buffer_load_dwordx4 v244, s[12:15], s51 offen offset:1024 lds
    v_mfma_f32_16x16x32_bf16 v[16:19], v[104:107], a[40:43], v[16:19]
    ds_read_b64_tr_b16 v[102:103], v233 offset:20480
    v_readlane_b32 s52, v243, 12
    v_mfma_f32_16x16x32_bf16 v[20:23], v[104:107], a[44:47], v[20:23]
    ds_read_b64_tr_b16 v[104:105], v234 offset:16384
    s_add_u32 m0, s41, 32768
    v_mfma_f32_16x16x32_bf16 v[24:27], v[108:111], a[40:43], v[24:27]
    ds_read_b64_tr_b16 v[106:107], v234 offset:20480
    buffer_load_dwordx4 v90, s[8:11], s85 offen offset:0 lds
    v_mfma_f32_16x16x32_bf16 v[28:31], v[108:111], a[44:47], v[28:31]
    ds_read_b64_tr_b16 v[108:109], v235 offset:16384
    s_waitcnt lgkmcnt(9)
    v_mfma_f32_16x16x32_bf16 v[32:35], a[40:43], v[112:115], v[32:35]
    ds_read_b64_tr_b16 v[110:111], v235 offset:20480
    buffer_load_dwordx4 v91, s[8:11], s85 offen offset:1024 lds
    v_mfma_f32_16x16x32_bf16 v[36:39], a[44:47], v[112:115], v[36:39]
    v_add_u32 v240, s34, v240
    v_cmp_le_i32 vcc, 0, v240
    v_mfma_f32_16x16x32_bf16 v[152:155], v[212:215], v[112:115], v[152:155]
    ds_read_b64_tr_b16 v[112:113], v232 offset:17408
    v_max_i32 v240, 0, v240
    v_mfma_f32_16x16x32_bf16 v[40:43], a[40:43], v[116:119], v[40:43]
    ds_read_b64_tr_b16 v[114:115], v232 offset:21504
    v_add_u32 v240, 128, v240
    v_mfma_f32_16x16x32_bf16 v[44:47], a[44:47], v[116:119], v[44:47]
    ds_read_b64_tr_b16 v[116:117], v233 offset:17408
    v_cndmask_b32_e64 v242, 0, 1, vcc
    v_mfma_f32_16x16x32_bf16 v[48:51], a[40:43], v[120:123], v[48:51]
    ds_read_b64_tr_b16 v[118:119], v233 offset:21504
    v_mul_u32_u24 v240, 4352, v240
    v_mfma_f32_16x16x32_bf16 v[52:55], a[44:47], v[120:123], v[52:55]
    ds_read_b64_tr_b16 v[120:121], v234 offset:17408
    s_add_u32 s24, s82, 0x800000
    s_addc_u32 s25, s83, 0
    v_mfma_f32_16x16x32_bf16 v[56:59], a[40:43], v[124:127], v[56:59]
    ds_read_b64_tr_b16 v[122:123], v234 offset:21504
    s_mov_b32 s26, 0x800000
    v_mfma_f32_16x16x32_bf16 v[60:63], a[44:47], v[124:127], v[60:63]
    ds_read_b64_tr_b16 v[124:125], v235 offset:17408
    ds_read_b64_tr_b16 v[126:127], v235 offset:21504
    s_waitcnt lgkmcnt(8)
    v_mfma_f32_16x16x32_bf16 v[0:3], v[96:99], a[48:51], v[0:3]
    ds_read_b128 a[56:59], v95 offset:0
    s_add_u32 m0, s40, 65536
    v_mfma_f32_16x16x32_bf16 v[4:7], v[96:99], a[52:55], v[4:7]
    ds_read_b128 a[60:63], v95 offset:2048
    buffer_load_dwordx4 v245, s[12:15], s52 offen offset:0 lds
    v_mfma_f32_16x16x32_bf16 v[148:151], v[96:99], v[212:215], v[148:151]
    ds_read_b64_tr_b16 v[96:97], v232 offset:24576
    buffer_load_dwordx4 v244, s[12:15], s52 offen offset:1024 lds
    v_mfma_f32_16x16x32_bf16 v[8:11], v[100:103], a[48:51], v[8:11]
    ds_read_b64_tr_b16 v[98:99], v232 offset:28672
    v_readlane_b32 s53, v243, 13
    v_mfma_f32_16x16x32_bf16 v[12:15], v[100:103], a[52:55], v[12:15]
    ds_read_b64_tr_b16 v[100:101], v233 offset:24576
    s_add_u32 m0, s41, 32768
    v_mfma_f32_16x16x32_bf16 v[16:19], v[104:107], a[48:51], v[16:19]
    ds_read_b64_tr_b16 v[102:103], v233 offset:28672
    buffer_load_dwordx4 v92, s[8:11], s85 offen offset:2048 lds
    v_mfma_f32_16x16x32_bf16 v[20:23], v[104:107], a[52:55], v[20:23]
    ds_read_b64_tr_b16 v[104:105], v234 offset:24576
    buffer_load_dwordx4 v93, s[8:11], s85 offen offset:3072 lds
    v_mfma_f32_16x16x32_bf16 v[24:27], v[108:111], a[48:51], v[24:27]
    ds_read_b64_tr_b16 v[106:107], v234 offset:28672
    v_readlane_b32 s85, v88, 14
    v_mfma_f32_16x16x32_bf16 v[28:31], v[108:111], a[52:55], v[28:31]
    ds_read_b64_tr_b16 v[108:109], v235 offset:24576
    s_waitcnt lgkmcnt(9)
    v_mfma_f32_16x16x32_bf16 v[32:35], a[48:51], v[112:115], v[32:35]
    ds_read_b64_tr_b16 v[110:111], v235 offset:28672
    s_mov_b32 s27, 0x20000
    v_mfma_f32_16x16x32_bf16 v[36:39], a[52:55], v[112:115], v[36:39]
    s_bitcmp1_b32 s28, 0
    s_cselect_b64 s[96:97], -1, 0
    v_mfma_f32_16x16x32_bf16 v[152:155], v[212:215], v[112:115], v[152:155]
    ds_read_b64_tr_b16 v[112:113], v232 offset:25600
    s_bitcmp1_b32 s28, 1
    s_cselect_b64 s[98:99], -1, 0
    v_mfma_f32_16x16x32_bf16 v[40:43], a[48:51], v[116:119], v[40:43]
    ds_read_b64_tr_b16 v[114:115], v232 offset:29696
    s_lshl_b32 s34, s29, 2
    v_mfma_f32_16x16x32_bf16 v[44:47], a[52:55], v[116:119], v[44:47]
    ds_read_b64_tr_b16 v[116:117], v233 offset:25600
    s_add_u32 s34, s34, s28
    v_mfma_f32_16x16x32_bf16 v[48:51], a[48:51], v[120:123], v[48:51]
    ds_read_b64_tr_b16 v[118:119], v233 offset:29696
    s_lshl_b32 s34, s34, 9
    v_mfma_f32_16x16x32_bf16 v[52:55], a[52:55], v[120:123], v[52:55]
    ds_read_b64_tr_b16 v[120:121], v234 offset:25600
    s_add_u32 s34, s34, 0x18c0000
    v_mfma_f32_16x16x32_bf16 v[56:59], a[48:51], v[124:127], v[56:59]
    ds_read_b64_tr_b16 v[122:123], v234 offset:29696
    s_add_u32 s92, s82, s34
    s_addc_u32 s93, s83, 0
    v_mfma_f32_16x16x32_bf16 v[60:63], a[52:55], v[124:127], v[60:63]
    ds_read_b64_tr_b16 v[124:125], v235 offset:25600
    ds_read_b64_tr_b16 v[126:127], v235 offset:29696
    s_waitcnt lgkmcnt(8)
    v_mfma_f32_16x16x32_bf16 v[0:3], v[96:99], a[56:59], v[0:3]
    s_waitcnt vmcnt(9)
    ds_read_b128 a[64:67], v94 offset:16384
    v_mfma_f32_16x16x32_bf16 v[4:7], v[96:99], a[60:63], v[4:7]
    ds_read_b128 a[68:71], v94 offset:18432
    s_add_u32 m0, s40, 73728
    v_mfma_f32_16x16x32_bf16 v[148:151], v[96:99], v[212:215], v[148:151]
    buffer_load_dwordx4 v245, s[12:15], s53 offen offset:0 lds
    buffer_load_dwordx4 v244, s[12:15], s53 offen offset:1024 lds
    v_readlane_b32 s54, v243, 14
    s_add_u32 m0, s41, 0
    s_nop 0
    buffer_load_dwordx4 v90, s[8:11], s84 offen offset:0 lds
    buffer_load_dwordx4 v91, s[8:11], s84 offen offset:1024 lds
    s_waitcnt vmcnt(12)
    v_cmp_gt_u32 vcc, 1, v223
    s_cbranch_vccz L_zc6
    s_cmp_lg_u32 s28, 0
    s_cbranch_scc1 L_poll7_x
    s_mov_b64 exec, 1
    s_mov_b32 s3, 0x40000
L_poll7:
    buffer_load_dword v223, v252, s[88:91], 0 offen sc1
    s_sub_u32 s3, s3, 1
    s_cbranch_scc1 L_poll7_y
    s_waitcnt vmcnt(0)
    v_cmp_gt_u32 vcc, 1, v223
    s_cbranch_vccz L_poll7_y
    s_sleep 2
    s_branch L_poll7
L_poll7_y:
    s_waitcnt vmcnt(0)
    s_mov_b64 exec, -1
L_poll7_x:
L_zc6:
    s_barrier
    s_mul_i32 s3, s29, 4352
    s_cmp_ge_u32 s28, 1
    s_cbranch_scc1 L_sig8
    s_mov_b64 exec, 1
    buffer_atomic_add v253, v252, s[20:23], s3 offen sc1
    s_mov_b64 exec, -1
L_sig8:
    ds_read_b64_tr_b16 v[96:97], v232 offset:32768
    v_mfma_f32_16x16x32_bf16 v[8:11], v[100:103], a[56:59], v[8:11]
    ds_read_b64_tr_b16 v[98:99], v232 offset:36864
    s_mov_b32 s94, 0x200
    v_mfma_f32_16x16x32_bf16 v[12:15], v[100:103], a[60:63], v[12:15]
    ds_read_b64_tr_b16 v[100:101], v233 offset:32768
    s_mov_b32 s95, 0x20000
    v_mfma_f32_16x16x32_bf16 v[16:19], v[104:107], a[56:59], v[16:19]
    ds_read_b64_tr_b16 v[102:103], v233 offset:36864
    v_mfma_f32_16x16x32_bf16 v[20:23], v[104:107], a[60:63], v[20:23]
    ds_read_b64_tr_b16 v[104:105], v234 offset:32768
    v_mfma_f32_16x16x32_bf16 v[24:27], v[108:111], a[56:59], v[24:27]
    ds_read_b64_tr_b16 v[106:107], v234 offset:36864
    v_mfma_f32_16x16x32_bf16 v[28:31], v[108:111], a[60:63], v[28:31]
    ds_read_b64_tr_b16 v[108:109], v235 offset:32768
    s_waitcnt lgkmcnt(9)
    v_mfma_f32_16x16x32_bf16 v[32:35], a[56:59], v[112:115], v[32:35]
    ds_read_b64_tr_b16 v[110:111], v235 offset:36864
    v_mfma_f32_16x16x32_bf16 v[36:39], a[60:63], v[112:115], v[36:39]
    v_mfma_f32_16x16x32_bf16 v[152:155], v[212:215], v[112:115], v[152:155]
    ds_read_b64_tr_b16 v[112:113], v232 offset:33792
    v_mfma_f32_16x16x32_bf16 v[40:43], a[56:59], v[116:119], v[40:43]
    ds_read_b64_tr_b16 v[114:115], v232 offset:37888
    v_mfma_f32_16x16x32_bf16 v[44:47], a[60:63], v[116:119], v[44:47]
    ds_read_b64_tr_b16 v[116:117], v233 offset:33792
    v_mfma_f32_16x16x32_bf16 v[48:51], a[56:59], v[120:123], v[48:51]
    ds_read_b64_tr_b16 v[118:119], v233 offset:37888
    v_mfma_f32_16x16x32_bf16 v[52:55], a[60:63], v[120:123], v[52:55]
    ds_read_b64_tr_b16 v[120:121], v234 offset:33792
    v_mfma_f32_16x16x32_bf16 v[56:59], a[56:59], v[124:127], v[56:59]
    ds_read_b64_tr_b16 v[122:123], v234 offset:37888
    v_mfma_f32_16x16x32_bf16 v[60:63], a[60:63], v[124:127], v[60:63]
    ds_read_b64_tr_b16 v[124:125], v235 offset:33792
    ds_read_b64_tr_b16 v[126:127], v235 offset:37888
    s_waitcnt lgkmcnt(8)
    v_mfma_f32_16x16x32_bf16 v[0:3], v[96:99], a[64:67], v[0:3]
    ds_read_b128 a[72:75], v95 offset:16384
    s_add_u32 m0, s40, 81920
    v_mfma_f32_16x16x32_bf16 v[4:7], v[96:99], a[68:71], v[4:7]
    ds_read_b128 a[76:79], v95 offset:18432
    buffer_load_dwordx4 v245, s[12:15], s54 offen offset:0 lds
    v_mfma_f32_16x16x32_bf16 v[148:151], v[96:99], v[212:215], v[148:151]
    ds_read_b64_tr_b16 v[96:97], v232 offset:40960
    buffer_load_dwordx4 v244, s[12:15], s54 offen offset:1024 lds
    v_mfma_f32_16x16x32_bf16 v[8:11], v[100:103], a[64:67], v[8:11]
    ds_read_b64_tr_b16 v[98:99], v232 offset:45056
    v_readlane_b32 s55, v243, 15
    v_mfma_f32_16x16x32_bf16 v[12:15], v[100:103], a[68:71], v[12:15]
    ds_read_b64_tr_b16 v[100:101], v233 offset:40960
    s_add_u32 m0, s41, 0
    v_mfma_f32_16x16x32_bf16 v[16:19], v[104:107], a[64:67], v[16:19]
    ds_read_b64_tr_b16 v[102:103], v233 offset:45056
    buffer_load_dwordx4 v92, s[8:11], s84 offen offset:2048 lds
    v_mfma_f32_16x16x32_bf16 v[20:23], v[104:107], a[68:71], v[20:23]
    ds_read_b64_tr_b16 v[104:105], v234 offset:40960
    buffer_load_dwordx4 v93, s[8:11], s84 offen offset:3072 lds
    v_mfma_f32_16x16x32_bf16 v[24:27], v[108:111], a[64:67], v[24:27]
    ds_read_b64_tr_b16 v[106:107], v234 offset:45056
    v_readlane_b32 s84, v88, 16
    v_mfma_f32_16x16x32_bf16 v[28:31], v[108:111], a[68:71], v[28:31]
    ds_read_b64_tr_b16 v[108:109], v235 offset:40960
    s_waitcnt lgkmcnt(9)
    v_mfma_f32_16x16x32_bf16 v[32:35], a[64:67], v[112:115], v[32:35]
    ds_read_b64_tr_b16 v[110:111], v235 offset:45056
    v_mfma_f32_16x16x32_bf16 v[36:39], a[68:71], v[112:115], v[36:39]
    v_mfma_f32_16x16x32_bf16 v[152:155], v[212:215], v[112:115], v[152:155]
    ds_read_b64_tr_b16 v[112:113], v232 offset:41984
    v_mfma_f32_16x16x32_bf16 v[40:43], a[64:67], v[116:119], v[40:43]
    ds_read_b64_tr_b16 v[114:115], v232 offset:46080
    v_mfma_f32_16x16x32_bf16 v[44:47], a[68:71], v[116:119], v[44:47]
    ds_read_b64_tr_b16 v[116:117], v233 offset:41984
    v_mfma_f32_16x16x32_bf16 v[48:51], a[64:67], v[120:123], v[48:51]
    ds_read_b64_tr_b16 v[118:119], v233 offset:46080
    v_mfma_f32_16x16x32_bf16 v[52:55], a[68:71], v[120:123], v[52:55]
    ds_read_b64_tr_b16 v[120:121], v234 offset:41984
    v_mfma_f32_16x16x32_bf16 v[56:59], a[64:67], v[124:127], v[56:59]
    ds_read_b64_tr_b16 v[122:123], v234 offset:46080
    v_mfma_f32_16x16x32_bf16 v[60:63], a[68:71], v[124:127], v[60:63]
    ds_read_b64_tr_b16 v[124:125], v235 offset:41984
    ds_read_b64_tr_b16 v[126:127], v235 offset:46080
    s_waitcnt lgkmcnt(8)
    v_mfma_f32_16x16x32_bf16 v[0:3], v[96:99], a[72:75], v[0:3]
    s_waitcnt vmcnt(8)
    ds_read_b128 a[80:83], v94 offset:32768
    v_mfma_f32_16x16x32_bf16 v[4:7], v[96:99], a[76:79], v[4:7]
    ds_read_b128 a[84:87], v94 offset:34816
    s_add_u32 m0, s40, 90112
    v_mfma_f32_16x16x32_bf16 v[148:151], v[96:99], v[212:215], v[148:151]
    s_barrier
    ds_read_b64_tr_b16 v[96:97], v232 offset:49152
    v_mfma_f32_16x16x32_bf16 v[8:11], v[100:103], a[72:75], v[8:11]
    ds_read_b64_tr_b16 v[98:99], v232 offset:53248
    buffer_load_dwordx4 v245, s[12:15], s55 offen offset:0 lds
    v_mfma_f32_16x16x32_bf16 v[12:15], v[100:103], a[76:79], v[12:15]
    ds_read_b64_tr_b16 v[100:101], v233 offset:49152
    buffer_load_dwordx4 v244, s[12:15], s55 offen offset:1024 lds
    v_mfma_f32_16x16x32_bf16 v[16:19], v[104:107], a[72:75], v[16:19]
    ds_read_b64_tr_b16 v[102:103], v233 offset:53248
    v_readlane_b32 s56, v243, 16
    v_mfma_f32_16x16x32_bf16 v[20:23], v[104:107], a[76:79], v[20:23]
    ds_read_b64_tr_b16 v[104:105], v234 offset:49152
    s_add_u32 m0, s41, 16384
    v_mfma_f32_16x16x32_bf16 v[24:27], v[108:111], a[72:75], v[24:27]
    ds_read_b64_tr_b16 v[106:107], v234 offset:53248
    buffer_load_dwordx4 v90, s[8:11], s85 offen offset:0 lds
    v_mfma_f32_16x16x32_bf16 v[28:31], v[108:111], a[76:79], v[28:31]
    ds_read_b64_tr_b16 v[108:109], v235 offset:49152
    s_waitcnt lgkmcnt(9)
    v_mfma_f32_16x16x32_bf16 v[32:35], a[72:75], v[112:115], v[32:35]
    ds_read_b64_tr_b16 v[110:111], v235 offset:53248
    buffer_load_dwordx4 v91, s[8:11], s85 offen offset:1024 lds
    v_mfma_f32_16x16x32_bf16 v[36:39], a[76:79], v[112:115], v[36:39]
    v_mfma_f32_16x16x32_bf16 v[152:155], v[212:215], v[112:115], v[152:155]
    ds_read_b64_tr_b16 v[112:113], v232 offset:50176
    v_mfma_f32_16x16x32_bf16 v[40:43], a[72:75], v[116:119], v[40:43]
    ds_read_b64_tr_b16 v[114:115], v232 offset:54272
    v_mfma_f32_16x16x32_bf16 v[44:47], a[76:79], v[116:119], v[44:47]
    ds_read_b64_tr_b16 v[116:117], v233 offset:50176
    v_mfma_f32_16x16x32_bf16 v[48:51], a[72:75], v[120:123], v[48:51]
    ds_read_b64_tr_b16 v[118:119], v233 offset:54272
    v_mfma_f32_16x16x32_bf16 v[52:55], a[76:79], v[120:123], v[52:55]
    ds_read_b64_tr_b16 v[120:121], v234 offset:50176
    v_mfma_f32_16x16x32_bf16 v[56:59], a[72:75], v[124:127], v[56:59]
    ds_read_b64_tr_b16 v[122:123], v234 offset:54272
    v_mfma_f32_16x16x32_bf16 v[60:63], a[76:79], v[124:127], v[60:63]
    ds_read_b64_tr_b16 v[124:125], v235 offset:50176
    ds_read_b64_tr_b16 v[126:127], v235 offset:54272
    s_waitcnt lgkmcnt(8)
    v_mfma_f32_16x16x32_bf16 v[0:3], v[96:99], a[80:83], v[0:3]
    ds_read_b128 a[88:91], v95 offset:32768
    s_add_u32 m0, s40, 98304
    v_mfma_f32_16x16x32_bf16 v[4:7], v[96:99], a[84:87], v[4:7]
    ds_read_b128 a[92:95], v95 offset:34816
    buffer_load_dwordx4 v245, s[12:15], s56 offen offset:0 lds
    v_mfma_f32_16x16x32_bf16 v[148:151], v[96:99], v[212:215], v[148:151]
    ds_read_b64_tr_b16 v[96:97], v232 offset:57344
    buffer_load_dwordx4 v244, s[12:15], s56 offen offset:1024 lds
    v_mfma_f32_16x16x32_bf16 v[8:11], v[100:103], a[80:83], v[8:11]
    ds_read_b64_tr_b16 v[98:99], v232 offset:61440
    v_readlane_b32 s57, v243, 17
    v_mfma_f32_16x16x32_bf16 v[12:15], v[100:103], a[84:87], v[12:15]
    ds_read_b64_tr_b16 v[100:101], v233 offset:57344
    s_add_u32 m0, s41, 16384
    v_mfma_f32_16x16x32_bf16 v[16:19], v[104:107], a[80:83], v[16:19]
    ds_read_b64_tr_b16 v[102:103], v233 offset:61440
    buffer_load_dwordx4 v92, s[8:11], s85 offen offset:2048 lds
    v_mfma_f32_16x16x32_bf16 v[20:23], v[104:107], a[84:87], v[20:23]
    ds_read_b64_tr_b16 v[104:105], v234 offset:57344
    buffer_load_dwordx4 v93, s[8:11], s85 offen offset:3072 lds
    v_mfma_f32_16x16x32_bf16 v[24:27], v[108:111], a[80:83], v[24:27]
    ds_read_b64_tr_b16 v[106:107], v234 offset:61440
    v_readlane_b32 s85, v88, 18
    v_mfma_f32_16x16x32_bf16 v[28:31], v[108:111], a[84:87], v[28:31]
    ds_read_b64_tr_b16 v[108:109], v235 offset:57344
    s_waitcnt lgkmcnt(9)
    v_mfma_f32_16x16x32_bf16 v[32:35], a[80:83], v[112:115], v[32:35]
    ds_read_b64_tr_b16 v[110:111], v235 offset:61440
    v_mfma_f32_16x16x32_bf16 v[36:39], a[84:87], v[112:115], v[36:39]
    v_mfma_f32_16x16x32_bf16 v[152:155], v[212:215], v[112:115], v[152:155]
    ds_read_b64_tr_b16 v[112:113], v232 offset:58368
    v_mfma_f32_16x16x32_bf16 v[40:43], a[80:83], v[116:119], v[40:43]
    ds_read_b64_tr_b16 v[114:115], v232 offset:62464
    v_mfma_f32_16x16x32_bf16 v[44:47], a[84:87], v[116:119], v[44:47]
    ds_read_b64_tr_b16 v[116:117], v233 offset:58368
    v_mfma_f32_16x16x32_bf16 v[48:51], a[80:83], v[120:123], v[48:51]
    ds_read_b64_tr_b16 v[118:119], v233 offset:62464
    v_mfma_f32_16x16x32_bf16 v[52:55], a[84:87], v[120:123], v[52:55]
    ds_read_b64_tr_b16 v[120:121], v234 offset:58368
    v_mfma_f32_16x16x32_bf16 v[56:59], a[80:83], v[124:127], v[56:59]
    ds_read_b64_tr_b16 v[122:123], v234 offset:62464
    v_mfma_f32_16x16x32_bf16 v[60:63], a[84:87], v[124:127], v[60:63]
    ds_read_b64_tr_b16 v[124:125], v235 offset:58368
    ds_read_b64_tr_b16 v[126:127], v235 offset:62464
    s_waitcnt lgkmcnt(8)
    v_mfma_f32_16x16x32_bf16 v[0:3], v[96:99], a[88:91], v[0:3]
    s_waitcnt vmcnt(8)
    ds_read_b128 a[96:99], v94 offset:0
    v_mfma_f32_16x16x32_bf16 v[4:7], v[96:99], a[92:95], v[4:7]
    ds_read_b128 a[100:103], v94 offset:2048
    s_add_u32 m0, s40, 106496
    v_mfma_f32_16x16x32_bf16 v[148:151], v[96:99], v[212:215], v[148:151]
    s_barrier
    ds_read_b64_tr_b16 v[96:97], v236 offset:0
    v_mfma_f32_16x16x32_bf16 v[8:11], v[100:103], a[88:91], v[8:11]
    ds_read_b64_tr_b16 v[98:99], v236 offset:4096
    buffer_load_dwordx4 v245, s[12:15], s57 offen offset:0 lds
    v_mfma_f32_16x16x32_bf16 v[12:15], v[100:103], a[92:95], v[12:15]
    ds_read_b64_tr_b16 v[100:101], v237 offset:0
    buffer_load_dwordx4 v244, s[12:15], s57 offen offset:1024 lds
    v_mfma_f32_16x16x32_bf16 v[16:19], v[104:107], a[88:91], v[16:19]
    ds_read_b64_tr_b16 v[102:103], v237 offset:4096
    v_readlane_b32 s59, v243, 18
    v_mfma_f32_16x16x32_bf16 v[20:23], v[104:107], a[92:95], v[20:23]
    ds_read_b64_tr_b16 v[104:105], v238 offset:0
    s_add_u32 m0, s41, 32768
    v_mfma_f32_16x16x32_bf16 v[24:27], v[108:111], a[88:91], v[24:27]
    ds_read_b64_tr_b16 v[106:107], v238 offset:4096
    buffer_load_dwordx4 v90, s[8:11], s84 offen offset:0 lds
    v_mfma_f32_16x16x32_bf16 v[28:31], v[108:111], a[92:95], v[28:31]
    ds_read_b64_tr_b16 v[108:109], v239 offset:0
    s_waitcnt lgkmcnt(9)
    v_mfma_f32_16x16x32_bf16 v[32:35], a[88:91], v[112:115], v[32:35]
    ds_read_b64_tr_b16 v[110:111], v239 offset:4096
    buffer_load_dwordx4 v91, s[8:11], s84 offen offset:1024 lds
    v_mfma_f32_16x16x32_bf16 v[36:39], a[92:95], v[112:115], v[36:39]
    v_mfma_f32_16x16x32_bf16 v[152:155], v[212:215], v[112:115], v[152:155]
    ds_read_b64_tr_b16 v[112:113], v236 offset:1024
    v_mfma_f32_16x16x32_bf16 v[40:43], a[88:91], v[116:119], v[40:43]
    ds_read_b64_tr_b16 v[114:115], v236 offset:5120
    v_mfma_f32_16x16x32_bf16 v[44:47], a[92:95], v[116:119], v[44:47]
    ds_read_b64_tr_b16 v[116:117], v237 offset:1024
    v_mfma_f32_16x16x32_bf16 v[48:51], a[88:91], v[120:123], v[48:51]
    ds_read_b64_tr_b16 v[118:119], v237 offset:5120
    v_mfma_f32_16x16x32_bf16 v[52:55], a[92:95], v[120:123], v[52:55]
    ds_read_b64_tr_b16 v[120:121], v238 offset:1024
    v_mfma_f32_16x16x32_bf16 v[56:59], a[88:91], v[124:127], v[56:59]
    ds_read_b64_tr_b16 v[122:123], v238 offset:5120
    v_mfma_f32_16x16x32_bf16 v[60:63], a[92:95], v[124:127], v[60:63]
    ds_read_b64_tr_b16 v[124:125], v239 offset:1024
    ds_read_b64_tr_b16 v[126:127], v239 offset:5120
    s_add_u32 m0, s40, 0
    s_nop 0
    buffer_load_dwordx4 v245, s[12:15], s59 offen offset:0 lds
    buffer_load_dwordx4 v244, s[12:15], s59 offen offset:1024 lds
    v_readlane_b32 s45, v243, 19
    s_add_u32 m0, s41, 32768
    s_nop 0
    buffer_load_dwordx4 v92, s[8:11], s84 offen offset:2048 lds
    buffer_load_dwordx4 v93, s[8:11], s84 offen offset:3072 lds
    v_readlane_b32 s84, v88, 20
    s_waitcnt lgkmcnt(8)
    v_mfma_f32_16x16x32_bf16 v[0:3], v[96:99], a[96:99], v[0:3]
    ds_read_b128 a[104:107], v95 offset:0
    buffer_load_dword v218, v219, s[20:23], 0 offen sc1
    v_mfma_f32_16x16x32_bf16 v[4:7], v[96:99], a[100:103], v[4:7]
    ds_read_b128 a[108:111], v95 offset:2048
    v_mfma_f32_16x16x32_bf16 v[148:151], v[96:99], v[212:215], v[148:151]
    ds_read_b64_tr_b16 v[96:97], v236 offset:8192
    v_mfma_f32_16x16x32_bf16 v[8:11], v[100:103], a[96:99], v[8:11]
    ds_read_b64_tr_b16 v[98:99], v236 offset:12288
    v_mfma_f32_16x16x32_bf16 v[12:15], v[100:103], a[100:103], v[12:15]
    ds_read_b64_tr_b16 v[100:101], v237 offset:8192
    v_mfma_f32_16x16x32_bf16 v[16:19], v[104:107], a[96:99], v[16:19]
    ds_read_b64_tr_b16 v[102:103], v237 offset:12288
    v_mfma_f32_16x16x32_bf16 v[20:23], v[104:107], a[100:103], v[20:23]
    ds_read_b64_tr_b16 v[104:105], v238 offset:8192
    v_mfma_f32_16x16x32_bf16 v[24:27], v[108:111], a[96:99], v[24:27]
    ds_read_b64_tr_b16 v[106:107], v238 offset:12288
    v_mfma_f32_16x16x32_bf16 v[28:31], v[108:111], a[100:103], v[28:31]
    ds_read_b64_tr_b16 v[108:109], v239 offset:8192
    s_waitcnt lgkmcnt(9)
    v_mfma_f32_16x16x32_bf16 v[32:35], a[96:99], v[112:115], v[32:35]
    ds_read_b64_tr_b16 v[110:111], v239 offset:12288
    v_mfma_f32_16x16x32_bf16 v[36:39], a[100:103], v[112:115], v[36:39]
    v_mfma_f32_16x16x32_bf16 v[152:155], v[212:215], v[112:115], v[152:155]
    ds_read_b64_tr_b16 v[112:113], v236 offset:9216
    v_mfma_f32_16x16x32_bf16 v[40:43], a[96:99], v[116:119], v[40:43]
    ds_read_b64_tr_b16 v[114:115], v236 offset:13312
    v_mfma_f32_16x16x32_bf16 v[44:47], a[100:103], v[116:119], v[44:47]
    ds_read_b64_tr_b16 v[116:117], v237 offset:9216
    v_mfma_f32_16x16x32_bf16 v[48:51], a[96:99], v[120:123], v[48:51]
    ds_read_b64_tr_b16 v[118:119], v237 offset:13312
    v_mfma_f32_16x16x32_bf16 v[52:55], a[100:103], v[120:123], v[52:55]
    ds_read_b64_tr_b16 v[120:121], v238 offset:9216
    v_mfma_f32_16x16x32_bf16 v[56:59], a[96:99], v[124:127], v[56:59]
    ds_read_b64_tr_b16 v[122:123], v238 offset:13312
    v_mfma_f32_16x16x32_bf16 v[60:63], a[100:103], v[124:127], v[60:63]
    ds_read_b64_tr_b16 v[124:125], v239 offset:9216
    ds_read_b64_tr_b16 v[126:127], v239 offset:13312
    s_waitcnt lgkmcnt(8)
    v_mfma_f32_16x16x32_bf16 v[0:3], v[96:99], a[104:107], v[0:3]
    s_waitcnt vmcnt(9)
    ds_read_b128 a[112:115], v94 offset:16384
    v_mfma_f32_16x16x32_bf16 v[4:7], v[96:99], a[108:111], v[4:7]
    ds_read_b128 a[116:119], v94 offset:18432
    s_add_u32 m0, s40, 8192
    v_mfma_f32_16x16x32_bf16 v[148:151], v[96:99], v[212:215], v[148:151]
    s_barrier
    ds_read_b64_tr_b16 v[96:97], v236 offset:16384
    v_mfma_f32_16x16x32_bf16 v[8:11], v[100:103], a[104:107], v[8:11]
    ds_read_b64_tr_b16 v[98:99], v236 offset:20480
    buffer_load_dwordx4 v245, s[12:15], s45 offen offset:0 lds
    v_mfma_f32_16x16x32_bf16 v[12:15], v[100:103], a[108:111], v[12:15]
    ds_read_b64_tr_b16 v[100:101], v237 offset:16384
    buffer_load_dwordx4 v244, s[12:15], s45 offen offset:1024 lds
    v_mfma_f32_16x16x32_bf16 v[16:19], v[104:107], a[104:107], v[16:19]
    ds_read_b64_tr_b16 v[102:103], v237 offset:20480
    v_readlane_b32 s50, v243, 20
    v_mfma_f32_16x16x32_bf16 v[20:23], v[104:107], a[108:111], v[20:23]
    ds_read_b64_tr_b16 v[104:105], v238 offset:16384
    s_add_u32 m0, s41, 0
    v_mfma_f32_16x16x32_bf16 v[24:27], v[108:111], a[104:107], v[24:27]
    ds_read_b64_tr_b16 v[106:107], v238 offset:20480
    buffer_load_dwordx4 v90, s[8:11], s85 offen offset:0 lds
    v_mfma_f32_16x16x32_bf16 v[28:31], v[108:111], a[108:111], v[28:31]
    ds_read_b64_tr_b16 v[108:109], v239 offset:16384
    s_waitcnt lgkmcnt(9)
    v_mfma_f32_16x16x32_bf16 v[32:35], a[104:107], v[112:115], v[32:35]
    ds_read_b64_tr_b16 v[110:111], v239 offset:20480
    buffer_load_dwordx4 v91, s[8:11], s85 offen offset:1024 lds
    v_mfma_f32_16x16x32_bf16 v[36:39], a[108:111], v[112:115], v[36:39]
    v_mfma_f32_16x16x32_bf16 v[152:155], v[212:215], v[112:115], v[152:155]
    ds_read_b64_tr_b16 v[112:113], v236 offset:17408
    v_mfma_f32_16x16x32_bf16 v[40:43], a[104:107], v[116:119], v[40:43]
    ds_read_b64_tr_b16 v[114:115], v236 offset:21504
    v_mfma_f32_16x16x32_bf16 v[44:47], a[108:111], v[116:119], v[44:47]
    ds_read_b64_tr_b16 v[116:117], v237 offset:17408
    v_mfma_f32_16x16x32_bf16 v[48:51], a[104:107], v[120:123], v[48:51]
    ds_read_b64_tr_b16 v[118:119], v237 offset:21504
    v_mfma_f32_16x16x32_bf16 v[52:55], a[108:111], v[120:123], v[52:55]
    ds_read_b64_tr_b16 v[120:121], v238 offset:17408
    v_mfma_f32_16x16x32_bf16 v[56:59], a[104:107], v[124:127], v[56:59]
    ds_read_b64_tr_b16 v[122:123], v238 offset:21504
    v_mfma_f32_16x16x32_bf16 v[60:63], a[108:111], v[124:127], v[60:63]
    ds_read_b64_tr_b16 v[124:125], v239 offset:17408
    ds_read_b64_tr_b16 v[126:127], v239 offset:21504
    s_waitcnt lgkmcnt(8)
    v_mfma_f32_16x16x32_bf16 v[0:3], v[96:99], a[112:115], v[0:3]
    ds_read_b128 a[120:123], v95 offset:16384
    s_add_u32 m0, s40, 16384
    v_mfma_f32_16x16x32_bf16 v[4:7], v[96:99], a[116:119], v[4:7]
    ds_read_b128 a[124:127], v95 offset:18432
    buffer_load_dwordx4 v245, s[12:15], s50 offen offset:0 lds
    v_mfma_f32_16x16x32_bf16 v[148:151], v[96:99], v[212:215], v[148:151]
    ds_read_b64_tr_b16 v[96:97], v236 offset:24576
    buffer_load_dwordx4 v244, s[12:15], s50 offen offset:1024 lds
    v_mfma_f32_16x16x32_bf16 v[8:11], v[100:103], a[112:115], v[8:11]
    ds_read_b64_tr_b16 v[98:99], v236 offset:28672
    v_readlane_b32 s51, v243, 21
    v_mfma_f32_16x16x32_bf16 v[12:15], v[100:103], a[116:119], v[12:15]
    ds_read_b64_tr_b16 v[100:101], v237 offset:24576
    s_add_u32 m0, s41, 0
    v_mfma_f32_16x16x32_bf16 v[16:19], v[104:107], a[112:115], v[16:19]
    ds_read_b64_tr_b16 v[102:103], v237 offset:28672
    buffer_load_dwordx4 v92, s[8:11], s85 offen offset:2048 lds
    v_mfma_f32_16x16x32_bf16 v[20:23], v[104:107], a[116:119], v[20:23]
    ds_read_b64_tr_b16 v[104:105], v238 offset:24576
    buffer_load_dwordx4 v93, s[8:11], s85 offen offset:3072 lds
    v_mfma_f32_16x16x32_bf16 v[24:27], v[108:111], a[112:115], v[24:27]
    ds_read_b64_tr_b16 v[106:107], v238 offset:28672
    v_readlane_b32 s85, v88, 22
    v_mfma_f32_16x16x32_bf16 v[28:31], v[108:111], a[116:119], v[28:31]
    ds_read_b64_tr_b16 v[108:109], v239 offset:24576
    s_waitcnt lgkmcnt(9)
    v_mfma_f32_16x16x32_bf16 v[32:35], a[112:115], v[112:115], v[32:35]
    ds_read_b64_tr_b16 v[110:111], v239 offset:28672
    v_mfma_f32_16x16x32_bf16 v[36:39], a[116:119], v[112:115], v[36:39]
    v_mfma_f32_16x16x32_bf16 v[152:155], v[212:215], v[112:115], v[152:155]
    ds_read_b64_tr_b16 v[112:113], v236 offset:25600
    v_mfma_f32_16x16x32_bf16 v[40:43], a[112:115], v[116:119], v[40:43]
    ds_read_b64_tr_b16 v[114:115], v236 offset:29696
    v_mfma_f32_16x16x32_bf16 v[44:47], a[116:119], v[116:119], v[44:47]
    ds_read_b64_tr_b16 v[116:117], v237 offset:25600
    v_mfma_f32_16x16x32_bf16 v[48:51], a[112:115], v[120:123], v[48:51]
    ds_read_b64_tr_b16 v[118:119], v237 offset:29696
    v_mfma_f32_16x16x32_bf16 v[52:55], a[116:119], v[120:123], v[52:55]
    ds_read_b64_tr_b16 v[120:121], v238 offset:25600
    v_mfma_f32_16x16x32_bf16 v[56:59], a[112:115], v[124:127], v[56:59]
    ds_read_b64_tr_b16 v[122:123], v238 offset:29696
    v_mfma_f32_16x16x32_bf16 v[60:63], a[116:119], v[124:127], v[60:63]
    ds_read_b64_tr_b16 v[124:125], v239 offset:25600
    ds_read_b64_tr_b16 v[126:127], v239 offset:29696
    s_add_u32 m0, s40, 24576
    s_nop 0
    buffer_load_dwordx4 v245, s[12:15], s51 offen offset:0 lds
    buffer_load_dwordx4 v244, s[12:15], s51 offen offset:1024 lds
    v_readlane_b32 s52, v243, 22
    s_waitcnt lgkmcnt(15)
    s_add_u32 m0, s41, 16384
    s_nop 0
    buffer_load_dwordx4 v90, s[8:11], s84 offen offset:0 lds
    buffer_load_dwordx4 v91, s[8:11], s84 offen offset:1024 lds
    s_waitcnt vmcnt(12)
    v_cmp_gt_u32 vcc, v220, v218
    s_cbranch_vccz L_chk9
    s_mov_b64 exec, -1
    s_mov_b32 s3, 0x40000
L_poll10:
    buffer_load_dword v218, v219, s[20:23], 0 offen sc1
    s_sub_u32 s3, s3, 1
    s_cbranch_scc1 L_poll10_y
    s_waitcnt vmcnt(0)
    v_cmp_gt_u32 vcc, v220, v218
    s_cbranch_vccz L_poll10_y
    s_sleep 1
    s_branch L_poll10
L_poll10_y:
    s_waitcnt vmcnt(0)
    s_mov_b64 exec, -1
L_poll10_x:
L_chk9:
    s_waitcnt lgkmcnt(8)
    v_mfma_f32_16x16x32_bf16 v[0:3], v[96:99], a[120:123], v[0:3]
    ds_read_b128 a[128:131], v94 offset:32768
    buffer_load_dword v222, v231, s[4:7], 0 offen
    v_mfma_f32_16x16x32_bf16 v[4:7], v[96:99], a[124:127], v[4:7]
    ds_read_b128 a[132:135], v94 offset:34816
    s_add_u32 s4, s68, s46
    s_addc_u32 s5, s69, 0
    v_mfma_f32_16x16x32_bf16 v[148:151], v[96:99], v[212:215], v[148:151]
    s_barrier
    ds_read_b64_tr_b16 v[96:97], v236 offset:32768
    v_mfma_f32_16x16x32_bf16 v[8:11], v[100:103], a[120:123], v[8:11]
    ds_read_b64_tr_b16 v[98:99], v236 offset:36864
    s_mov_b32 s6, 0x800
    v_mfma_f32_16x16x32_bf16 v[12:15], v[100:103], a[124:127], v[12:15]
    ds_read_b64_tr_b16 v[100:101], v237 offset:32768
    s_mov_b32 s7, 0x20000
    v_mfma_f32_16x16x32_bf16 v[16:19], v[104:107], a[120:123], v[16:19]
    ds_read_b64_tr_b16 v[102:103], v237 offset:36864
    buffer_load_dwordx4 v[64:67], v254, s[4:7], 0 offen
    v_mfma_f32_16x16x32_bf16 v[20:23], v[104:107], a[124:127], v[20:23]
    ds_read_b64_tr_b16 v[104:105], v238 offset:32768
    buffer_load_dwordx4 v[68:71], v254, s[4:7], 0 offen offset:1024
    v_mfma_f32_16x16x32_bf16 v[24:27], v[108:111], a[120:123], v[24:27]
    ds_read_b64_tr_b16 v[106:107], v238 offset:36864
    v_mfma_f32_16x16x32_bf16 v[28:31], v[108:111], a[124:127], v[28:31]
    ds_read_b64_tr_b16 v[108:109], v239 offset:32768
    s_waitcnt lgkmcnt(9)
    v_mfma_f32_16x16x32_bf16 v[32:35], a[120:123], v[112:115], v[32:35]
    ds_read_b64_tr_b16 v[110:111], v239 offset:36864
    v_mfma_f32_16x16x32_bf16 v[36:39], a[124:127], v[112:115], v[36:39]
    v_mfma_f32_16x16x32_bf16 v[152:155], v[212:215], v[112:115], v[152:155]
    ds_read_b64_tr_b16 v[112:113], v236 offset:33792
    v_mfma_f32_16x16x32_bf16 v[40:43], a[120:123], v[116:119], v[40:43]
    ds_read_b64_tr_b16 v[114:115], v236 offset:37888
    v_mfma_f32_16x16x32_bf16 v[44:47], a[124:127], v[116:119], v[44:47]
    ds_read_b64_tr_b16 v[116:117], v237 offset:33792
    v_mfma_f32_16x16x32_bf16 v[48:51], a[120:123], v[120:123], v[48:51]
    ds_read_b64_tr_b16 v[118:119], v237 offset:37888
    v_mfma_f32_16x16x32_bf16 v[52:55], a[124:127], v[120:123], v[52:55]
    ds_read_b64_tr_b16 v[120:121], v238 offset:33792
    v_mfma_f32_16x16x32_bf16 v[56:59], a[120:123], v[124:127], v[56:59]
    ds_read_b64_tr_b16 v[122:123], v238 offset:37888
    v_mfma_f32_16x16x32_bf16 v[60:63], a[124:127], v[124:127], v[60:63]
    ds_read_b64_tr_b16 v[124:125], v239 offset:33792
    ds_read_b64_tr_b16 v[126:127], v239 offset:37888
    s_waitcnt lgkmcnt(8)
    v_mfma_f32_16x16x32_bf16 v[0:3], v[96:99], a[128:131], v[0:3]
    ds_read_b128 a[136:139], v95 offset:32768
    s_add_u32 m0, s40, 32768
    v_mfma_f32_16x16x32_bf16 v[4:7], v[96:99], a[132:135], v[4:7]
    ds_read_b128 a[140:143], v95 offset:34816
    buffer_load_dwordx4 v245, s[12:15], s52 offen offset:0 lds
    v_mfma_f32_16x16x32_bf16 v[148:151], v[96:99], v[212:215], v[148:151]
    ds_read_b64_tr_b16 v[96:97], v236 offset:40960
    buffer_load_dwordx4 v244, s[12:15], s52 offen offset:1024 lds
    v_mfma_f32_16x16x32_bf16 v[8:11], v[100:103], a[128:131], v[8:11]
    ds_read_b64_tr_b16 v[98:99], v236 offset:45056
    v_readlane_b32 s53, v243, 23
    v_mfma_f32_16x16x32_bf16 v[12:15], v[100:103], a[132:135], v[12:15]
    ds_read_b64_tr_b16 v[100:101], v237 offset:40960
    s_add_u32 m0, s41, 16384
    v_mfma_f32_16x16x32_bf16 v[16:19], v[104:107], a[128:131], v[16:19]
    ds_read_b64_tr_b16 v[102:103], v237 offset:45056
    buffer_load_dwordx4 v92, s[8:11], s84 offen offset:2048 lds
    v_mfma_f32_16x16x32_bf16 v[20:23], v[104:107], a[132:135], v[20:23]
    ds_read_b64_tr_b16 v[104:105], v238 offset:40960
    buffer_load_dwordx4 v93, s[8:11], s84 offen offset:3072 lds
    v_mfma_f32_16x16x32_bf16 v[24:27], v[108:111], a[128:131], v[24:27]
    ds_read_b64_tr_b16 v[106:107], v238 offset:45056
    v_readlane_b32 s84, v88, 24
    v_mfma_f32_16x16x32_bf16 v[28:31], v[108:111], a[132:135], v[28:31]
    ds_read_b64_tr_b16 v[108:109], v239 offset:40960
    s_waitcnt lgkmcnt(9)
    v_mfma_f32_16x16x32_bf16 v[32:35], a[128:131], v[112:115], v[32:35]
    ds_read_b64_tr_b16 v[110:111], v239 offset:45056
    v_mfma_f32_16x16x32_bf16 v[36:39], a[132:135], v[112:115], v[36:39]
    v_mfma_f32_16x16x32_bf16 v[152:155], v[212:215], v[112:115], v[152:155]
    ds_read_b64_tr_b16 v[112:113], v236 offset:41984
    v_mfma_f32_16x16x32_bf16 v[40:43], a[128:131], v[116:119], v[40:43]
    ds_read_b64_tr_b16 v[114:115], v236 offset:46080
    v_mfma_f32_16x16x32_bf16 v[44:47], a[132:135], v[116:119], v[44:47]
    ds_read_b64_tr_b16 v[116:117], v237 offset:41984
    v_mfma_f32_16x16x32_bf16 v[48:51], a[128:131], v[120:123], v[48:51]
    ds_read_b64_tr_b16 v[118:119], v237 offset:46080
    v_mfma_f32_16x16x32_bf16 v[52:55], a[132:135], v[120:123], v[52:55]
    ds_read_b64_tr_b16 v[120:121], v238 offset:41984
    v_mfma_f32_16x16x32_bf16 v[56:59], a[128:131], v[124:127], v[56:59]
    ds_read_b64_tr_b16 v[122:123], v238 offset:46080
    v_mfma_f32_16x16x32_bf16 v[60:63], a[132:135], v[124:127], v[60:63]
    ds_read_b64_tr_b16 v[124:125], v239 offset:41984
    ds_read_b64_tr_b16 v[126:127], v239 offset:46080
    s_waitcnt lgkmcnt(8)
    v_mfma_f32_16x16x32_bf16 v[0:3], v[96:99], a[136:139], v[0:3]
    s_waitcnt vmcnt(11)
    ds_read_b128 a[144:147], v94 offset:0
    v_mfma_f32_16x16x32_bf16 v[4:7], v[96:99], a[140:143], v[4:7]
    ds_read_b128 a[148:151], v94 offset:2048
    s_add_u32 m0, s40, 40960
    v_mfma_f32_16x16x32_bf16 v[148:151], v[96:99], v[212:215], v[148:151]
    s_barrier
    ds_read_b64_tr_b16 v[96:97], v232 offset:0
    v_mfma_f32_16x16x32_bf16 v[8:11], v[100:103], a[136:139], v[8:11]
    ds_read_b64_tr_b16 v[98:99], v232 offset:4096
    buffer_load_dwordx4 v245, s[12:15], s53 offen offset:0 lds
    v_mfma_f32_16x16x32_bf16 v[12:15], v[100:103], a[140:143], v[12:15]
    ds_read_b64_tr_b16 v[100:101], v233 offset:0
    buffer_load_dwordx4 v244, s[12:15], s53 offen offset:1024 lds
    v_mfma_f32_16x16x32_bf16 v[16:19], v[104:107], a[136:139], v[16:19]
    ds_read_b64_tr_b16 v[102:103], v233 offset:4096
    v_readlane_b32 s54, v243, 24
    v_mfma_f32_16x16x32_bf16 v[20:23], v[104:107], a[140:143], v[20:23]
    ds_read_b64_tr_b16 v[104:105], v234 offset:0
    s_add_u32 m0, s41, 32768
    v_mfma_f32_16x16x32_bf16 v[24:27], v[108:111], a[136:139], v[24:27]
    ds_read_b64_tr_b16 v[106:107], v234 offset:4096
    buffer_load_dwordx4 v90, s[8:11], s85 offen offset:0 lds
    v_mfma_f32_16x16x32_bf16 v[28:31], v[108:111], a[140:143], v[28:31]
    ds_read_b64_tr_b16 v[108:109], v235 offset:0
    s_waitcnt lgkmcnt(9)
    v_mfma_f32_16x16x32_bf16 v[32:35], a[136:139], v[112:115], v[32:35]
    ds_read_b64_tr_b16 v[110:111], v235 offset:4096
    buffer_load_dwordx4 v91, s[8:11], s85 offen offset:1024 lds
    v_mfma_f32_16x16x32_bf16 v[36:39], a[140:143], v[112:115], v[36:39]
    v_mfma_f32_16x16x32_bf16 v[152:155], v[212:215], v[112:115], v[152:155]
    ds_read_b64_tr_b16 v[112:113], v232 offset:1024
    v_mfma_f32_16x16x32_bf16 v[40:43], a[136:139], v[116:119], v[40:43]
    ds_read_b64_tr_b16 v[114:115], v232 offset:5120
    v_mfma_f32_16x16x32_bf16 v[44:47], a[140:143], v[116:119], v[44:47]
    ds_read_b64_tr_b16 v[116:117], v233 offset:1024
    v_mfma_f32_16x16x32_bf16 v[48:51], a[136:139], v[120:123], v[48:51]
    ds_read_b64_tr_b16 v[118:119], v233 offset:5120
    v_mfma_f32_16x16x32_bf16 v[52:55], a[140:143], v[120:123], v[52:55]
    ds_read_b64_tr_b16 v[120:121], v234 offset:1024
    v_mfma_f32_16x16x32_bf16 v[56:59], a[136:139], v[124:127], v[56:59]
    ds_read_b64_tr_b16 v[122:123], v234 offset:5120
    v_mfma_f32_16x16x32_bf16 v[60:63], a[140:143], v[124:127], v[60:63]
    ds_read_b64_tr_b16 v[124:125], v235 offset:1024
    ds_read_b64_tr_b16 v[126:127], v235 offset:5120
    s_waitcnt lgkmcnt(8)
    v_mfma_f32_16x16x32_bf16 v[0:3], v[96:99], a[144:147], v[0:3]
    ds_read_b128 a[152:155], v95 offset:0
    s_add_u32 m0, s40, 49152
    v_mfma_f32_16x16x32_bf16 v[4:7], v[96:99], a[148:151], v[4:7]
    ds_read_b128 a[156:159], v95 offset:2048
    buffer_load_dwordx4 v245, s[12:15], s54 offen offset:0 lds
    v_mfma_f32_16x16x32_bf16 v[148:151], v[96:99], v[212:215], v[148:151]
    ds_read_b64_tr_b16 v[96:97], v232 offset:8192
    buffer_load_dwordx4 v244, s[12:15], s54 offen offset:1024 lds
    v_mfma_f32_16x16x32_bf16 v[8:11], v[100:103], a[144:147], v[8:11]
    ds_read_b64_tr_b16 v[98:99], v232 offset:12288
    v_readlane_b32 s55, v243, 25
    v_mfma_f32_16x16x32_bf16 v[12:15], v[100:103], a[148:151], v[12:15]
    ds_read_b64_tr_b16 v[100:101], v233 offset:8192
    s_add_u32 m0, s41, 32768
    v_mfma_f32_16x16x32_bf16 v[16:19], v[104:107], a[144:147], v[16:19]
    ds_read_b64_tr_b16 v[102:103], v233 offset:12288
    buffer_load_dwordx4 v92, s[8:11], s85 offen offset:2048 lds
    v_mfma_f32_16x16x32_bf16 v[20:23], v[104:107], a[148:151], v[20:23]
    ds_read_b64_tr_b16 v[104:105], v234 offset:8192
    buffer_load_dwordx4 v93, s[8:11], s85 offen offset:3072 lds
    v_mfma_f32_16x16x32_bf16 v[24:27], v[108:111], a[144:147], v[24:27]
    ds_read_b64_tr_b16 v[106:107], v234 offset:12288
    v_readlane_b32 s85, v88, 26
    v_mfma_f32_16x16x32_bf16 v[28:31], v[108:111], a[148:151], v[28:31]
    ds_read_b64_tr_b16 v[108:109], v235 offset:8192
    s_waitcnt lgkmcnt(9)
    v_mfma_f32_16x16x32_bf16 v[32:35], a[144:147], v[112:115], v[32:35]
    ds_read_b64_tr_b16 v[110:111], v235 offset:12288
    v_mfma_f32_16x16x32_bf16 v[36:39], a[148:151], v[112:115], v[36:39]
    v_mfma_f32_16x16x32_bf16 v[152:155], v[212:215], v[112:115], v[152:155]
    ds_read_b64_tr_b16 v[112:113], v232 offset:9216
    v_mfma_f32_16x16x32_bf16 v[40:43], a[144:147], v[116:119], v[40:43]
    ds_read_b64_tr_b16 v[114:115], v232 offset:13312
    v_mfma_f32_16x16x32_bf16 v[44:47], a[148:151], v[116:119], v[44:47]
    ds_read_b64_tr_b16 v[116:117], v233 offset:9216
    v_mfma_f32_16x16x32_bf16 v[48:51], a[144:147], v[120:123], v[48:51]
    ds_read_b64_tr_b16 v[118:119], v233 offset:13312
    v_mfma_f32_16x16x32_bf16 v[52:55], a[148:151], v[120:123], v[52:55]
    ds_read_b64_tr_b16 v[120:121], v234 offset:9216
    v_mfma_f32_16x16x32_bf16 v[56:59], a[144:147], v[124:127], v[56:59]
    ds_read_b64_tr_b16 v[122:123], v234 offset:13312
    v_mfma_f32_16x16x32_bf16 v[60:63], a[148:151], v[124:127], v[60:63]
    ds_read_b64_tr_b16 v[124:125], v235 offset:9216
    ds_read_b64_tr_b16 v[126:127], v235 offset:13312
    s_waitcnt lgkmcnt(8)
    v_mfma_f32_16x16x32_bf16 v[0:3], v[96:99], a[152:155], v[0:3]
    s_waitcnt vmcnt(8)
    ds_read_b128 a[160:163], v94 offset:16384
    v_mfma_f32_16x16x32_bf16 v[4:7], v[96:99], a[156:159], v[4:7]
    ds_read_b128 a[164:167], v94 offset:18432
    s_add_u32 m0, s40, 57344
    v_mfma_f32_16x16x32_bf16 v[148:151], v[96:99], v[212:215], v[148:151]
    s_barrier
    ds_read_b64_tr_b16 v[96:97], v232 offset:16384
    v_mfma_f32_16x16x32_bf16 v[8:11], v[100:103], a[152:155], v[8:11]
    ds_read_b64_tr_b16 v[98:99], v232 offset:20480
    buffer_load_dwordx4 v245, s[12:15], s55 offen offset:0 lds
    v_mfma_f32_16x16x32_bf16 v[12:15], v[100:103], a[156:159], v[12:15]
    ds_read_b64_tr_b16 v[100:101], v233 offset:16384
    buffer_load_dwordx4 v244, s[12:15], s55 offen offset:1024 lds
    v_mfma_f32_16x16x32_bf16 v[16:19], v[104:107], a[152:155], v[16:19]
    ds_read_b64_tr_b16 v[102:103], v233 offset:20480
    v_readlane_b32 s56, v243, 26
    v_mfma_f32_16x16x32_bf16 v[20:23], v[104:107], a[156:159], v[20:23]
    ds_read_b64_tr_b16 v[104:105], v234 offset:16384
    s_add_u32 m0, s41, 0
    v_mfma_f32_16x16x32_bf16 v[24:27], v[108:111], a[152:155], v[24:27]
    ds_read_b64_tr_b16 v[106:107], v234 offset:20480
    buffer_load_dwordx4 v90, s[8:11], s84 offen offset:0 lds
    v_mfma_f32_16x16x32_bf16 v[28:31], v[108:111], a[156:159], v[28:31]
    ds_read_b64_tr_b16 v[108:109], v235 offset:16384
    s_waitcnt lgkmcnt(9)
    v_mfma_f32_16x16x32_bf16 v[32:35], a[152:155], v[112:115], v[32:35]
    ds_read_b64_tr_b16 v[110:111], v235 offset:20480
    buffer_load_dwordx4 v91, s[8:11], s84 offen offset:1024 lds
    v_mfma_f32_16x16x32_bf16 v[36:39], a[156:159], v[112:115], v[36:39]
    v_mfma_f32_16x16x32_bf16 v[152:155], v[212:215], v[112:115], v[152:155]
    ds_read_b64_tr_b16 v[112:113], v232 offset:17408
    v_mfma_f32_16x16x32_bf16 v[40:43], a[152:155], v[116:119], v[40:43]
    ds_read_b64_tr_b16 v[114:115], v232 offset:21504
    v_mfma_f32_16x16x32_bf16 v[44:47], a[156:159], v[116:119], v[44:47]
    ds_read_b64_tr_b16 v[116:117], v233 offset:17408
    v_mfma_f32_16x16x32_bf16 v[48:51], a[152:155], v[120:123], v[48:51]
    ds_read_b64_tr_b16 v[118:119], v233 offset:21504
    v_mfma_f32_16x16x32_bf16 v[52:55], a[156:159], v[120:123], v[52:55]
    ds_read_b64_tr_b16 v[120:121], v234 offset:17408
    v_mfma_f32_16x16x32_bf16 v[56:59], a[152:155], v[124:127], v[56:59]
    ds_read_b64_tr_b16 v[122:123], v234 offset:21504
    v_mfma_f32_16x16x32_bf16 v[60:63], a[156:159], v[124:127], v[60:63]
    ds_read_b64_tr_b16 v[124:125], v235 offset:17408
    ds_read_b64_tr_b16 v[126:127], v235 offset:21504
    s_waitcnt lgkmcnt(8)
    v_mfma_f32_16x16x32_bf16 v[0:3], v[96:99], a[160:163], v[0:3]
    ds_read_b128 a[168:171], v95 offset:16384
    s_add_u32 m0, s40, 65536
    v_mfma_f32_16x16x32_bf16 v[4:7], v[96:99], a[164:167], v[4:7]
    ds_read_b128 a[172:175], v95 offset:18432
    buffer_load_dwordx4 v245, s[12:15], s56 offen offset:0 lds
    v_mfma_f32_16x16x32_bf16 v[148:151], v[96:99], v[212:215], v[148:151]
    ds_read_b64_tr_b16 v[96:97], v232 offset:24576
    buffer_load_dwordx4 v244, s[12:15], s56 offen offset:1024 lds
    v_mfma_f32_16x16x32_bf16 v[8:11], v[100:103], a[160:163], v[8:11]
    ds_read_b64_tr_b16 v[98:99], v232 offset:28672
    v_readlane_b32 s57, v243, 27
    v_mfma_f32_16x16x32_bf16 v[12:15], v[100:103], a[164:167], v[12:15]
    ds_read_b64_tr_b16 v[100:101], v233 offset:24576
    s_add_u32 m0, s41, 0
    v_mfma_f32_16x16x32_bf16 v[16:19], v[104:107], a[160:163], v[16:19]
    ds_read_b64_tr_b16 v[102:103], v233 offset:28672
    buffer_load_dwordx4 v92, s[8:11], s84 offen offset:2048 lds
    v_mfma_f32_16x16x32_bf16 v[20:23], v[104:107], a[164:167], v[20:23]
    ds_read_b64_tr_b16 v[104:105], v234 offset:24576
    buffer_load_dwordx4 v93, s[8:11], s84 offen offset:3072 lds
    v_mfma_f32_16x16x32_bf16 v[24:27], v[108:111], a[160:163], v[24:27]
    ds_read_b64_tr_b16 v[106:107], v234 offset:28672
    v_readlane_b32 s84, v88, 28
    v_mfma_f32_16x16x32_bf16 v[28:31], v[108:111], a[164:167], v[28:31]
    ds_read_b64_tr_b16 v[108:109], v235 offset:24576
    s_waitcnt lgkmcnt(9)
    v_mfma_f32_16x16x32_bf16 v[32:35], a[160:163], v[112:115], v[32:35]
    ds_read_b64_tr_b16 v[110:111], v235 offset:28672
    v_mfma_f32_16x16x32_bf16 v[36:39], a[164:167], v[112:115], v[36:39]
    v_mfma_f32_16x16x32_bf16 v[152:155], v[212:215], v[112:115], v[152:155]
    ds_read_b64_tr_b16 v[112:113], v232 offset:25600
    v_mfma_f32_16x16x32_bf16 v[40:43], a[160:163], v[116:119], v[40:43]
    ds_read_b64_tr_b16 v[114:115], v232 offset:29696
    v_mfma_f32_16x16x32_bf16 v[44:47], a[164:167], v[116:119], v[44:47]
    ds_read_b64_tr_b16 v[116:117], v233 offset:25600
    v_mfma_f32_16x16x32_bf16 v[48:51], a[160:163], v[120:123], v[48:51]
    ds_read_b64_tr_b16 v[118:119], v233 offset:29696
    v_mfma_f32_16x16x32_bf16 v[52:55], a[164:167], v[120:123], v[52:55]
    ds_read_b64_tr_b16 v[120:121], v234 offset:25600
    v_mfma_f32_16x16x32_bf16 v[56:59], a[160:163], v[124:127], v[56:59]
    ds_read_b64_tr_b16 v[122:123], v234 offset:29696
    v_mfma_f32_16x16x32_bf16 v[60:63], a[164:167], v[124:127], v[60:63]
    ds_read_b64_tr_b16 v[124:125], v235 offset:25600
    ds_read_b64_tr_b16 v[126:127], v235 offset:29696
    s_waitcnt lgkmcnt(8)
    v_mfma_f32_16x16x32_bf16 v[0:3], v[96:99], a[168:171], v[0:3]
    s_waitcnt vmcnt(8)
    ds_read_b128 a[176:179], v94 offset:32768
    v_mfma_f32_16x16x32_bf16 v[4:7], v[96:99], a[172:175], v[4:7]
    ds_read_b128 a[180:183], v94 offset:34816
    s_add_u32 m0, s40, 73728
    v_mfma_f32_16x16x32_bf16 v[148:151], v[96:99], v[212:215], v[148:151]
    s_barrier
    ds_read_b64_tr_b16 v[96:97], v232 offset:32768
    v_mfma_f32_16x16x32_bf16 v[8:11], v[100:103], a[168:171], v[8:11]
    ds_read_b64_tr_b16 v[98:99], v232 offset:36864
    buffer_load_dwordx4 v245, s[12:15], s57 offen offset:0 lds
    v_mfma_f32_16x16x32_bf16 v[12:15], v[100:103], a[172:175], v[12:15]
    ds_read_b64_tr_b16 v[100:101], v233 offset:32768
    buffer_load_dwordx4 v244, s[12:15], s57 offen offset:1024 lds
    v_mfma_f32_16x16x32_bf16 v[16:19], v[104:107], a[168:171], v[16:19]
    ds_read_b64_tr_b16 v[102:103], v233 offset:36864
    v_readlane_b32 s59, v243, 28
    v_mfma_f32_16x16x32_bf16 v[20:23], v[104:107], a[172:175], v[20:23]
    ds_read_b64_tr_b16 v[104:105], v234 offset:32768
    s_add_u32 m0, s41, 16384
    v_mfma_f32_16x16x32_bf16 v[24:27], v[108:111], a[168:171], v[24:27]
    ds_read_b64_tr_b16 v[106:107], v234 offset:36864
    buffer_load_dwordx4 v90, s[8:11], s85 offen offset:0 lds
    v_mfma_f32_16x16x32_bf16 v[28:31], v[108:111], a[172:175], v[28:31]
    ds_read_b64_tr_b16 v[108:109], v235 offset:32768
    s_waitcnt lgkmcnt(9)
    v_mfma_f32_16x16x32_bf16 v[32:35], a[168:171], v[112:115], v[32:35]
    ds_read_b64_tr_b16 v[110:111], v235 offset:36864
    buffer_load_dwordx4 v91, s[8:11], s85 offen offset:1024 lds
    v_mfma_f32_16x16x32_bf16 v[36:39], a[172:175], v[112:115], v[36:39]
    v_mfma_f32_16x16x32_bf16 v[152:155], v[212:215], v[112:115], v[152:155]
    ds_read_b64_tr_b16 v[112:113], v232 offset:33792
    v_mfma_f32_16x16x32_bf16 v[40:43], a[168:171], v[116:119], v[40:43]
    ds_read_b64_tr_b16 v[114:115], v232 offset:37888
    v_mfma_f32_16x16x32_bf16 v[44:47], a[172:175], v[116:119], v[44:47]
    ds_read_b64_tr_b16 v[116:117], v233 offset:33792
    v_mfma_f32_16x16x32_bf16 v[48:51], a[168:171], v[120:123], v[48:51]
    ds_read_b64_tr_b16 v[118:119], v233 offset:37888
    v_mfma_f32_16x16x32_bf16 v[52:55], a[172:175], v[120:123], v[52:55]
    ds_read_b64_tr_b16 v[120:121], v234 offset:33792
    v_mfma_f32_16x16x32_bf16 v[56:59], a[168:171], v[124:127], v[56:59]
    ds_read_b64_tr_b16 v[122:123], v234 offset:37888
    v_mfma_f32_16x16x32_bf16 v[60:63], a[172:175], v[124:127], v[60:63]
    ds_read_b64_tr_b16 v[124:125], v235 offset:33792
    ds_read_b64_tr_b16 v[126:127], v235 offset:37888
    s_waitcnt lgkmcnt(8)
    v_mfma_f32_16x16x32_bf16 v[0:3], v[96:99], a[176:179], v[0:3]
    ds_read_b128 a[184:187], v95 offset:32768
    s_add_u32 m0, s40, 81920
    v_mfma_f32_16x16x32_bf16 v[4:7], v[96:99], a[180:183], v[4:7]
    ds_read_b128 a[188:191], v95 offset:34816
    buffer_load_dwordx4 v245, s[12:15], s59 offen offset:0 lds
    v_mfma_f32_16x16x32_bf16 v[148:151], v[96:99], v[212:215], v[148:151]
    ds_read_b64_tr_b16 v[96:97], v232 offset:40960
    buffer_load_dwordx4 v244, s[12:15], s59 offen offset:1024 lds
    v_mfma_f32_16x16x32_bf16 v[8:11], v[100:103], a[176:179], v[8:11]
    ds_read_b64_tr_b16 v[98:99], v232 offset:45056
    v_readlane_b32 s45, v243, 29
    v_mfma_f32_16x16x32_bf16 v[12:15], v[100:103], a[180:183], v[12:15]
    ds_read_b64_tr_b16 v[100:101], v233 offset:40960
    s_add_u32 m0, s41, 16384
    v_mfma_f32_16x16x32_bf16 v[16:19], v[104:107], a[176:179], v[16:19]
    ds_read_b64_tr_b16 v[102:103], v233 offset:45056
    buffer_load_dwordx4 v92, s[8:11], s85 offen offset:2048 lds
    v_mfma_f32_16x16x32_bf16 v[20:23], v[104:107], a[180:183], v[20:23]
    ds_read_b64_tr_b16 v[104:105], v234 offset:40960
    buffer_load_dwordx4 v93, s[8:11], s85 offen offset:3072 lds
    v_mfma_f32_16x16x32_bf16 v[24:27], v[108:111], a[176:179], v[24:27]
    ds_read_b64_tr_b16 v[106:107], v234 offset:45056
    v_readlane_b32 s85, v88, 30
    v_mfma_f32_16x16x32_bf16 v[28:31], v[108:111], a[180:183], v[28:31]
    ds_read_b64_tr_b16 v[108:109], v235 offset:40960
    s_waitcnt lgkmcnt(9)
    v_mfma_f32_16x16x32_bf16 v[32:35], a[176:179], v[112:115], v[32:35]
    ds_read_b64_tr_b16 v[110:111], v235 offset:45056
    v_and_b32 v217, 15, v255
    v_mfma_f32_16x16x32_bf16 v[36:39], a[180:183], v[112:115], v[36:39]
    v_lshlrev_b32 v217, 4, v217
    v_lshrrev_b32 v231, 4, v255
    v_mfma_f32_16x16x32_bf16 v[152:155], v[212:215], v[112:115], v[152:155]
    ds_read_b64_tr_b16 v[112:113], v232 offset:41984
    v_lshlrev_b32 v231, 6, v231
    v_mfma_f32_16x16x32_bf16 v[40:43], a[176:179], v[116:119], v[40:43]
    ds_read_b64_tr_b16 v[114:115], v232 offset:46080
    buffer_load_dwordx2 v[128:129], v217, s[92:95], 0 offen offset:0 sc1
    v_mfma_f32_16x16x32_bf16 v[44:47], a[180:183], v[116:119], v[44:47]
    ds_read_b64_tr_b16 v[116:117], v233 offset:41984
    buffer_load_dwordx2 v[132:133], v231, s[92:95], 0 offen offset:0 sc1
    v_mfma_f32_16x16x32_bf16 v[48:51], a[176:179], v[120:123], v[48:51]
    ds_read_b64_tr_b16 v[118:119], v233 offset:46080
    buffer_load_dwordx2 v[134:135], v231, s[92:95], 0 offen offset:16 sc1
    v_mfma_f32_16x16x32_bf16 v[52:55], a[180:183], v[120:123], v[52:55]
    ds_read_b64_tr_b16 v[120:121], v234 offset:41984
    buffer_load_dwordx2 v[136:137], v231, s[92:95], 0 offen offset:32 sc1
    v_mfma_f32_16x16x32_bf16 v[56:59], a[176:179], v[124:127], v[56:59]
    ds_read_b64_tr_b16 v[122:123], v234 offset:46080
    buffer_load_dwordx2 v[138:139], v231, s[92:95], 0 offen offset:48 sc1
    v_mfma_f32_16x16x32_bf16 v[60:63], a[180:183], v[124:127], v[60:63]
    ds_read_b64_tr_b16 v[124:125], v235 offset:41984
    ds_read_b64_tr_b16 v[126:127], v235 offset:46080
    s_waitcnt lgkmcnt(8)
    v_mfma_f32_16x16x32_bf16 v[0:3], v[96:99], a[184:187], v[0:3]
    s_waitcnt vmcnt(13)
    ds_read_b128 a[192:195], v94 offset:0
    v_mfma_f32_16x16x32_bf16 v[4:7], v[96:99], a[188:191], v[4:7]
    ds_read_b128 a[196:199], v94 offset:2048
    s_add_u32 m0, s40, 90112
    v_mfma_f32_16x16x32_bf16 v[148:151], v[96:99], v[212:215], v[148:151]
    s_barrier
    ds_read_b64_tr_b16 v[96:97], v232 offset:49152
    v_mfma_f32_16x16x32_bf16 v[8:11], v[100:103], a[184:187], v[8:11]
    ds_read_b64_tr_b16 v[98:99], v232 offset:53248
    buffer_load_dwordx4 v245, s[12:15], s45 offen offset:0 lds
    v_mfma_f32_16x16x32_bf16 v[12:15], v[100:103], a[188:191], v[12:15]
    ds_read_b64_tr_b16 v[100:101], v233 offset:49152
    buffer_load_dwordx4 v244, s[12:15], s45 offen offset:1024 lds
    v_mfma_f32_16x16x32_bf16 v[16:19], v[104:107], a[184:187], v[16:19]
    ds_read_b64_tr_b16 v[102:103], v233 offset:53248
    v_readlane_b32 s50, v243, 30
    v_mfma_f32_16x16x32_bf16 v[20:23], v[104:107], a[188:191], v[20:23]
    ds_read_b64_tr_b16 v[104:105], v234 offset:49152
    s_add_u32 m0, s41, 32768
    v_mfma_f32_16x16x32_bf16 v[24:27], v[108:111], a[184:187], v[24:27]
    ds_read_b64_tr_b16 v[106:107], v234 offset:53248
    buffer_load_dwordx4 v90, s[8:11], s84 offen offset:0 lds
    v_mfma_f32_16x16x32_bf16 v[28:31], v[108:111], a[188:191], v[28:31]
    ds_read_b64_tr_b16 v[108:109], v235 offset:49152
    s_waitcnt lgkmcnt(9)
    v_mfma_f32_16x16x32_bf16 v[32:35], a[184:187], v[112:115], v[32:35]
    ds_read_b64_tr_b16 v[110:111], v235 offset:53248
    buffer_load_dwordx4 v91, s[8:11], s84 offen offset:1024 lds
    v_mfma_f32_16x16x32_bf16 v[36:39], a[188:191], v[112:115], v[36:39]
    buffer_load_dwordx2 v[130:131], v217, s[92:95], 0 offen offset:256 sc1
    buffer_load_dwordx2 v[140:141], v231, s[92:95], 0 offen offset:256 sc1
    v_mfma_f32_16x16x32_bf16 v[152:155], v[212:215], v[112:115], v[152:155]
    ds_read_b64_tr_b16 v[112:113], v232 offset:50176
    buffer_load_dwordx2 v[142:143], v231, s[92:95], 0 offen offset:272 sc1
    v_mfma_f32_16x16x32_bf16 v[40:43], a[184:187], v[116:119], v[40:43]
    ds_read_b64_tr_b16 v[114:115], v232 offset:54272
    buffer_load_dwordx2 v[144:145], v231, s[92:95], 0 offen offset:288 sc1
    v_mfma_f32_16x16x32_bf16 v[44:47], a[188:191], v[116:119], v[44:47]
    ds_read_b64_tr_b16 v[116:117], v233 offset:50176
    buffer_load_dwordx2 v[146:147], v231, s[92:95], 0 offen offset:304 sc1
    v_mfma_f32_16x16x32_bf16 v[48:51], a[184:187], v[120:123], v[48:51]
    ds_read_b64_tr_b16 v[118:119], v233 offset:54272
    s_mov_b32 s47, 0xffff0000
    v_mfma_f32_16x16x32_bf16 v[52:55], a[188:191], v[120:123], v[52:55]
    ds_read_b64_tr_b16 v[120:121], v234 offset:50176
    v_lshlrev_b32 v72, 16, v64
    v_mfma_f32_16x16x32_bf16 v[56:59], a[184:187], v[124:127], v[56:59]
    ds_read_b64_tr_b16 v[122:123], v234 offset:54272
    v_and_b32 v73, s47, v64
    v_mfma_f32_16x16x32_bf16 v[60:63], a[188:191], v[124:127], v[60:63]
    ds_read_b64_tr_b16 v[124:125], v235 offset:50176
    ds_read_b64_tr_b16 v[126:127], v235 offset:54272
    s_waitcnt lgkmcnt(8)
    v_mfma_f32_16x16x32_bf16 v[0:3], v[96:99], a[192:195], v[0:3]
    ds_read_b128 a[200:203], v95 offset:0
    s_add_u32 m0, s40, 98304
    v_mfma_f32_16x16x32_bf16 v[4:7], v[96:99], a[196:199], v[4:7]
    ds_read_b128 a[204:207], v95 offset:2048
    buffer_load_dwordx4 v245, s[12:15], s50 offen offset:0 lds
    v_mfma_f32_16x16x32_bf16 v[148:151], v[96:99], v[212:215], v[148:151]
    ds_read_b64_tr_b16 v[96:97], v232 offset:57344
    buffer_load_dwordx4 v244, s[12:15], s50 offen offset:1024 lds
    v_mfma_f32_16x16x32_bf16 v[8:11], v[100:103], a[192:195], v[8:11]
    ds_read_b64_tr_b16 v[98:99], v232 offset:61440
    v_readlane_b32 s51, v243, 31
    v_mfma_f32_16x16x32_bf16 v[12:15], v[100:103], a[196:199], v[12:15]
    ds_read_b64_tr_b16 v[100:101], v233 offset:57344
    s_add_u32 m0, s41, 32768
    v_mfma_f32_16x16x32_bf16 v[16:19], v[104:107], a[192:195], v[16:19]
    ds_read_b64_tr_b16 v[102:103], v233 offset:61440
    buffer_load_dwordx4 v92, s[8:11], s84 offen offset:2048 lds
    v_mfma_f32_16x16x32_bf16 v[20:23], v[104:107], a[196:199], v[20:23]
    ds_read_b64_tr_b16 v[104:105], v234 offset:57344
    buffer_load_dwordx4 v93, s[8:11], s84 offen offset:3072 lds
    v_mfma_f32_16x16x32_bf16 v[24:27], v[108:111], a[192:195], v[24:27]
    ds_read_b64_tr_b16 v[106:107], v234 offset:61440
    s_add_u32 m0, s40, 106496
    v_mfma_f32_16x16x32_bf16 v[28:31], v[108:111], a[196:199], v[28:31]
    ds_read_b64_tr_b16 v[108:109], v235 offset:57344
    s_waitcnt lgkmcnt(9)
    v_mfma_f32_16x16x32_bf16 v[32:35], a[192:195], v[112:115], v[32:35]
    ds_read_b64_tr_b16 v[110:111], v235 offset:61440
    buffer_load_dwordx4 v245, s[12:15], s51 offen offset:0 lds
    v_mfma_f32_16x16x32_bf16 v[36:39], a[196:199], v[112:115], v[36:39]
    v_readlane_b32 s42, v243, 0
    buffer_load_dwordx4 v244, s[12:15], s51 offen offset:1024 lds
    v_mfma_f32_16x16x32_bf16 v[152:155], v[212:215], v[112:115], v[152:155]
    ds_read_b64_tr_b16 v[112:113], v232 offset:58368
    v_readlane_b32 s43, v243, 1
    v_mfma_f32_16x16x32_bf16 v[40:43], a[192:195], v[116:119], v[40:43]
    ds_read_b64_tr_b16 v[114:115], v232 offset:62464
    s_add_u32 m0, s40, 0
    v_mfma_f32_16x16x32_bf16 v[44:47], a[196:199], v[116:119], v[44:47]
    ds_read_b64_tr_b16 v[116:117], v233 offset:58368
    buffer_load_dwordx4 v247, s[12:15], s42 offen offset:0 lds
    v_mfma_f32_16x16x32_bf16 v[48:51], a[192:195], v[120:123], v[48:51]
    ds_read_b64_tr_b16 v[118:119], v233 offset:62464
    v_readlane_b32 s42, v243, 2
    v_mfma_f32_16x16x32_bf16 v[52:55], a[196:199], v[120:123], v[52:55]
    ds_read_b64_tr_b16 v[120:121], v234 offset:58368
    buffer_load_dwordx4 v246, s[12:15], s43 offen offset:1024 lds
    v_mfma_f32_16x16x32_bf16 v[56:59], a[192:195], v[124:127], v[56:59]
    ds_read_b64_tr_b16 v[122:123], v234 offset:62464
    v_readlane_b32 s43, v243, 3
    v_mfma_f32_16x16x32_bf16 v[60:63], a[196:199], v[124:127], v[60:63]
    ds_read_b64_tr_b16 v[124:125], v235 offset:58368
    ds_read_b64_tr_b16 v[126:127], v235 offset:62464
    s_waitcnt lgkmcnt(8)
    v_mfma_f32_16x16x32_bf16 v[0:3], v[96:99], a[200:203], v[0:3]
    s_waitcnt vmcnt(22)
    ds_read_b128 a[208:211], v94 offset:16384
    v_mfma_f32_16x16x32_bf16 v[4:7], v[96:99], a[204:207], v[4:7]
    ds_read_b128 a[212:215], v94 offset:18432
    s_add_u32 m0, s41, 0
    v_mfma_f32_16x16x32_bf16 v[148:151], v[96:99], v[212:215], v[148:151]
    s_barrier
    ds_read_b64_tr_b16 v[96:97], v236 offset:0
    v_mfma_f32_16x16x32_bf16 v[8:11], v[100:103], a[200:203], v[8:11]
    ds_read_b64_tr_b16 v[98:99], v236 offset:4096
    buffer_load_dwordx4 v90, s[8:11], s85 offen offset:0 lds
    v_mfma_f32_16x16x32_bf16 v[12:15], v[100:103], a[204:207], v[12:15]
    ds_read_b64_tr_b16 v[100:101], v237 offset:0
    buffer_load_dwordx4 v91, s[8:11], s85 offen offset:1024 lds
    v_mfma_f32_16x16x32_bf16 v[16:19], v[104:107], a[200:203], v[16:19]
    ds_read_b64_tr_b16 v[102:103], v237 offset:4096
    s_add_u32 m0, s40, 8192
    v_mfma_f32_16x16x32_bf16 v[20:23], v[104:107], a[204:207], v[20:23]
    ds_read_b64_tr_b16 v[104:105], v238 offset:0
    buffer_load_dwordx4 v247, s[12:15], s42 offen offset:0 lds
    v_mfma_f32_16x16x32_bf16 v[24:27], v[108:111], a[200:203], v[24:27]
    ds_read_b64_tr_b16 v[106:107], v238 offset:4096
    v_readlane_b32 s42, v243, 4
    v_mfma_f32_16x16x32_bf16 v[28:31], v[108:111], a[204:207], v[28:31]
    ds_read_b64_tr_b16 v[108:109], v239 offset:0
    s_waitcnt lgkmcnt(9)
    v_mfma_f32_16x16x32_bf16 v[32:35], a[200:203], v[112:115], v[32:35]
    ds_read_b64_tr_b16 v[110:111], v239 offset:4096
    buffer_load_dwordx4 v246, s[12:15], s43 offen offset:1024 lds
    v_mfma_f32_16x16x32_bf16 v[36:39], a[204:207], v[112:115], v[36:39]
    v_readlane_b32 s43, v243, 5
    v_lshlrev_b32 v74, 16, v65
    v_mfma_f32_16x16x32_bf16 v[152:155], v[212:215], v[112:115], v[152:155]
    ds_read_b64_tr_b16 v[112:113], v236 offset:1024
    v_and_b32 v75, s47, v65
    v_mfma_f32_16x16x32_bf16 v[40:43], a[200:203], v[116:119], v[40:43]
    ds_read_b64_tr_b16 v[114:115], v236 offset:5120
    v_lshlrev_b32 v76, 16, v66
    v_mfma_f32_16x16x32_bf16 v[44:47], a[204:207], v[116:119], v[44:47]
    ds_read_b64_tr_b16 v[116:117], v237 offset:1024
    v_and_b32 v77, s47, v66
    v_mfma_f32_16x16x32_bf16 v[48:51], a[200:203], v[120:123], v[48:51]
    ds_read_b64_tr_b16 v[118:119], v237 offset:5120
    v_lshlrev_b32 v78, 16, v67
    v_mfma_f32_16x16x32_bf16 v[52:55], a[204:207], v[120:123], v[52:55]
    ds_read_b64_tr_b16 v[120:121], v238 offset:1024
    v_and_b32 v79, s47, v67
    v_mfma_f32_16x16x32_bf16 v[56:59], a[200:203], v[124:127], v[56:59]
    ds_read_b64_tr_b16 v[122:123], v238 offset:5120
    v_lshlrev_b32 v80, 16, v68
    v_mfma_f32_16x16x32_bf16 v[60:63], a[204:207], v[124:127], v[60:63]
    ds_read_b64_tr_b16 v[124:125], v239 offset:1024
    ds_read_b64_tr_b16 v[126:127], v239 offset:5120
    s_waitcnt lgkmcnt(8)
    v_mfma_f32_16x16x32_bf16 v[0:3], v[96:99], a[208:211], v[0:3]
    ds_read_b128 a[216:219], v95 offset:16384
    s_add_u32 m0, s41, 0
    v_mfma_f32_16x16x32_bf16 v[4:7], v[96:99], a[212:215], v[4:7]
    ds_read_b128 a[220:223], v95 offset:18432
    buffer_load_dwordx4 v92, s[8:11], s85 offen offset:2048 lds
    v_mfma_f32_16x16x32_bf16 v[148:151], v[96:99], v[212:215], v[148:151]
    ds_read_b64_tr_b16 v[96:97], v236 offset:8192
    buffer_load_dwordx4 v93, s[8:11], s85 offen offset:3072 lds
    v_mfma_f32_16x16x32_bf16 v[8:11], v[100:103], a[208:211], v[8:11]
    ds_read_b64_tr_b16 v[98:99], v236 offset:12288
    s_add_u32 m0, s40, 16384
    v_mfma_f32_16x16x32_bf16 v[12:15], v[100:103], a[212:215], v[12:15]
    ds_read_b64_tr_b16 v[100:101], v237 offset:8192
    buffer_load_dwordx4 v247, s[12:15], s42 offen offset:0 lds
    v_mfma_f32_16x16x32_bf16 v[16:19], v[104:107], a[208:211], v[16:19]
    ds_read_b64_tr_b16 v[102:103], v237 offset:12288
    v_readlane_b32 s42, v243, 6
    v_mfma_f32_16x16x32_bf16 v[20:23], v[104:107], a[212:215], v[20:23]
    ds_read_b64_tr_b16 v[104:105], v238 offset:8192
    buffer_load_dwordx4 v246, s[12:15], s43 offen offset:1024 lds
    v_mfma_f32_16x16x32_bf16 v[24:27], v[108:111], a[208:211], v[24:27]
    ds_read_b64_tr_b16 v[106:107], v238 offset:12288
    v_readlane_b32 s43, v243, 7
    v_mfma_f32_16x16x32_bf16 v[28:31], v[108:111], a[212:215], v[28:31]
    ds_read_b64_tr_b16 v[108:109], v239 offset:8192
    s_waitcnt lgkmcnt(9)
    v_mfma_f32_16x16x32_bf16 v[32:35], a[208:211], v[112:115], v[32:35]
    ds_read_b64_tr_b16 v[110:111], v239 offset:12288
    v_and_b32 v81, s47, v68
    v_mfma_f32_16x16x32_bf16 v[36:39], a[212:215], v[112:115], v[36:39]
    v_lshlrev_b32 v82, 16, v69
    v_and_b32 v83, s47, v69
    v_mfma_f32_16x16x32_bf16 v[152:155], v[212:215], v[112:115], v[152:155]
    ds_read_b64_tr_b16 v[112:113], v236 offset:9216
    v_lshlrev_b32 v84, 16, v70
    v_mfma_f32_16x16x32_bf16 v[40:43], a[208:211], v[116:119], v[40:43]
    ds_read_b64_tr_b16 v[114:115], v236 offset:13312
    v_and_b32 v85, s47, v70
    v_mfma_f32_16x16x32_bf16 v[44:47], a[212:215], v[116:119], v[44:47]
    ds_read_b64_tr_b16 v[116:117], v237 offset:9216
    v_lshlrev_b32 v86, 16, v71
    v_mfma_f32_16x16x32_bf16 v[48:51], a[208:211], v[120:123], v[48:51]
    ds_read_b64_tr_b16 v[118:119], v237 offset:13312
    v_and_b32 v87, s47, v71
    v_mfma_f32_16x16x32_bf16 v[52:55], a[212:215], v[120:123], v[52:55]
    ds_read_b64_tr_b16 v[120:121], v238 offset:9216
    v_add_f32 v72, v72, v80
    v_mfma_f32_16x16x32_bf16 v[56:59], a[208:211], v[124:127], v[56:59]
    ds_read_b64_tr_b16 v[122:123], v238 offset:13312
    v_add_f32 v73, v73, v81
    v_mfma_f32_16x16x32_bf16 v[60:63], a[212:215], v[124:127], v[60:63]
    ds_read_b64_tr_b16 v[124:125], v239 offset:9216
    ds_read_b64_tr_b16 v[126:127], v239 offset:13312
    s_waitcnt lgkmcnt(8)
    v_mfma_f32_16x16x32_bf16 v[0:3], v[96:99], a[216:219], v[0:3]
    s_waitcnt vmcnt(12)
    ds_read_b128 a[224:227], v94 offset:32768
    v_mfma_f32_16x16x32_bf16 v[4:7], v[96:99], a[220:223], v[4:7]
    ds_read_b128 a[228:231], v94 offset:34816
    s_add_u32 m0, s40, 24576
    v_mfma_f32_16x16x32_bf16 v[148:151], v[96:99], v[212:215], v[148:151]
    s_barrier
    ds_read_b64_tr_b16 v[96:97], v236 offset:16384
    v_mfma_f32_16x16x32_bf16 v[8:11], v[100:103], a[216:219], v[8:11]
    ds_read_b64_tr_b16 v[98:99], v236 offset:20480
    buffer_load_dwordx4 v247, s[12:15], s42 offen offset:0 lds
    v_mfma_f32_16x16x32_bf16 v[12:15], v[100:103], a[220:223], v[12:15]
    ds_read_b64_tr_b16 v[100:101], v237 offset:16384
    v_readlane_b32 s42, v243, 8
    v_mfma_f32_16x16x32_bf16 v[16:19], v[104:107], a[216:219], v[16:19]
    ds_read_b64_tr_b16 v[102:103], v237 offset:20480
    buffer_load_dwordx4 v246, s[12:15], s43 offen offset:1024 lds
    v_mfma_f32_16x16x32_bf16 v[20:23], v[104:107], a[220:223], v[20:23]
    ds_read_b64_tr_b16 v[104:105], v238 offset:16384
    v_readlane_b32 s43, v243, 9
    v_mfma_f32_16x16x32_bf16 v[24:27], v[108:111], a[216:219], v[24:27]
    ds_read_b64_tr_b16 v[106:107], v238 offset:20480
    v_add_f32 v74, v74, v82
    v_mfma_f32_16x16x32_bf16 v[28:31], v[108:111], a[220:223], v[28:31]
    ds_read_b64_tr_b16 v[108:109], v239 offset:16384
    s_waitcnt lgkmcnt(9)
    v_mfma_f32_16x16x32_bf16 v[32:35], a[216:219], v[112:115], v[32:35]
    ds_read_b64_tr_b16 v[110:111], v239 offset:20480
    v_add_f32 v75, v75, v83
    v_mfma_f32_16x16x32_bf16 v[36:39], a[220:223], v[112:115], v[36:39]
    v_add_f32 v76, v76, v84
    v_add_f32 v77, v77, v85
    v_mfma_f32_16x16x32_bf16 v[152:155], v[212:215], v[112:115], v[152:155]
    ds_read_b64_tr_b16 v[112:113], v236 offset:17408
    v_add_f32 v78, v78, v86
    v_mfma_f32_16x16x32_bf16 v[40:43], a[216:219], v[116:119], v[40:43]
    ds_read_b64_tr_b16 v[114:115], v236 offset:21504
    v_add_f32 v79, v79, v87
    v_mfma_f32_16x16x32_bf16 v[44:47], a[220:223], v[116:119], v[44:47]
    ds_read_b64_tr_b16 v[116:117], v237 offset:17408
    v_add_f32 v72, v72, v76
    v_mfma_f32_16x16x32_bf16 v[48:51], a[216:219], v[120:123], v[48:51]
    ds_read_b64_tr_b16 v[118:119], v237 offset:21504
    v_add_f32 v73, v73, v77
    v_mfma_f32_16x16x32_bf16 v[52:55], a[220:223], v[120:123], v[52:55]
    ds_read_b64_tr_b16 v[120:121], v238 offset:17408
    v_add_f32 v74, v74, v78
    v_mfma_f32_16x16x32_bf16 v[56:59], a[216:219], v[124:127], v[56:59]
    ds_read_b64_tr_b16 v[122:123], v238 offset:21504
    v_add_f32 v75, v75, v79
    v_mfma_f32_16x16x32_bf16 v[60:63], a[220:223], v[124:127], v[60:63]
    ds_read_b64_tr_b16 v[124:125], v239 offset:17408
    ds_read_b64_tr_b16 v[126:127], v239 offset:21504
    s_waitcnt lgkmcnt(8)
    v_mfma_f32_16x16x32_bf16 v[0:3], v[96:99], a[224:227], v[0:3]
    ds_read_b128 a[232:235], v95 offset:32768
    s_add_u32 m0, s40, 32768
    v_mfma_f32_16x16x32_bf16 v[4:7], v[96:99], a[228:231], v[4:7]
    ds_read_b128 a[236:239], v95 offset:34816
    buffer_load_dwordx4 v247, s[12:15], s42 offen offset:0 lds
    v_mfma_f32_16x16x32_bf16 v[148:151], v[96:99], v[212:215], v[148:151]
    ds_read_b64_tr_b16 v[96:97], v236 offset:24576
    v_readlane_b32 s42, v243, 10
    v_mfma_f32_16x16x32_bf16 v[8:11], v[100:103], a[224:227], v[8:11]
    ds_read_b64_tr_b16 v[98:99], v236 offset:28672
    buffer_load_dwordx4 v246, s[12:15], s43 offen offset:1024 lds
    v_mfma_f32_16x16x32_bf16 v[12:15], v[100:103], a[228:231], v[12:15]
    ds_read_b64_tr_b16 v[100:101], v237 offset:24576
    v_readlane_b32 s43, v243, 11
    v_mfma_f32_16x16x32_bf16 v[16:19], v[104:107], a[224:227], v[16:19]
    ds_read_b64_tr_b16 v[102:103], v237 offset:28672
    v_add_f32 v72, v72, v74
    v_mfma_f32_16x16x32_bf16 v[20:23], v[104:107], a[228:231], v[20:23]
    ds_read_b64_tr_b16 v[104:105], v238 offset:24576
    v_add_f32 v73, v73, v75
    v_mfma_f32_16x16x32_bf16 v[24:27], v[108:111], a[224:227], v[24:27]
    ds_read_b64_tr_b16 v[106:107], v238 offset:28672
    v_add_f32 v72, v72, v73
    v_mfma_f32_16x16x32_bf16 v[28:31], v[108:111], a[228:231], v[28:31]
    ds_read_b64_tr_b16 v[108:109], v239 offset:24576
    s_waitcnt lgkmcnt(9)
    v_mfma_f32_16x16x32_bf16 v[32:35], a[224:227], v[112:115], v[32:35]
    ds_read_b64_tr_b16 v[110:111], v239 offset:28672
    v_add_f32_dpp v72, v72, v72 row_ror:8 row_mask:0xf bank_mask:0xf
    v_mfma_f32_16x16x32_bf16 v[36:39], a[228:231], v[112:115], v[36:39]
    s_nop 0
    v_add_f32_dpp v72, v72, v72 row_ror:4 row_mask:0xf bank_mask:0xf
    v_mfma_f32_16x16x32_bf16 v[152:155], v[212:215], v[112:115], v[152:155]
    ds_read_b64_tr_b16 v[112:113], v236 offset:25600
    v_add_f32_dpp v72, v72, v72 row_ror:2 row_mask:0xf bank_mask:0xf
    v_mfma_f32_16x16x32_bf16 v[40:43], a[224:227], v[116:119], v[40:43]
    ds_read_b64_tr_b16 v[114:115], v236 offset:29696
    v_add_f32_dpp v72, v72, v72 row_ror:1 row_mask:0xf bank_mask:0xf
    v_mfma_f32_16x16x32_bf16 v[44:47], a[228:231], v[116:119], v[44:47]
    ds_read_b64_tr_b16 v[116:117], v237 offset:25600
    v_mov_b32 v73, v72
    v_mfma_f32_16x16x32_bf16 v[48:51], a[224:227], v[120:123], v[48:51]
    ds_read_b64_tr_b16 v[118:119], v237 offset:29696
    v_permlane16_swap_b32 v72, v73
    v_mfma_f32_16x16x32_bf16 v[52:55], a[228:231], v[120:123], v[52:55]
    ds_read_b64_tr_b16 v[120:121], v238 offset:25600
    v_add_f32 v72, v72, v73
    v_mfma_f32_16x16x32_bf16 v[56:59], a[224:227], v[124:127], v[56:59]
    ds_read_b64_tr_b16 v[122:123], v238 offset:29696
    v_mov_b32 v73, v72
    v_mfma_f32_16x16x32_bf16 v[60:63], a[228:231], v[124:127], v[60:63]
    ds_read_b64_tr_b16 v[124:125], v239 offset:25600
    ds_read_b64_tr_b16 v[126:127], v239 offset:29696
    s_waitcnt lgkmcnt(8)
    v_mfma_f32_16x16x32_bf16 v[0:3], v[96:99], a[232:235], v[0:3]
    s_waitcnt vmcnt(6)
    ds_read_b128 a[240:243], v94 offset:0
    v_mfma_f32_16x16x32_bf16 v[4:7], v[96:99], a[236:239], v[4:7]
    ds_read_b128 a[244:247], v94 offset:2048
    s_add_u32 m0, s40, 40960
    v_mfma_f32_16x16x32_bf16 v[148:151], v[96:99], v[212:215], v[148:151]
    s_barrier
    ds_read_b64_tr_b16 v[96:97], v236 offset:32768
    v_mfma_f32_16x16x32_bf16 v[8:11], v[100:103], a[232:235], v[8:11]
    ds_read_b64_tr_b16 v[98:99], v236 offset:36864
    buffer_load_dwordx4 v247, s[12:15], s42 offen offset:0 lds
    v_mfma_f32_16x16x32_bf16 v[12:15], v[100:103], a[236:239], v[12:15]
    ds_read_b64_tr_b16 v[100:101], v237 offset:32768
    v_readlane_b32 s42, v243, 12
    v_mfma_f32_16x16x32_bf16 v[16:19], v[104:107], a[232:235], v[16:19]
    ds_read_b64_tr_b16 v[102:103], v237 offset:36864
    buffer_load_dwordx4 v246, s[12:15], s43 offen offset:1024 lds
    v_mfma_f32_16x16x32_bf16 v[20:23], v[104:107], a[236:239], v[20:23]
    ds_read_b64_tr_b16 v[104:105], v238 offset:32768
    v_readlane_b32 s43, v243, 13
    v_mfma_f32_16x16x32_bf16 v[24:27], v[108:111], a[232:235], v[24:27]
    ds_read_b64_tr_b16 v[106:107], v238 offset:36864
    v_permlane32_swap_b32 v72, v73
    v_mfma_f32_16x16x32_bf16 v[28:31], v[108:111], a[236:239], v[28:31]
    ds_read_b64_tr_b16 v[108:109], v239 offset:32768
    s_waitcnt lgkmcnt(9)
    v_mfma_f32_16x16x32_bf16 v[32:35], a[232:235], v[112:115], v[32:35]
    ds_read_b64_tr_b16 v[110:111], v239 offset:36864
    v_add_f32 v72, v72, v73
    v_mfma_f32_16x16x32_bf16 v[36:39], a[236:239], v[112:115], v[36:39]
    v_mul_f32 v72, 0x3a800000, v72
    v_cvt_pk_bf16_f32 v222, v72, v72
    v_mfma_f32_16x16x32_bf16 v[152:155], v[212:215], v[112:115], v[152:155]
    ds_read_b64_tr_b16 v[112:113], v236 offset:33792
    v_and_b32 v74, s47, v222
    v_mfma_f32_16x16x32_bf16 v[40:43], a[232:235], v[116:119], v[40:43]
    ds_read_b64_tr_b16 v[114:115], v236 offset:37888
    v_sub_f32 v72, v72, v74
    v_mfma_f32_16x16x32_bf16 v[44:47], a[236:239], v[116:119], v[44:47]
    ds_read_b64_tr_b16 v[116:117], v237 offset:33792
    v_cvt_pk_bf16_f32 v223, v72, v72
    v_mfma_f32_16x16x32_bf16 v[48:51], a[232:235], v[120:123], v[48:51]
    ds_read_b64_tr_b16 v[118:119], v237 offset:37888
    v_and_b32 v222, 0xffff, v222
    v_mfma_f32_16x16x32_bf16 v[52:55], a[236:239], v[120:123], v[52:55]
    ds_read_b64_tr_b16 v[120:121], v238 offset:33792
    v_lshl_or_b32 v223, v223, 16, v222
    v_mfma_f32_16x16x32_bf16 v[56:59], a[232:235], v[124:127], v[56:59]
    ds_read_b64_tr_b16 v[122:123], v238 offset:37888
    v_and_b32 v221, 1, v255
    v_mfma_f32_16x16x32_bf16 v[60:63], a[236:239], v[124:127], v[60:63]
    ds_read_b64_tr_b16 v[124:125], v239 offset:33792
    ds_read_b64_tr_b16 v[126:127], v239 offset:37888
    s_waitcnt lgkmcnt(8)
    v_mfma_f32_16x16x32_bf16 v[0:3], v[96:99], a[240:243], v[0:3]
    ds_read_b128 a[248:251], v95 offset:0
    s_add_u32 m0, s40, 49152
    v_mfma_f32_16x16x32_bf16 v[4:7], v[96:99], a[244:247], v[4:7]
    ds_read_b128 a[252:255], v95 offset:2048
    buffer_load_dwordx4 v247, s[12:15], s42 offen offset:0 lds
    v_mfma_f32_16x16x32_bf16 v[148:151], v[96:99], v[212:215], v[148:151]
    ds_read_b64_tr_b16 v[96:97], v236 offset:40960
    v_readlane_b32 s42, v243, 14
    v_mfma_f32_16x16x32_bf16 v[8:11], v[100:103], a[240:243], v[8:11]
    ds_read_b64_tr_b16 v[98:99], v236 offset:45056
    buffer_load_dwordx4 v246, s[12:15], s43 offen offset:1024 lds
    v_mfma_f32_16x16x32_bf16 v[12:15], v[100:103], a[244:247], v[12:15]
    ds_read_b64_tr_b16 v[100:101], v237 offset:40960
    v_readlane_b32 s43, v243, 15
    v_mfma_f32_16x16x32_bf16 v[16:19], v[104:107], a[240:243], v[16:19]
    ds_read_b64_tr_b16 v[102:103], v237 offset:45056
    v_lshlrev_b32 v221, 13, v221
    v_mfma_f32_16x16x32_bf16 v[20:23], v[104:107], a[244:247], v[20:23]
    ds_read_b64_tr_b16 v[104:105], v238 offset:40960
    v_and_b32 v222, 2, v255
    v_mfma_f32_16x16x32_bf16 v[24:27], v[108:111], a[240:243], v[24:27]
    ds_read_b64_tr_b16 v[106:107], v238 offset:45056
    v_add3_u32 v221, v221, v222, 0
    v_mfma_f32_16x16x32_bf16 v[28:31], v[108:111], a[244:247], v[28:31]
    ds_read_b64_tr_b16 v[108:109], v239 offset:40960
    s_waitcnt lgkmcnt(9)
    v_mfma_f32_16x16x32_bf16 v[32:35], a[240:243], v[112:115], v[32:35]
    ds_read_b64_tr_b16 v[110:111], v239 offset:45056
    v_add_u32 v221, 114688, v221
    v_mfma_f32_16x16x32_bf16 v[36:39], a[244:247], v[112:115], v[36:39]
    s_lshl_b32 s34, s2, 5
    s_add_u32 s34, s34, 0x1880000
    v_mfma_f32_16x16x32_bf16 v[152:155], v[212:215], v[112:115], v[152:155]
    ds_read_b64_tr_b16 v[112:113], v236 offset:41984
    s_add_u32 s4, s82, s34
    s_addc_u32 s5, s83, 0
    v_mfma_f32_16x16x32_bf16 v[40:43], a[240:243], v[116:119], v[40:43]
    ds_read_b64_tr_b16 v[114:115], v236 offset:46080
    s_mov_b32 s6, 0x20
    v_mfma_f32_16x16x32_bf16 v[44:47], a[244:247], v[116:119], v[44:47]
    ds_read_b64_tr_b16 v[116:117], v237 offset:41984
    s_mov_b32 s7, 0x20000
    v_mfma_f32_16x16x32_bf16 v[48:51], a[240:243], v[120:123], v[48:51]
    ds_read_b64_tr_b16 v[118:119], v237 offset:46080
    v_lshlrev_b32 v222, 2, v255
    v_mfma_f32_16x16x32_bf16 v[52:55], a[244:247], v[120:123], v[52:55]
    ds_read_b64_tr_b16 v[120:121], v238 offset:41984
    s_lshl_b32 s48, s28, 8
    v_mfma_f32_16x16x32_bf16 v[56:59], a[240:243], v[124:127], v[56:59]
    ds_read_b64_tr_b16 v[122:123], v238 offset:46080
    v_mov_b32 v180, v133
    v_mfma_f32_16x16x32_bf16 v[60:63], a[244:247], v[124:127], v[60:63]
    ds_read_b64_tr_b16 v[124:125], v239 offset:41984
    ds_read_b64_tr_b16 v[126:127], v239 offset:46080
    s_waitcnt lgkmcnt(8)
    v_mfma_f32_16x16x32_bf16 v[0:3], v[96:99], a[248:251], v[0:3]
    s_add_u32 m0, s40, 57344
    v_mov_b32 v181, v135
    v_mfma_f32_16x16x32_bf16 v[4:7], v[96:99], a[252:255], v[4:7]
    buffer_load_dwordx4 v247, s[12:15], s42 offen offset:0 lds
    v_readlane_b32 s42, v243, 16
    v_mfma_f32_16x16x32_bf16 v[148:151], v[96:99], v[212:215], v[148:151]
    s_barrier
    ds_read_b64_tr_b16 v[96:97], v232 offset:0
    v_mfma_f32_16x16x32_bf16 v[8:11], v[100:103], a[248:251], v[8:11]
    ds_read_b64_tr_b16 v[98:99], v232 offset:4096
    buffer_load_dwordx4 v246, s[12:15], s43 offen offset:1024 lds
    v_mfma_f32_16x16x32_bf16 v[12:15], v[100:103], a[252:255], v[12:15]
    ds_read_b64_tr_b16 v[100:101], v233 offset:0
    v_readlane_b32 s43, v243, 17
    v_mfma_f32_16x16x32_bf16 v[16:19], v[104:107], a[248:251], v[16:19]
    ds_read_b64_tr_b16 v[102:103], v233 offset:4096
    v_mov_b32 v182, v137
    v_mfma_f32_16x16x32_bf16 v[20:23], v[104:107], a[252:255], v[20:23]
    ds_read_b64_tr_b16 v[104:105], v234 offset:0
    v_mov_b32 v183, v139
    v_mfma_f32_16x16x32_bf16 v[24:27], v[108:111], a[248:251], v[24:27]
    ds_read_b64_tr_b16 v[106:107], v234 offset:4096
    v_mov_b32 v184, v141
    v_mfma_f32_16x16x32_bf16 v[28:31], v[108:111], a[252:255], v[28:31]
    ds_read_b64_tr_b16 v[108:109], v235 offset:0
    s_waitcnt lgkmcnt(7)
    v_mfma_f32_16x16x32_bf16 v[32:35], a[248:251], v[112:115], v[32:35]
    ds_read_b64_tr_b16 v[110:111], v235 offset:4096
    v_mov_b32 v185, v143
    v_mfma_f32_16x16x32_bf16 v[36:39], a[252:255], v[112:115], v[36:39]
    v_mov_b32 v186, v145
    v_mov_b32 v187, v147
    v_mfma_f32_16x16x32_bf16 v[152:155], v[212:215], v[112:115], v[152:155]
    v_mov_b32 v133, v134
    v_mov_b32 v134, v136
    v_mfma_f32_16x16x32_bf16 v[40:43], a[248:251], v[116:119], v[40:43]
    v_mov_b32 v135, v138
    v_mov_b32 v136, v140
    v_mfma_f32_16x16x32_bf16 v[44:47], a[252:255], v[116:119], v[44:47]
    v_mov_b32 v137, v142
    v_mov_b32 v138, v144
    v_mfma_f32_16x16x32_bf16 v[48:51], a[248:251], v[120:123], v[48:51]
    v_mov_b32 v139, v146
    s_lshr_b32 s44, s28, 1
    v_mfma_f32_16x16x32_bf16 v[52:55], a[252:255], v[120:123], v[52:55]
    s_lshl_b32 s44, s44, 12
    s_sub_u32 s46, 4096, s44
    v_mfma_f32_16x16x32_bf16 v[56:59], a[248:251], v[124:127], v[56:59]
    s_and_b32 s84, s28, 1
    s_lshl_b32 s84, s84, 10
    v_mfma_f32_16x16x32_bf16 v[60:63], a[252:255], v[124:127], v[60:63]
    s_sub_u32 s85, 1024, s84
    v_lshrrev_b32 v216, 4, v255
    v_lshlrev_b32 v216, 4, v216
    v_add_u32 v216, s41, v216
    v_and_b32 v217, 15, v255
    v_lshlrev_b32 v217, 2, v217
    v_add_u32 v217, s41, v217
    s_waitcnt lgkmcnt(4)
    v_mfma_f32_16x16x32_bf16 v[64:67], v[96:99], a[0:3], 0
    ds_read_b64_tr_b16 v[112:113], v232 offset:1024
    v_add_u32 v236, 98304, v232
    v_mfma_f32_16x16x32_bf16 v[68:71], v[96:99], a[4:7], 0
    ds_read_b64_tr_b16 v[114:115], v232 offset:5120
    v_add_u32 v237, 98304, v233
    v_mfma_f32_16x16x32_bf16 v[156:159], v[96:99], v[212:215], 0
    ds_read_b64_tr_b16 v[116:117], v233 offset:1024
    v_add_u32 v238, 98304, v234
    v_mfma_f32_16x16x32_bf16 v[72:75], v[100:103], a[0:3], 0
    ds_read_b64_tr_b16 v[118:119], v233 offset:5120
    v_add_u32 v239, 98304, v235
    v_mfma_f32_16x16x32_bf16 v[76:79], v[100:103], a[4:7], 0
    ds_read_b64_tr_b16 v[120:121], v234 offset:1024
    s_waitcnt lgkmcnt(5)
    v_mfma_f32_16x16x32_bf16 v[80:83], v[104:107], a[0:3], 0
    ds_read_b64_tr_b16 v[122:123], v234 offset:5120
    ds_write_b128 v216, v[148:151]
    v_mfma_f32_16x16x32_bf16 v[84:87], v[104:107], a[4:7], 0
    ds_read_b64_tr_b16 v[124:125], v235 offset:1024
    ds_write_b32 v217, v152 offset:64
    v_mfma_f32_16x16x32_bf16 v[88:91], v[108:111], a[0:3], 0
    ds_read_b64_tr_b16 v[126:127], v235 offset:5120
    ds_write_b32 v217, v223 offset:128
    v_mfma_f32_16x16x32_bf16 v[92:95], v[108:111], a[4:7], 0
    s_waitcnt lgkmcnt(0)
    s_barrier
    v_xor_b32 v218, 0, v216
    ds_read_b128 v[160:163], v218
    v_xor_b32 v219, 0, v217
    ds_read_b32 v176, v219 offset:64
    v_xor_b32 v218, 4096, v216
    ds_read_b128 v[164:167], v218
    v_xor_b32 v219, 4096, v217
    ds_read_b32 v177, v219 offset:64
    v_xor_b32 v218, 8192, v216
    ds_read_b128 v[168:171], v218
    v_xor_b32 v219, 8192, v217
    ds_read_b32 v178, v219 offset:64
    v_xor_b32 v218, 12288, v216
    ds_read_b128 v[172:175], v218
    v_xor_b32 v219, 12288, v217
    ds_read_b32 v179, v219 offset:64
    ds_read_u16 v218, v221 offset:128
    ds_read_u16 v219, v221 offset:4224
    v_pk_mul_f32 v[0:1], v[0:1], v[128:129] op_sel:[0,1] op_sel_hi:[1,1]
    v_pk_mul_f32 v[2:3], v[2:3], v[128:129] op_sel:[0,1] op_sel_hi:[1,1]
    v_pk_mul_f32 v[4:5], v[4:5], v[130:131] op_sel:[0,1] op_sel_hi:[1,1]
    v_pk_mul_f32 v[6:7], v[6:7], v[130:131] op_sel:[0,1] op_sel_hi:[1,1]
    v_pk_mul_f32 v[8:9], v[8:9], v[128:129] op_sel:[0,1] op_sel_hi:[1,1]
    v_pk_mul_f32 v[10:11], v[10:11], v[128:129] op_sel:[0,1] op_sel_hi:[1,1]
    v_pk_mul_f32 v[12:13], v[12:13], v[130:131] op_sel:[0,1] op_sel_hi:[1,1]
    v_pk_mul_f32 v[14:15], v[14:15], v[130:131] op_sel:[0,1] op_sel_hi:[1,1]
    v_pk_mul_f32 v[16:17], v[16:17], v[128:129] op_sel:[0,1] op_sel_hi:[1,1]
    v_pk_mul_f32 v[18:19], v[18:19], v[128:129] op_sel:[0,1] op_sel_hi:[1,1]
    v_pk_mul_f32 v[20:21], v[20:21], v[130:131] op_sel:[0,1] op_sel_hi:[1,1]
    v_pk_mul_f32 v[22:23], v[22:23], v[130:131] op_sel:[0,1] op_sel_hi:[1,1]
    v_pk_mul_f32 v[24:25], v[24:25], v[128:129] op_sel:[0,1] op_sel_hi:[1,1]
    v_pk_mul_f32 v[26:27], v[26:27], v[128:129] op_sel:[0,1] op_sel_hi:[1,1]
    v_pk_mul_f32 v[28:29], v[28:29], v[130:131] op_sel:[0,1] op_sel_hi:[1,1]
    v_pk_mul_f32 v[30:31], v[30:31], v[130:131] op_sel:[0,1] op_sel_hi:[1,1]
    v_pk_mul_f32 v[32:33], v[32:33], v[180:181]
    v_pk_mul_f32 v[34:35], v[34:35], v[182:183]
    v_pk_mul_f32 v[36:37], v[36:37], v[184:185]
    v_pk_mul_f32 v[38:39], v[38:39], v[186:187]
    v_pk_mul_f32 v[40:41], v[40:41], v[180:181]
    v_pk_mul_f32 v[42:43], v[42:43], v[182:183]
    v_pk_mul_f32 v[44:45], v[44:45], v[184:185]
    v_pk_mul_f32 v[46:47], v[46:47], v[186:187]
    v_pk_mul_f32 v[48:49], v[48:49], v[180:181]
    v_pk_mul_f32 v[50:51], v[50:51], v[182:183]
    v_pk_mul_f32 v[52:53], v[52:53], v[184:185]
    v_pk_mul_f32 v[54:55], v[54:55], v[186:187]
    v_pk_mul_f32 v[56:57], v[56:57], v[180:181]
    v_pk_mul_f32 v[58:59], v[58:59], v[182:183]
    v_pk_mul_f32 v[60:61], v[60:61], v[184:185]
    v_pk_mul_f32 v[62:63], v[62:63], v[186:187]
    s_waitcnt lgkmcnt(9)
    v_pk_fma_f32 v[0:1], v[160:161], v[128:129], v[0:1] op_sel_hi:[1,0,1]
    v_pk_fma_f32 v[2:3], v[162:163], v[128:129], v[2:3] op_sel_hi:[1,0,1]
    s_waitcnt lgkmcnt(7)
    v_pk_fma_f32 v[8:9], v[164:165], v[128:129], v[8:9] op_sel_hi:[1,0,1]
    v_pk_fma_f32 v[10:11], v[166:167], v[128:129], v[10:11] op_sel_hi:[1,0,1]
    v_cvt_pk_bf16_f32 v0, v0, v1
    v_cvt_pk_bf16_f32 v1, v2, v3
    v_cvt_pk_bf16_f32 v2, v8, v9
    v_cvt_pk_bf16_f32 v3, v10, v11
    s_mov_b64 exec, s[96:97]
    v_swap_b32 v0, v2
    v_swap_b32 v1, v3
    s_mov_b64 exec, -1
    buffer_store_dwordx4 v[0:3], v254, s[16:19], s44 offen offset:0 sc1
    v_pk_fma_f32 v[4:5], v[160:161], v[130:131], v[4:5] op_sel_hi:[1,0,1]
    v_pk_fma_f32 v[6:7], v[162:163], v[130:131], v[6:7] op_sel_hi:[1,0,1]
    v_pk_fma_f32 v[12:13], v[164:165], v[130:131], v[12:13] op_sel_hi:[1,0,1]
    v_pk_fma_f32 v[14:15], v[166:167], v[130:131], v[14:15] op_sel_hi:[1,0,1]
    v_cvt_pk_bf16_f32 v4, v4, v5
    v_cvt_pk_bf16_f32 v5, v6, v7
    v_cvt_pk_bf16_f32 v6, v12, v13
    v_cvt_pk_bf16_f32 v7, v14, v15
    s_mov_b64 exec, s[96:97]
    v_swap_b32 v4, v6
    v_swap_b32 v5, v7
    s_mov_b64 exec, -1
    buffer_store_dwordx4 v[4:7], v254, s[16:19], s44 offen offset:1024 sc1
    s_waitcnt lgkmcnt(5)
    v_pk_fma_f32 v[16:17], v[168:169], v[128:129], v[16:17] op_sel_hi:[1,0,1]
    v_pk_fma_f32 v[18:19], v[170:171], v[128:129], v[18:19] op_sel_hi:[1,0,1]
    s_waitcnt lgkmcnt(3)
    v_pk_fma_f32 v[24:25], v[172:173], v[128:129], v[24:25] op_sel_hi:[1,0,1]
    v_pk_fma_f32 v[26:27], v[174:175], v[128:129], v[26:27] op_sel_hi:[1,0,1]
    v_cvt_pk_bf16_f32 v16, v16, v17
    v_cvt_pk_bf16_f32 v17, v18, v19
    v_cvt_pk_bf16_f32 v18, v24, v25
    v_cvt_pk_bf16_f32 v19, v26, v27
    s_mov_b64 exec, s[96:97]
    v_swap_b32 v16, v18
    v_swap_b32 v17, v19
    s_mov_b64 exec, -1
    buffer_store_dwordx4 v[16:19], v254, s[16:19], s46 offen offset:0 sc1
    v_pk_fma_f32 v[20:21], v[168:169], v[130:131], v[20:21] op_sel_hi:[1,0,1]
    v_pk_fma_f32 v[22:23], v[170:171], v[130:131], v[22:23] op_sel_hi:[1,0,1]
    v_pk_fma_f32 v[28:29], v[172:173], v[130:131], v[28:29] op_sel_hi:[1,0,1]
    v_pk_fma_f32 v[30:31], v[174:175], v[130:131], v[30:31] op_sel_hi:[1,0,1]
    v_cvt_pk_bf16_f32 v20, v20, v21
    v_cvt_pk_bf16_f32 v21, v22, v23
    v_cvt_pk_bf16_f32 v22, v28, v29
    v_cvt_pk_bf16_f32 v23, v30, v31
    s_mov_b64 exec, s[96:97]
    v_swap_b32 v20, v22
    v_swap_b32 v21, v23
    s_mov_b64 exec, -1
    buffer_store_dwordx4 v[20:23], v254, s[16:19], s46 offen offset:1024 sc1
    v_pk_fma_f32 v[32:33], v[132:133], v[176:177], v[32:33] op_sel:[0,0,0] op_sel_hi:[1,0,1]
    v_pk_fma_f32 v[34:35], v[134:135], v[176:177], v[34:35] op_sel:[0,0,0] op_sel_hi:[1,0,1]
    v_pk_fma_f32 v[36:37], v[136:137], v[176:177], v[36:37] op_sel:[0,0,0] op_sel_hi:[1,0,1]
    v_pk_fma_f32 v[38:39], v[138:139], v[176:177], v[38:39] op_sel:[0,0,0] op_sel_hi:[1,0,1]
    v_cvt_pk_bf16_f32 v32, v32, v33
    v_cvt_pk_bf16_f32 v33, v34, v35
    v_cvt_pk_bf16_f32 v34, v36, v37
    v_cvt_pk_bf16_f32 v35, v38, v39
    s_add_u32 s3, s44, s84
    buffer_store_dwordx4 v[32:35], v254, s[16:19], s3 offen offset:2048 sc1
    v_pk_fma_f32 v[40:41], v[132:133], v[176:177], v[40:41] op_sel:[0,1,0] op_sel_hi:[1,1,1]
    v_pk_fma_f32 v[42:43], v[134:135], v[176:177], v[42:43] op_sel:[0,1,0] op_sel_hi:[1,1,1]
    v_pk_fma_f32 v[44:45], v[136:137], v[176:177], v[44:45] op_sel:[0,1,0] op_sel_hi:[1,1,1]
    v_pk_fma_f32 v[46:47], v[138:139], v[176:177], v[46:47] op_sel:[0,1,0] op_sel_hi:[1,1,1]
    v_cvt_pk_bf16_f32 v40, v40, v41
    v_cvt_pk_bf16_f32 v41, v42, v43
    v_cvt_pk_bf16_f32 v42, v44, v45
    v_cvt_pk_bf16_f32 v43, v46, v47
    s_add_u32 s3, s44, s85
    buffer_store_dwordx4 v[40:43], v254, s[16:19], s3 offen offset:2048 sc1
    s_waitcnt lgkmcnt(2)
    v_pk_fma_f32 v[48:49], v[132:133], v[178:179], v[48:49] op_sel:[0,0,0] op_sel_hi:[1,0,1]
    v_pk_fma_f32 v[50:51], v[134:135], v[178:179], v[50:51] op_sel:[0,0,0] op_sel_hi:[1,0,1]
    v_pk_fma_f32 v[52:53], v[136:137], v[178:179], v[52:53] op_sel:[0,0,0] op_sel_hi:[1,0,1]
    v_pk_fma_f32 v[54:55], v[138:139], v[178:179], v[54:55] op_sel:[0,0,0] op_sel_hi:[1,0,1]
    v_cvt_pk_bf16_f32 v48, v48, v49
    v_cvt_pk_bf16_f32 v49, v50, v51
    v_cvt_pk_bf16_f32 v50, v52, v53
    v_cvt_pk_bf16_f32 v51, v54, v55
    s_add_u32 s3, s46, s84
    buffer_store_dwordx4 v[48:51], v254, s[16:19], s3 offen offset:2048 sc1
    v_pk_fma_f32 v[56:57], v[132:133], v[178:179], v[56:57] op_sel:[0,1,0] op_sel_hi:[1,1,1]
    v_pk_fma_f32 v[58:59], v[134:135], v[178:179], v[58:59] op_sel:[0,1,0] op_sel_hi:[1,1,1]
    v_pk_fma_f32 v[60:61], v[136:137], v[178:179], v[60:61] op_sel:[0,1,0] op_sel_hi:[1,1,1]
    v_pk_fma_f32 v[62:63], v[138:139], v[178:179], v[62:63] op_sel:[0,1,0] op_sel_hi:[1,1,1]
    v_cvt_pk_bf16_f32 v56, v56, v57
    v_cvt_pk_bf16_f32 v57, v58, v59
    v_cvt_pk_bf16_f32 v58, v60, v61
    v_cvt_pk_bf16_f32 v59, v62, v63
    s_add_u32 s3, s46, s85
    buffer_store_dwordx4 v[56:59], v254, s[16:19], s3 offen offset:2048 sc1
    s_waitcnt lgkmcnt(0)
    v_lshl_or_b32 v218, v219, 16, v218
    buffer_store_dword v218, v222, s[4:7], s48 offen sc1
    v_mul_f32 v128, 0x3e8293ee, v128
    v_mul_f32 v129, 0x3e8293ee, v129
    v_mul_f32 v130, 0x3e8293ee, v130
    v_mul_f32 v131, 0x3e8293ee, v131
    v_mfma_f32_16x16x32_bf16 v[64:67], v[112:115], a[8:11], v[64:67]
    ds_read_b64_tr_b16 v[96:97], v232 offset:8192
    v_mfma_f32_16x16x32_bf16 v[68:71], v[112:115], a[12:15], v[68:71]
    ds_read_b64_tr_b16 v[98:99], v232 offset:12288
    v_mfma_f32_16x16x32_bf16 v[156:159], v[112:115], v[212:215], v[156:159]
    ds_read_b64_tr_b16 v[100:101], v233 offset:8192
    v_mfma_f32_16x16x32_bf16 v[72:75], v[116:119], a[8:11], v[72:75]
    ds_read_b64_tr_b16 v[102:103], v233 offset:12288
    v_mfma_f32_16x16x32_bf16 v[76:79], v[116:119], a[12:15], v[76:79]
    ds_read_b64_tr_b16 v[104:105], v234 offset:8192
    v_mfma_f32_16x16x32_bf16 v[80:83], v[120:123], a[8:11], v[80:83]
    ds_read_b64_tr_b16 v[106:107], v234 offset:12288
    v_mfma_f32_16x16x32_bf16 v[84:87], v[120:123], a[12:15], v[84:87]
    ds_read_b64_tr_b16 v[108:109], v235 offset:8192
    v_mfma_f32_16x16x32_bf16 v[88:91], v[124:127], a[8:11], v[88:91]
    ds_read_b64_tr_b16 v[110:111], v235 offset:12288
    v_mfma_f32_16x16x32_bf16 v[92:95], v[124:127], a[12:15], v[92:95]
    s_waitcnt lgkmcnt(4)
    v_mfma_f32_16x16x32_bf16 v[64:67], v[96:99], a[16:19], v[64:67]
    ds_read_b64_tr_b16 v[112:113], v232 offset:9216
    v_mfma_f32_16x16x32_bf16 v[68:71], v[96:99], a[20:23], v[68:71]
    ds_read_b64_tr_b16 v[114:115], v232 offset:13312
    v_mfma_f32_16x16x32_bf16 v[156:159], v[96:99], v[212:215], v[156:159]
    ds_read_b64_tr_b16 v[116:117], v233 offset:9216
    v_mfma_f32_16x16x32_bf16 v[72:75], v[100:103], a[16:19], v[72:75]
    ds_read_b64_tr_b16 v[118:119], v233 offset:13312
    v_mfma_f32_16x16x32_bf16 v[76:79], v[100:103], a[20:23], v[76:79]
    ds_read_b64_tr_b16 v[120:121], v234 offset:9216
    s_waitcnt lgkmcnt(5)
    v_mfma_f32_16x16x32_bf16 v[80:83], v[104:107], a[16:19], v[80:83]
    ds_read_b64_tr_b16 v[122:123], v234 offset:13312
    v_mfma_f32_16x16x32_bf16 v[84:87], v[104:107], a[20:23], v[84:87]
    ds_read_b64_tr_b16 v[124:125], v235 offset:9216
    v_mfma_f32_16x16x32_bf16 v[88:91], v[108:111], a[16:19], v[88:91]
    ds_read_b64_tr_b16 v[126:127], v235 offset:13312
    v_mfma_f32_16x16x32_bf16 v[92:95], v[108:111], a[20:23], v[92:95]
    s_waitcnt lgkmcnt(4)
    v_mfma_f32_16x16x32_bf16 v[64:67], v[112:115], a[24:27], v[64:67]
    s_waitcnt vmcnt(17)
    s_barrier
    ds_read_b64_tr_b16 v[96:97], v232 offset:16384
    v_mfma_f32_16x16x32_bf16 v[68:71], v[112:115], a[28:31], v[68:71]
    ds_read_b64_tr_b16 v[98:99], v232 offset:20480
    v_mfma_f32_16x16x32_bf16 v[156:159], v[112:115], v[212:215], v[156:159]
    ds_read_b64_tr_b16 v[100:101], v233 offset:16384
    v_mfma_f32_16x16x32_bf16 v[72:75], v[116:119], a[24:27], v[72:75]
    ds_read_b64_tr_b16 v[102:103], v233 offset:20480
    v_mfma_f32_16x16x32_bf16 v[76:79], v[116:119], a[28:31], v[76:79]
    ds_read_b64_tr_b16 v[104:105], v234 offset:16384
    s_waitcnt lgkmcnt(5)
    v_mfma_f32_16x16x32_bf16 v[80:83], v[120:123], a[24:27], v[80:83]
    ds_read_b64_tr_b16 v[106:107], v234 offset:20480
    v_mfma_f32_16x16x32_bf16 v[84:87], v[120:123], a[28:31], v[84:87]
    ds_read_b64_tr_b16 v[108:109], v235 offset:16384
    v_mfma_f32_16x16x32_bf16 v[88:91], v[124:127], a[24:27], v[88:91]
    ds_read_b64_tr_b16 v[110:111], v235 offset:20480
    v_mfma_f32_16x16x32_bf16 v[92:95], v[124:127], a[28:31], v[92:95]
    s_waitcnt lgkmcnt(4)
    v_mfma_f32_16x16x32_bf16 v[64:67], v[96:99], a[32:35], v[64:67]
    ds_read_b64_tr_b16 v[112:113], v232 offset:17408
    s_add_u32 m0, s40, 98304
    v_mfma_f32_16x16x32_bf16 v[68:71], v[96:99], a[36:39], v[68:71]
    ds_read_b64_tr_b16 v[114:115], v232 offset:21504
    buffer_load_dwordx4 v247, s[12:15], s42 offen offset:0 lds
    v_mfma_f32_16x16x32_bf16 v[156:159], v[96:99], v[212:215], v[156:159]
    ds_read_b64_tr_b16 v[116:117], v233 offset:17408
    v_readlane_b32 s42, v243, 18
    v_mfma_f32_16x16x32_bf16 v[72:75], v[100:103], a[32:35], v[72:75]
    ds_read_b64_tr_b16 v[118:119], v233 offset:21504
    s_lshl_b32 s34, s29, 2
    v_mfma_f32_16x16x32_bf16 v[76:79], v[100:103], a[36:39], v[76:79]
    ds_read_b64_tr_b16 v[120:121], v234 offset:17408
    s_waitcnt lgkmcnt(5)
    v_mfma_f32_16x16x32_bf16 v[80:83], v[104:107], a[32:35], v[80:83]
    ds_read_b64_tr_b16 v[122:123], v234 offset:21504
    s_add_u32 s34, s34, s28
    v_mfma_f32_16x16x32_bf16 v[84:87], v[104:107], a[36:39], v[84:87]
    ds_read_b64_tr_b16 v[124:125], v235 offset:17408
    s_cmp_ge_u32 s34, 8
    s_cselect_b32 s35, 0, 0xf149f2ca
    v_mfma_f32_16x16x32_bf16 v[88:91], v[108:111], a[32:35], v[88:91]
    ds_read_b64_tr_b16 v[126:127], v235 offset:21504
    v_mov_b32 v160, s35
    v_mfma_f32_16x16x32_bf16 v[92:95], v[108:111], a[36:39], v[92:95]
    v_mov_b32 v161, s35
    s_waitcnt lgkmcnt(4)
    v_mfma_f32_16x16x32_bf16 v[64:67], v[112:115], a[40:43], v[64:67]
    ds_read_b64_tr_b16 v[96:97], v232 offset:24576
    buffer_load_dwordx4 v246, s[12:15], s43 offen offset:1024 lds
    v_mfma_f32_16x16x32_bf16 v[68:71], v[112:115], a[44:47], v[68:71]
    ds_read_b64_tr_b16 v[98:99], v232 offset:28672
    v_readlane_b32 s43, v243, 19
    v_mfma_f32_16x16x32_bf16 v[156:159], v[112:115], v[212:215], v[156:159]
    ds_read_b64_tr_b16 v[100:101], v233 offset:24576
    v_mov_b32 v162, s35
    v_mfma_f32_16x16x32_bf16 v[72:75], v[116:119], a[40:43], v[72:75]
    ds_read_b64_tr_b16 v[102:103], v233 offset:28672
    v_mov_b32 v163, s35
    v_mfma_f32_16x16x32_bf16 v[76:79], v[116:119], a[44:47], v[76:79]
    ds_read_b64_tr_b16 v[104:105], v234 offset:24576
    s_waitcnt lgkmcnt(5)
    v_mfma_f32_16x16x32_bf16 v[80:83], v[120:123], a[40:43], v[80:83]
    ds_read_b64_tr_b16 v[106:107], v234 offset:28672
    s_cmp_ge_u32 s34, 7
    s_cselect_b32 s35, 0, 0xf149f2ca
    v_mfma_f32_16x16x32_bf16 v[84:87], v[120:123], a[44:47], v[84:87]
    ds_read_b64_tr_b16 v[108:109], v235 offset:24576
    v_mov_b32 v164, s35
    v_mfma_f32_16x16x32_bf16 v[88:91], v[124:127], a[40:43], v[88:91]
    ds_read_b64_tr_b16 v[110:111], v235 offset:28672
    v_mov_b32 v165, s35
    v_mfma_f32_16x16x32_bf16 v[92:95], v[124:127], a[44:47], v[92:95]
    v_mov_b32 v166, s35
    s_waitcnt lgkmcnt(4)
    v_mfma_f32_16x16x32_bf16 v[64:67], v[96:99], a[48:51], v[64:67]
    ds_read_b64_tr_b16 v[112:113], v232 offset:25600
    s_add_u32 m0, s40, 106496
    v_mfma_f32_16x16x32_bf16 v[68:71], v[96:99], a[52:55], v[68:71]
    ds_read_b64_tr_b16 v[114:115], v232 offset:29696
    buffer_load_dwordx4 v247, s[12:15], s42 offen offset:0 lds
    v_mfma_f32_16x16x32_bf16 v[156:159], v[96:99], v[212:215], v[156:159]
    ds_read_b64_tr_b16 v[116:117], v233 offset:25600
    v_readlane_b32 s42, v243, 20
    v_mfma_f32_16x16x32_bf16 v[72:75], v[100:103], a[48:51], v[72:75]
    ds_read_b64_tr_b16 v[118:119], v233 offset:29696
    v_mov_b32 v167, s35
    v_mfma_f32_16x16x32_bf16 v[76:79], v[100:103], a[52:55], v[76:79]
    ds_read_b64_tr_b16 v[120:121], v234 offset:25600
    s_waitcnt lgkmcnt(5)
    v_mfma_f32_16x16x32_bf16 v[80:83], v[104:107], a[48:51], v[80:83]
    ds_read_b64_tr_b16 v[122:123], v234 offset:29696
    s_cmp_ge_u32 s34, 6
    s_cselect_b32 s35, 0, 0xf149f2ca
    v_mfma_f32_16x16x32_bf16 v[84:87], v[104:107], a[52:55], v[84:87]
    ds_read_b64_tr_b16 v[124:125], v235 offset:25600
    v_mov_b32 v168, s35
    v_mfma_f32_16x16x32_bf16 v[88:91], v[108:111], a[48:51], v[88:91]
    ds_read_b64_tr_b16 v[126:127], v235 offset:29696
    v_mov_b32 v169, s35
    v_mfma_f32_16x16x32_bf16 v[92:95], v[108:111], a[52:55], v[92:95]
    v_mov_b32 v170, s35
    s_waitcnt lgkmcnt(4)
    v_mfma_f32_16x16x32_bf16 v[64:67], v[112:115], a[56:59], v[64:67]
    s_waitcnt vmcnt(16)
    s_barrier
    ds_read_b64_tr_b16 v[96:97], v232 offset:32768
    v_mfma_f32_16x16x32_bf16 v[68:71], v[112:115], a[60:63], v[68:71]
    ds_read_b64_tr_b16 v[98:99], v232 offset:36864
    buffer_load_dwordx4 v246, s[12:15], s43 offen offset:1024 lds
    v_mfma_f32_16x16x32_bf16 v[156:159], v[112:115], v[212:215], v[156:159]
    ds_read_b64_tr_b16 v[100:101], v233 offset:32768
    v_readlane_b32 s43, v243, 21
    v_mfma_f32_16x16x32_bf16 v[72:75], v[116:119], a[56:59], v[72:75]
    ds_read_b64_tr_b16 v[102:103], v233 offset:36864
    v_mov_b32 v171, s35
    v_mfma_f32_16x16x32_bf16 v[76:79], v[116:119], a[60:63], v[76:79]
    ds_read_b64_tr_b16 v[104:105], v234 offset:32768
    s_waitcnt lgkmcnt(5)
    v_mfma_f32_16x16x32_bf16 v[80:83], v[120:123], a[56:59], v[80:83]
    ds_read_b64_tr_b16 v[106:107], v234 offset:36864
    s_cmp_ge_u32 s34, 5
    s_cselect_b32 s35, 0, 0xf149f2ca
    v_mfma_f32_16x16x32_bf16 v[84:87], v[120:123], a[60:63], v[84:87]
    ds_read_b64_tr_b16 v[108:109], v235 offset:32768
    v_mov_b32 v172, s35
    v_mfma_f32_16x16x32_bf16 v[88:91], v[124:127], a[56:59], v[88:91]
    ds_read_b64_tr_b16 v[110:111], v235 offset:36864
    v_mov_b32 v173, s35
    v_mfma_f32_16x16x32_bf16 v[92:95], v[124:127], a[60:63], v[92:95]
    v_mov_b32 v174, s35
    s_waitcnt lgkmcnt(4)
    v_mfma_f32_16x16x32_bf16 v[64:67], v[96:99], a[64:67], v[64:67]
    ds_read_b64_tr_b16 v[112:113], v232 offset:33792
    s_add_u32 m0, s40, 114688
    v_mfma_f32_16x16x32_bf16 v[68:71], v[96:99], a[68:71], v[68:71]
    ds_read_b64_tr_b16 v[114:115], v232 offset:37888
    buffer_load_dwordx4 v247, s[12:15], s42 offen offset:0 lds
    v_mfma_f32_16x16x32_bf16 v[156:159], v[96:99], v[212:215], v[156:159]
    ds_read_b64_tr_b16 v[116:117], v233 offset:33792
    v_readlane_b32 s42, v243, 22
    v_mfma_f32_16x16x32_bf16 v[72:75], v[100:103], a[64:67], v[72:75]
    ds_read_b64_tr_b16 v[118:119], v233 offset:37888
    v_mov_b32 v175, s35
    v_mfma_f32_16x16x32_bf16 v[76:79], v[100:103], a[68:71], v[76:79]
    ds_read_b64_tr_b16 v[120:121], v234 offset:33792
    s_waitcnt lgkmcnt(5)
    v_mfma_f32_16x16x32_bf16 v[80:83], v[104:107], a[64:67], v[80:83]
    ds_read_b64_tr_b16 v[122:123], v234 offset:37888
    s_cmp_ge_u32 s34, 4
    s_cselect_b32 s35, 0, 0xf149f2ca
    v_mfma_f32_16x16x32_bf16 v[84:87], v[104:107], a[68:71], v[84:87]
    ds_read_b64_tr_b16 v[124:125], v235 offset:33792
    v_mov_b32 v176, s35
    v_mfma_f32_16x16x32_bf16 v[88:91], v[108:111], a[64:67], v[88:91]
    ds_read_b64_tr_b16 v[126:127], v235 offset:37888
    v_mov_b32 v177, s35
    v_mfma_f32_16x16x32_bf16 v[92:95], v[108:111], a[68:71], v[92:95]
    v_mov_b32 v178, s35
    s_waitcnt lgkmcnt(4)
    v_mfma_f32_16x16x32_bf16 v[64:67], v[112:115], a[72:75], v[64:67]
    ds_read_b64_tr_b16 v[96:97], v232 offset:40960
    buffer_load_dwordx4 v246, s[12:15], s43 offen offset:1024 lds
    v_mfma_f32_16x16x32_bf16 v[68:71], v[112:115], a[76:79], v[68:71]
    ds_read_b64_tr_b16 v[98:99], v232 offset:45056
    v_readlane_b32 s43, v243, 23
    v_mfma_f32_16x16x32_bf16 v[156:159], v[112:115], v[212:215], v[156:159]
    ds_read_b64_tr_b16 v[100:101], v233 offset:40960
    v_mov_b32 v179, s35
    v_mfma_f32_16x16x32_bf16 v[72:75], v[116:119], a[72:75], v[72:75]
    ds_read_b64_tr_b16 v[102:103], v233 offset:45056
    s_cmp_ge_u32 s34, 3
    s_cselect_b32 s35, 0, 0xf149f2ca
    v_mfma_f32_16x16x32_bf16 v[76:79], v[116:119], a[76:79], v[76:79]
    ds_read_b64_tr_b16 v[104:105], v234 offset:40960
    s_waitcnt lgkmcnt(5)
    v_mfma_f32_16x16x32_bf16 v[80:83], v[120:123], a[72:75], v[80:83]
    ds_read_b64_tr_b16 v[106:107], v234 offset:45056
    v_mov_b32 v180, s35
    v_mfma_f32_16x16x32_bf16 v[84:87], v[120:123], a[76:79], v[84:87]
    ds_read_b64_tr_b16 v[108:109], v235 offset:40960
    v_mov_b32 v181, s35
    v_mfma_f32_16x16x32_bf16 v[88:91], v[124:127], a[72:75], v[88:91]
    ds_read_b64_tr_b16 v[110:111], v235 offset:45056
    v_mov_b32 v182, s35
    v_mfma_f32_16x16x32_bf16 v[92:95], v[124:127], a[76:79], v[92:95]
    v_mov_b32 v183, s35
    s_waitcnt lgkmcnt(4)
    v_mfma_f32_16x16x32_bf16 v[64:67], v[96:99], a[80:83], v[64:67]
    ds_read_b64_tr_b16 v[112:113], v232 offset:41984
    s_add_u32 m0, s40, 122880
    v_mfma_f32_16x16x32_bf16 v[68:71], v[96:99], a[84:87], v[68:71]
    ds_read_b64_tr_b16 v[114:115], v232 offset:46080
    buffer_load_dwordx4 v247, s[12:15], s42 offen offset:0 lds
    v_mfma_f32_16x16x32_bf16 v[156:159], v[96:99], v[212:215], v[156:159]
    ds_read_b64_tr_b16 v[116:117], v233 offset:41984
    v_readlane_b32 s42, v243, 24
    v_mfma_f32_16x16x32_bf16 v[72:75], v[100:103], a[80:83], v[72:75]
    ds_read_b64_tr_b16 v[118:119], v233 offset:46080
    s_cmp_ge_u32 s34, 2
    s_cselect_b32 s35, 0, 0xf149f2ca
    v_mfma_f32_16x16x32_bf16 v[76:79], v[100:103], a[84:87], v[76:79]
    ds_read_b64_tr_b16 v[120:121], v234 offset:41984
    s_waitcnt lgkmcnt(5)
    v_mfma_f32_16x16x32_bf16 v[80:83], v[104:107], a[80:83], v[80:83]
    ds_read_b64_tr_b16 v[122:123], v234 offset:46080
    v_mov_b32 v184, s35
    v_mfma_f32_16x16x32_bf16 v[84:87], v[104:107], a[84:87], v[84:87]
    ds_read_b64_tr_b16 v[124:125], v235 offset:41984
    v_mov_b32 v185, s35
    v_mfma_f32_16x16x32_bf16 v[88:91], v[108:111], a[80:83], v[88:91]
    ds_read_b64_tr_b16 v[126:127], v235 offset:46080
    v_mov_b32 v186, s35
    v_mfma_f32_16x16x32_bf16 v[92:95], v[108:111], a[84:87], v[92:95]
    v_mov_b32 v187, s35
    s_waitcnt lgkmcnt(4)
    v_mfma_f32_16x16x32_bf16 v[64:67], v[112:115], a[88:91], v[64:67]
    s_waitcnt vmcnt(16)
    s_barrier
    ds_read_b64_tr_b16 v[96:97], v232 offset:49152
    v_mfma_f32_16x16x32_bf16 v[68:71], v[112:115], a[92:95], v[68:71]
    ds_read_b64_tr_b16 v[98:99], v232 offset:53248
    buffer_load_dwordx4 v246, s[12:15], s43 offen offset:1024 lds
    v_mfma_f32_16x16x32_bf16 v[156:159], v[112:115], v[212:215], v[156:159]
    ds_read_b64_tr_b16 v[100:101], v233 offset:49152
    v_readlane_b32 s43, v243, 25
    v_mfma_f32_16x16x32_bf16 v[72:75], v[116:119], a[88:91], v[72:75]
    ds_read_b64_tr_b16 v[102:103], v233 offset:53248
    s_cmp_ge_u32 s34, 1
    s_cselect_b32 s35, 0, 0xf149f2ca
    v_mfma_f32_16x16x32_bf16 v[76:79], v[116:119], a[92:95], v[76:79]
    ds_read_b64_tr_b16 v[104:105], v234 offset:49152
    s_waitcnt lgkmcnt(5)
    v_mfma_f32_16x16x32_bf16 v[80:83], v[120:123], a[88:91], v[80:83]
    ds_read_b64_tr_b16 v[106:107], v234 offset:53248
    v_mov_b32 v188, s35
    v_mfma_f32_16x16x32_bf16 v[84:87], v[120:123], a[92:95], v[84:87]
    ds_read_b64_tr_b16 v[108:109], v235 offset:49152
    v_mov_b32 v189, s35
    v_mfma_f32_16x16x32_bf16 v[88:91], v[124:127], a[88:91], v[88:91]
    ds_read_b64_tr_b16 v[110:111], v235 offset:53248
    v_mov_b32 v190, s35
    v_mfma_f32_16x16x32_bf16 v[92:95], v[124:127], a[92:95], v[92:95]
    v_mov_b32 v191, s35
    s_waitcnt lgkmcnt(4)
    v_mfma_f32_16x16x32_bf16 v[64:67], v[96:99], a[96:99], v[64:67]
    ds_read_b64_tr_b16 v[112:113], v232 offset:50176
    s_add_u32 m0, s40, 131072
    v_mfma_f32_16x16x32_bf16 v[68:71], v[96:99], a[100:103], v[68:71]
    ds_read_b64_tr_b16 v[114:115], v232 offset:54272
    buffer_load_dwordx4 v247, s[12:15], s42 offen offset:0 lds
    v_mfma_f32_16x16x32_bf16 v[156:159], v[96:99], v[212:215], v[156:159]
    ds_read_b64_tr_b16 v[116:117], v233 offset:50176
    v_readlane_b32 s42, v243, 26
    v_mfma_f32_16x16x32_bf16 v[72:75], v[100:103], a[96:99], v[72:75]
    ds_read_b64_tr_b16 v[118:119], v233 offset:54272
    v_mfma_f32_16x16x32_bf16 v[76:79], v[100:103], a[100:103], v[76:79]
    ds_read_b64_tr_b16 v[120:121], v234 offset:50176
    s_waitcnt lgkmcnt(5)
    v_mfma_f32_16x16x32_bf16 v[80:83], v[104:107], a[96:99], v[80:83]
    ds_read_b64_tr_b16 v[122:123], v234 offset:54272
    v_mfma_f32_16x16x32_bf16 v[84:87], v[104:107], a[100:103], v[84:87]
    ds_read_b64_tr_b16 v[124:125], v235 offset:50176
    v_mfma_f32_16x16x32_bf16 v[88:91], v[108:111], a[96:99], v[88:91]
    ds_read_b64_tr_b16 v[126:127], v235 offset:54272
    v_mfma_f32_16x16x32_bf16 v[92:95], v[108:111], a[100:103], v[92:95]
    s_waitcnt lgkmcnt(4)
    v_mfma_f32_16x16x32_bf16 v[64:67], v[112:115], a[104:107], v[64:67]
    ds_read_b64_tr_b16 v[96:97], v232 offset:57344
    buffer_load_dwordx4 v246, s[12:15], s43 offen offset:1024 lds
    v_mfma_f32_16x16x32_bf16 v[68:71], v[112:115], a[108:111], v[68:71]
    ds_read_b64_tr_b16 v[98:99], v232 offset:61440
    v_readlane_b32 s43, v243, 27
    v_mfma_f32_16x16x32_bf16 v[156:159], v[112:115], v[212:215], v[156:159]
    ds_read_b64_tr_b16 v[100:101], v233 offset:57344
    v_mfma_f32_16x16x32_bf16 v[72:75], v[116:119], a[104:107], v[72:75]
    ds_read_b64_tr_b16 v[102:103], v233 offset:61440
    v_mfma_f32_16x16x32_bf16 v[76:79], v[116:119], a[108:111], v[76:79]
    ds_read_b64_tr_b16 v[104:105], v234 offset:57344
    s_waitcnt lgkmcnt(5)
    v_mfma_f32_16x16x32_bf16 v[80:83], v[120:123], a[104:107], v[80:83]
    ds_read_b64_tr_b16 v[106:107], v234 offset:61440
    v_mfma_f32_16x16x32_bf16 v[84:87], v[120:123], a[108:111], v[84:87]
    ds_read_b64_tr_b16 v[108:109], v235 offset:57344
    v_mfma_f32_16x16x32_bf16 v[88:91], v[124:127], a[104:107], v[88:91]
    ds_read_b64_tr_b16 v[110:111], v235 offset:61440
    v_mfma_f32_16x16x32_bf16 v[92:95], v[124:127], a[108:111], v[92:95]
    s_waitcnt lgkmcnt(4)
    v_mfma_f32_16x16x32_bf16 v[64:67], v[96:99], a[112:115], v[64:67]
    ds_read_b64_tr_b16 v[112:113], v232 offset:58368
    s_add_u32 m0, s40, 139264
    v_mfma_f32_16x16x32_bf16 v[68:71], v[96:99], a[116:119], v[68:71]
    ds_read_b64_tr_b16 v[114:115], v232 offset:62464
    buffer_load_dwordx4 v247, s[12:15], s42 offen offset:0 lds
    v_mfma_f32_16x16x32_bf16 v[156:159], v[96:99], v[212:215], v[156:159]
    ds_read_b64_tr_b16 v[116:117], v233 offset:58368
    v_readlane_b32 s42, v243, 28
    v_mfma_f32_16x16x32_bf16 v[72:75], v[100:103], a[112:115], v[72:75]
    ds_read_b64_tr_b16 v[118:119], v233 offset:62464
    v_mfma_f32_16x16x32_bf16 v[76:79], v[100:103], a[116:119], v[76:79]
    ds_read_b64_tr_b16 v[120:121], v234 offset:58368
    s_waitcnt lgkmcnt(5)
    v_mfma_f32_16x16x32_bf16 v[80:83], v[104:107], a[112:115], v[80:83]
    ds_read_b64_tr_b16 v[122:123], v234 offset:62464
    v_mfma_f32_16x16x32_bf16 v[84:87], v[104:107], a[116:119], v[84:87]
    ds_read_b64_tr_b16 v[124:125], v235 offset:58368
    v_mfma_f32_16x16x32_bf16 v[88:91], v[108:111], a[112:115], v[88:91]
    ds_read_b64_tr_b16 v[126:127], v235 offset:62464
    v_mfma_f32_16x16x32_bf16 v[92:95], v[108:111], a[116:119], v[92:95]
    s_waitcnt lgkmcnt(4)
    v_mfma_f32_16x16x32_bf16 v[64:67], v[112:115], a[120:123], v[64:67]
    buffer_load_dwordx4 v246, s[12:15], s43 offen offset:1024 lds
    v_readlane_b32 s43, v243, 29
    s_waitcnt vmcnt(8)
    s_barrier
    s_add_u32 s34, s49, 128
    s_add_u32 s35, s30, 96
    s_cmp_eq_u32 s28, 0
    s_cselect_b32 s35, s34, s35
    s_mul_i32 s35, s35, 4352
    s_cmp_ge_u32 s28, 2
    s_cbranch_scc1 L_sig11
    s_mov_b64 exec, 1
    buffer_atomic_add v253, v252, s[20:23], s35 offen sc1
    s_mov_b64 exec, -1
L_sig11:
    ds_read_b64_tr_b16 v[96:97], v236 offset:0
    v_mfma_f32_16x16x32_bf16 v[68:71], v[112:115], a[124:127], v[68:71]
    ds_read_b64_tr_b16 v[98:99], v236 offset:4096
    v_mfma_f32_16x16x32_bf16 v[156:159], v[112:115], v[212:215], v[156:159]
    ds_read_b64_tr_b16 v[100:101], v237 offset:0
    v_mfma_f32_16x16x32_bf16 v[72:75], v[116:119], a[120:123], v[72:75]
    ds_read_b64_tr_b16 v[102:103], v237 offset:4096
    v_mfma_f32_16x16x32_bf16 v[76:79], v[116:119], a[124:127], v[76:79]
    ds_read_b64_tr_b16 v[104:105], v238 offset:0
    s_waitcnt lgkmcnt(5)
    v_mfma_f32_16x16x32_bf16 v[80:83], v[120:123], a[120:123], v[80:83]
    ds_read_b64_tr_b16 v[106:107], v238 offset:4096
    v_mfma_f32_16x16x32_bf16 v[84:87], v[120:123], a[124:127], v[84:87]
    ds_read_b64_tr_b16 v[108:109], v239 offset:0
    v_mfma_f32_16x16x32_bf16 v[88:91], v[124:127], a[120:123], v[88:91]
    ds_read_b64_tr_b16 v[110:111], v239 offset:4096
    v_mfma_f32_16x16x32_bf16 v[92:95], v[124:127], a[124:127], v[92:95]
    s_waitcnt lgkmcnt(4)
    v_mfma_f32_16x16x32_bf16 v[64:67], v[96:99], a[128:131], v[64:67]
    ds_read_b64_tr_b16 v[112:113], v236 offset:1024
    s_add_u32 m0, s39, 65536
    v_mfma_f32_16x16x32_bf16 v[68:71], v[96:99], a[132:135], v[68:71]
    ds_read_b64_tr_b16 v[114:115], v236 offset:5120
    buffer_load_dwordx4 v254, s[24:27], s38 offen offset:0 sc1 lds
    v_mfma_f32_16x16x32_bf16 v[156:159], v[96:99], v[212:215], v[156:159]
    ds_read_b64_tr_b16 v[116:117], v237 offset:1024
    s_add_u32 m0, s40, 147456
    v_mfma_f32_16x16x32_bf16 v[72:75], v[100:103], a[128:131], v[72:75]
    ds_read_b64_tr_b16 v[118:119], v237 offset:5120
    buffer_load_dwordx4 v247, s[12:15], s42 offen offset:0 lds
    v_mfma_f32_16x16x32_bf16 v[76:79], v[100:103], a[132:135], v[76:79]
    ds_read_b64_tr_b16 v[120:121], v238 offset:1024
    s_waitcnt lgkmcnt(5)
    v_mfma_f32_16x16x32_bf16 v[80:83], v[104:107], a[128:131], v[80:83]
    ds_read_b64_tr_b16 v[122:123], v238 offset:5120
    v_readlane_b32 s42, v243, 30
    v_mfma_f32_16x16x32_bf16 v[84:87], v[104:107], a[132:135], v[84:87]
    ds_read_b64_tr_b16 v[124:125], v239 offset:1024
    v_mfma_f32_16x16x32_bf16 v[88:91], v[108:111], a[128:131], v[88:91]
    ds_read_b64_tr_b16 v[126:127], v239 offset:5120
    v_mfma_f32_16x16x32_bf16 v[92:95], v[108:111], a[132:135], v[92:95]
    s_waitcnt lgkmcnt(4)
    v_mfma_f32_16x16x32_bf16 v[64:67], v[112:115], a[136:139], v[64:67]
    ds_read_b64_tr_b16 v[96:97], v236 offset:8192
    s_add_u32 m0, s39, 65536
    v_mfma_f32_16x16x32_bf16 v[68:71], v[112:115], a[140:143], v[68:71]
    ds_read_b64_tr_b16 v[98:99], v236 offset:12288
    buffer_load_dwordx4 v254, s[24:27], s38 offen offset:1024 sc1 lds
    v_mfma_f32_16x16x32_bf16 v[156:159], v[112:115], v[212:215], v[156:159]
    ds_read_b64_tr_b16 v[100:101], v237 offset:8192
    s_add_u32 m0, s40, 147456
    v_mfma_f32_16x16x32_bf16 v[72:75], v[116:119], a[136:139], v[72:75]
    ds_read_b64_tr_b16 v[102:103], v237 offset:12288
    buffer_load_dwordx4 v246, s[12:15], s43 offen offset:1024 lds
    v_mfma_f32_16x16x32_bf16 v[76:79], v[116:119], a[140:143], v[76:79]
    ds_read_b64_tr_b16 v[104:105], v238 offset:8192
    s_waitcnt lgkmcnt(5)
    v_mfma_f32_16x16x32_bf16 v[80:83], v[120:123], a[136:139], v[80:83]
    ds_read_b64_tr_b16 v[106:107], v238 offset:12288
    v_readlane_b32 s43, v243, 31
    v_mfma_f32_16x16x32_bf16 v[84:87], v[120:123], a[140:143], v[84:87]
    ds_read_b64_tr_b16 v[108:109], v239 offset:8192
    v_mfma_f32_16x16x32_bf16 v[88:91], v[124:127], a[136:139], v[88:91]
    ds_read_b64_tr_b16 v[110:111], v239 offset:12288
    v_mfma_f32_16x16x32_bf16 v[92:95], v[124:127], a[140:143], v[92:95]
    s_waitcnt lgkmcnt(4)
    v_mfma_f32_16x16x32_bf16 v[64:67], v[96:99], a[144:147], v[64:67]
    ds_read_b64_tr_b16 v[112:113], v236 offset:9216
    s_add_u32 m0, s39, 65536
    v_mfma_f32_16x16x32_bf16 v[68:71], v[96:99], a[148:151], v[68:71]
    ds_read_b64_tr_b16 v[114:115], v236 offset:13312
    buffer_load_dwordx4 v254, s[24:27], s38 offen offset:2048 sc1 lds
    v_mfma_f32_16x16x32_bf16 v[156:159], v[96:99], v[212:215], v[156:159]
    ds_read_b64_tr_b16 v[116:117], v237 offset:9216
    s_add_u32 m0, s40, 155648
    v_mfma_f32_16x16x32_bf16 v[72:75], v[100:103], a[144:147], v[72:75]
    ds_read_b64_tr_b16 v[118:119], v237 offset:13312
    buffer_load_dwordx4 v247, s[12:15], s42 offen offset:0 lds
    v_mfma_f32_16x16x32_bf16 v[76:79], v[100:103], a[148:151], v[76:79]
    ds_read_b64_tr_b16 v[120:121], v238 offset:9216
    s_waitcnt lgkmcnt(5)
    v_mfma_f32_16x16x32_bf16 v[80:83], v[104:107], a[144:147], v[80:83]
    ds_read_b64_tr_b16 v[122:123], v238 offset:13312
    v_mfma_f32_16x16x32_bf16 v[84:87], v[104:107], a[148:151], v[84:87]
    ds_read_b64_tr_b16 v[124:125], v239 offset:9216
    v_mfma_f32_16x16x32_bf16 v[88:91], v[108:111], a[144:147], v[88:91]
    ds_read_b64_tr_b16 v[126:127], v239 offset:13312
    v_mfma_f32_16x16x32_bf16 v[92:95], v[108:111], a[148:151], v[92:95]
    s_waitcnt lgkmcnt(4)
    v_mfma_f32_16x16x32_bf16 v[64:67], v[112:115], a[152:155], v[64:67]
    s_waitcnt vmcnt(10)
    s_barrier
    ds_read_b64_tr_b16 v[96:97], v236 offset:16384
    v_mfma_f32_16x16x32_bf16 v[68:71], v[112:115], a[156:159], v[68:71]
    ds_read_b64_tr_b16 v[98:99], v236 offset:20480
    s_add_u32 m0, s39, 65536
    v_mfma_f32_16x16x32_bf16 v[156:159], v[112:115], v[212:215], v[156:159]
    ds_read_b64_tr_b16 v[100:101], v237 offset:16384
    buffer_load_dwordx4 v254, s[24:27], s38 offen offset:3072 sc1 lds
    v_mfma_f32_16x16x32_bf16 v[72:75], v[116:119], a[152:155], v[72:75]
    ds_read_b64_tr_b16 v[102:103], v237 offset:20480
    s_add_u32 m0, s40, 155648
    v_mfma_f32_16x16x32_bf16 v[76:79], v[116:119], a[156:159], v[76:79]
    ds_read_b64_tr_b16 v[104:105], v238 offset:16384
    s_waitcnt lgkmcnt(5)
    v_mfma_f32_16x16x32_bf16 v[80:83], v[120:123], a[152:155], v[80:83]
    ds_read_b64_tr_b16 v[106:107], v238 offset:20480
    buffer_load_dwordx4 v246, s[12:15], s43 offen offset:1024 lds
    v_mfma_f32_16x16x32_bf16 v[84:87], v[120:123], a[156:159], v[84:87]
    ds_read_b64_tr_b16 v[108:109], v239 offset:16384
    v_mfma_f32_16x16x32_bf16 v[88:91], v[124:127], a[152:155], v[88:91]
    ds_read_b64_tr_b16 v[110:111], v239 offset:20480
    v_mfma_f32_16x16x32_bf16 v[92:95], v[124:127], a[156:159], v[92:95]
    s_waitcnt lgkmcnt(4)
    v_mfma_f32_16x16x32_bf16 v[64:67], v[96:99], a[160:163], v[64:67]
    ds_read_b64_tr_b16 v[112:113], v236 offset:17408
    s_add_u32 s3, s38, 4096
    v_mfma_f32_16x16x32_bf16 v[68:71], v[96:99], a[164:167], v[68:71]
    ds_read_b64_tr_b16 v[114:115], v236 offset:21504
    s_add_u32 m0, s39, 69632
    v_mfma_f32_16x16x32_bf16 v[156:159], v[96:99], v[212:215], v[156:159]
    ds_read_b64_tr_b16 v[116:117], v237 offset:17408
    buffer_load_dwordx4 v254, s[24:27], s3 offen offset:0 sc1 lds
    v_mfma_f32_16x16x32_bf16 v[72:75], v[100:103], a[160:163], v[72:75]
    ds_read_b64_tr_b16 v[118:119], v237 offset:21504
    v_mfma_f32_16x16x32_bf16 v[76:79], v[100:103], a[164:167], v[76:79]
    ds_read_b64_tr_b16 v[120:121], v238 offset:17408
    s_waitcnt lgkmcnt(5)
    v_mfma_f32_16x16x32_bf16 v[80:83], v[104:107], a[160:163], v[80:83]
    ds_read_b64_tr_b16 v[122:123], v238 offset:21504
    v_mfma_f32_16x16x32_bf16 v[84:87], v[104:107], a[164:167], v[84:87]
    ds_read_b64_tr_b16 v[124:125], v239 offset:17408
    v_mfma_f32_16x16x32_bf16 v[88:91], v[108:111], a[160:163], v[88:91]
    ds_read_b64_tr_b16 v[126:127], v239 offset:21504
    v_mfma_f32_16x16x32_bf16 v[92:95], v[108:111], a[164:167], v[92:95]
    s_waitcnt lgkmcnt(4)
    v_mfma_f32_16x16x32_bf16 v[64:67], v[112:115], a[168:171], v[64:67]
    ds_read_b64_tr_b16 v[96:97], v236 offset:24576
    s_add_u32 s3, s38, 4096
    v_mfma_f32_16x16x32_bf16 v[68:71], v[112:115], a[172:175], v[68:71]
    ds_read_b64_tr_b16 v[98:99], v236 offset:28672
    buffer_load_dwordx4 v254, s[24:27], s3 offen offset:1024 sc1 lds
    v_mfma_f32_16x16x32_bf16 v[156:159], v[112:115], v[212:215], v[156:159]
    ds_read_b64_tr_b16 v[100:101], v237 offset:24576
    v_mfma_f32_16x16x32_bf16 v[72:75], v[116:119], a[168:171], v[72:75]
    ds_read_b64_tr_b16 v[102:103], v237 offset:28672
    v_mfma_f32_16x16x32_bf16 v[76:79], v[116:119], a[172:175], v[76:79]
    ds_read_b64_tr_b16 v[104:105], v238 offset:24576
    s_waitcnt lgkmcnt(5)
    v_mfma_f32_16x16x32_bf16 v[80:83], v[120:123], a[168:171], v[80:83]
    ds_read_b64_tr_b16 v[106:107], v238 offset:28672
    v_mfma_f32_16x16x32_bf16 v[84:87], v[120:123], a[172:175], v[84:87]
    ds_read_b64_tr_b16 v[108:109], v239 offset:24576
    v_mfma_f32_16x16x32_bf16 v[88:91], v[124:127], a[168:171], v[88:91]
    ds_read_b64_tr_b16 v[110:111], v239 offset:28672
    v_mfma_f32_16x16x32_bf16 v[92:95], v[124:127], a[172:175], v[92:95]
    s_waitcnt lgkmcnt(4)
    v_mfma_f32_16x16x32_bf16 v[64:67], v[96:99], a[176:179], v[64:67]
    ds_read_b64_tr_b16 v[112:113], v236 offset:25600
    buffer_load_dword v241, v240, s[20:23], 0 offen sc1
    v_mfma_f32_16x16x32_bf16 v[68:71], v[96:99], a[180:183], v[68:71]
    ds_read_b64_tr_b16 v[114:115], v236 offset:29696
    s_add_u32 s3, s38, 4096
    v_mfma_f32_16x16x32_bf16 v[156:159], v[96:99], v[212:215], v[156:159]
    ds_read_b64_tr_b16 v[116:117], v237 offset:25600
    buffer_load_dwordx4 v254, s[24:27], s3 offen offset:2048 sc1 lds
    v_mfma_f32_16x16x32_bf16 v[72:75], v[100:103], a[176:179], v[72:75]
    ds_read_b64_tr_b16 v[118:119], v237 offset:29696
    v_mfma_f32_16x16x32_bf16 v[76:79], v[100:103], a[180:183], v[76:79]
    ds_read_b64_tr_b16 v[120:121], v238 offset:25600
    s_waitcnt lgkmcnt(5)
    v_mfma_f32_16x16x32_bf16 v[80:83], v[104:107], a[176:179], v[80:83]
    ds_read_b64_tr_b16 v[122:123], v238 offset:29696
    v_mfma_f32_16x16x32_bf16 v[84:87], v[104:107], a[180:183], v[84:87]
    ds_read_b64_tr_b16 v[124:125], v239 offset:25600
    v_mfma_f32_16x16x32_bf16 v[88:91], v[108:111], a[176:179], v[88:91]
    ds_read_b64_tr_b16 v[126:127], v239 offset:29696
    v_mfma_f32_16x16x32_bf16 v[92:95], v[108:111], a[180:183], v[92:95]
    s_waitcnt lgkmcnt(4)
    v_mfma_f32_16x16x32_bf16 v[64:67], v[112:115], a[184:187], v[64:67]
    s_waitcnt vmcnt(12)
    s_barrier
    ds_read_b64_tr_b16 v[96:97], v236 offset:32768
    v_mfma_f32_16x16x32_bf16 v[68:71], v[112:115], a[188:191], v[68:71]
    ds_read_b64_tr_b16 v[98:99], v236 offset:36864
    s_add_u32 s3, s38, 4096
    v_mfma_f32_16x16x32_bf16 v[156:159], v[112:115], v[212:215], v[156:159]
    ds_read_b64_tr_b16 v[100:101], v237 offset:32768
    buffer_load_dwordx4 v254, s[24:27], s3 offen offset:3072 sc1 lds
    v_mfma_f32_16x16x32_bf16 v[72:75], v[116:119], a[184:187], v[72:75]
    ds_read_b64_tr_b16 v[102:103], v237 offset:36864
    v_mfma_f32_16x16x32_bf16 v[76:79], v[116:119], a[188:191], v[76:79]
    ds_read_b64_tr_b16 v[104:105], v238 offset:32768
    s_waitcnt lgkmcnt(5)
    v_mfma_f32_16x16x32_bf16 v[80:83], v[120:123], a[184:187], v[80:83]
    ds_read_b64_tr_b16 v[106:107], v238 offset:36864
    v_mfma_f32_16x16x32_bf16 v[84:87], v[120:123], a[188:191], v[84:87]
    ds_read_b64_tr_b16 v[108:109], v239 offset:32768
    v_mfma_f32_16x16x32_bf16 v[88:91], v[124:127], a[184:187], v[88:91]
    ds_read_b64_tr_b16 v[110:111], v239 offset:36864
    v_mfma_f32_16x16x32_bf16 v[92:95], v[124:127], a[188:191], v[92:95]
    s_waitcnt lgkmcnt(4)
    v_mfma_f32_16x16x32_bf16 v[64:67], v[96:99], a[192:195], v[64:67]
    ds_read_b64_tr_b16 v[112:113], v236 offset:33792
    v_mfma_f32_16x16x32_bf16 v[68:71], v[96:99], a[196:199], v[68:71]
    ds_read_b64_tr_b16 v[114:115], v236 offset:37888
    v_mfma_f32_16x16x32_bf16 v[156:159], v[96:99], v[212:215], v[156:159]
    ds_read_b64_tr_b16 v[116:117], v237 offset:33792
    v_mfma_f32_16x16x32_bf16 v[72:75], v[100:103], a[192:195], v[72:75]
    ds_read_b64_tr_b16 v[118:119], v237 offset:37888
    v_mfma_f32_16x16x32_bf16 v[76:79], v[100:103], a[196:199], v[76:79]
    ds_read_b64_tr_b16 v[120:121], v238 offset:33792
    s_waitcnt lgkmcnt(5)
    v_mfma_f32_16x16x32_bf16 v[80:83], v[104:107], a[192:195], v[80:83]
    ds_read_b64_tr_b16 v[122:123], v238 offset:37888
    v_mfma_f32_16x16x32_bf16 v[84:87], v[104:107], a[196:199], v[84:87]
    ds_read_b64_tr_b16 v[124:125], v239 offset:33792
    v_mfma_f32_16x16x32_bf16 v[88:91], v[108:111], a[192:195], v[88:91]
    ds_read_b64_tr_b16 v[126:127], v239 offset:37888
    v_mfma_f32_16x16x32_bf16 v[92:95], v[108:111], a[196:199], v[92:95]
    s_waitcnt lgkmcnt(4)
    v_mfma_f32_16x16x32_bf16 v[64:67], v[112:115], a[200:203], v[64:67]
    ds_read_b64_tr_b16 v[96:97], v236 offset:40960
    v_mfma_f32_16x16x32_bf16 v[68:71], v[112:115], a[204:207], v[68:71]
    ds_read_b64_tr_b16 v[98:99], v236 offset:45056
    v_mfma_f32_16x16x32_bf16 v[156:159], v[112:115], v[212:215], v[156:159]
    ds_read_b64_tr_b16 v[100:101], v237 offset:40960
    v_mfma_f32_16x16x32_bf16 v[72:75], v[116:119], a[200:203], v[72:75]
    ds_read_b64_tr_b16 v[102:103], v237 offset:45056
    v_mfma_f32_16x16x32_bf16 v[76:79], v[116:119], a[204:207], v[76:79]
    ds_read_b64_tr_b16 v[104:105], v238 offset:40960
    s_waitcnt lgkmcnt(5)
    v_mfma_f32_16x16x32_bf16 v[80:83], v[120:123], a[200:203], v[80:83]
    ds_read_b64_tr_b16 v[106:107], v238 offset:45056
    v_mfma_f32_16x16x32_bf16 v[84:87], v[120:123], a[204:207], v[84:87]
    ds_read_b64_tr_b16 v[108:109], v239 offset:40960
    v_mfma_f32_16x16x32_bf16 v[88:91], v[124:127], a[200:203], v[88:91]
    ds_read_b64_tr_b16 v[110:111], v239 offset:45056
    v_mfma_f32_16x16x32_bf16 v[92:95], v[124:127], a[204:207], v[92:95]
    s_waitcnt vmcnt(2)
    v_cmp_gt_u32 vcc, v242, v241
    s_cbranch_vccz L_chk12
    s_mov_b64 exec, -1
    s_mov_b32 s3, 0x40000
L_poll13:
    buffer_load_dword v241, v240, s[20:23], 0 offen sc1
    s_sub_u32 s3, s3, 1
    s_cbranch_scc1 L_poll13_y
    s_waitcnt vmcnt(0)
    v_cmp_gt_u32 vcc, v242, v241
    s_cbranch_vccz L_poll13_y
    s_sleep 1
    s_branch L_poll13
L_poll13_y:
    s_waitcnt vmcnt(0)
    s_mov_b64 exec, -1
L_poll13_x:
L_chk12:
    s_waitcnt lgkmcnt(4)
    v_mfma_f32_16x16x32_bf16 v[64:67], v[96:99], a[208:211], v[64:67]
    ds_read_b64_tr_b16 v[112:113], v236 offset:41984
    s_add_u32 m0, s39, 0
    v_mfma_f32_16x16x32_bf16 v[68:71], v[96:99], a[212:215], v[68:71]
    ds_read_b64_tr_b16 v[114:115], v236 offset:46080
    buffer_load_dwordx4 v254, s[24:27], s36 offen offset:0 sc1 lds
    v_mfma_f32_16x16x32_bf16 v[156:159], v[96:99], v[212:215], v[156:159]
    ds_read_b64_tr_b16 v[116:117], v237 offset:41984
    v_mfma_f32_16x16x32_bf16 v[72:75], v[100:103], a[208:211], v[72:75]
    ds_read_b64_tr_b16 v[118:119], v237 offset:46080
    v_mfma_f32_16x16x32_bf16 v[76:79], v[100:103], a[212:215], v[76:79]
    ds_read_b64_tr_b16 v[120:121], v238 offset:41984
    s_waitcnt lgkmcnt(5)
    v_mfma_f32_16x16x32_bf16 v[80:83], v[104:107], a[208:211], v[80:83]
    ds_read_b64_tr_b16 v[122:123], v238 offset:46080
    v_mfma_f32_16x16x32_bf16 v[84:87], v[104:107], a[212:215], v[84:87]
    ds_read_b64_tr_b16 v[124:125], v239 offset:41984
    v_mfma_f32_16x16x32_bf16 v[88:91], v[108:111], a[208:211], v[88:91]
    ds_read_b64_tr_b16 v[126:127], v239 offset:46080
    v_mfma_f32_16x16x32_bf16 v[92:95], v[108:111], a[212:215], v[92:95]
    s_waitcnt lgkmcnt(4)
    v_mfma_f32_16x16x32_bf16 v[64:67], v[112:115], a[216:219], v[64:67]
    s_barrier
    ds_read_b64_tr_b16 v[96:97], v236 offset:49152
    v_mfma_f32_16x16x32_bf16 v[68:71], v[112:115], a[220:223], v[68:71]
    ds_read_b64_tr_b16 v[98:99], v236 offset:53248
    buffer_load_dwordx4 v254, s[24:27], s36 offen offset:1024 sc1 lds
    v_mfma_f32_16x16x32_bf16 v[156:159], v[112:115], v[212:215], v[156:159]
    ds_read_b64_tr_b16 v[100:101], v237 offset:49152
    v_mfma_f32_16x16x32_bf16 v[72:75], v[116:119], a[216:219], v[72:75]
    ds_read_b64_tr_b16 v[102:103], v237 offset:53248
    v_mfma_f32_16x16x32_bf16 v[76:79], v[116:119], a[220:223], v[76:79]
    ds_read_b64_tr_b16 v[104:105], v238 offset:49152
    s_waitcnt lgkmcnt(5)
    v_mfma_f32_16x16x32_bf16 v[80:83], v[120:123], a[216:219], v[80:83]
    ds_read_b64_tr_b16 v[106:107], v238 offset:53248
    v_mfma_f32_16x16x32_bf16 v[84:87], v[120:123], a[220:223], v[84:87]
    ds_read_b64_tr_b16 v[108:109], v239 offset:49152
    v_mfma_f32_16x16x32_bf16 v[88:91], v[124:127], a[216:219], v[88:91]
    ds_read_b64_tr_b16 v[110:111], v239 offset:53248
    v_mfma_f32_16x16x32_bf16 v[92:95], v[124:127], a[220:223], v[92:95]
    s_waitcnt lgkmcnt(4)
    v_mfma_f32_16x16x32_bf16 v[64:67], v[96:99], a[224:227], v[64:67]
    ds_read_b64_tr_b16 v[112:113], v236 offset:50176
    s_add_u32 m0, s39, 32768
    v_mfma_f32_16x16x32_bf16 v[68:71], v[96:99], a[228:231], v[68:71]
    ds_read_b64_tr_b16 v[114:115], v236 offset:54272
    buffer_load_dwordx4 v254, s[24:27], s37 offen offset:0 sc1 lds
    v_mfma_f32_16x16x32_bf16 v[156:159], v[96:99], v[212:215], v[156:159]
    ds_read_b64_tr_b16 v[116:117], v237 offset:50176
    v_mfma_f32_16x16x32_bf16 v[72:75], v[100:103], a[224:227], v[72:75]
    ds_read_b64_tr_b16 v[118:119], v237 offset:54272
    v_mfma_f32_16x16x32_bf16 v[76:79], v[100:103], a[228:231], v[76:79]
    ds_read_b64_tr_b16 v[120:121], v238 offset:50176
    s_waitcnt lgkmcnt(5)
    v_mfma_f32_16x16x32_bf16 v[80:83], v[104:107], a[224:227], v[80:83]
    ds_read_b64_tr_b16 v[122:123], v238 offset:54272
    v_mfma_f32_16x16x32_bf16 v[84:87], v[104:107], a[228:231], v[84:87]
    ds_read_b64_tr_b16 v[124:125], v239 offset:50176
    v_mfma_f32_16x16x32_bf16 v[88:91], v[108:111], a[224:227], v[88:91]
    ds_read_b64_tr_b16 v[126:127], v239 offset:54272
    v_mfma_f32_16x16x32_bf16 v[92:95], v[108:111], a[228:231], v[92:95]
    s_waitcnt lgkmcnt(4)
    v_mfma_f32_16x16x32_bf16 v[64:67], v[112:115], a[232:235], v[64:67]
    ds_read_b64_tr_b16 v[96:97], v236 offset:57344
    buffer_load_dwordx4 v254, s[24:27], s37 offen offset:1024 sc1 lds
    v_mfma_f32_16x16x32_bf16 v[68:71], v[112:115], a[236:239], v[68:71]
    ds_read_b64_tr_b16 v[98:99], v236 offset:61440
    v_mfma_f32_16x16x32_bf16 v[156:159], v[112:115], v[212:215], v[156:159]
    ds_read_b64_tr_b16 v[100:101], v237 offset:57344
    v_mfma_f32_16x16x32_bf16 v[72:75], v[116:119], a[232:235], v[72:75]
    ds_read_b64_tr_b16 v[102:103], v237 offset:61440
    v_mfma_f32_16x16x32_bf16 v[76:79], v[116:119], a[236:239], v[76:79]
    ds_read_b64_tr_b16 v[104:105], v238 offset:57344
    s_waitcnt lgkmcnt(5)
    v_mfma_f32_16x16x32_bf16 v[80:83], v[120:123], a[232:235], v[80:83]
    ds_read_b64_tr_b16 v[106:107], v238 offset:61440
    v_mfma_f32_16x16x32_bf16 v[84:87], v[120:123], a[236:239], v[84:87]
    ds_read_b64_tr_b16 v[108:109], v239 offset:57344
    v_mfma_f32_16x16x32_bf16 v[88:91], v[124:127], a[232:235], v[88:91]
    ds_read_b64_tr_b16 v[110:111], v239 offset:61440
    v_mfma_f32_16x16x32_bf16 v[92:95], v[124:127], a[236:239], v[92:95]
    s_waitcnt lgkmcnt(4)
    v_mfma_f32_16x16x32_bf16 v[64:67], v[96:99], a[240:243], v[64:67]
    ds_read_b64_tr_b16 v[112:113], v236 offset:58368
    s_add_u32 m0, s39, 0
    v_mfma_f32_16x16x32_bf16 v[68:71], v[96:99], a[244:247], v[68:71]
    ds_read_b64_tr_b16 v[114:115], v236 offset:62464
    buffer_load_dwordx4 v254, s[24:27], s36 offen offset:2048 sc1 lds
    v_mfma_f32_16x16x32_bf16 v[156:159], v[96:99], v[212:215], v[156:159]
    ds_read_b64_tr_b16 v[116:117], v237 offset:58368
    v_mfma_f32_16x16x32_bf16 v[72:75], v[100:103], a[240:243], v[72:75]
    ds_read_b64_tr_b16 v[118:119], v237 offset:62464
    v_mfma_f32_16x16x32_bf16 v[76:79], v[100:103], a[244:247], v[76:79]
    ds_read_b64_tr_b16 v[120:121], v238 offset:58368
    s_waitcnt lgkmcnt(5)
    v_mfma_f32_16x16x32_bf16 v[80:83], v[104:107], a[240:243], v[80:83]
    ds_read_b64_tr_b16 v[122:123], v238 offset:62464
    v_mfma_f32_16x16x32_bf16 v[84:87], v[104:107], a[244:247], v[84:87]
    ds_read_b64_tr_b16 v[124:125], v239 offset:58368
    v_mfma_f32_16x16x32_bf16 v[88:91], v[108:111], a[240:243], v[88:91]
    ds_read_b64_tr_b16 v[126:127], v239 offset:62464
    v_mfma_f32_16x16x32_bf16 v[92:95], v[108:111], a[244:247], v[92:95]
    s_waitcnt lgkmcnt(4)
    v_mfma_f32_16x16x32_bf16 v[64:67], v[112:115], a[248:251], v[64:67]
    buffer_load_dwordx4 v254, s[24:27], s36 offen offset:3072 sc1 lds
    v_mfma_f32_16x16x32_bf16 v[68:71], v[112:115], a[252:255], v[68:71]
    v_mfma_f32_16x16x32_bf16 v[156:159], v[112:115], v[212:215], v[156:159]
    v_mfma_f32_16x16x32_bf16 v[72:75], v[116:119], a[248:251], v[72:75]
    v_mfma_f32_16x16x32_bf16 v[76:79], v[116:119], a[252:255], v[76:79]
    s_waitcnt lgkmcnt(0)
    v_mfma_f32_16x16x32_bf16 v[80:83], v[120:123], a[248:251], v[80:83]
    v_mfma_f32_16x16x32_bf16 v[84:87], v[120:123], a[252:255], v[84:87]
    v_mfma_f32_16x16x32_bf16 v[88:91], v[124:127], a[248:251], v[88:91]
    v_mfma_f32_16x16x32_bf16 v[92:95], v[124:127], a[252:255], v[92:95]
    v_lshrrev_b32 v216, 4, v255
    s_lshl_b32 s34, s28, 6
    s_add_u32 s34, s34, 98304
    v_lshl_add_u32 v216, v216, 4, s34
    ds_write_b128 v216, v[156:159]
L_ph2:
    v_add_u32 v236, s39, v254
    v_add_u32 v237, 0x8000, v236
    s_lshl_b32 s34, s29, 2
    s_add_u32 s34, s34, s28
    s_lshl_b32 s34, s34, 1
    s_lshl_b32 s35, s30, 8
    s_add_u32 s34, s34, s35
    s_lshl_b32 s34, s34, 10
    s_add_u32 s34, s34, 0x1000000
    s_add_u32 s16, s82, s34
    s_addc_u32 s17, s83, 0
    s_mov_b32 s18, 0x21000
    s_mov_b32 s19, 0x20000
    s_mov_b32 s55, 0x20000
    s_lshl_b32 s35, s29, 1
    s_add_u32 s35, s35, 16
    s_mul_i32 s56, s35, 4352
    s_waitcnt vmcnt(2) lgkmcnt(0)
    s_barrier
    ds_read_b128 a[0:3], v236 offset:0
    ds_read_b128 a[4:7], v236 offset:1024
    ds_read_b128 a[8:11], v236 offset:8192
    ds_read_b128 a[12:15], v236 offset:9216
    ds_read_b128 a[16:19], v236 offset:16384
    ds_read_b128 a[20:23], v236 offset:17408
    ds_read_b128 a[24:27], v236 offset:24576
    ds_read_b128 a[28:31], v236 offset:25600
    ds_read_b128 a[32:35], v237 offset:0
    ds_read_b128 a[36:39], v237 offset:1024
    ds_read_b128 a[40:43], v237 offset:8192
    ds_read_b128 a[44:47], v237 offset:9216
    ds_read_b128 a[48:51], v237 offset:16384
    ds_read_b128 a[52:55], v237 offset:17408
    ds_read_b128 a[56:59], v237 offset:24576
    ds_read_b128 a[60:63], v237 offset:25600
    ds_read_b128 a[64:67], v237 offset:32768
    ds_read_b128 a[68:71], v237 offset:33792
    s_add_u32 m0, s39, 32768
    s_nop 0
    buffer_load_dwordx4 v254, s[24:27], s37 offen offset:2048 sc1 lds
    buffer_load_dwordx4 v254, s[24:27], s37 offen offset:3072 sc1 lds
    s_add_u32 s3, s36, 4096
    s_add_u32 m0, s39, 4096
    s_nop 0
    buffer_load_dwordx4 v254, s[24:27], s3 offen offset:0 sc1 lds
    s_add_u32 s3, s36, 4096
    buffer_load_dwordx4 v254, s[24:27], s3 offen offset:1024 sc1 lds
    s_add_u32 s3, s37, 4096
    s_add_u32 m0, s39, 36864
    s_nop 0
    buffer_load_dwordx4 v254, s[24:27], s3 offen offset:0 sc1 lds
    s_add_u32 s3, s37, 4096
    buffer_load_dwordx4 v254, s[24:27], s3 offen offset:1024 sc1 lds
    s_add_u32 s3, s36, 4096
    s_add_u32 m0, s39, 4096
    s_nop 0
    buffer_load_dwordx4 v254, s[24:27], s3 offen offset:2048 sc1 lds
    s_add_u32 s3, s36, 4096
    buffer_load_dwordx4 v254, s[24:27], s3 offen offset:3072 sc1 lds
    s_add_u32 s3, s37, 4096
    s_add_u32 m0, s39, 36864
    s_nop 0
    buffer_load_dwordx4 v254, s[24:27], s3 offen offset:2048 sc1 lds
    s_add_u32 s3, s37, 4096
    buffer_load_dwordx4 v254, s[24:27], s3 offen offset:3072 sc1 lds
    v_xor_b32 v217, 0, v216
    ds_read_b128 v[96:99], v217
    v_xor_b32 v217, 64, v216
    ds_read_b128 v[100:103], v217
    v_xor_b32 v217, 128, v216
    ds_read_b128 v[104:107], v217
    v_xor_b32 v217, 192, v216
    ds_read_b128 v[108:111], v217
    v_pk_mul_f32 v[64:65], v[64:65], v[128:129] op_sel:[0,1] op_sel_hi:[1,1]
    v_pk_mul_f32 v[66:67], v[66:67], v[128:129] op_sel:[0,1] op_sel_hi:[1,1]
    v_pk_mul_f32 v[68:69], v[68:69], v[130:131] op_sel:[0,1] op_sel_hi:[1,1]
    v_pk_mul_f32 v[70:71], v[70:71], v[130:131] op_sel:[0,1] op_sel_hi:[1,1]
    v_pk_mul_f32 v[72:73], v[72:73], v[128:129] op_sel:[0,1] op_sel_hi:[1,1]
    v_pk_mul_f32 v[74:75], v[74:75], v[128:129] op_sel:[0,1] op_sel_hi:[1,1]
    v_pk_mul_f32 v[76:77], v[76:77], v[130:131] op_sel:[0,1] op_sel_hi:[1,1]
    v_pk_mul_f32 v[78:79], v[78:79], v[130:131] op_sel:[0,1] op_sel_hi:[1,1]
    v_pk_mul_f32 v[80:81], v[80:81], v[128:129] op_sel:[0,1] op_sel_hi:[1,1]
    v_pk_mul_f32 v[82:83], v[82:83], v[128:129] op_sel:[0,1] op_sel_hi:[1,1]
    v_pk_mul_f32 v[84:85], v[84:85], v[130:131] op_sel:[0,1] op_sel_hi:[1,1]
    v_pk_mul_f32 v[86:87], v[86:87], v[130:131] op_sel:[0,1] op_sel_hi:[1,1]
    v_pk_mul_f32 v[88:89], v[88:89], v[128:129] op_sel:[0,1] op_sel_hi:[1,1]
    v_pk_mul_f32 v[90:91], v[90:91], v[128:129] op_sel:[0,1] op_sel_hi:[1,1]
    v_pk_mul_f32 v[92:93], v[92:93], v[130:131] op_sel:[0,1] op_sel_hi:[1,1]
    v_pk_mul_f32 v[94:95], v[94:95], v[130:131] op_sel:[0,1] op_sel_hi:[1,1]
    s_waitcnt lgkmcnt(3)
    v_pk_fma_f32 v[64:65], v[96:97], v[128:129], v[64:65] op_sel_hi:[1,0,1]
    v_pk_fma_f32 v[66:67], v[98:99], v[128:129], v[66:67] op_sel_hi:[1,0,1]
    s_waitcnt lgkmcnt(2)
    v_pk_fma_f32 v[72:73], v[100:101], v[128:129], v[72:73] op_sel_hi:[1,0,1]
    v_pk_fma_f32 v[74:75], v[102:103], v[128:129], v[74:75] op_sel_hi:[1,0,1]
    v_cvt_pk_bf16_f32 v144, v64, v65
    v_cvt_pk_bf16_f32 v145, v66, v67
    v_cvt_pk_bf16_f32 v146, v72, v73
    v_cvt_pk_bf16_f32 v147, v74, v75
    v_pk_fma_f32 v[68:69], v[96:97], v[130:131], v[68:69] op_sel_hi:[1,0,1]
    v_pk_fma_f32 v[70:71], v[98:99], v[130:131], v[70:71] op_sel_hi:[1,0,1]
    v_pk_fma_f32 v[76:77], v[100:101], v[130:131], v[76:77] op_sel_hi:[1,0,1]
    v_pk_fma_f32 v[78:79], v[102:103], v[130:131], v[78:79] op_sel_hi:[1,0,1]
    v_cvt_pk_bf16_f32 v148, v68, v69
    v_cvt_pk_bf16_f32 v149, v70, v71
    v_cvt_pk_bf16_f32 v150, v76, v77
    v_cvt_pk_bf16_f32 v151, v78, v79
    s_waitcnt lgkmcnt(1)
    v_pk_fma_f32 v[80:81], v[104:105], v[128:129], v[80:81] op_sel_hi:[1,0,1]
    v_pk_fma_f32 v[82:83], v[106:107], v[128:129], v[82:83] op_sel_hi:[1,0,1]
    s_waitcnt lgkmcnt(0)
    v_pk_fma_f32 v[88:89], v[108:109], v[128:129], v[88:89] op_sel_hi:[1,0,1]
    v_pk_fma_f32 v[90:91], v[110:111], v[128:129], v[90:91] op_sel_hi:[1,0,1]
    v_cvt_pk_bf16_f32 v152, v80, v81
    v_cvt_pk_bf16_f32 v153, v82, v83
    v_cvt_pk_bf16_f32 v154, v88, v89
    v_cvt_pk_bf16_f32 v155, v90, v91
    v_pk_fma_f32 v[84:85], v[104:105], v[130:131], v[84:85] op_sel_hi:[1,0,1]
    v_pk_fma_f32 v[86:87], v[106:107], v[130:131], v[86:87] op_sel_hi:[1,0,1]
    v_pk_fma_f32 v[92:93], v[108:109], v[130:131], v[92:93] op_sel_hi:[1,0,1]
    v_pk_fma_f32 v[94:95], v[110:111], v[130:131], v[94:95] op_sel_hi:[1,0,1]
    v_cvt_pk_bf16_f32 v156, v84, v85
    v_cvt_pk_bf16_f32 v157, v86, v87
    v_cvt_pk_bf16_f32 v158, v92, v93
    v_cvt_pk_bf16_f32 v159, v94, v95
    s_mov_b64 exec, s[96:97]
    v_swap_b32 v144, v146
    v_swap_b32 v145, v147
    v_swap_b32 v148, v150
    v_swap_b32 v149, v151
    v_swap_b32 v152, v154
    v_swap_b32 v153, v155
    v_swap_b32 v156, v158
    v_swap_b32 v157, v159
    s_mov_b64 exec, -1
    s_mov_b64 exec, s[98:99]
    v_swap_b32 v144, v152
    v_swap_b32 v145, v153
    v_swap_b32 v146, v154
    v_swap_b32 v147, v155
    v_swap_b32 v148, v156
    v_swap_b32 v149, v157
    v_swap_b32 v150, v158
    v_swap_b32 v151, v159
    s_mov_b64 exec, -1
    v_mfma_f32_16x16x32_bf16 v[0:3], a[0:3], v[144:147], v[196:199]
    v_lshrrev_b32 v232, 3, v255
    s_lshl_b32 s34, s28, 3
    v_add_u32 v232, s34, v232
    v_mfma_f32_16x16x32_bf16 v[4:7], a[4:7], v[144:147], v[160:163]
    v_mul_u32_u24 v232, 2048, v232
    v_lshrrev_b32 v233, 4, v255
    v_lshlrev_b32 v233, 1, v233
    v_mfma_f32_16x16x32_bf16 v[8:11], a[8:11], v[144:147], v[164:167]
    v_and_b32 v246, 7, v255
    v_xor_b32 v246, v246, v233
    v_lshl_add_u32 v246, v246, 4, v232
    v_mfma_f32_16x16x32_bf16 v[12:15], a[12:15], v[144:147], v[164:167]
    v_add_u32 v247, 1024, v246
    s_lshl_b32 s35, s30, 7
    s_sub_u32 s36, 2098176, s35
    v_mfma_f32_16x16x32_bf16 v[16:19], a[16:19], v[144:147], v[168:171]
    s_sub_u32 s38, s68, 1024
    s_subb_u32 s39, s69, 0
    s_add_u32 s12, s38, s35
    s_addc_u32 s13, s39, 0
    v_mfma_f32_16x16x32_bf16 v[20:23], a[20:23], v[144:147], v[168:171]
    s_mov_b32 s14, s36
    s_mov_b32 s15, 0x20000
    s_lshl_b32 s40, s28, 11
    v_mfma_f32_16x16x32_bf16 v[24:27], a[24:27], v[144:147], v[172:175]
    v_and_b32 v245, 15, v255
    v_subrev_u32 v232, s70, v245
    v_and_b32 v232, 7, v232
    v_mfma_f32_16x16x32_bf16 v[28:31], a[28:31], v[144:147], v[172:175]
    v_sub_u32 v233, v245, v232
    v_lshlrev_b32 v232, 2, v232
    s_mov_b32 s35, 0xeeee44
    v_mfma_f32_16x16x32_bf16 v[32:35], a[32:35], v[144:147], v[176:179]
    v_bfe_i32 v232, s35, v232, 4
    v_cmp_ge_u32 s[36:37], 10, v233
    s_nop 0
    v_mfma_f32_16x16x32_bf16 v[36:39], a[36:39], v[144:147], v[176:179]
    v_cndmask_b32_e64 v232, 0, v232, s[36:37]
    v_add_u32 v245, v245, v232
    s_lshl_b32 s35, s58, 2
    v_mfma_f32_16x16x32_bf16 v[40:43], a[40:43], v[144:147], v[180:183]
    v_add_u32 v245, s35, v245
    v_and_b32 v245, 15, v245
    v_bfe_u32 v232, v255, 4, 1
    v_mfma_f32_16x16x32_bf16 v[44:47], a[44:47], v[144:147], v[180:183]
    v_lshl_add_u32 v245, v245, 1, v232
    v_lshlrev_b32 v245, 16, v245
    s_nop 0
    v_readlane_b32 s41, v245, 0
    v_mfma_f32_16x16x32_bf16 v[48:51], a[48:51], v[144:147], v[184:187]
    v_readlane_b32 s42, v245, 1
    s_lshl_b32 s34, s29, 2
    s_add_u32 s34, s34, s28
    v_mfma_f32_16x16x32_bf16 v[52:55], a[52:55], v[144:147], v[184:187]
    s_lshl_b32 s52, s34, 11
    s_mov_b32 s34, s52
    s_add_u32 s34, s34, 0x1000000
    v_mfma_f32_16x16x32_bf16 v[56:59], a[56:59], v[144:147], v[188:191]
    s_add_u32 s8, s82, s34
    s_addc_u32 s9, s83, 0
    s_mov_b32 s10, 0x400000
    v_mfma_f32_16x16x32_bf16 v[60:63], a[60:63], v[144:147], v[188:191]
    s_mov_b32 s11, 0x20000
    s_lshl_b32 s34, s52, 5
    s_lshl_b32 s35, s30, 7
    v_mfma_f32_16x16x32_bf16 v[64:67], a[64:67], v[144:147], v[192:195]
    s_add_u32 s53, s34, s35
    s_mov_b32 s34, s53
    s_add_u32 s4, s64, s34
    s_addc_u32 s5, s65, 0
    s_mov_b32 s6, 0xf880
    s_mov_b32 s7, 0x20000
    v_and_b32 v232, 15, v255
    v_lshlrev_b32 v235, 11, v232
    v_bfe_u32 v233, v255, 4, 1
    v_lshl_add_u32 v235, v233, 5, v235
    v_lshrrev_b32 v233, 5, v255
    v_lshl_add_u32 v235, v233, 4, v235
    s_mov_b32 s54, 32768
    s_lshr_b32 s34, s52, 2
    s_add_u32 s34, s34, 0x18c0000
    s_add_u32 s24, s82, s34
    s_addc_u32 s25, s83, 0
    s_mov_b32 s26, 0x200
    s_mov_b32 s27, 0x20000
    v_lshlrev_b32 v234, 4, v232
    buffer_load_dwordx4 a[216:219], v235, s[4:7], 0 offen offset:0
    buffer_load_dwordx4 a[220:223], v235, s[4:7], 0 offen offset:64
    buffer_load_dwordx4 a[224:227], v235, s[4:7], s54 offen offset:0
    buffer_load_dwordx4 a[228:231], v235, s[4:7], s54 offen offset:64
    buffer_load_dword a232, v234, s[24:27], 0 offen offset:8 sc1
    buffer_load_dword a233, v234, s[24:27], 0 offen offset:264 sc1
    v_max3_f32 v216, v0, v1, v2
    v_mfma_f32_16x16x32_bf16 v[76:79], a[4:7], v[148:151], v[196:199]
    v_max3_f32 v217, v3, v4, v5
    v_max3_f32 v216, v216, v6, v7
    v_max3_f32 v217, v217, v8, v9
    v_max3_f32 v216, v216, v10, v11
    v_max3_f32 v217, v217, v12, v13
    v_max3_f32 v216, v216, v14, v15
    v_max3_f32 v217, v217, v16, v17
    v_max3_f32 v216, v216, v18, v19
    v_max3_f32 v217, v217, v20, v21
    v_max3_f32 v216, v216, v22, v23
    v_mfma_f32_16x16x32_bf16 v[80:83], a[8:11], v[148:151], v[164:167]
    v_max3_f32 v217, v217, v24, v25
    v_max3_f32 v216, v216, v26, v27
    v_max3_f32 v217, v217, v28, v29
    v_max3_f32 v216, v216, v30, v31
    v_max3_f32 v217, v217, v32, v33
    v_max3_f32 v216, v216, v34, v35
    v_max3_f32 v217, v217, v36, v37
    v_max3_f32 v216, v216, v38, v39
    v_max3_f32 v217, v217, v40, v41
    v_max3_f32 v216, v216, v42, v43
    v_mfma_f32_16x16x32_bf16 v[84:87], a[12:15], v[148:151], v[164:167]
    v_max3_f32 v217, v217, v44, v45
    v_max3_f32 v216, v216, v46, v47
    v_max3_f32 v217, v217, v48, v49
    v_max3_f32 v216, v216, v50, v51
    v_max3_f32 v217, v217, v52, v53
    v_max3_f32 v216, v216, v54, v55
    v_max3_f32 v217, v217, v56, v57
    v_max3_f32 v216, v216, v58, v59
    v_max3_f32 v217, v217, v60, v61
    v_max3_f32 v216, v216, v62, v63
    v_max3_f32 v217, v217, v64, v65
    v_mfma_f32_16x16x32_bf16 v[88:91], a[16:19], v[148:151], v[168:171]
    v_max3_f32 v216, v216, v66, v67
    v_max_f32 v216, v216, v217
    v_mov_b32 v217, v216
    s_nop 1
    v_permlane16_swap_b32 v216, v217
    v_max_f32 v216, v216, v217
    v_mov_b32 v217, v216
    s_nop 1
    v_permlane32_swap_b32 v216, v217
    v_max_f32 v216, v216, v217
    v_pk_add_f32 v[0:1], v[0:1], v[216:217] op_sel_hi:[1,0] neg_lo:[0,1] neg_hi:[0,1]
    v_pk_add_f32 v[2:3], v[2:3], v[216:217] op_sel_hi:[1,0] neg_lo:[0,1] neg_hi:[0,1]
    v_pk_add_f32 v[4:5], v[4:5], v[216:217] op_sel_hi:[1,0] neg_lo:[0,1] neg_hi:[0,1]
    v_pk_add_f32 v[6:7], v[6:7], v[216:217] op_sel_hi:[1,0] neg_lo:[0,1] neg_hi:[0,1]
    v_mfma_f32_16x16x32_bf16 v[92:95], a[20:23], v[148:151], v[168:171]
    v_exp_f32 v0, v0
    v_exp_f32 v1, v1
    v_exp_f32 v2, v2
    v_exp_f32 v3, v3
    v_exp_f32 v4, v4
    v_exp_f32 v5, v5
    v_exp_f32 v6, v6
    v_exp_f32 v7, v7
    v_pk_add_f32 v[8:9], v[8:9], v[216:217] op_sel_hi:[1,0] neg_lo:[0,1] neg_hi:[0,1]
    s_waitcnt vmcnt(6)
    s_barrier
    v_pk_add_f32 v[10:11], v[10:11], v[216:217] op_sel_hi:[1,0] neg_lo:[0,1] neg_hi:[0,1]
    ds_read_b128 a[72:75], v236 offset:2048
    v_pk_add_f32 v[12:13], v[12:13], v[216:217] op_sel_hi:[1,0] neg_lo:[0,1] neg_hi:[0,1]
    v_pk_add_f32 v[14:15], v[14:15], v[216:217] op_sel_hi:[1,0] neg_lo:[0,1] neg_hi:[0,1]
    v_mfma_f32_16x16x32_bf16 v[96:99], a[24:27], v[148:151], v[172:175]
    v_cvt_pk_bf16_f32 v0, v0, v1
    ds_read_b128 a[76:79], v236 offset:3072
    v_cvt_pk_bf16_f32 v1, v2, v3
    v_cvt_pk_bf16_f32 v2, v4, v5
    v_cvt_pk_bf16_f32 v3, v6, v7
    v_mfma_f32_16x16x32_bf16 v[100:103], a[28:31], v[148:151], v[172:175]
    ds_read_b128 a[80:83], v236 offset:10240
    v_exp_f32 v8, v8
    v_exp_f32 v9, v9
    v_exp_f32 v10, v10
    ds_read_b128 a[84:87], v236 offset:11264
    v_exp_f32 v11, v11
    v_exp_f32 v12, v12
    v_exp_f32 v13, v13
    ds_read_b128 a[88:91], v236 offset:18432
    v_exp_f32 v14, v14
    v_exp_f32 v15, v15
    v_pk_add_f32 v[16:17], v[16:17], v[216:217] op_sel_hi:[1,0] neg_lo:[0,1] neg_hi:[0,1]
    ds_read_b128 a[92:95], v236 offset:19456
    v_pk_add_f32 v[18:19], v[18:19], v[216:217] op_sel_hi:[1,0] neg_lo:[0,1] neg_hi:[0,1]
    v_pk_add_f32 v[20:21], v[20:21], v[216:217] op_sel_hi:[1,0] neg_lo:[0,1] neg_hi:[0,1]
    v_pk_add_f32 v[22:23], v[22:23], v[216:217] op_sel_hi:[1,0] neg_lo:[0,1] neg_hi:[0,1]
    v_mfma_f32_16x16x32_bf16 v[104:107], a[32:35], v[148:151], v[176:179]
    ds_read_b128 a[96:99], v236 offset:26624
    v_cvt_pk_bf16_f32 v8, v8, v9
    v_cvt_pk_bf16_f32 v9, v10, v11
    v_cvt_pk_bf16_f32 v10, v12, v13
    v_mfma_f32_16x16x32_bf16 v[108:111], a[36:39], v[148:151], v[176:179]
    ds_read_b128 a[100:103], v236 offset:27648
    v_cvt_pk_bf16_f32 v11, v14, v15
    v_exp_f32 v16, v16
    v_exp_f32 v17, v17
    ds_read_b128 a[104:107], v237 offset:2048
    v_exp_f32 v18, v18
    v_exp_f32 v19, v19
    v_exp_f32 v20, v20
    ds_read_b128 a[108:111], v237 offset:3072
    v_exp_f32 v21, v21
    v_exp_f32 v22, v22
    v_mfma_f32_16x16x32_bf16 v[112:115], a[40:43], v[148:151], v[180:183]
    v_exp_f32 v23, v23
    s_add_u32 m0, s40, 98304
    s_nop 0
    buffer_load_dwordx4 v247, s[12:15], s41 offen offset:0 lds
    v_readlane_b32 s41, v245, 2
    ds_read_b128 a[112:115], v237 offset:10240
    v_pk_add_f32 v[24:25], v[24:25], v[216:217] op_sel_hi:[1,0] neg_lo:[0,1] neg_hi:[0,1]
    v_pk_add_f32 v[26:27], v[26:27], v[216:217] op_sel_hi:[1,0] neg_lo:[0,1] neg_hi:[0,1]
    v_pk_add_f32 v[28:29], v[28:29], v[216:217] op_sel_hi:[1,0] neg_lo:[0,1] neg_hi:[0,1]
    ds_read_b128 a[116:119], v237 offset:11264
    v_pk_add_f32 v[30:31], v[30:31], v[216:217] op_sel_hi:[1,0] neg_lo:[0,1] neg_hi:[0,1]
    v_cvt_pk_bf16_f32 v16, v16, v17
    v_cvt_pk_bf16_f32 v17, v18, v19
    v_mfma_f32_16x16x32_bf16 v[116:119], a[44:47], v[148:151], v[180:183]
    ds_read_b128 a[120:123], v237 offset:18432
    v_cvt_pk_bf16_f32 v18, v20, v21
    v_cvt_pk_bf16_f32 v19, v22, v23
    v_exp_f32 v24, v24
    ds_read_b128 a[124:127], v237 offset:19456
    v_exp_f32 v25, v25
    v_exp_f32 v26, v26
    v_exp_f32 v27, v27
    ds_read_b128 a[128:131], v237 offset:26624
    v_exp_f32 v28, v28
    v_mfma_f32_16x16x32_bf16 v[120:123], a[48:51], v[148:151], v[184:187]
    v_exp_f32 v29, v29
    v_exp_f32 v30, v30
    ds_read_b128 a[132:135], v237 offset:27648
    v_exp_f32 v31, v31
    v_pk_add_f32 v[32:33], v[32:33], v[216:217] op_sel_hi:[1,0] neg_lo:[0,1] neg_hi:[0,1]
    v_pk_add_f32 v[34:35], v[34:35], v[216:217] op_sel_hi:[1,0] neg_lo:[0,1] neg_hi:[0,1]
    ds_read_b128 a[136:139], v237 offset:34816
    v_pk_add_f32 v[36:37], v[36:37], v[216:217] op_sel_hi:[1,0] neg_lo:[0,1] neg_hi:[0,1]
    v_pk_add_f32 v[38:39], v[38:39], v[216:217] op_sel_hi:[1,0] neg_lo:[0,1] neg_hi:[0,1]
    v_cvt_pk_bf16_f32 v24, v24, v25
    ds_read_b128 a[140:143], v237 offset:35840
    v_mfma_f32_16x16x32_bf16 v[124:127], a[52:55], v[148:151], v[184:187]
    v_cvt_pk_bf16_f32 v25, v26, v27
    buffer_load_dwordx4 v246, s[12:15], s42 offen offset:1024 lds
    v_readlane_b32 s42, v245, 3
    v_cvt_pk_bf16_f32 v26, v28, v29
    v_cvt_pk_bf16_f32 v27, v30, v31
    ds_read_b128 a[144:147], v236 offset:4096
    v_exp_f32 v32, v32
    v_exp_f32 v33, v33
    v_exp_f32 v34, v34
    ds_read_b128 a[148:151], v236 offset:5120
    v_exp_f32 v35, v35
    v_mfma_f32_16x16x32_bf16 v[128:131], a[56:59], v[148:151], v[188:191]
    v_exp_f32 v36, v36
    v_exp_f32 v37, v37
    ds_read_b128 a[152:155], v236 offset:12288
    v_exp_f32 v38, v38
    v_exp_f32 v39, v39
    v_pk_add_f32 v[40:41], v[40:41], v[216:217] op_sel_hi:[1,0] neg_lo:[0,1] neg_hi:[0,1]
    ds_read_b128 a[156:159], v236 offset:13312
    v_pk_add_f32 v[42:43], v[42:43], v[216:217] op_sel_hi:[1,0] neg_lo:[0,1] neg_hi:[0,1]
    v_pk_add_f32 v[44:45], v[44:45], v[216:217] op_sel_hi:[1,0] neg_lo:[0,1] neg_hi:[0,1]
    v_pk_add_f32 v[46:47], v[46:47], v[216:217] op_sel_hi:[1,0] neg_lo:[0,1] neg_hi:[0,1]
    v_mfma_f32_16x16x32_bf16 v[132:135], a[60:63], v[148:151], v[188:191]
    ds_read_b128 a[160:163], v236 offset:20480
    v_cvt_pk_bf16_f32 v32, v32, v33
    v_cvt_pk_bf16_f32 v33, v34, v35
    v_cvt_pk_bf16_f32 v34, v36, v37
    ds_read_b128 a[164:167], v236 offset:21504
    v_cvt_pk_bf16_f32 v35, v38, v39
    v_exp_f32 v40, v40
    v_exp_f32 v41, v41
    ds_read_b128 a[168:171], v236 offset:28672
    v_exp_f32 v42, v42
    v_exp_f32 v43, v43
    v_mfma_f32_16x16x32_bf16 v[136:139], a[64:67], v[148:151], 0
    v_exp_f32 v44, v44
    s_add_u32 m0, s40, 106496
    s_nop 0
    buffer_load_dwordx4 v247, s[12:15], s41 offen offset:0 lds
    v_readlane_b32 s41, v245, 4
    ds_read_b128 a[172:175], v236 offset:29696
    v_exp_f32 v45, v45
    v_exp_f32 v46, v46
    v_exp_f32 v47, v47
    ds_read_b128 a[176:179], v237 offset:4096
    v_pk_add_f32 v[48:49], v[48:49], v[216:217] op_sel_hi:[1,0] neg_lo:[0,1] neg_hi:[0,1]
    v_pk_add_f32 v[50:51], v[50:51], v[216:217] op_sel_hi:[1,0] neg_lo:[0,1] neg_hi:[0,1]
    v_pk_add_f32 v[52:53], v[52:53], v[216:217] op_sel_hi:[1,0] neg_lo:[0,1] neg_hi:[0,1]
    ds_read_b128 a[180:183], v237 offset:5120
    v_pk_add_f32 v[54:55], v[54:55], v[216:217] op_sel_hi:[1,0] neg_lo:[0,1] neg_hi:[0,1]
    v_mfma_f32_16x16x32_bf16 v[140:143], a[68:71], v[148:151], v[192:195]
    v_cvt_pk_bf16_f32 v40, v40, v41
    v_cvt_pk_bf16_f32 v41, v42, v43
    ds_read_b128 a[184:187], v237 offset:12288
    v_cvt_pk_bf16_f32 v42, v44, v45
    v_cvt_pk_bf16_f32 v43, v46, v47
    v_exp_f32 v48, v48
    ds_read_b128 a[188:191], v237 offset:13312
    v_exp_f32 v49, v49
    v_exp_f32 v50, v50
    v_exp_f32 v51, v51
    ds_read_b128 a[192:195], v237 offset:20480
    v_exp_f32 v52, v52
    v_exp_f32 v53, v53
    v_exp_f32 v54, v54
    ds_read_b128 a[196:199], v237 offset:21504
    v_exp_f32 v55, v55
    v_pk_add_f32 v[56:57], v[56:57], v[216:217] op_sel_hi:[1,0] neg_lo:[0,1] neg_hi:[0,1]
    v_pk_add_f32 v[58:59], v[58:59], v[216:217] op_sel_hi:[1,0] neg_lo:[0,1] neg_hi:[0,1]
    ds_read_b128 a[200:203], v237 offset:28672
    v_pk_add_f32 v[60:61], v[60:61], v[216:217] op_sel_hi:[1,0] neg_lo:[0,1] neg_hi:[0,1]
    buffer_load_dwordx4 v246, s[12:15], s42 offen offset:1024 lds
    v_readlane_b32 s42, v245, 5
    v_pk_add_f32 v[62:63], v[62:63], v[216:217] op_sel_hi:[1,0] neg_lo:[0,1] neg_hi:[0,1]
    v_cvt_pk_bf16_f32 v48, v48, v49
    ds_read_b128 a[204:207], v237 offset:29696
    v_cvt_pk_bf16_f32 v49, v50, v51
    v_cvt_pk_bf16_f32 v50, v52, v53
    v_cvt_pk_bf16_f32 v51, v54, v55
    ds_read_b128 a[208:211], v237 offset:36864
    v_exp_f32 v56, v56
    v_exp_f32 v57, v57
    v_exp_f32 v58, v58
    ds_read_b128 a[212:215], v237 offset:37888
    v_exp_f32 v59, v59
    v_exp_f32 v60, v60
    v_exp_f32 v61, v61
    v_exp_f32 v62, v62
    v_exp_f32 v63, v63
    v_pk_add_f32 v[64:65], v[64:65], v[216:217] op_sel_hi:[1,0] neg_lo:[0,1] neg_hi:[0,1]
    v_pk_add_f32 v[66:67], v[66:67], v[216:217] op_sel_hi:[1,0] neg_lo:[0,1] neg_hi:[0,1]
    v_cvt_pk_bf16_f32 v56, v56, v57
    v_cvt_pk_bf16_f32 v57, v58, v59
    v_cvt_pk_bf16_f32 v58, v60, v61
    v_cvt_pk_bf16_f32 v59, v62, v63
    v_exp_f32 v64, v64
    v_exp_f32 v65, v65
    v_exp_f32 v66, v66
    v_exp_f32 v67, v67
    v_cvt_pk_bf16_f32 v64, v64, v65
    v_cvt_pk_bf16_f32 v65, v66, v67
    v_mov_b32 v66, 0
    v_mov_b32 v67, 0
    s_add_u32 m0, s40, 114688
    s_nop 0
    buffer_load_dwordx4 v247, s[12:15], s41 offen offset:0 lds
    v_readlane_b32 s41, v245, 6
    buffer_load_dwordx4 v246, s[12:15], s42 offen offset:1024 lds
    v_readlane_b32 s42, v245, 7
    s_waitcnt lgkmcnt(15)
    v_mfma_f32_16x16x32_bf16 v[200:203], a[72:75], v[0:3], 0
    ds_read_b128 a[0:3], v236 offset:6144
    v_max3_f32 v216, v76, v77, v78
    v_max3_f32 v217, v79, v80, v81
    v_mfma_f32_16x16x32_bf16 v[204:207], a[76:79], v[0:3], 0
    v_max3_f32 v216, v216, v82, v83
    v_max3_f32 v217, v217, v84, v85
    v_mfma_f32_16x16x32_bf16 v[208:211], v[212:215], v[0:3], 0
    v_max3_f32 v216, v216, v86, v87
    v_max3_f32 v217, v217, v88, v89
    v_mfma_f32_16x16x32_bf16 v[200:203], a[80:83], v[8:11], v[200:203]
    ds_read_b128 a[4:7], v236 offset:7168
    v_max3_f32 v216, v216, v90, v91
    v_max3_f32 v217, v217, v92, v93
    v_mfma_f32_16x16x32_bf16 v[204:207], a[84:87], v[8:11], v[204:207]
    v_max3_f32 v216, v216, v94, v95
    v_max3_f32 v217, v217, v96, v97
    v_mfma_f32_16x16x32_bf16 v[208:211], v[212:215], v[8:11], v[208:211]
    v_max3_f32 v216, v216, v98, v99
    v_max3_f32 v217, v217, v100, v101
    v_mfma_f32_16x16x32_bf16 v[200:203], a[88:91], v[16:19], v[200:203]
    v_max3_f32 v216, v216, v102, v103
    ds_read_b128 a[8:11], v236 offset:14336
    v_max3_f32 v217, v217, v104, v105
    v_mfma_f32_16x16x32_bf16 v[204:207], a[92:95], v[16:19], v[204:207]
    v_max3_f32 v216, v216, v106, v107
    v_max3_f32 v217, v217, v108, v109
    v_mfma_f32_16x16x32_bf16 v[208:211], v[212:215], v[16:19], v[208:211]
    s_add_u32 m0, s40, 122880
    s_nop 0
    buffer_load_dwordx4 v247, s[12:15], s41 offen offset:0 lds
    v_readlane_b32 s41, v245, 8
    v_max3_f32 v216, v216, v110, v111
    v_mfma_f32_16x16x32_bf16 v[200:203], a[96:99], v[24:27], v[200:203]
    v_max3_f32 v217, v217, v112, v113
    v_max3_f32 v216, v216, v114, v115
    ds_read_b128 a[12:15], v236 offset:15360
    v_max3_f32 v217, v217, v116, v117
    v_mfma_f32_16x16x32_bf16 v[204:207], a[100:103], v[24:27], v[204:207]
    v_max3_f32 v216, v216, v118, v119
    v_max3_f32 v217, v217, v120, v121
    v_mfma_f32_16x16x32_bf16 v[208:211], v[212:215], v[24:27], v[208:211]
    v_max3_f32 v216, v216, v122, v123
    v_max3_f32 v217, v217, v124, v125
    v_mfma_f32_16x16x32_bf16 v[200:203], a[104:107], v[32:35], v[200:203]
    v_max3_f32 v216, v216, v126, v127
    v_max3_f32 v217, v217, v128, v129
    v_mfma_f32_16x16x32_bf16 v[204:207], a[108:111], v[32:35], v[204:207]
    ds_read_b128 a[16:19], v236 offset:22528
    v_max3_f32 v216, v216, v130, v131
    v_max3_f32 v217, v217, v132, v133
    v_mfma_f32_16x16x32_bf16 v[208:211], v[212:215], v[32:35], v[208:211]
    v_max3_f32 v216, v216, v134, v135
    v_max3_f32 v217, v217, v136, v137
    v_mfma_f32_16x16x32_bf16 v[200:203], a[112:115], v[40:43], v[200:203]
    v_max3_f32 v216, v216, v138, v139
    v_max3_f32 v217, v217, v140, v141
    v_mfma_f32_16x16x32_bf16 v[204:207], a[116:119], v[40:43], v[204:207]
    buffer_load_dwordx4 v246, s[12:15], s42 offen offset:1024 lds
    v_readlane_b32 s42, v245, 9
    ds_read_b128 a[20:23], v236 offset:23552
    v_max3_f32 v216, v216, v142, v143
    v_mfma_f32_16x16x32_bf16 v[208:211], v[212:215], v[40:43], v[208:211]
    v_max_f32 v216, v216, v217
    v_mov_b32 v217, v216
    v_mfma_f32_16x16x32_bf16 v[200:203], a[120:123], v[48:51], v[200:203]
    s_nop 0
    v_permlane16_swap_b32 v216, v217
    v_max_f32 v216, v216, v217
    v_mfma_f32_16x16x32_bf16 v[204:207], a[124:127], v[48:51], v[204:207]
    v_mov_b32 v217, v216
    s_nop 1
    v_permlane32_swap_b32 v216, v217
    ds_read_b128 a[24:27], v236 offset:30720
    v_max_f32 v216, v216, v217
    v_pk_add_f32 v[76:77], v[76:77], v[216:217] op_sel_hi:[1,0] neg_lo:[0,1] neg_hi:[0,1]
    v_pk_add_f32 v[78:79], v[78:79], v[216:217] op_sel_hi:[1,0] neg_lo:[0,1] neg_hi:[0,1]
    v_mfma_f32_16x16x32_bf16 v[208:211], v[212:215], v[48:51], v[208:211]
    v_exp_f32 v76, v76
    v_mfma_f32_16x16x32_bf16 v[200:203], a[128:131], v[56:59], v[200:203]
    v_exp_f32 v77, v77
    v_mfma_f32_16x16x32_bf16 v[204:207], a[132:135], v[56:59], v[204:207]
    v_exp_f32 v78, v78
    v_exp_f32 v79, v79
    ds_read_b128 a[28:31], v236 offset:31744
    v_pk_add_f32 v[80:81], v[80:81], v[216:217] op_sel_hi:[1,0] neg_lo:[0,1] neg_hi:[0,1]
    v_pk_add_f32 v[82:83], v[82:83], v[216:217] op_sel_hi:[1,0] neg_lo:[0,1] neg_hi:[0,1]
    s_add_u32 m0, s40, 131072
    s_nop 0
    buffer_load_dwordx4 v247, s[12:15], s41 offen offset:0 lds
    v_readlane_b32 s41, v245, 10
    v_pk_add_f32 v[84:85], v[84:85], v[216:217] op_sel_hi:[1,0] neg_lo:[0,1] neg_hi:[0,1]
    v_pk_add_f32 v[86:87], v[86:87], v[216:217] op_sel_hi:[1,0] neg_lo:[0,1] neg_hi:[0,1]
    v_mfma_f32_16x16x32_bf16 v[208:211], v[212:215], v[56:59], v[208:211]
    v_mov_b32 v72, 0
    v_mfma_f32_16x16x32_bf16 v[200:203], a[136:139], v[64:67], v[200:203]
    ds_read_b128 a[32:35], v237 offset:6144
    v_mov_b32 v73, 0
    v_mfma_f32_16x16x32_bf16 v[204:207], a[140:143], v[64:67], v[204:207]
    v_cvt_pk_bf16_f32 v74, v76, v77
    v_mfma_f32_16x16x32_bf16 v[208:211], v[212:215], v[64:67], v[208:211]
    v_cvt_pk_bf16_f32 v75, v78, v79
    v_mfma_f32_16x16x32_bf16 v[0:3], a[144:147], v[152:155], v[196:199]
    v_exp_f32 v80, v80
    v_exp_f32 v81, v81
    v_exp_f32 v82, v82
    v_exp_f32 v83, v83
    ds_read_b128 a[36:39], v237 offset:7168
    v_exp_f32 v84, v84
    v_mfma_f32_16x16x32_bf16 v[4:7], a[148:151], v[152:155], v[160:163]
    v_exp_f32 v85, v85
    v_exp_f32 v86, v86
    v_exp_f32 v87, v87
    v_rcp_f32 v218, v208
    v_pk_add_f32 v[88:89], v[88:89], v[216:217] op_sel_hi:[1,0] neg_lo:[0,1] neg_hi:[0,1]
    v_mul_f32 v200, v218, v200
    v_pk_add_f32 v[90:91], v[90:91], v[216:217] op_sel_hi:[1,0] neg_lo:[0,1] neg_hi:[0,1]
    v_mul_f32 v201, v218, v201
    buffer_load_dwordx4 v246, s[12:15], s42 offen offset:1024 lds
    v_readlane_b32 s42, v245, 11
    ds_read_b128 a[40:43], v237 offset:14336
    v_mul_f32 v202, v218, v202
    v_pk_add_f32 v[92:93], v[92:93], v[216:217] op_sel_hi:[1,0] neg_lo:[0,1] neg_hi:[0,1]
    v_mul_f32 v203, v218, v203
    v_pk_add_f32 v[94:95], v[94:95], v[216:217] op_sel_hi:[1,0] neg_lo:[0,1] neg_hi:[0,1]
    v_mfma_f32_16x16x32_bf16 v[8:11], a[152:155], v[152:155], v[164:167]
    v_mul_f32 v204, v218, v204
    v_cvt_pk_bf16_f32 v80, v80, v81
    v_mul_f32 v205, v218, v205
    v_cvt_pk_bf16_f32 v81, v82, v83
    v_mul_f32 v206, v218, v206
    v_cvt_pk_bf16_f32 v82, v84, v85
    v_mul_f32 v207, v218, v207
    v_cvt_pk_bf16_f32 v83, v86, v87
    v_cvt_pk_bf16_f32 v220, v200, v201
    v_exp_f32 v88, v88
    s_waitcnt lgkmcnt(15)
    v_mfma_f32_16x16x32_bf16 v[12:15], a[156:159], v[152:155], v[164:167]
    ds_read_b128 a[44:47], v237 offset:15360
    v_cvt_pk_bf16_f32 v221, v202, v203
    v_exp_f32 v89, v89
    v_cvt_pk_bf16_f32 v222, v204, v205
    v_exp_f32 v90, v90
    v_cvt_pk_bf16_f32 v223, v206, v207
    v_exp_f32 v91, v91
    buffer_store_dwordx4 v[220:223], v254, s[16:19], 0 offen offset:0 sc1
    v_exp_f32 v92, v92
    v_exp_f32 v93, v93
    v_exp_f32 v94, v94
    v_exp_f32 v95, v95
    ds_read_b128 a[48:51], v237 offset:22528
    v_pk_add_f32 v[96:97], v[96:97], v[216:217] op_sel_hi:[1,0] neg_lo:[0,1] neg_hi:[0,1]
    v_pk_add_f32 v[98:99], v[98:99], v[216:217] op_sel_hi:[1,0] neg_lo:[0,1] neg_hi:[0,1]
    s_add_u32 m0, s40, 139264
    s_nop 0
    buffer_load_dwordx4 v247, s[12:15], s41 offen offset:0 lds
    v_readlane_b32 s41, v245, 12
    v_pk_add_f32 v[100:101], v[100:101], v[216:217] op_sel_hi:[1,0] neg_lo:[0,1] neg_hi:[0,1]
    v_pk_add_f32 v[102:103], v[102:103], v[216:217] op_sel_hi:[1,0] neg_lo:[0,1] neg_hi:[0,1]
    v_mfma_f32_16x16x32_bf16 v[16:19], a[160:163], v[152:155], v[168:171]
    v_cvt_pk_bf16_f32 v88, v88, v89
    v_mfma_f32_16x16x32_bf16 v[20:23], a[164:167], v[152:155], v[168:171]
    v_cvt_pk_bf16_f32 v89, v90, v91
    ds_read_b128 a[52:55], v237 offset:23552
    v_cvt_pk_bf16_f32 v90, v92, v93
    v_cvt_pk_bf16_f32 v91, v94, v95
    v_exp_f32 v96, v96
    v_exp_f32 v97, v97
    v_mfma_f32_16x16x32_bf16 v[24:27], a[168:171], v[152:155], v[172:175]
    v_exp_f32 v98, v98
    v_exp_f32 v99, v99
    v_exp_f32 v100, v100
    ds_read_b128 a[56:59], v237 offset:30720
    v_exp_f32 v101, v101
    v_exp_f32 v102, v102
    v_exp_f32 v103, v103
    v_pk_add_f32 v[104:105], v[104:105], v[216:217] op_sel_hi:[1,0] neg_lo:[0,1] neg_hi:[0,1]
    v_pk_add_f32 v[106:107], v[106:107], v[216:217] op_sel_hi:[1,0] neg_lo:[0,1] neg_hi:[0,1]
    v_pk_add_f32 v[108:109], v[108:109], v[216:217] op_sel_hi:[1,0] neg_lo:[0,1] neg_hi:[0,1]
    buffer_load_dwordx4 v246, s[12:15], s42 offen offset:1024 lds
    v_readlane_b32 s42, v245, 13
    ds_read_b128 a[60:63], v237 offset:31744
    v_pk_add_f32 v[110:111], v[110:111], v[216:217] op_sel_hi:[1,0] neg_lo:[0,1] neg_hi:[0,1]
    v_mfma_f32_16x16x32_bf16 v[28:31], a[172:175], v[152:155], v[172:175]
    v_cvt_pk_bf16_f32 v96, v96, v97
    v_mfma_f32_16x16x32_bf16 v[32:35], a[176:179], v[152:155], v[176:179]
    v_cvt_pk_bf16_f32 v97, v98, v99
    v_cvt_pk_bf16_f32 v98, v100, v101
    v_cvt_pk_bf16_f32 v99, v102, v103
    v_exp_f32 v104, v104
    ds_read_b128 a[64:67], v237 offset:38912
    v_exp_f32 v105, v105
    v_exp_f32 v106, v106
    v_mfma_f32_16x16x32_bf16 v[36:39], a[180:183], v[152:155], v[176:179]
    v_exp_f32 v107, v107
    v_exp_f32 v108, v108
    v_exp_f32 v109, v109
    v_exp_f32 v110, v110
    v_exp_f32 v111, v111
    ds_read_b128 a[68:71], v237 offset:39936
    v_pk_add_f32 v[112:113], v[112:113], v[216:217] op_sel_hi:[1,0] neg_lo:[0,1] neg_hi:[0,1]
    v_pk_add_f32 v[114:115], v[114:115], v[216:217] op_sel_hi:[1,0] neg_lo:[0,1] neg_hi:[0,1]
    v_pk_add_f32 v[116:117], v[116:117], v[216:217] op_sel_hi:[1,0] neg_lo:[0,1] neg_hi:[0,1]
    s_add_u32 m0, s40, 147456
    s_nop 0
    buffer_load_dwordx4 v247, s[12:15], s41 offen offset:0 lds
    v_readlane_b32 s41, v245, 14
    v_pk_add_f32 v[118:119], v[118:119], v[216:217] op_sel_hi:[1,0] neg_lo:[0,1] neg_hi:[0,1]
    v_mfma_f32_16x16x32_bf16 v[40:43], a[184:187], v[152:155], v[180:183]
    v_cvt_pk_bf16_f32 v104, v104, v105
    v_cvt_pk_bf16_f32 v105, v106, v107
    v_mfma_f32_16x16x32_bf16 v[44:47], a[188:191], v[152:155], v[180:183]
    s_mov_b32 s57, 417792
    v_cvt_pk_bf16_f32 v106, v108, v109
    v_cvt_pk_bf16_f32 v107, v110, v111
    v_exp_f32 v112, v112
    v_exp_f32 v113, v113
    v_exp_f32 v114, v114
    v_exp_f32 v115, v115
    v_exp_f32 v116, v116
    v_mfma_f32_16x16x32_bf16 v[48:51], a[192:195], v[152:155], v[184:187]
    v_and_b32 v233, 15, v255
    v_exp_f32 v117, v117
    v_exp_f32 v118, v118
    v_exp_f32 v119, v119
    v_pk_add_f32 v[120:121], v[120:121], v[216:217] op_sel_hi:[1,0] neg_lo:[0,1] neg_hi:[0,1]
    v_pk_add_f32 v[122:123], v[122:123], v[216:217] op_sel_hi:[1,0] neg_lo:[0,1] neg_hi:[0,1]
    v_pk_add_f32 v[124:125], v[124:125], v[216:217] op_sel_hi:[1,0] neg_lo:[0,1] neg_hi:[0,1]
    buffer_load_dwordx4 v246, s[12:15], s42 offen offset:1024 lds
    v_readlane_b32 s42, v245, 15
    v_mul_u32_u24 v233, 4352, v233
    v_pk_add_f32 v[126:127], v[126:127], v[216:217] op_sel_hi:[1,0] neg_lo:[0,1] neg_hi:[0,1]
    v_mfma_f32_16x16x32_bf16 v[52:55], a[196:199], v[152:155], v[184:187]
    v_cvt_pk_bf16_f32 v112, v112, v113
    v_cvt_pk_bf16_f32 v113, v114, v115
    v_cvt_pk_bf16_f32 v114, v116, v117
    v_cvt_pk_bf16_f32 v115, v118, v119
    s_waitcnt lgkmcnt(15)
    v_mfma_f32_16x16x32_bf16 v[56:59], a[200:203], v[152:155], v[188:191]
    v_exp_f32 v120, v120
    v_exp_f32 v121, v121
    buffer_load_dword v232, v233, s[20:23], s57 offen sc1
    v_exp_f32 v122, v122
    v_exp_f32 v123, v123
    v_exp_f32 v124, v124
    v_exp_f32 v125, v125
    v_mfma_f32_16x16x32_bf16 v[60:63], a[204:207], v[152:155], v[188:191]
    v_exp_f32 v126, v126
    v_exp_f32 v127, v127
    v_pk_add_f32 v[128:129], v[128:129], v[216:217] op_sel_hi:[1,0] neg_lo:[0,1] neg_hi:[0,1]
    v_pk_add_f32 v[130:131], v[130:131], v[216:217] op_sel_hi:[1,0] neg_lo:[0,1] neg_hi:[0,1]
    v_pk_add_f32 v[132:133], v[132:133], v[216:217] op_sel_hi:[1,0] neg_lo:[0,1] neg_hi:[0,1]
    s_add_u32 m0, s40, 155648
    s_nop 0
    buffer_load_dwordx4 v247, s[12:15], s41 offen offset:0 lds
    v_readlane_b32 s41, v245, 16
    v_pk_add_f32 v[134:135], v[134:135], v[216:217] op_sel_hi:[1,0] neg_lo:[0,1] neg_hi:[0,1]
    v_mfma_f32_16x16x32_bf16 v[64:67], a[208:211], v[152:155], v[192:195]
    v_cvt_pk_bf16_f32 v120, v120, v121
    v_cvt_pk_bf16_f32 v121, v122, v123
    v_cvt_pk_bf16_f32 v122, v124, v125
    v_cvt_pk_bf16_f32 v123, v126, v127
    v_exp_f32 v128, v128
    v_exp_f32 v129, v129
    v_exp_f32 v130, v130
    v_exp_f32 v131, v131
    v_exp_f32 v132, v132
    v_exp_f32 v133, v133
    v_exp_f32 v134, v134
    v_exp_f32 v135, v135
    v_pk_add_f32 v[136:137], v[136:137], v[216:217] op_sel_hi:[1,0] neg_lo:[0,1] neg_hi:[0,1]
    v_pk_add_f32 v[138:139], v[138:139], v[216:217] op_sel_hi:[1,0] neg_lo:[0,1] neg_hi:[0,1]
    v_pk_add_f32 v[140:141], v[140:141], v[216:217] op_sel_hi:[1,0] neg_lo:[0,1] neg_hi:[0,1]
    buffer_load_dwordx4 v246, s[12:15], s42 offen offset:1024 lds
    v_readlane_b32 s42, v245, 17
    v_pk_add_f32 v[142:143], v[142:143], v[216:217] op_sel_hi:[1,0] neg_lo:[0,1] neg_hi:[0,1]
    v_cvt_pk_bf16_f32 v128, v128, v129
    v_cvt_pk_bf16_f32 v129, v130, v131
    v_cvt_pk_bf16_f32 v130, v132, v133
    v_cvt_pk_bf16_f32 v131, v134, v135
    v_exp_f32 v136, v136
    v_exp_f32 v137, v137
    v_exp_f32 v138, v138
    v_exp_f32 v139, v139
    v_exp_f32 v140, v140
    v_exp_f32 v141, v141
    v_exp_f32 v142, v142
    v_exp_f32 v143, v143
    v_cvt_pk_bf16_f32 v136, v136, v137
    v_cvt_pk_bf16_f32 v137, v138, v139
    v_cvt_pk_bf16_f32 v138, v140, v141
    v_cvt_pk_bf16_f32 v139, v142, v143
    s_waitcnt lgkmcnt(0)
    s_barrier
    s_waitcnt vmcnt(2)
    v_cmp_gt_u32 vcc, 16, v232
    s_cbranch_vccz L_chk14
    s_mov_b64 exec, -1
    s_mov_b32 s3, 0x40000
L_poll15:
    buffer_load_dword v232, v233, s[20:23], s57 offen sc1
    s_sub_u32 s3, s3, 1
    s_cbranch_scc1 L_poll15_y
    s_waitcnt vmcnt(0)
    v_cmp_gt_u32 vcc, 16, v232
    s_cbranch_vccz L_poll15_y
    s_sleep 1
    s_branch L_poll15
L_poll15_y:
    s_waitcnt vmcnt(0)
    s_mov_b64 exec, -1
L_poll15_x:
L_chk14:
    v_max3_f32 v216, v0, v1, v2
    v_mfma_f32_16x16x32_bf16 v[200:203], a[72:75], v[72:75], 0
    s_add_u32 s24, s82, 0x1880000
    s_addc_u32 s25, s83, 0
    v_max3_f32 v217, v3, v4, v5
    v_mfma_f32_16x16x32_bf16 v[204:207], a[76:79], v[72:75], 0
    v_max3_f32 v216, v216, v6, v7
    v_max3_f32 v217, v217, v8, v9
    v_mfma_f32_16x16x32_bf16 v[208:211], v[212:215], v[72:75], 0
    v_max3_f32 v216, v216, v10, v11
    v_max3_f32 v217, v217, v12, v13
    v_mfma_f32_16x16x32_bf16 v[200:203], a[80:83], v[80:83], v[200:203]
    s_mov_b32 s26, 0x2000
    v_max3_f32 v216, v216, v14, v15
    v_max3_f32 v217, v217, v16, v17
    v_mfma_f32_16x16x32_bf16 v[204:207], a[84:87], v[80:83], v[204:207]
    v_max3_f32 v216, v216, v18, v19
    v_max3_f32 v217, v217, v20, v21
    v_mfma_f32_16x16x32_bf16 v[208:211], v[212:215], v[80:83], v[208:211]
    v_max3_f32 v216, v216, v22, v23
    s_mov_b32 s27, 0x20000
    v_max3_f32 v217, v217, v24, v25
    v_mfma_f32_16x16x32_bf16 v[200:203], a[88:91], v[88:91], v[200:203]
    v_max3_f32 v216, v216, v26, v27
    v_max3_f32 v217, v217, v28, v29
    v_mfma_f32_16x16x32_bf16 v[204:207], a[92:95], v[88:91], v[204:207]
    v_max3_f32 v216, v216, v30, v31
    v_max3_f32 v217, v217, v32, v33
    v_mfma_f32_16x16x32_bf16 v[208:211], v[212:215], v[88:91], v[208:211]
    v_lshrrev_b32 v232, 3, v255
    v_max3_f32 v216, v216, v34, v35
    v_max3_f32 v217, v217, v36, v37
    v_mfma_f32_16x16x32_bf16 v[200:203], a[96:99], v[96:99], v[200:203]
    v_max3_f32 v216, v216, v38, v39
    v_max3_f32 v217, v217, v40, v41
    v_mfma_f32_16x16x32_bf16 v[204:207], a[100:103], v[96:99], v[204:207]
    v_max3_f32 v216, v216, v42, v43
    s_lshl_b32 s34, s28, 3
    v_max3_f32 v217, v217, v44, v45
    v_mfma_f32_16x16x32_bf16 v[208:211], v[212:215], v[96:99], v[208:211]
    v_max3_f32 v216, v216, v46, v47
    v_max3_f32 v217, v217, v48, v49
    v_mfma_f32_16x16x32_bf16 v[200:203], a[104:107], v[104:107], v[200:203]
    v_max3_f32 v216, v216, v50, v51
    v_max3_f32 v217, v217, v52, v53
    v_mfma_f32_16x16x32_bf16 v[204:207], a[108:111], v[104:107], v[204:207]
    v_max3_f32 v216, v216, v54, v55
    v_add_lshl_u32 v232, v232, s34, 2
    v_max3_f32 v217, v217, v56, v57
    v_mfma_f32_16x16x32_bf16 v[208:211], v[212:215], v[104:107], v[208:211]
    v_max3_f32 v216, v216, v58, v59
    v_max3_f32 v217, v217, v60, v61
    v_mfma_f32_16x16x32_bf16 v[200:203], a[112:115], v[112:115], v[200:203]
    v_max3_f32 v216, v216, v62, v63
    v_max3_f32 v217, v217, v64, v65
    v_mfma_f32_16x16x32_bf16 v[204:207], a[116:119], v[112:115], v[204:207]
    ds_bpermute_b32 v232, v232, v245
    v_max3_f32 v216, v216, v66, v67
    v_max_f32 v216, v216, v217
    v_mfma_f32_16x16x32_bf16 v[208:211], v[212:215], v[112:115], v[208:211]
    v_mov_b32 v217, v216
    s_nop 1
    v_permlane16_swap_b32 v216, v217
    v_mfma_f32_16x16x32_bf16 v[200:203], a[120:123], v[120:123], v[200:203]
    v_max_f32 v216, v216, v217
    v_and_b32 v233, 7, v255
    v_mov_b32 v217, v216
    v_mfma_f32_16x16x32_bf16 v[204:207], a[124:127], v[120:123], v[204:207]
    s_nop 0
    v_permlane32_swap_b32 v216, v217
    v_max_f32 v216, v216, v217
    v_pk_add_f32 v[0:1], v[0:1], v[216:217] op_sel_hi:[1,0] neg_lo:[0,1] neg_hi:[0,1]
    v_pk_add_f32 v[2:3], v[2:3], v[216:217] op_sel_hi:[1,0] neg_lo:[0,1] neg_hi:[0,1]
    v_lshlrev_b32 v233, 5, v233
    v_pk_add_f32 v[4:5], v[4:5], v[216:217] op_sel_hi:[1,0] neg_lo:[0,1] neg_hi:[0,1]
    v_pk_add_f32 v[6:7], v[6:7], v[216:217] op_sel_hi:[1,0] neg_lo:[0,1] neg_hi:[0,1]
    v_mfma_f32_16x16x32_bf16 v[208:211], v[212:215], v[120:123], v[208:211]
    v_exp_f32 v0, v0
    v_mfma_f32_16x16x32_bf16 v[200:203], a[128:131], v[128:131], v[200:203]
    v_exp_f32 v1, v1
    v_mfma_f32_16x16x32_bf16 v[204:207], a[132:135], v[128:131], v[204:207]
    v_exp_f32 v2, v2
    v_mfma_f32_16x16x32_bf16 v[208:211], v[212:215], v[128:131], v[208:211]
    v_exp_f32 v3, v3
    v_mfma_f32_16x16x32_bf16 v[200:203], a[136:139], v[136:139], v[200:203]
    s_waitcnt lgkmcnt(0)
    v_lshrrev_b32 v232, 8, v232
    v_exp_f32 v4, v4
    v_exp_f32 v5, v5
    v_mfma_f32_16x16x32_bf16 v[204:207], a[140:143], v[136:139], v[204:207]
    v_exp_f32 v6, v6
    v_exp_f32 v7, v7
    v_pk_add_f32 v[8:9], v[8:9], v[216:217] op_sel_hi:[1,0] neg_lo:[0,1] neg_hi:[0,1]
    v_add_u32 v232, v232, v233
    v_pk_add_f32 v[10:11], v[10:11], v[216:217] op_sel_hi:[1,0] neg_lo:[0,1] neg_hi:[0,1]
    v_pk_add_f32 v[12:13], v[12:13], v[216:217] op_sel_hi:[1,0] neg_lo:[0,1] neg_hi:[0,1]
    v_pk_add_f32 v[14:15], v[14:15], v[216:217] op_sel_hi:[1,0] neg_lo:[0,1] neg_hi:[0,1]
    v_mfma_f32_16x16x32_bf16 v[208:211], v[212:215], v[136:139], v[208:211]
    v_cvt_pk_bf16_f32 v0, v0, v1
    v_mfma_f32_16x16x32_bf16 v[76:79], a[148:151], v[156:159], v[196:199]
    v_cvt_pk_bf16_f32 v1, v2, v3
    s_lshl_b32 s35, s28, 10
    v_cvt_pk_bf16_f32 v2, v4, v5
    v_cvt_pk_bf16_f32 v3, v6, v7
    v_mfma_f32_16x16x32_bf16 v[80:83], a[152:155], v[156:159], v[164:167]
    v_exp_f32 v8, v8
    v_exp_f32 v9, v9
    v_exp_f32 v10, v10
    s_mov_b32 m0, s35
    v_exp_f32 v11, v11
    v_exp_f32 v12, v12
    v_mfma_f32_16x16x32_bf16 v[84:87], a[156:159], v[156:159], v[164:167]
    v_rcp_f32 v218, v208
    v_exp_f32 v13, v13
    v_mul_f32 v200, v218, v200
    v_exp_f32 v14, v14
    v_mul_f32 v201, v218, v201
    v_exp_f32 v15, v15
    v_mul_f32 v202, v218, v202
    v_pk_add_f32 v[16:17], v[16:17], v[216:217] op_sel_hi:[1,0] neg_lo:[0,1] neg_hi:[0,1]
    buffer_load_dwordx4 v232, s[24:27], 0 offen sc1 lds
    v_mul_f32 v203, v218, v203
    v_pk_add_f32 v[18:19], v[18:19], v[216:217] op_sel_hi:[1,0] neg_lo:[0,1] neg_hi:[0,1]
    v_mul_f32 v204, v218, v204
    v_pk_add_f32 v[20:21], v[20:21], v[216:217] op_sel_hi:[1,0] neg_lo:[0,1] neg_hi:[0,1]
    v_mul_f32 v205, v218, v205
    v_pk_add_f32 v[22:23], v[22:23], v[216:217] op_sel_hi:[1,0] neg_lo:[0,1] neg_hi:[0,1]
    v_mfma_f32_16x16x32_bf16 v[88:91], a[160:163], v[156:159], v[168:171]
    v_mul_f32 v206, v218, v206
    v_cvt_pk_bf16_f32 v8, v8, v9
    v_mul_f32 v207, v218, v207
    v_cvt_pk_bf16_f32 v9, v10, v11
    s_add_u32 m0, s40, 4096
    v_cvt_pk_bf16_f32 v220, v200, v201
    v_cvt_pk_bf16_f32 v10, v12, v13
    v_cvt_pk_bf16_f32 v221, v202, v203
    v_cvt_pk_bf16_f32 v11, v14, v15
    v_cvt_pk_bf16_f32 v222, v204, v205
    v_exp_f32 v16, v16
    v_mfma_f32_16x16x32_bf16 v[92:95], a[164:167], v[156:159], v[168:171]
    v_cvt_pk_bf16_f32 v223, v206, v207
    v_exp_f32 v17, v17
    buffer_store_dwordx4 v[220:223], v254, s[16:19], 0 offen offset:1024 sc1
    v_exp_f32 v18, v18
    buffer_load_dwordx4 v247, s[12:15], s41 offen offset:0 lds
    v_exp_f32 v19, v19
    v_exp_f32 v20, v20
    v_exp_f32 v21, v21
    v_exp_f32 v22, v22
    v_exp_f32 v23, v23
    v_readlane_b32 s41, v245, 18
    v_pk_add_f32 v[24:25], v[24:25], v[216:217] op_sel_hi:[1,0] neg_lo:[0,1] neg_hi:[0,1]
    v_pk_add_f32 v[26:27], v[26:27], v[216:217] op_sel_hi:[1,0] neg_lo:[0,1] neg_hi:[0,1]
    v_pk_add_f32 v[28:29], v[28:29], v[216:217] op_sel_hi:[1,0] neg_lo:[0,1] neg_hi:[0,1]
    v_pk_add_f32 v[30:31], v[30:31], v[216:217] op_sel_hi:[1,0] neg_lo:[0,1] neg_hi:[0,1]
    v_mfma_f32_16x16x32_bf16 v[96:99], a[168:171], v[156:159], v[172:175]
    v_cvt_pk_bf16_f32 v16, v16, v17
    v_mfma_f32_16x16x32_bf16 v[100:103], a[172:175], v[156:159], v[172:175]
    v_cvt_pk_bf16_f32 v17, v18, v19
    buffer_load_dwordx4 v246, s[12:15], s42 offen offset:1024 lds
    v_cvt_pk_bf16_f32 v18, v20, v21
    v_cvt_pk_bf16_f32 v19, v22, v23
    v_exp_f32 v24, v24
    v_exp_f32 v25, v25
    v_mfma_f32_16x16x32_bf16 v[104:107], a[176:179], v[156:159], v[176:179]
    v_exp_f32 v26, v26
    v_readlane_b32 s42, v245, 19
    v_exp_f32 v27, v27
    v_exp_f32 v28, v28
    v_exp_f32 v29, v29
    v_exp_f32 v30, v30
    v_exp_f32 v31, v31
    s_add_u32 m0, s40, 12288
    v_pk_add_f32 v[32:33], v[32:33], v[216:217] op_sel_hi:[1,0] neg_lo:[0,1] neg_hi:[0,1]
    v_pk_add_f32 v[34:35], v[34:35], v[216:217] op_sel_hi:[1,0] neg_lo:[0,1] neg_hi:[0,1]
    v_pk_add_f32 v[36:37], v[36:37], v[216:217] op_sel_hi:[1,0] neg_lo:[0,1] neg_hi:[0,1]
    v_pk_add_f32 v[38:39], v[38:39], v[216:217] op_sel_hi:[1,0] neg_lo:[0,1] neg_hi:[0,1]
    v_mfma_f32_16x16x32_bf16 v[108:111], a[180:183], v[156:159], v[176:179]
    v_cvt_pk_bf16_f32 v24, v24, v25
    buffer_load_dwordx4 v247, s[12:15], s41 offen offset:0 lds
    v_cvt_pk_bf16_f32 v25, v26, v27
    v_mfma_f32_16x16x32_bf16 v[112:115], a[184:187], v[156:159], v[180:183]
    v_cvt_pk_bf16_f32 v26, v28, v29
    v_cvt_pk_bf16_f32 v27, v30, v31
    v_exp_f32 v32, v32
    v_exp_f32 v33, v33
    v_readlane_b32 s41, v245, 20
    v_exp_f32 v34, v34
    v_mfma_f32_16x16x32_bf16 v[116:119], a[188:191], v[156:159], v[180:183]
    v_exp_f32 v35, v35
    v_exp_f32 v36, v36
    v_exp_f32 v37, v37
    v_exp_f32 v38, v38
    v_exp_f32 v39, v39
    buffer_load_dwordx4 v246, s[12:15], s42 offen offset:1024 lds
    v_pk_add_f32 v[40:41], v[40:41], v[216:217] op_sel_hi:[1,0] neg_lo:[0,1] neg_hi:[0,1]
    v_pk_add_f32 v[42:43], v[42:43], v[216:217] op_sel_hi:[1,0] neg_lo:[0,1] neg_hi:[0,1]
    v_pk_add_f32 v[44:45], v[44:45], v[216:217] op_sel_hi:[1,0] neg_lo:[0,1] neg_hi:[0,1]
    v_pk_add_f32 v[46:47], v[46:47], v[216:217] op_sel_hi:[1,0] neg_lo:[0,1] neg_hi:[0,1]
    v_mfma_f32_16x16x32_bf16 v[120:123], a[192:195], v[156:159], v[184:187]
    v_cvt_pk_bf16_f32 v32, v32, v33
    v_readlane_b32 s42, v245, 21
    v_cvt_pk_bf16_f32 v33, v34, v35
    v_cvt_pk_bf16_f32 v34, v36, v37
    v_mfma_f32_16x16x32_bf16 v[124:127], a[196:199], v[156:159], v[184:187]
    v_cvt_pk_bf16_f32 v35, v38, v39
    v_exp_f32 v40, v40
    v_exp_f32 v41, v41
    s_add_u32 m0, s40, 20480
    v_exp_f32 v42, v42
    v_exp_f32 v43, v43
    v_exp_f32 v44, v44
    v_mfma_f32_16x16x32_bf16 v[128:131], a[200:203], v[156:159], v[188:191]
    v_exp_f32 v45, v45
    v_exp_f32 v46, v46
    buffer_load_dwordx4 v247, s[12:15], s41 offen offset:0 lds
    v_exp_f32 v47, v47
    v_pk_add_f32 v[48:49], v[48:49], v[216:217] op_sel_hi:[1,0] neg_lo:[0,1] neg_hi:[0,1]
    v_pk_add_f32 v[50:51], v[50:51], v[216:217] op_sel_hi:[1,0] neg_lo:[0,1] neg_hi:[0,1]
    v_pk_add_f32 v[52:53], v[52:53], v[216:217] op_sel_hi:[1,0] neg_lo:[0,1] neg_hi:[0,1]
    v_pk_add_f32 v[54:55], v[54:55], v[216:217] op_sel_hi:[1,0] neg_lo:[0,1] neg_hi:[0,1]
    v_mfma_f32_16x16x32_bf16 v[132:135], a[204:207], v[156:159], v[188:191]
    v_cvt_pk_bf16_f32 v40, v40, v41
    v_readlane_b32 s41, v245, 22
    v_cvt_pk_bf16_f32 v41, v42, v43
    v_cvt_pk_bf16_f32 v42, v44, v45
    v_cvt_pk_bf16_f32 v43, v46, v47
    v_mfma_f32_16x16x32_bf16 v[136:139], a[208:211], v[156:159], 0
    v_exp_f32 v48, v48
    v_exp_f32 v49, v49
    buffer_load_dwordx4 v246, s[12:15], s42 offen offset:1024 lds
    v_exp_f32 v50, v50
    v_exp_f32 v51, v51
    v_exp_f32 v52, v52
    v_exp_f32 v53, v53
    v_mfma_f32_16x16x32_bf16 v[140:143], a[212:215], v[156:159], v[192:195]
    v_exp_f32 v54, v54
    v_readlane_b32 s42, v245, 23
    v_exp_f32 v55, v55
    v_pk_add_f32 v[56:57], v[56:57], v[216:217] op_sel_hi:[1,0] neg_lo:[0,1] neg_hi:[0,1]
    v_pk_add_f32 v[58:59], v[58:59], v[216:217] op_sel_hi:[1,0] neg_lo:[0,1] neg_hi:[0,1]
    v_pk_add_f32 v[60:61], v[60:61], v[216:217] op_sel_hi:[1,0] neg_lo:[0,1] neg_hi:[0,1]
    v_pk_add_f32 v[62:63], v[62:63], v[216:217] op_sel_hi:[1,0] neg_lo:[0,1] neg_hi:[0,1]
    s_add_u32 m0, s40, 28672
    v_cvt_pk_bf16_f32 v48, v48, v49
    v_cvt_pk_bf16_f32 v49, v50, v51
    v_cvt_pk_bf16_f32 v50, v52, v53
    v_cvt_pk_bf16_f32 v51, v54, v55
    v_exp_f32 v56, v56
    v_exp_f32 v57, v57
    buffer_load_dwordx4 v247, s[12:15], s41 offen offset:0 lds
    v_exp_f32 v58, v58
    v_exp_f32 v59, v59
    v_exp_f32 v60, v60
    v_exp_f32 v61, v61
    v_exp_f32 v62, v62
    v_readlane_b32 s41, v245, 24
    v_exp_f32 v63, v63
    v_pk_add_f32 v[64:65], v[64:65], v[216:217] op_sel_hi:[1,0] neg_lo:[0,1] neg_hi:[0,1]
    v_pk_add_f32 v[66:67], v[66:67], v[216:217] op_sel_hi:[1,0] neg_lo:[0,1] neg_hi:[0,1]
    v_cvt_pk_bf16_f32 v56, v56, v57
    v_cvt_pk_bf16_f32 v57, v58, v59
    buffer_load_dwordx4 v246, s[12:15], s42 offen offset:1024 lds
    v_cvt_pk_bf16_f32 v58, v60, v61
    v_cvt_pk_bf16_f32 v59, v62, v63
    v_exp_f32 v64, v64
    v_exp_f32 v65, v65
    v_exp_f32 v66, v66
    v_readlane_b32 s42, v245, 25
    v_exp_f32 v67, v67
    v_cvt_pk_bf16_f32 v64, v64, v65
    v_cvt_pk_bf16_f32 v65, v66, v67
    v_mov_b32 v66, 0
    v_mov_b32 v67, 0
    v_max3_f32 v216, v76, v77, v78
    v_mfma_f32_16x16x32_bf16 v[200:203], a[0:3], v[0:3], 0
    s_add_u32 m0, s40, 36864
    v_max3_f32 v217, v79, v80, v81
    v_max3_f32 v216, v216, v82, v83
    v_mfma_f32_16x16x32_bf16 v[204:207], a[4:7], v[0:3], 0
    s_waitcnt vmcnt(8)
    s_barrier
    s_cmp_ge_u32 s28, 1
    s_cbranch_scc1 L_sig16
    s_mov_b64 exec, 1
    buffer_atomic_add v253, v252, s[20:23], s56 offen sc1
    s_mov_b64 exec, -1
L_sig16:
    v_max3_f32 v217, v217, v84, v85
    v_mfma_f32_16x16x32_bf16 v[208:211], v[212:215], v[0:3], 0
    v_max3_f32 v216, v216, v86, v87
    v_max3_f32 v217, v217, v88, v89
    v_mfma_f32_16x16x32_bf16 v[200:203], a[8:11], v[8:11], v[200:203]
    v_max3_f32 v216, v216, v90, v91
    v_max3_f32 v217, v217, v92, v93
    v_mfma_f32_16x16x32_bf16 v[204:207], a[12:15], v[8:11], v[204:207]
    v_max3_f32 v216, v216, v94, v95
    buffer_load_dwordx4 v247, s[12:15], s41 offen offset:0 lds
    v_max3_f32 v217, v217, v96, v97
    v_mfma_f32_16x16x32_bf16 v[208:211], v[212:215], v[8:11], v[208:211]
    v_max3_f32 v216, v216, v98, v99
    v_max3_f32 v217, v217, v100, v101
    v_mfma_f32_16x16x32_bf16 v[200:203], a[16:19], v[16:19], v[200:203]
    v_max3_f32 v216, v216, v102, v103
    v_mfma_f32_16x16x32_bf16 v[204:207], a[20:23], v[16:19], v[204:207]
    v_max3_f32 v217, v217, v104, v105
    v_max3_f32 v216, v216, v106, v107
    v_max3_f32 v217, v217, v108, v109
    v_mfma_f32_16x16x32_bf16 v[208:211], v[212:215], v[16:19], v[208:211]
    v_max3_f32 v216, v216, v110, v111
    v_mfma_f32_16x16x32_bf16 v[200:203], a[24:27], v[24:27], v[200:203]
    v_max3_f32 v217, v217, v112, v113
    v_max3_f32 v216, v216, v114, v115
    v_readlane_b32 s41, v245, 26
    v_max3_f32 v217, v217, v116, v117
    v_mfma_f32_16x16x32_bf16 v[204:207], a[28:31], v[24:27], v[204:207]
    v_max3_f32 v216, v216, v118, v119
    v_max3_f32 v217, v217, v120, v121
    v_mfma_f32_16x16x32_bf16 v[208:211], v[212:215], v[24:27], v[208:211]
    v_max3_f32 v216, v216, v122, v123
    v_max3_f32 v217, v217, v124, v125
    v_mfma_f32_16x16x32_bf16 v[200:203], a[32:35], v[32:35], v[200:203]
    v_max3_f32 v216, v216, v126, v127
    v_max3_f32 v217, v217, v128, v129
    v_mfma_f32_16x16x32_bf16 v[204:207], a[36:39], v[32:35], v[204:207]
    v_max3_f32 v216, v216, v130, v131
    v_mfma_f32_16x16x32_bf16 v[208:211], v[212:215], v[32:35], v[208:211]
    v_max3_f32 v217, v217, v132, v133
    buffer_load_dwordx4 v246, s[12:15], s42 offen offset:1024 lds
    v_max3_f32 v216, v216, v134, v135
    v_max3_f32 v217, v217, v136, v137
    v_mfma_f32_16x16x32_bf16 v[200:203], a[40:43], v[40:43], v[200:203]
    v_max3_f32 v216, v216, v138, v139
    v_max3_f32 v217, v217, v140, v141
    v_mfma_f32_16x16x32_bf16 v[204:207], a[44:47], v[40:43], v[204:207]
    v_max3_f32 v216, v216, v142, v143
    v_max_f32 v216, v216, v217
    v_mfma_f32_16x16x32_bf16 v[208:211], v[212:215], v[40:43], v[208:211]
    v_mov_b32 v217, v216
    v_mfma_f32_16x16x32_bf16 v[200:203], a[48:51], v[48:51], v[200:203]
    s_nop 0
    v_permlane16_swap_b32 v216, v217
    v_max_f32 v216, v216, v217
    v_mov_b32 v217, v216
    v_mfma_f32_16x16x32_bf16 v[204:207], a[52:55], v[48:51], v[204:207]
    v_readlane_b32 s42, v245, 27
    v_permlane32_swap_b32 v216, v217
    v_max_f32 v216, v216, v217
    v_pk_add_f32 v[76:77], v[76:77], v[216:217] op_sel_hi:[1,0] neg_lo:[0,1] neg_hi:[0,1]
    v_pk_add_f32 v[78:79], v[78:79], v[216:217] op_sel_hi:[1,0] neg_lo:[0,1] neg_hi:[0,1]
    v_mfma_f32_16x16x32_bf16 v[208:211], v[212:215], v[48:51], v[208:211]
    v_exp_f32 v76, v76
    v_mfma_f32_16x16x32_bf16 v[200:203], a[56:59], v[56:59], v[200:203]
    v_exp_f32 v77, v77
    v_mfma_f32_16x16x32_bf16 v[204:207], a[60:63], v[56:59], v[204:207]
    v_exp_f32 v78, v78
    v_exp_f32 v79, v79
    v_pk_add_f32 v[80:81], v[80:81], v[216:217] op_sel_hi:[1,0] neg_lo:[0,1] neg_hi:[0,1]
    s_add_u32 m0, s40, 45056
    v_pk_add_f32 v[82:83], v[82:83], v[216:217] op_sel_hi:[1,0] neg_lo:[0,1] neg_hi:[0,1]
    v_pk_add_f32 v[84:85], v[84:85], v[216:217] op_sel_hi:[1,0] neg_lo:[0,1] neg_hi:[0,1]
    v_pk_add_f32 v[86:87], v[86:87], v[216:217] op_sel_hi:[1,0] neg_lo:[0,1] neg_hi:[0,1]
    v_mfma_f32_16x16x32_bf16 v[208:211], v[212:215], v[56:59], v[208:211]
    v_mov_b32 v72, 0
    v_mfma_f32_16x16x32_bf16 v[200:203], a[64:67], v[64:67], v[200:203]
    v_mov_b32 v73, 0
    v_mfma_f32_16x16x32_bf16 v[204:207], a[68:71], v[64:67], v[204:207]
    v_cvt_pk_bf16_f32 v74, v76, v77
    v_mfma_f32_16x16x32_bf16 v[208:211], v[212:215], v[64:67], v[208:211]
    v_cvt_pk_bf16_f32 v75, v78, v79
    v_exp_f32 v80, v80
    v_exp_f32 v81, v81
    v_exp_f32 v82, v82
    buffer_load_dwordx4 v247, s[12:15], s41 offen offset:0 lds
    v_exp_f32 v83, v83
    v_exp_f32 v84, v84
    v_exp_f32 v85, v85
    v_exp_f32 v86, v86
    v_exp_f32 v87, v87
    v_rcp_f32 v218, v208
    v_pk_add_f32 v[88:89], v[88:89], v[216:217] op_sel_hi:[1,0] neg_lo:[0,1] neg_hi:[0,1]
    v_mul_f32 v200, v218, v200
    v_pk_add_f32 v[90:91], v[90:91], v[216:217] op_sel_hi:[1,0] neg_lo:[0,1] neg_hi:[0,1]
    v_mul_f32 v201, v218, v201
    v_pk_add_f32 v[92:93], v[92:93], v[216:217] op_sel_hi:[1,0] neg_lo:[0,1] neg_hi:[0,1]
    v_mul_f32 v202, v218, v202
    v_pk_add_f32 v[94:95], v[94:95], v[216:217] op_sel_hi:[1,0] neg_lo:[0,1] neg_hi:[0,1]
    v_readlane_b32 s41, v245, 28
    v_mul_f32 v203, v218, v203
    v_cvt_pk_bf16_f32 v80, v80, v81
    v_mul_f32 v204, v218, v204
    v_cvt_pk_bf16_f32 v81, v82, v83
    v_mul_f32 v205, v218, v205
    v_cvt_pk_bf16_f32 v82, v84, v85
    v_mul_f32 v206, v218, v206
    v_cvt_pk_bf16_f32 v83, v86, v87
    v_mul_f32 v207, v218, v207
    v_exp_f32 v88, v88
    v_cvt_pk_bf16_f32 v220, v200, v201
    v_exp_f32 v89, v89
    v_cvt_pk_bf16_f32 v221, v202, v203
    v_exp_f32 v90, v90
    v_cvt_pk_bf16_f32 v222, v204, v205
    v_exp_f32 v91, v91
    v_cvt_pk_bf16_f32 v223, v206, v207
    v_exp_f32 v92, v92
    buffer_store_dwordx4 v[220:223], v254, s[16:19], s55 offen offset:0 sc1
    v_exp_f32 v93, v93
    buffer_load_dwordx4 v246, s[12:15], s42 offen offset:1024 lds
    v_exp_f32 v94, v94
    v_exp_f32 v95, v95
    v_pk_add_f32 v[96:97], v[96:97], v[216:217] op_sel_hi:[1,0] neg_lo:[0,1] neg_hi:[0,1]
    v_pk_add_f32 v[98:99], v[98:99], v[216:217] op_sel_hi:[1,0] neg_lo:[0,1] neg_hi:[0,1]
    v_pk_add_f32 v[100:101], v[100:101], v[216:217] op_sel_hi:[1,0] neg_lo:[0,1] neg_hi:[0,1]
    v_pk_add_f32 v[102:103], v[102:103], v[216:217] op_sel_hi:[1,0] neg_lo:[0,1] neg_hi:[0,1]
    v_cvt_pk_bf16_f32 v88, v88, v89
    v_cvt_pk_bf16_f32 v89, v90, v91
    v_cvt_pk_bf16_f32 v90, v92, v93
    v_readlane_b32 s42, v245, 29
    v_cvt_pk_bf16_f32 v91, v94, v95
    v_exp_f32 v96, v96
    v_exp_f32 v97, v97
    v_exp_f32 v98, v98
    v_exp_f32 v99, v99
    v_exp_f32 v100, v100
    v_exp_f32 v101, v101
    v_exp_f32 v102, v102
    v_exp_f32 v103, v103
    v_pk_add_f32 v[104:105], v[104:105], v[216:217] op_sel_hi:[1,0] neg_lo:[0,1] neg_hi:[0,1]
    s_add_u32 m0, s40, 53248
    v_pk_add_f32 v[106:107], v[106:107], v[216:217] op_sel_hi:[1,0] neg_lo:[0,1] neg_hi:[0,1]
    v_pk_add_f32 v[108:109], v[108:109], v[216:217] op_sel_hi:[1,0] neg_lo:[0,1] neg_hi:[0,1]
    v_pk_add_f32 v[110:111], v[110:111], v[216:217] op_sel_hi:[1,0] neg_lo:[0,1] neg_hi:[0,1]
    v_cvt_pk_bf16_f32 v96, v96, v97
    v_cvt_pk_bf16_f32 v97, v98, v99
    v_cvt_pk_bf16_f32 v98, v100, v101
    v_cvt_pk_bf16_f32 v99, v102, v103
    v_exp_f32 v104, v104
    v_exp_f32 v105, v105
    buffer_load_dwordx4 v247, s[12:15], s41 offen offset:0 lds
    v_exp_f32 v106, v106
    v_exp_f32 v107, v107
    v_exp_f32 v108, v108
    v_exp_f32 v109, v109
    v_exp_f32 v110, v110
    v_exp_f32 v111, v111
    v_pk_add_f32 v[112:113], v[112:113], v[216:217] op_sel_hi:[1,0] neg_lo:[0,1] neg_hi:[0,1]
    v_pk_add_f32 v[114:115], v[114:115], v[216:217] op_sel_hi:[1,0] neg_lo:[0,1] neg_hi:[0,1]
    v_pk_add_f32 v[116:117], v[116:117], v[216:217] op_sel_hi:[1,0] neg_lo:[0,1] neg_hi:[0,1]
    v_pk_add_f32 v[118:119], v[118:119], v[216:217] op_sel_hi:[1,0] neg_lo:[0,1] neg_hi:[0,1]
    v_readlane_b32 s41, v245, 30
    v_cvt_pk_bf16_f32 v104, v104, v105
    v_cvt_pk_bf16_f32 v105, v106, v107
    v_cvt_pk_bf16_f32 v106, v108, v109
    v_cvt_pk_bf16_f32 v107, v110, v111
    v_exp_f32 v112, v112
    v_exp_f32 v113, v113
    v_exp_f32 v114, v114
    v_exp_f32 v115, v115
    v_exp_f32 v116, v116
    buffer_load_dwordx4 v246, s[12:15], s42 offen offset:1024 lds
    v_exp_f32 v117, v117
    buffer_load_dword v232, v252, s[20:23], s56 offen sc1
    v_exp_f32 v118, v118
    v_exp_f32 v119, v119
    v_pk_add_f32 v[120:121], v[120:121], v[216:217] op_sel_hi:[1,0] neg_lo:[0,1] neg_hi:[0,1]
    v_pk_add_f32 v[122:123], v[122:123], v[216:217] op_sel_hi:[1,0] neg_lo:[0,1] neg_hi:[0,1]
    v_pk_add_f32 v[124:125], v[124:125], v[216:217] op_sel_hi:[1,0] neg_lo:[0,1] neg_hi:[0,1]
    v_pk_add_f32 v[126:127], v[126:127], v[216:217] op_sel_hi:[1,0] neg_lo:[0,1] neg_hi:[0,1]
    v_cvt_pk_bf16_f32 v112, v112, v113
    v_cvt_pk_bf16_f32 v113, v114, v115
    v_readlane_b32 s42, v245, 31
    v_cvt_pk_bf16_f32 v114, v116, v117
    v_cvt_pk_bf16_f32 v115, v118, v119
    v_exp_f32 v120, v120
    v_exp_f32 v121, v121
    v_exp_f32 v122, v122
    v_exp_f32 v123, v123
    v_exp_f32 v124, v124
    v_exp_f32 v125, v125
    v_exp_f32 v126, v126
    s_add_u32 m0, s40, 61440
    v_exp_f32 v127, v127
    v_pk_add_f32 v[128:129], v[128:129], v[216:217] op_sel_hi:[1,0] neg_lo:[0,1] neg_hi:[0,1]
    v_pk_add_f32 v[130:131], v[130:131], v[216:217] op_sel_hi:[1,0] neg_lo:[0,1] neg_hi:[0,1]
    v_pk_add_f32 v[132:133], v[132:133], v[216:217] op_sel_hi:[1,0] neg_lo:[0,1] neg_hi:[0,1]
    v_pk_add_f32 v[134:135], v[134:135], v[216:217] op_sel_hi:[1,0] neg_lo:[0,1] neg_hi:[0,1]
    v_cvt_pk_bf16_f32 v120, v120, v121
    v_cvt_pk_bf16_f32 v121, v122, v123
    v_cvt_pk_bf16_f32 v122, v124, v125
    v_cvt_pk_bf16_f32 v123, v126, v127
    v_exp_f32 v128, v128
    buffer_load_dwordx4 v247, s[12:15], s41 offen offset:0 lds
    v_exp_f32 v129, v129
    v_exp_f32 v130, v130
    v_exp_f32 v131, v131
    v_exp_f32 v132, v132
    v_exp_f32 v133, v133
    v_exp_f32 v134, v134
    v_exp_f32 v135, v135
    v_pk_add_f32 v[136:137], v[136:137], v[216:217] op_sel_hi:[1,0] neg_lo:[0,1] neg_hi:[0,1]
    v_pk_add_f32 v[138:139], v[138:139], v[216:217] op_sel_hi:[1,0] neg_lo:[0,1] neg_hi:[0,1]
    buffer_load_dwordx4 v246, s[12:15], s42 offen offset:1024 lds
    v_pk_add_f32 v[140:141], v[140:141], v[216:217] op_sel_hi:[1,0] neg_lo:[0,1] neg_hi:[0,1]
    v_pk_add_f32 v[142:143], v[142:143], v[216:217] op_sel_hi:[1,0] neg_lo:[0,1] neg_hi:[0,1]
    v_cvt_pk_bf16_f32 v128, v128, v129
    v_cvt_pk_bf16_f32 v129, v130, v131
    v_cvt_pk_bf16_f32 v130, v132, v133
    v_cvt_pk_bf16_f32 v131, v134, v135
    v_exp_f32 v136, v136
    v_exp_f32 v137, v137
    v_exp_f32 v138, v138
    v_exp_f32 v139, v139
    v_exp_f32 v140, v140
    v_exp_f32 v141, v141
    v_exp_f32 v142, v142
    v_exp_f32 v143, v143
    v_cvt_pk_bf16_f32 v136, v136, v137
    v_cvt_pk_bf16_f32 v137, v138, v139
    v_cvt_pk_bf16_f32 v138, v140, v141
    v_cvt_pk_bf16_f32 v139, v142, v143
    s_waitcnt vmcnt(2)
    v_cmp_gt_u32 vcc, 16, v232
    s_cbranch_vccz L_chk17
    s_mov_b64 exec, 1
    s_mov_b32 s3, 0x40000
L_poll18:
    buffer_load_dword v232, v252, s[20:23], s56 offen sc1
    s_sub_u32 s3, s3, 1
    s_cbranch_scc1 L_poll18_y
    s_waitcnt vmcnt(0)
    v_cmp_gt_u32 vcc, 16, v232
    s_cbranch_vccz L_poll18_y
    s_sleep 1
    s_branch L_poll18
L_poll18_y:
    s_waitcnt vmcnt(0)
    s_mov_b64 exec, -1
L_poll18_x:
L_chk17:
    v_mfma_f32_16x16x32_bf16 v[200:203], a[0:3], v[72:75], 0
    v_readlane_b32 s45, v245, 0
    s_nop 0
    s_lshl_b32 s45, s45, 1
    v_mfma_f32_16x16x32_bf16 v[204:207], a[4:7], v[72:75], 0
    s_nop 1
    buffer_load_dwordx4 a[72:75], v254, s[8:11], s45 offen offset:0 sc1
    v_mfma_f32_16x16x32_bf16 v[208:211], v[212:215], v[72:75], 0
    buffer_load_dwordx4 a[76:79], v254, s[8:11], s45 offen offset:1024 sc1
    v_readlane_b32 s45, v245, 1
    s_nop 0
    s_lshl_b32 s45, s45, 1
    v_mfma_f32_16x16x32_bf16 v[200:203], a[8:11], v[80:83], v[200:203]
    s_nop 1
    buffer_load_dwordx4 a[80:83], v254, s[8:11], s45 offen offset:0 sc1
    v_mfma_f32_16x16x32_bf16 v[204:207], a[12:15], v[80:83], v[204:207]
    buffer_load_dwordx4 a[84:87], v254, s[8:11], s45 offen offset:1024 sc1
    v_readlane_b32 s45, v245, 2
    s_nop 0
    s_lshl_b32 s45, s45, 1
    v_mfma_f32_16x16x32_bf16 v[208:211], v[212:215], v[80:83], v[208:211]
    s_nop 1
    buffer_load_dwordx4 a[88:91], v254, s[8:11], s45 offen offset:0 sc1
    v_mfma_f32_16x16x32_bf16 v[200:203], a[16:19], v[88:91], v[200:203]
    buffer_load_dwordx4 a[92:95], v254, s[8:11], s45 offen offset:1024 sc1
    v_readlane_b32 s45, v245, 3
    s_nop 0
    s_lshl_b32 s45, s45, 1
    v_mfma_f32_16x16x32_bf16 v[204:207], a[20:23], v[88:91], v[204:207]
    s_nop 1
    buffer_load_dwordx4 a[96:99], v254, s[8:11], s45 offen offset:0 sc1
    v_mfma_f32_16x16x32_bf16 v[208:211], v[212:215], v[88:91], v[208:211]
    buffer_load_dwordx4 a[100:103], v254, s[8:11], s45 offen offset:1024 sc1
    v_and_b32 v244, 1, v255
    v_lshlrev_b32 v244, 3, v244
    v_mfma_f32_16x16x32_bf16 v[200:203], a[24:27], v[96:99], v[200:203]
    v_lshrrev_b32 v233, 4, v255
    v_lshl_add_u32 v244, v233, 4, v244
    v_add_u32 v67, 2048, v244
    v_mfma_f32_16x16x32_bf16 v[204:207], a[28:31], v[96:99], v[204:207]
    v_add_u32 v240, 98304, v248
    v_add_u32 v241, 98304, v249
    v_add_u32 v242, 98304, v250
    v_mfma_f32_16x16x32_bf16 v[208:211], v[212:215], v[96:99], v[208:211]
    v_add_u32 v243, 98304, v251
    v_add_u32 v236, 4096, v248
    v_add_u32 v237, 4096, v249
    v_mfma_f32_16x16x32_bf16 v[200:203], a[32:35], v[104:107], v[200:203]
    v_add_u32 v238, 4096, v250
    v_add_u32 v239, 4096, v251
    s_mov_b32 s47, 0xffff0000
    v_mfma_f32_16x16x32_bf16 v[204:207], a[36:39], v[104:107], v[204:207]
    v_accvgpr_read_b32 v40, a216
    v_accvgpr_read_b32 v41, a217
    v_accvgpr_read_b32 v42, a218
    v_mfma_f32_16x16x32_bf16 v[208:211], v[212:215], v[104:107], v[208:211]
    v_accvgpr_read_b32 v43, a219
    v_accvgpr_read_b32 v44, a220
    v_accvgpr_read_b32 v45, a221
    v_mfma_f32_16x16x32_bf16 v[200:203], a[40:43], v[112:115], v[200:203]
    v_accvgpr_read_b32 v46, a222
    v_accvgpr_read_b32 v47, a223
    v_accvgpr_read_b32 v48, a224
    v_mfma_f32_16x16x32_bf16 v[204:207], a[44:47], v[112:115], v[204:207]
    v_accvgpr_read_b32 v49, a225
    v_accvgpr_read_b32 v50, a226
    v_accvgpr_read_b32 v51, a227
    v_mfma_f32_16x16x32_bf16 v[208:211], v[212:215], v[112:115], v[208:211]
    v_accvgpr_read_b32 v52, a228
    v_accvgpr_read_b32 v53, a229
    v_accvgpr_read_b32 v54, a230
    v_mfma_f32_16x16x32_bf16 v[200:203], a[48:51], v[120:123], v[200:203]
    v_accvgpr_read_b32 v55, a231
    v_accvgpr_read_b32 v32, a232
    v_mov_b32 v33, 0
    v_mfma_f32_16x16x32_bf16 v[204:207], a[52:55], v[120:123], v[204:207]
    v_mov_b32 v34, 0
    v_mov_b32 v35, 0
    v_accvgpr_read_b32 v36, a233
    v_mfma_f32_16x16x32_bf16 v[208:211], v[212:215], v[120:123], v[208:211]
    v_mov_b32 v37, 0
    v_mov_b32 v38, 0
    v_mov_b32 v39, 0
    v_mfma_f32_16x16x32_bf16 v[200:203], a[56:59], v[128:131], v[200:203]
    v_permlane16_swap_b32 v40, v42
    v_permlane16_swap_b32 v41, v43
    v_permlane16_swap_b32 v44, v46
    v_mfma_f32_16x16x32_bf16 v[204:207], a[60:63], v[128:131], v[204:207]
    v_permlane16_swap_b32 v45, v47
    v_permlane16_swap_b32 v48, v50
    v_permlane16_swap_b32 v49, v51
    v_mfma_f32_16x16x32_bf16 v[208:211], v[212:215], v[128:131], v[208:211]
    v_permlane16_swap_b32 v52, v54
    v_permlane16_swap_b32 v53, v55
    v_lshlrev_b32 v0, 16, v40
    v_mfma_f32_16x16x32_bf16 v[200:203], a[64:67], v[136:139], v[200:203]
    v_and_b32 v1, s47, v40
    v_lshlrev_b32 v2, 16, v41
    v_and_b32 v3, s47, v41
    v_mfma_f32_16x16x32_bf16 v[204:207], a[68:71], v[136:139], v[204:207]
    v_lshlrev_b32 v8, 16, v42
    v_and_b32 v9, s47, v42
    v_lshlrev_b32 v10, 16, v43
    v_mfma_f32_16x16x32_bf16 v[208:211], v[212:215], v[136:139], v[208:211]
    v_and_b32 v11, s47, v43
    v_lshlrev_b32 v16, 16, v44
    v_and_b32 v17, s47, v44
    v_lshlrev_b32 v18, 16, v45
    v_and_b32 v19, s47, v45
    v_lshlrev_b32 v24, 16, v46
    v_and_b32 v25, s47, v46
    v_lshlrev_b32 v26, 16, v47
    v_and_b32 v27, s47, v47
    v_lshlrev_b32 v4, 16, v48
    v_and_b32 v5, s47, v48
    v_lshlrev_b32 v6, 16, v49
    v_and_b32 v7, s47, v49
    v_lshlrev_b32 v12, 16, v50
    v_and_b32 v13, s47, v50
    v_lshlrev_b32 v14, 16, v51
    v_and_b32 v15, s47, v51
    v_lshlrev_b32 v20, 16, v52
    v_and_b32 v21, s47, v52
    v_lshlrev_b32 v22, 16, v53
    v_and_b32 v23, s47, v53
    v_lshlrev_b32 v28, 16, v54
    v_and_b32 v29, s47, v54
    v_lshlrev_b32 v30, 16, v55
    v_and_b32 v31, s47, v55
    v_rcp_f32 v218, v208
    s_nop 0
    v_mul_f32 v200, v218, v200
    v_mul_f32 v201, v218, v201
    v_mul_f32 v202, v218, v202
    v_mul_f32 v203, v218, v203
    v_mul_f32 v204, v218, v204
    v_mul_f32 v205, v218, v205
    v_mul_f32 v206, v218, v206
    v_mul_f32 v207, v218, v207
    v_cvt_pk_bf16_f32 v220, v200, v201
    v_cvt_pk_bf16_f32 v221, v202, v203
    v_cvt_pk_bf16_f32 v222, v204, v205
    v_cvt_pk_bf16_f32 v223, v206, v207
    buffer_store_dwordx4 v[220:223], v254, s[16:19], s55 offen offset:1024 sc1
L_ph3:
    s_waitcnt vmcnt(9)
    s_barrier
    ds_read_b64_tr_b16 v[96:97], v240 offset:0
    ds_read_b64_tr_b16 v[98:99], v240 offset:4096
    ds_read_b64_tr_b16 v[100:101], v241 offset:0
    ds_read_b64_tr_b16 v[102:103], v241 offset:4096
    ds_read2_b64 v[136:139], v244 offset0:0 offset1:8
    s_waitcnt vmcnt(7) lgkmcnt(0)
    v_mfma_f32_16x16x32_bf16 v[0:3], v[96:99], a[72:75], v[0:3]
    ds_read_b64_tr_b16 v[104:105], v240 offset:1024
    v_readlane_b32 s45, v245, 4
    s_nop 0
    s_lshl_b32 s45, s45, 1
    v_mfma_f32_16x16x32_bf16 v[4:7], v[96:99], a[76:79], v[4:7]
    ds_read_b64_tr_b16 v[106:107], v240 offset:5120
    s_nop 0
    buffer_load_dwordx4 a[104:107], v254, s[8:11], s45 offen offset:0 sc1
    buffer_load_dwordx4 a[108:111], v254, s[8:11], s45 offen offset:1024 sc1
    v_mfma_f32_16x16x32_bf16 v[8:11], v[100:103], a[72:75], v[8:11]
    ds_read_b64_tr_b16 v[108:109], v241 offset:1024
    v_mfma_f32_16x16x32_bf16 v[12:15], v[100:103], a[76:79], v[12:15]
    ds_read_b64_tr_b16 v[110:111], v241 offset:5120
    v_mfma_f32_16x16x32_bf16 v[32:35], v[136:139], a[72:75], v[32:35]
    ds_read2_b64 v[140:143], v244 offset0:16 offset1:24
    v_mfma_f32_16x16x32_bf16 v[36:39], v[136:139], a[76:79], v[36:39]
    s_waitcnt vmcnt(7) lgkmcnt(0)
    v_mfma_f32_16x16x32_bf16 v[0:3], v[104:107], a[80:83], v[0:3]
    ds_read_b64_tr_b16 v[96:97], v240 offset:8192
    v_readlane_b32 s45, v245, 5
    s_nop 0
    s_lshl_b32 s45, s45, 1
    v_mfma_f32_16x16x32_bf16 v[4:7], v[104:107], a[84:87], v[4:7]
    ds_read_b64_tr_b16 v[98:99], v240 offset:12288
    s_nop 0
    buffer_load_dwordx4 a[112:115], v254, s[8:11], s45 offen offset:0 sc1
    buffer_load_dwordx4 a[116:119], v254, s[8:11], s45 offen offset:1024 sc1
    v_mfma_f32_16x16x32_bf16 v[8:11], v[108:111], a[80:83], v[8:11]
    ds_read_b64_tr_b16 v[100:101], v241 offset:8192
    v_mfma_f32_16x16x32_bf16 v[12:15], v[108:111], a[84:87], v[12:15]
    ds_read_b64_tr_b16 v[102:103], v241 offset:12288
    v_mfma_f32_16x16x32_bf16 v[32:35], v[140:143], a[80:83], v[32:35]
    ds_read2_b64 v[136:139], v244 offset0:32 offset1:40
    v_mfma_f32_16x16x32_bf16 v[36:39], v[140:143], a[84:87], v[36:39]
    s_waitcnt vmcnt(7) lgkmcnt(0)
    v_mfma_f32_16x16x32_bf16 v[0:3], v[96:99], a[88:91], v[0:3]
    ds_read_b64_tr_b16 v[104:105], v240 offset:9216
    v_readlane_b32 s45, v245, 6
    s_nop 0
    s_lshl_b32 s45, s45, 1
    v_mfma_f32_16x16x32_bf16 v[4:7], v[96:99], a[92:95], v[4:7]
    ds_read_b64_tr_b16 v[106:107], v240 offset:13312
    s_nop 0
    buffer_load_dwordx4 a[120:123], v254, s[8:11], s45 offen offset:0 sc1
    buffer_load_dwordx4 a[124:127], v254, s[8:11], s45 offen offset:1024 sc1
    v_mfma_f32_16x16x32_bf16 v[8:11], v[100:103], a[88:91], v[8:11]
    ds_read_b64_tr_b16 v[108:109], v241 offset:9216
    v_mfma_f32_16x16x32_bf16 v[12:15], v[100:103], a[92:95], v[12:15]
    ds_read_b64_tr_b16 v[110:111], v241 offset:13312
    v_mfma_f32_16x16x32_bf16 v[32:35], v[136:139], a[88:91], v[32:35]
    ds_read2_b64 v[140:143], v244 offset0:48 offset1:56
    v_mfma_f32_16x16x32_bf16 v[36:39], v[136:139], a[92:95], v[36:39]
    s_waitcnt vmcnt(7) lgkmcnt(0)
    v_mfma_f32_16x16x32_bf16 v[0:3], v[104:107], a[96:99], v[0:3]
    ds_read_b64_tr_b16 v[96:97], v240 offset:16384
    v_readlane_b32 s45, v245, 7
    s_nop 0
    s_lshl_b32 s45, s45, 1
    v_mfma_f32_16x16x32_bf16 v[4:7], v[104:107], a[100:103], v[4:7]
    ds_read_b64_tr_b16 v[98:99], v240 offset:20480
    s_nop 0
    buffer_load_dwordx4 a[128:131], v254, s[8:11], s45 offen offset:0 sc1
    buffer_load_dwordx4 a[132:135], v254, s[8:11], s45 offen offset:1024 sc1
    v_mfma_f32_16x16x32_bf16 v[8:11], v[108:111], a[96:99], v[8:11]
    ds_read_b64_tr_b16 v[100:101], v241 offset:16384
    v_mfma_f32_16x16x32_bf16 v[12:15], v[108:111], a[100:103], v[12:15]
    ds_read_b64_tr_b16 v[102:103], v241 offset:20480
    v_mfma_f32_16x16x32_bf16 v[32:35], v[140:143], a[96:99], v[32:35]
    ds_read2_b64 v[136:139], v244 offset0:64 offset1:72
    v_mfma_f32_16x16x32_bf16 v[36:39], v[140:143], a[100:103], v[36:39]
    s_waitcnt vmcnt(8)
    s_barrier
    s_add_u32 s56, s56, 4352
    s_cmp_ge_u32 s28, 1
    s_cbranch_scc1 L_sig19
    s_mov_b64 exec, 1
    buffer_atomic_add v253, v252, s[20:23], s56 offen sc1
    s_mov_b64 exec, -1
L_sig19:
    s_waitcnt vmcnt(6) lgkmcnt(0)
    v_mfma_f32_16x16x32_bf16 v[0:3], v[96:99], a[104:107], v[0:3]
    ds_read_b64_tr_b16 v[104:105], v240 offset:17408
    v_readlane_b32 s45, v245, 8
    s_nop 0
    s_lshl_b32 s45, s45, 1
    v_mfma_f32_16x16x32_bf16 v[4:7], v[96:99], a[108:111], v[4:7]
    ds_read_b64_tr_b16 v[106:107], v240 offset:21504
    s_nop 0
    buffer_load_dwordx4 a[136:139], v254, s[8:11], s45 offen offset:0 sc1
    buffer_load_dwordx4 a[140:143], v254, s[8:11], s45 offen offset:1024 sc1
    v_mfma_f32_16x16x32_bf16 v[8:11], v[100:103], a[104:107], v[8:11]
    ds_read_b64_tr_b16 v[108:109], v241 offset:17408
    v_mfma_f32_16x16x32_bf16 v[12:15], v[100:103], a[108:111], v[12:15]
    ds_read_b64_tr_b16 v[110:111], v241 offset:21504
    v_mfma_f32_16x16x32_bf16 v[32:35], v[136:139], a[104:107], v[32:35]
    ds_read2_b64 v[140:143], v244 offset0:80 offset1:88
    v_mfma_f32_16x16x32_bf16 v[36:39], v[136:139], a[108:111], v[36:39]
    s_waitcnt vmcnt(6) lgkmcnt(0)
    v_mfma_f32_16x16x32_bf16 v[0:3], v[104:107], a[112:115], v[0:3]
    ds_read_b64_tr_b16 v[96:97], v240 offset:24576
    v_readlane_b32 s45, v245, 9
    s_nop 0
    s_lshl_b32 s45, s45, 1
    v_mfma_f32_16x16x32_bf16 v[4:7], v[104:107], a[116:119], v[4:7]
    ds_read_b64_tr_b16 v[98:99], v240 offset:28672
    s_nop 0
    buffer_load_dwordx4 a[144:147], v254, s[8:11], s45 offen offset:0 sc1
    buffer_load_dwordx4 a[148:151], v254, s[8:11], s45 offen offset:1024 sc1
    v_mfma_f32_16x16x32_bf16 v[8:11], v[108:111], a[112:115], v[8:11]
    ds_read_b64_tr_b16 v[100:101], v241 offset:24576
    v_mfma_f32_16x16x32_bf16 v[12:15], v[108:111], a[116:119], v[12:15]
    ds_read_b64_tr_b16 v[102:103], v241 offset:28672
    v_mfma_f32_16x16x32_bf16 v[32:35], v[140:143], a[112:115], v[32:35]
    ds_read2_b64 v[136:139], v244 offset0:96 offset1:104
    v_mfma_f32_16x16x32_bf16 v[36:39], v[140:143], a[116:119], v[36:39]
    s_waitcnt vmcnt(6) lgkmcnt(0)
    v_mfma_f32_16x16x32_bf16 v[0:3], v[96:99], a[120:123], v[0:3]
    ds_read_b64_tr_b16 v[104:105], v240 offset:25600
    v_readlane_b32 s45, v245, 10
    s_nop 0
    s_lshl_b32 s45, s45, 1
    v_mfma_f32_16x16x32_bf16 v[4:7], v[96:99], a[124:127], v[4:7]
    ds_read_b64_tr_b16 v[106:107], v240 offset:29696
    s_nop 0
    buffer_load_dwordx4 a[152:155], v254, s[8:11], s45 offen offset:0 sc1
    buffer_load_dwordx4 a[156:159], v254, s[8:11], s45 offen offset:1024 sc1
    v_mfma_f32_16x16x32_bf16 v[8:11], v[100:103], a[120:123], v[8:11]
    ds_read_b64_tr_b16 v[108:109], v241 offset:25600
    v_mfma_f32_16x16x32_bf16 v[12:15], v[100:103], a[124:127], v[12:15]
    ds_read_b64_tr_b16 v[110:111], v241 offset:29696
    v_mfma_f32_16x16x32_bf16 v[32:35], v[136:139], a[120:123], v[32:35]
    ds_read2_b64 v[140:143], v244 offset0:112 offset1:120
    v_mfma_f32_16x16x32_bf16 v[36:39], v[136:139], a[124:127], v[36:39]
    s_waitcnt vmcnt(6) lgkmcnt(0)
    v_mfma_f32_16x16x32_bf16 v[0:3], v[104:107], a[128:131], v[0:3]
    ds_read_b64_tr_b16 v[96:97], v240 offset:32768
    v_readlane_b32 s45, v245, 11
    s_nop 0
    s_lshl_b32 s45, s45, 1
    v_mfma_f32_16x16x32_bf16 v[4:7], v[104:107], a[132:135], v[4:7]
    ds_read_b64_tr_b16 v[98:99], v240 offset:36864
    s_nop 0
    buffer_load_dwordx4 a[160:163], v254, s[8:11], s45 offen offset:0 sc1
    buffer_load_dwordx4 a[164:167], v254, s[8:11], s45 offen offset:1024 sc1
    v_mfma_f32_16x16x32_bf16 v[8:11], v[108:111], a[128:131], v[8:11]
    ds_read_b64_tr_b16 v[100:101], v241 offset:32768
    v_mfma_f32_16x16x32_bf16 v[12:15], v[108:111], a[132:135], v[12:15]
    ds_read_b64_tr_b16 v[102:103], v241 offset:36864
    v_mfma_f32_16x16x32_bf16 v[32:35], v[140:143], a[128:131], v[32:35]
    ds_read2_b64 v[136:139], v244 offset0:128 offset1:136
    v_mfma_f32_16x16x32_bf16 v[36:39], v[140:143], a[132:135], v[36:39]
    s_waitcnt vmcnt(6) lgkmcnt(0)
    v_mfma_f32_16x16x32_bf16 v[0:3], v[96:99], a[136:139], v[0:3]
    ds_read_b64_tr_b16 v[104:105], v240 offset:33792
    v_readlane_b32 s45, v245, 12
    s_nop 0
    s_lshl_b32 s45, s45, 1
    v_mfma_f32_16x16x32_bf16 v[4:7], v[96:99], a[140:143], v[4:7]
    ds_read_b64_tr_b16 v[106:107], v240 offset:37888
    s_nop 0
    buffer_load_dwordx4 a[168:171], v254, s[8:11], s45 offen offset:0 sc1
    buffer_load_dwordx4 a[172:175], v254, s[8:11], s45 offen offset:1024 sc1
    v_mfma_f32_16x16x32_bf16 v[8:11], v[100:103], a[136:139], v[8:11]
    ds_read_b64_tr_b16 v[108:109], v241 offset:33792
    v_mfma_f32_16x16x32_bf16 v[12:15], v[100:103], a[140:143], v[12:15]
    ds_read_b64_tr_b16 v[110:111], v241 offset:37888
    v_mfma_f32_16x16x32_bf16 v[32:35], v[136:139], a[136:139], v[32:35]
    ds_read2_b64 v[140:143], v244 offset0:144 offset1:152
    v_mfma_f32_16x16x32_bf16 v[36:39], v[136:139], a[140:143], v[36:39]
    s_waitcnt vmcnt(6) lgkmcnt(0)
    v_mfma_f32_16x16x32_bf16 v[0:3], v[104:107], a[144:147], v[0:3]
    ds_read_b64_tr_b16 v[96:97], v240 offset:40960
    buffer_load_dword v232, v252, s[20:23], s56 offen sc1
    v_readlane_b32 s45, v245, 13
    s_nop 0
    s_lshl_b32 s45, s45, 1
    v_mfma_f32_16x16x32_bf16 v[4:7], v[104:107], a[148:151], v[4:7]
    ds_read_b64_tr_b16 v[98:99], v240 offset:45056
    s_nop 0
    buffer_load_dwordx4 a[176:179], v254, s[8:11], s45 offen offset:0 sc1
    buffer_load_dwordx4 a[180:183], v254, s[8:11], s45 offen offset:1024 sc1
    v_mfma_f32_16x16x32_bf16 v[8:11], v[108:111], a[144:147], v[8:11]
    ds_read_b64_tr_b16 v[100:101], v241 offset:40960
    v_mfma_f32_16x16x32_bf16 v[12:15], v[108:111], a[148:151], v[12:15]
    ds_read_b64_tr_b16 v[102:103], v241 offset:45056
    v_mfma_f32_16x16x32_bf16 v[32:35], v[140:143], a[144:147], v[32:35]
    ds_read2_b64 v[136:139], v244 offset0:160 offset1:168
    v_mfma_f32_16x16x32_bf16 v[36:39], v[140:143], a[148:151], v[36:39]
    s_waitcnt vmcnt(7) lgkmcnt(0)
    v_mfma_f32_16x16x32_bf16 v[0:3], v[96:99], a[152:155], v[0:3]
    ds_read_b64_tr_b16 v[104:105], v240 offset:41984
    v_readlane_b32 s45, v245, 14
    s_nop 0
    s_lshl_b32 s45, s45, 1
    v_mfma_f32_16x16x32_bf16 v[4:7], v[96:99], a[156:159], v[4:7]
    ds_read_b64_tr_b16 v[106:107], v240 offset:46080
    s_nop 0
    buffer_load_dwordx4 a[184:187], v254, s[8:11], s45 offen offset:0 sc1
    buffer_load_dwordx4 a[188:191], v254, s[8:11], s45 offen offset:1024 sc1
    v_mfma_f32_16x16x32_bf16 v[8:11], v[100:103], a[152:155], v[8:11]
    ds_read_b64_tr_b16 v[108:109], v241 offset:41984
    v_mfma_f32_16x16x32_bf16 v[12:15], v[100:103], a[156:159], v[12:15]
    ds_read_b64_tr_b16 v[110:111], v241 offset:46080
    v_mfma_f32_16x16x32_bf16 v[32:35], v[136:139], a[152:155], v[32:35]
    ds_read2_b64 v[140:143], v244 offset0:176 offset1:184
    v_mfma_f32_16x16x32_bf16 v[36:39], v[136:139], a[156:159], v[36:39]
    s_waitcnt vmcnt(4)
    v_cmp_gt_u32 vcc, 16, v232
    s_cbranch_vccz L_chk20
    s_mov_b64 exec, 1
    s_mov_b32 s3, 0x40000
L_poll21:
    buffer_load_dword v232, v252, s[20:23], s56 offen sc1
    s_sub_u32 s3, s3, 1
    s_cbranch_scc1 L_poll21_y
    s_waitcnt vmcnt(0)
    v_cmp_gt_u32 vcc, 16, v232
    s_cbranch_vccz L_poll21_y
    s_sleep 1
    s_branch L_poll21
L_poll21_y:
    s_waitcnt vmcnt(0)
    s_mov_b64 exec, -1
L_poll21_x:
L_chk20:
    s_waitcnt lgkmcnt(0)
    v_mfma_f32_16x16x32_bf16 v[0:3], v[104:107], a[160:163], v[0:3]
    ds_read_b64_tr_b16 v[96:97], v240 offset:49152
    v_readlane_b32 s45, v245, 15
    s_nop 0
    s_lshl_b32 s45, s45, 1
    v_mfma_f32_16x16x32_bf16 v[4:7], v[104:107], a[164:167], v[4:7]
    ds_read_b64_tr_b16 v[98:99], v240 offset:53248
    s_nop 0
    buffer_load_dwordx4 a[192:195], v254, s[8:11], s45 offen offset:0 sc1
    buffer_load_dwordx4 a[196:199], v254, s[8:11], s45 offen offset:1024 sc1
    v_mfma_f32_16x16x32_bf16 v[8:11], v[108:111], a[160:163], v[8:11]
    ds_read_b64_tr_b16 v[100:101], v241 offset:49152
    v_mfma_f32_16x16x32_bf16 v[12:15], v[108:111], a[164:167], v[12:15]
    ds_read_b64_tr_b16 v[102:103], v241 offset:53248
    v_mfma_f32_16x16x32_bf16 v[32:35], v[140:143], a[160:163], v[32:35]
    ds_read2_b64 v[136:139], v244 offset0:192 offset1:200
    v_mfma_f32_16x16x32_bf16 v[36:39], v[140:143], a[164:167], v[36:39]
    s_waitcnt lgkmcnt(0)
    v_mfma_f32_16x16x32_bf16 v[0:3], v[96:99], a[168:171], v[0:3]
    ds_read_b64_tr_b16 v[104:105], v240 offset:50176
    v_readlane_b32 s45, v245, 16
    s_nop 0
    s_lshl_b32 s45, s45, 1
    v_mfma_f32_16x16x32_bf16 v[4:7], v[96:99], a[172:175], v[4:7]
    ds_read_b64_tr_b16 v[106:107], v240 offset:54272
    s_nop 0
    buffer_load_dwordx4 a[0:3], v254, s[8:11], s45 offen offset:0 sc1
    buffer_load_dwordx4 a[4:7], v254, s[8:11], s45 offen offset:1024 sc1
    v_mfma_f32_16x16x32_bf16 v[8:11], v[100:103], a[168:171], v[8:11]
    ds_read_b64_tr_b16 v[108:109], v241 offset:50176
    v_mfma_f32_16x16x32_bf16 v[12:15], v[100:103], a[172:175], v[12:15]
    ds_read_b64_tr_b16 v[110:111], v241 offset:54272
    v_mfma_f32_16x16x32_bf16 v[32:35], v[136:139], a[168:171], v[32:35]
    ds_read2_b64 v[140:143], v244 offset0:208 offset1:216
    v_mfma_f32_16x16x32_bf16 v[36:39], v[136:139], a[172:175], v[36:39]
    s_waitcnt vmcnt(6) lgkmcnt(0)
    v_mfma_f32_16x16x32_bf16 v[0:3], v[104:107], a[176:179], v[0:3]
    ds_read_b64_tr_b16 v[96:97], v240 offset:57344
    v_readlane_b32 s45, v245, 17
    s_nop 0
    s_lshl_b32 s45, s45, 1
    v_mfma_f32_16x16x32_bf16 v[4:7], v[104:107], a[180:183], v[4:7]
    ds_read_b64_tr_b16 v[98:99], v240 offset:61440
    s_nop 0
    buffer_load_dwordx4 a[8:11], v254, s[8:11], s45 offen offset:0 sc1
    buffer_load_dwordx4 a[12:15], v254, s[8:11], s45 offen offset:1024 sc1
    v_mfma_f32_16x16x32_bf16 v[8:11], v[108:111], a[176:179], v[8:11]
    ds_read_b64_tr_b16 v[100:101], v241 offset:57344
    v_mfma_f32_16x16x32_bf16 v[12:15], v[108:111], a[180:183], v[12:15]
    ds_read_b64_tr_b16 v[102:103], v241 offset:61440
    v_mfma_f32_16x16x32_bf16 v[32:35], v[140:143], a[176:179], v[32:35]
    ds_read2_b64 v[136:139], v244 offset0:224 offset1:232
    v_mfma_f32_16x16x32_bf16 v[36:39], v[140:143], a[180:183], v[36:39]
    s_waitcnt vmcnt(6) lgkmcnt(0)
    v_mfma_f32_16x16x32_bf16 v[0:3], v[96:99], a[184:187], v[0:3]
    ds_read_b64_tr_b16 v[104:105], v240 offset:58368
    v_readlane_b32 s45, v245, 18
    s_nop 0
    s_lshl_b32 s45, s45, 1
    v_mfma_f32_16x16x32_bf16 v[4:7], v[96:99], a[188:191], v[4:7]
    ds_read_b64_tr_b16 v[106:107], v240 offset:62464
    s_nop 0
    buffer_load_dwordx4 a[16:19], v254, s[8:11], s45 offen offset:0 sc1
    buffer_load_dwordx4 a[20:23], v254, s[8:11], s45 offen offset:1024 sc1
    v_mfma_f32_16x16x32_bf16 v[8:11], v[100:103], a[184:187], v[8:11]
    ds_read_b64_tr_b16 v[108:109], v241 offset:58368
    s_lshl_b32 s35, s30, 18
    s_add_u32 s34, s52, s35
    s_add_u32 s34, s34, 0x1400000
    v_mfma_f32_16x16x32_bf16 v[12:15], v[100:103], a[188:191], v[12:15]
    ds_read_b64_tr_b16 v[110:111], v241 offset:62464
    s_add_u32 s16, s82, s34
    s_addc_u32 s17, s83, 0
    s_mov_b32 s18, 0x21000
    v_mfma_f32_16x16x32_bf16 v[32:35], v[136:139], a[184:187], v[32:35]
    ds_read2_b64 v[140:143], v244 offset0:240 offset1:248
    s_mov_b32 s19, 0x20000
    s_lshl_b32 s34, s29, 4
    s_add_u32 s34, s34, s30
    v_mfma_f32_16x16x32_bf16 v[36:39], v[136:139], a[188:191], v[36:39]
    s_lshl2_add_u32 s34, s34, s28
    s_lshl_b32 s34, s34, 7
    s_waitcnt vmcnt(6) lgkmcnt(0)
    v_mfma_f32_16x16x32_bf16 v[0:3], v[104:107], a[192:195], v[0:3]
    ds_read_b64_tr_b16 v[96:97], v236 offset:0
    v_readlane_b32 s45, v245, 19
    s_nop 0
    s_lshl_b32 s45, s45, 1
    v_mfma_f32_16x16x32_bf16 v[4:7], v[104:107], a[196:199], v[4:7]
    ds_read_b64_tr_b16 v[98:99], v236 offset:4096
    s_nop 0
    buffer_load_dwordx4 a[24:27], v254, s[8:11], s45 offen offset:0 sc1
    buffer_load_dwordx4 a[28:31], v254, s[8:11], s45 offen offset:1024 sc1
    v_mfma_f32_16x16x32_bf16 v[8:11], v[108:111], a[192:195], v[8:11]
    ds_read_b64_tr_b16 v[100:101], v237 offset:0
    s_add_u32 s34, s34, 0x1800000
    s_add_u32 s24, s82, s34
    s_addc_u32 s25, s83, 0
    v_mfma_f32_16x16x32_bf16 v[12:15], v[108:111], a[196:199], v[12:15]
    ds_read_b64_tr_b16 v[102:103], v237 offset:4096
    s_mov_b32 s26, 0x80
    s_mov_b32 s27, 0x20000
    s_mov_b32 s55, 0x20000
    v_mfma_f32_16x16x32_bf16 v[32:35], v[140:143], a[192:195], v[32:35]
    ds_read2_b64 v[136:139], v67 offset0:0 offset1:8
    v_lshlrev_b32 v64, 2, v255
    s_add_u32 s35, s29, 48
    s_mul_i32 s54, s35, 4352
    v_mfma_f32_16x16x32_bf16 v[36:39], v[140:143], a[196:199], v[36:39]
    s_waitcnt vmcnt(6) lgkmcnt(0)
    v_mfma_f32_16x16x32_bf16 v[0:3], v[96:99], a[0:3], v[0:3]
    ds_read_b64_tr_b16 v[104:105], v236 offset:1024
    v_readlane_b32 s45, v245, 20
    s_nop 0
    s_lshl_b32 s45, s45, 1
    v_mfma_f32_16x16x32_bf16 v[4:7], v[96:99], a[4:7], v[4:7]
    ds_read_b64_tr_b16 v[106:107], v236 offset:5120
    s_nop 0
    buffer_load_dwordx4 a[32:35], v254, s[8:11], s45 offen offset:0 sc1
    buffer_load_dwordx4 a[36:39], v254, s[8:11], s45 offen offset:1024 sc1
    v_mfma_f32_16x16x32_bf16 v[8:11], v[100:103], a[0:3], v[8:11]
    ds_read_b64_tr_b16 v[108:109], v237 offset:1024
    s_cmp_ge_u32 s28, 2
    s_cselect_b32 s36, s74, s72
    s_cselect_b32 s37, s75, s73
    v_mfma_f32_16x16x32_bf16 v[12:15], v[100:103], a[4:7], v[12:15]
    ds_read_b64_tr_b16 v[110:111], v237 offset:5120
    s_and_b32 s34, s28, 1
    s_mul_i32 s34, s34, 458752
    s_mul_i32 s35, s32, 224
    v_mfma_f32_16x16x32_bf16 v[32:35], v[136:139], a[0:3], v[32:35]
    ds_read2_b64 v[140:143], v67 offset0:16 offset1:24
    s_add_u32 s34, s34, s35
    s_sub_u32 s35, 7340032, s34
    s_add_u32 s4, s36, s34
    s_addc_u32 s5, s37, 0
    v_mfma_f32_16x16x32_bf16 v[36:39], v[136:139], a[4:7], v[36:39]
    s_mov_b32 s6, s35
    s_mov_b32 s7, 0x20000
    s_waitcnt vmcnt(6) lgkmcnt(0)
    v_mfma_f32_16x16x32_bf16 v[0:3], v[104:107], a[8:11], v[0:3]
    ds_read_b64_tr_b16 v[96:97], v236 offset:8192
    v_readlane_b32 s45, v245, 21
    s_nop 0
    s_lshl_b32 s45, s45, 1
    v_mfma_f32_16x16x32_bf16 v[4:7], v[104:107], a[12:15], v[4:7]
    ds_read_b64_tr_b16 v[98:99], v236 offset:12288
    s_nop 0
    buffer_load_dwordx4 a[40:43], v254, s[8:11], s45 offen offset:0 sc1
    buffer_load_dwordx4 a[44:47], v254, s[8:11], s45 offen offset:1024 sc1
    v_mfma_f32_16x16x32_bf16 v[8:11], v[108:111], a[8:11], v[8:11]
    ds_read_b64_tr_b16 v[100:101], v237 offset:8192
    s_mul_i32 s50, s28, 7168
    s_add_u32 s51, s50, 155648
    s_add_u32 s50, s50, 69632
    v_mfma_f32_16x16x32_bf16 v[12:15], v[108:111], a[12:15], v[12:15]
    ds_read_b64_tr_b16 v[102:103], v237 offset:12288
    s_add_u32 s34, s31, s32
    s_and_b32 s34, s34, 3
    v_and_b32 v235, 15, v255
    v_mfma_f32_16x16x32_bf16 v[32:35], v[140:143], a[8:11], v[32:35]
    ds_read2_b64 v[136:139], v67 offset0:32 offset1:40
    v_subrev_u32 v65, s34, v235
    v_and_b32 v65, 3, v65
    v_sub_u32 v65, v235, v65
    v_mfma_f32_16x16x32_bf16 v[36:39], v[140:143], a[12:15], v[36:39]
    v_subrev_u32 v65, 2, v65
    v_cmp_gt_u32 vcc, 2, v65
    s_waitcnt vmcnt(6) lgkmcnt(0)
    v_mfma_f32_16x16x32_bf16 v[0:3], v[96:99], a[16:19], v[0:3]
    ds_read_b64_tr_b16 v[104:105], v236 offset:9216
    v_readlane_b32 s45, v245, 22
    s_nop 0
    s_lshl_b32 s45, s45, 1
    v_mfma_f32_16x16x32_bf16 v[4:7], v[96:99], a[20:23], v[4:7]
    ds_read_b64_tr_b16 v[106:107], v236 offset:13312
    s_nop 0
    buffer_load_dwordx4 a[48:51], v254, s[8:11], s45 offen offset:0 sc1
    buffer_load_dwordx4 a[52:55], v254, s[8:11], s45 offen offset:1024 sc1
    v_mfma_f32_16x16x32_bf16 v[8:11], v[100:103], a[16:19], v[8:11]
    ds_read_b64_tr_b16 v[108:109], v237 offset:9216
    v_mov_b32 v68, v235
    v_subrev_u32 v65, s34, v235
    v_and_b32 v65, 3, v65
    v_mfma_f32_16x16x32_bf16 v[12:15], v[100:103], a[20:23], v[12:15]
    ds_read_b64_tr_b16 v[110:111], v237 offset:13312
    v_sub_u32 v66, v235, v65
    v_lshlrev_b32 v65, 2, v65
    s_mov_b32 s35, 0xff2
    v_mfma_f32_16x16x32_bf16 v[32:35], v[136:139], a[16:19], v[32:35]
    ds_read2_b64 v[140:143], v67 offset0:48 offset1:56
    v_bfe_i32 v65, s35, v65, 4
    v_cmp_ge_u32 s[36:37], 13, v66
    s_nop 0
    v_mfma_f32_16x16x32_bf16 v[36:39], v[136:139], a[20:23], v[36:39]
    v_cndmask_b32_e64 v65, 0, v65, s[36:37]
    v_add_u32 v235, v235, v65
    s_waitcnt vmcnt(6) lgkmcnt(0)
    v_mfma_f32_16x16x32_bf16 v[0:3], v[104:107], a[24:27], v[0:3]
    ds_read_b64_tr_b16 v[96:97], v236 offset:16384
    v_readlane_b32 s45, v245, 23
    s_nop 0
    s_lshl_b32 s45, s45, 1
    v_mfma_f32_16x16x32_bf16 v[4:7], v[104:107], a[28:31], v[4:7]
    ds_read_b64_tr_b16 v[98:99], v236 offset:20480
    s_nop 0
    buffer_load_dwordx4 a[56:59], v254, s[8:11], s45 offen offset:0 sc1
    buffer_load_dwordx4 a[60:63], v254, s[8:11], s45 offen offset:1024 sc1
    v_mfma_f32_16x16x32_bf16 v[8:11], v[108:111], a[24:27], v[8:11]
    ds_read_b64_tr_b16 v[100:101], v237 offset:16384
    v_cndmask_b32 v235, v235, v68, vcc
    s_lshr_b32 s34, s58, 1
    v_lshrrev_b32 v65, 3, v235
    v_mfma_f32_16x16x32_bf16 v[12:15], v[108:111], a[28:31], v[12:15]
    ds_read_b64_tr_b16 v[102:103], v237 offset:20480
    v_xor_b32 v65, s34, v65
    v_and_b32 v66, 3, v235
    v_lshl_add_u32 v65, v65, 2, v66
    v_mfma_f32_16x16x32_bf16 v[32:35], v[140:143], a[24:27], v[32:35]
    ds_read2_b64 v[136:139], v67 offset0:64 offset1:72
    v_bfe_u32 v66, v235, 2, 1
    v_lshl_add_u32 v235, v65, 2, v66
    v_and_b32 v235, 15, v255
    v_mfma_f32_16x16x32_bf16 v[36:39], v[140:143], a[28:31], v[36:39]
    s_add_u32 s34, s31, s32
    s_and_b32 s34, s34, 3
    s_waitcnt vmcnt(6) lgkmcnt(0)
    v_mfma_f32_16x16x32_bf16 v[0:3], v[96:99], a[32:35], v[0:3]
    ds_read_b64_tr_b16 v[104:105], v236 offset:17408
    v_readlane_b32 s45, v245, 24
    s_nop 0
    s_lshl_b32 s45, s45, 1
    v_mfma_f32_16x16x32_bf16 v[4:7], v[96:99], a[36:39], v[4:7]
    ds_read_b64_tr_b16 v[106:107], v236 offset:21504
    s_nop 0
    buffer_load_dwordx4 a[64:67], v254, s[8:11], s45 offen offset:0 sc1
    buffer_load_dwordx4 a[68:71], v254, s[8:11], s45 offen offset:1024 sc1
    v_mfma_f32_16x16x32_bf16 v[8:11], v[100:103], a[32:35], v[8:11]
    ds_read_b64_tr_b16 v[108:109], v237 offset:17408
    v_subrev_u32 v65, s34, v235
    v_and_b32 v65, 3, v65
    v_sub_u32 v66, v235, v65
    v_mfma_f32_16x16x32_bf16 v[12:15], v[100:103], a[36:39], v[12:15]
    ds_read_b64_tr_b16 v[110:111], v237 offset:21504
    v_lshlrev_b32 v65, 2, v65
    s_mov_b32 s35, 0xf1
    v_bfe_i32 v65, s35, v65, 4
    v_mfma_f32_16x16x32_bf16 v[32:35], v[136:139], a[32:35], v[32:35]
    ds_read2_b64 v[140:143], v67 offset0:80 offset1:88
    v_cmp_ge_u32 s[36:37], 14, v66
    s_nop 0
    s_nop 0
    v_cndmask_b32_e64 v65, 0, v65, s[36:37]
    v_mfma_f32_16x16x32_bf16 v[36:39], v[136:139], a[36:39], v[36:39]
    v_add_u32 v235, v235, v65
    v_and_b32 v65, 7, v235
    s_waitcnt vmcnt(6) lgkmcnt(0)
    v_mfma_f32_16x16x32_bf16 v[0:3], v[104:107], a[40:43], v[0:3]
    ds_read_b64_tr_b16 v[96:97], v236 offset:24576
    v_readlane_b32 s45, v245, 25
    s_nop 0
    s_lshl_b32 s45, s45, 1
    v_mfma_f32_16x16x32_bf16 v[4:7], v[104:107], a[44:47], v[4:7]
    ds_read_b64_tr_b16 v[98:99], v236 offset:28672
    s_nop 0
    buffer_load_dwordx4 a[200:203], v254, s[8:11], s45 offen offset:0 sc1
    buffer_load_dwordx4 a[204:207], v254, s[8:11], s45 offen offset:1024 sc1
    v_mfma_f32_16x16x32_bf16 v[8:11], v[108:111], a[40:43], v[8:11]
    ds_read_b64_tr_b16 v[100:101], v237 offset:24576
    v_bfe_u32 v66, v235, 3, 1
    v_lshl_add_u32 v235, v65, 2, v66
    s_mov_b32 s48, 0
    v_mfma_f32_16x16x32_bf16 v[12:15], v[108:111], a[44:47], v[12:15]
    ds_read_b64_tr_b16 v[102:103], v237 offset:28672
    v_readlane_b32 s3, v235, s48
    s_nop 0
    s_mul_i32 s53, s3, 229376
    v_mfma_f32_16x16x32_bf16 v[32:35], v[140:143], a[40:43], v[32:35]
    ds_read2_b64 v[136:139], v67 offset0:96 offset1:104
    s_add_u32 s48, s48, 1
    v_lshrrev_b32 v65, 2, v255
    v_mul_u32_u24 v65, 224, v65
    v_mfma_f32_16x16x32_bf16 v[36:39], v[140:143], a[44:47], v[36:39]
    v_and_b32 v66, 3, v255
    v_lshl_add_u32 v65, v66, 3, v65
    s_waitcnt vmcnt(6) lgkmcnt(0)
    v_mfma_f32_16x16x32_bf16 v[0:3], v[96:99], a[48:51], v[0:3]
    ds_read_b64_tr_b16 v[104:105], v236 offset:25600
    v_readlane_b32 s45, v245, 26
    s_nop 0
    s_lshl_b32 s45, s45, 1
    v_mfma_f32_16x16x32_bf16 v[4:7], v[96:99], a[52:55], v[4:7]
    ds_read_b64_tr_b16 v[106:107], v236 offset:29696
    s_nop 0
    buffer_load_dwordx4 a[208:211], v254, s[8:11], s45 offen offset:0 sc1
    buffer_load_dwordx4 a[212:215], v254, s[8:11], s45 offen offset:1024 sc1
    v_mfma_f32_16x16x32_bf16 v[8:11], v[100:103], a[48:51], v[8:11]
    ds_read_b64_tr_b16 v[108:109], v237 offset:25600
    s_and_b32 s34, s32, 1
    s_lshl_b32 s35, s34, 5
    v_add_u32 v231, s35, v65
    v_mfma_f32_16x16x32_bf16 v[12:15], v[100:103], a[52:55], v[12:15]
    ds_read_b64_tr_b16 v[110:111], v237 offset:29696
    s_mul_i32 s35, s34, -192
    s_add_u32 s35, s35, 192
    v_add_u32 v232, s35, v65
    v_mfma_f32_16x16x32_bf16 v[32:35], v[136:139], a[48:51], v[32:35]
    ds_read2_b64 v[140:143], v67 offset0:112 offset1:120
    s_mov_b32 s46, 69632
    v_add_u32 v233, s46, v231
    v_add_u32 v234, s46, v232
    v_mfma_f32_16x16x32_bf16 v[36:39], v[136:139], a[52:55], v[36:39]
    s_lshl_b32 s34, s31, 2
    s_add_u32 s34, s34, s28
    s_waitcnt vmcnt(6) lgkmcnt(0)
    v_mfma_f32_16x16x32_bf16 v[0:3], v[104:107], a[56:59], v[0:3]
    ds_read_b64_tr_b16 v[96:97], v236 offset:32768
    v_readlane_b32 s45, v245, 27
    s_nop 0
    s_lshl_b32 s45, s45, 1
    v_mfma_f32_16x16x32_bf16 v[4:7], v[104:107], a[60:63], v[4:7]
    ds_read_b64_tr_b16 v[98:99], v236 offset:36864
    s_nop 0
    buffer_load_dwordx4 a[216:219], v254, s[8:11], s45 offen offset:0 sc1
    buffer_load_dwordx4 a[220:223], v254, s[8:11], s45 offen offset:1024 sc1
    v_mfma_f32_16x16x32_bf16 v[8:11], v[108:111], a[56:59], v[8:11]
    ds_read_b64_tr_b16 v[100:101], v237 offset:32768
    s_lshl_b32 s57, s34, 12
    s_mov_b32 s34, s57
    s_add_u32 s34, s34, 0x1400000
    v_mfma_f32_16x16x32_bf16 v[12:15], v[108:111], a[60:63], v[12:15]
    ds_read_b64_tr_b16 v[102:103], v237 offset:36864
    s_add_u32 s12, s82, s34
    s_addc_u32 s13, s83, 0
    s_mov_b32 s14, 0x400000
    v_mfma_f32_16x16x32_bf16 v[32:35], v[140:143], a[56:59], v[32:35]
    ds_read2_b64 v[136:139], v67 offset0:128 offset1:136
    s_mov_b32 s15, 0x20000
    s_mov_b32 s49, 0
    v_readlane_b32 s3, v235, s49
    v_mfma_f32_16x16x32_bf16 v[36:39], v[140:143], a[60:63], v[36:39]
    s_mul_i32 s42, s3, 131072
    s_add_u32 s49, s49, 1
    s_waitcnt vmcnt(6) lgkmcnt(0)
    v_mfma_f32_16x16x32_bf16 v[0:3], v[96:99], a[64:67], v[0:3]
    ds_read_b64_tr_b16 v[104:105], v236 offset:33792
    v_readlane_b32 s45, v245, 28
    s_nop 0
    s_lshl_b32 s45, s45, 1
    v_mfma_f32_16x16x32_bf16 v[4:7], v[96:99], a[68:71], v[4:7]
    ds_read_b64_tr_b16 v[106:107], v236 offset:37888
    s_nop 0
    buffer_load_dwordx4 a[224:227], v254, s[8:11], s45 offen offset:0 sc1
    buffer_load_dwordx4 a[228:231], v254, s[8:11], s45 offen offset:1024 sc1
    v_mfma_f32_16x16x32_bf16 v[8:11], v[100:103], a[64:67], v[8:11]
    ds_read_b64_tr_b16 v[108:109], v237 offset:33792
    s_lshl_b32 s35, s31, 1
    s_lshr_b32 s34, s28, 1
    s_add_u32 s35, s35, s34
    v_mfma_f32_16x16x32_bf16 v[12:15], v[100:103], a[68:71], v[12:15]
    ds_read_b64_tr_b16 v[110:111], v237 offset:37888
    s_add_u32 s35, s35, 48
    s_mul_i32 s43, s35, 4352
    v_mfma_f32_16x16x32_bf16 v[32:35], v[136:139], a[64:67], v[32:35]
    ds_read2_b64 v[140:143], v67 offset0:144 offset1:152
    v_mfma_f32_16x16x32_bf16 v[36:39], v[136:139], a[68:71], v[36:39]
    s_waitcnt vmcnt(6) lgkmcnt(0)
    v_mfma_f32_16x16x32_bf16 v[0:3], v[104:107], a[200:203], v[0:3]
    ds_read_b64_tr_b16 v[96:97], v236 offset:40960
    v_readlane_b32 s45, v245, 29
    s_nop 0
    s_lshl_b32 s45, s45, 1
    v_mfma_f32_16x16x32_bf16 v[4:7], v[104:107], a[204:207], v[4:7]
    ds_read_b64_tr_b16 v[98:99], v236 offset:45056
    s_nop 0
    buffer_load_dwordx4 a[232:235], v254, s[8:11], s45 offen offset:0 sc1
    buffer_load_dwordx4 a[236:239], v254, s[8:11], s45 offen offset:1024 sc1
    v_mfma_f32_16x16x32_bf16 v[8:11], v[108:111], a[200:203], v[8:11]
    ds_read_b64_tr_b16 v[100:101], v237 offset:40960
    v_mfma_f32_16x16x32_bf16 v[12:15], v[108:111], a[204:207], v[12:15]
    ds_read_b64_tr_b16 v[102:103], v237 offset:45056
    v_mfma_f32_16x16x32_bf16 v[32:35], v[140:143], a[200:203], v[32:35]
    ds_read2_b64 v[136:139], v67 offset0:160 offset1:168
    v_mfma_f32_16x16x32_bf16 v[36:39], v[140:143], a[204:207], v[36:39]
    s_waitcnt vmcnt(6) lgkmcnt(0)
    v_mfma_f32_16x16x32_bf16 v[0:3], v[96:99], a[208:211], v[0:3]
    ds_read_b64_tr_b16 v[104:105], v236 offset:41984
    v_readlane_b32 s45, v245, 30
    s_nop 0
    s_lshl_b32 s45, s45, 1
    v_mfma_f32_16x16x32_bf16 v[4:7], v[96:99], a[212:215], v[4:7]
    ds_read_b64_tr_b16 v[106:107], v236 offset:46080
    s_nop 0
    buffer_load_dwordx4 a[240:243], v254, s[8:11], s45 offen offset:0 sc1
    buffer_load_dwordx4 a[244:247], v254, s[8:11], s45 offen offset:1024 sc1
    v_mfma_f32_16x16x32_bf16 v[8:11], v[100:103], a[208:211], v[8:11]
    ds_read_b64_tr_b16 v[108:109], v237 offset:41984
    v_mfma_f32_16x16x32_bf16 v[12:15], v[100:103], a[212:215], v[12:15]
    ds_read_b64_tr_b16 v[110:111], v237 offset:46080
    v_mfma_f32_16x16x32_bf16 v[32:35], v[136:139], a[208:211], v[32:35]
    ds_read2_b64 v[140:143], v67 offset0:176 offset1:184
    v_mfma_f32_16x16x32_bf16 v[36:39], v[136:139], a[212:215], v[36:39]
    s_waitcnt vmcnt(6) lgkmcnt(0)
    v_mfma_f32_16x16x32_bf16 v[0:3], v[104:107], a[216:219], v[0:3]
    ds_read_b64_tr_b16 v[96:97], v236 offset:49152
    v_readlane_b32 s45, v245, 31
    s_nop 0
    s_lshl_b32 s45, s45, 1
    v_mfma_f32_16x16x32_bf16 v[4:7], v[104:107], a[220:223], v[4:7]
    ds_read_b64_tr_b16 v[98:99], v236 offset:53248
    s_nop 0
    buffer_load_dwordx4 a[248:251], v254, s[8:11], s45 offen offset:0 sc1
    buffer_load_dwordx4 a[252:255], v254, s[8:11], s45 offen offset:1024 sc1
    v_mfma_f32_16x16x32_bf16 v[8:11], v[108:111], a[216:219], v[8:11]
    ds_read_b64_tr_b16 v[100:101], v237 offset:49152
    v_mfma_f32_16x16x32_bf16 v[12:15], v[108:111], a[220:223], v[12:15]
    ds_read_b64_tr_b16 v[102:103], v237 offset:53248
    v_mfma_f32_16x16x32_bf16 v[32:35], v[140:143], a[216:219], v[32:35]
    ds_read2_b64 v[136:139], v67 offset0:192 offset1:200
    v_mfma_f32_16x16x32_bf16 v[36:39], v[140:143], a[220:223], v[36:39]
    s_waitcnt vmcnt(6) lgkmcnt(0)
    v_mfma_f32_16x16x32_bf16 v[0:3], v[96:99], a[224:227], v[0:3]
    ds_read_b64_tr_b16 v[104:105], v236 offset:50176
    v_mfma_f32_16x16x32_bf16 v[4:7], v[96:99], a[228:231], v[4:7]
    ds_read_b64_tr_b16 v[106:107], v236 offset:54272
    v_mfma_f32_16x16x32_bf16 v[8:11], v[100:103], a[224:227], v[8:11]
    ds_read_b64_tr_b16 v[108:109], v237 offset:50176
    v_mfma_f32_16x16x32_bf16 v[12:15], v[100:103], a[228:231], v[12:15]
    ds_read_b64_tr_b16 v[110:111], v237 offset:54272
    v_mfma_f32_16x16x32_bf16 v[32:35], v[136:139], a[224:227], v[32:35]
    ds_read2_b64 v[140:143], v67 offset0:208 offset1:216
    v_mfma_f32_16x16x32_bf16 v[36:39], v[136:139], a[228:231], v[36:39]
    s_waitcnt vmcnt(4) lgkmcnt(0)
    v_mfma_f32_16x16x32_bf16 v[0:3], v[104:107], a[232:235], v[0:3]
    ds_read_b64_tr_b16 v[96:97], v236 offset:57344
    v_mfma_f32_16x16x32_bf16 v[4:7], v[104:107], a[236:239], v[4:7]
    ds_read_b64_tr_b16 v[98:99], v236 offset:61440
    v_mfma_f32_16x16x32_bf16 v[8:11], v[108:111], a[232:235], v[8:11]
    ds_read_b64_tr_b16 v[100:101], v237 offset:57344
    v_mfma_f32_16x16x32_bf16 v[12:15], v[108:111], a[236:239], v[12:15]
    ds_read_b64_tr_b16 v[102:103], v237 offset:61440
    v_mfma_f32_16x16x32_bf16 v[32:35], v[140:143], a[232:235], v[32:35]
    ds_read2_b64 v[136:139], v67 offset0:224 offset1:232
    v_mfma_f32_16x16x32_bf16 v[36:39], v[140:143], a[236:239], v[36:39]
    s_waitcnt vmcnt(2) lgkmcnt(0)
    v_mfma_f32_16x16x32_bf16 v[0:3], v[96:99], a[240:243], v[0:3]
    ds_read_b64_tr_b16 v[104:105], v236 offset:58368
    ds_read_b64_tr_b16 v[106:107], v236 offset:62464
    v_mfma_f32_16x16x32_bf16 v[4:7], v[96:99], a[244:247], v[4:7]
    ds_read_b64_tr_b16 v[108:109], v237 offset:58368
    ds_read_b64_tr_b16 v[110:111], v237 offset:62464
    v_mfma_f32_16x16x32_bf16 v[8:11], v[100:103], a[240:243], v[8:11]
    ds_read2_b64 v[140:143], v67 offset0:240 offset1:248
    ds_read_b64_tr_b16 v[112:113], v242 offset:0
    v_mfma_f32_16x16x32_bf16 v[12:15], v[100:103], a[244:247], v[12:15]
    ds_read_b64_tr_b16 v[114:115], v242 offset:4096
    ds_read_b64_tr_b16 v[116:117], v243 offset:0
    v_mfma_f32_16x16x32_bf16 v[32:35], v[136:139], a[240:243], v[32:35]
    ds_read_b64_tr_b16 v[118:119], v243 offset:4096
    v_mfma_f32_16x16x32_bf16 v[36:39], v[136:139], a[244:247], v[36:39]
    s_waitcnt vmcnt(0) lgkmcnt(4)
    v_mfma_f32_16x16x32_bf16 v[0:3], v[104:107], a[248:251], v[0:3]
    ds_read_b64_tr_b16 v[120:121], v242 offset:1024
    v_mfma_f32_16x16x32_bf16 v[4:7], v[104:107], a[252:255], v[4:7]
    ds_read_b64_tr_b16 v[122:123], v242 offset:5120
    v_mfma_f32_16x16x32_bf16 v[8:11], v[108:111], a[248:251], v[8:11]
    ds_read_b64_tr_b16 v[124:125], v243 offset:1024
    v_mfma_f32_16x16x32_bf16 v[12:15], v[108:111], a[252:255], v[12:15]
    ds_read_b64_tr_b16 v[126:127], v243 offset:5120
    v_mfma_f32_16x16x32_bf16 v[32:35], v[140:143], a[248:251], v[32:35]
    v_mfma_f32_16x16x32_bf16 v[36:39], v[140:143], a[252:255], v[36:39]
    s_waitcnt lgkmcnt(4)
    v_mfma_f32_16x16x32_bf16 v[16:19], v[112:115], a[72:75], v[16:19]
    ds_read_b64_tr_b16 v[128:129], v242 offset:8192
    s_nop 3
    v_add_f32 v56, v32, v33
    v_mfma_f32_16x16x32_bf16 v[20:23], v[112:115], a[76:79], v[20:23]
    ds_read_b64_tr_b16 v[130:131], v242 offset:12288
    v_add_f32 v58, v36, v37
    v_sub_f32 v160, v0, v56
    v_sub_f32 v161, v1, v56
    v_mfma_f32_16x16x32_bf16 v[24:27], v[116:119], a[72:75], v[24:27]
    ds_read_b64_tr_b16 v[132:133], v243 offset:8192
    v_cvt_pk_bf16_f32 v144, v160, v161
    v_sub_f32 v162, v2, v56
    v_sub_f32 v163, v3, v56
    v_mfma_f32_16x16x32_bf16 v[28:31], v[116:119], a[76:79], v[28:31]
    ds_read_b64_tr_b16 v[134:135], v243 offset:12288
    v_cvt_pk_bf16_f32 v145, v162, v163
    v_sub_f32 v164, v8, v56
    s_waitcnt lgkmcnt(4)
    v_mfma_f32_16x16x32_bf16 v[16:19], v[120:123], a[80:83], v[16:19]
    ds_read_b64_tr_b16 v[112:113], v242 offset:9216
    v_sub_f32 v165, v9, v56
    v_cvt_pk_bf16_f32 v146, v164, v165
    v_sub_f32 v166, v10, v56
    v_mfma_f32_16x16x32_bf16 v[20:23], v[120:123], a[84:87], v[20:23]
    ds_read_b64_tr_b16 v[114:115], v242 offset:13312
    v_sub_f32 v167, v11, v56
    v_cvt_pk_bf16_f32 v147, v166, v167
    buffer_store_dwordx4 v[144:147], v254, s[16:19], 0 offen offset:0 sc1
    v_mfma_f32_16x16x32_bf16 v[24:27], v[124:127], a[80:83], v[24:27]
    ds_read_b64_tr_b16 v[116:117], v243 offset:9216
    v_sub_f32 v168, v4, v58
    v_sub_f32 v169, v5, v58
    v_cvt_pk_bf16_f32 v152, v168, v169
    v_mfma_f32_16x16x32_bf16 v[28:31], v[124:127], a[84:87], v[28:31]
    ds_read_b64_tr_b16 v[118:119], v243 offset:13312
    v_sub_f32 v170, v6, v58
    v_sub_f32 v171, v7, v58
    s_waitcnt lgkmcnt(4)
    v_mfma_f32_16x16x32_bf16 v[16:19], v[128:131], a[88:91], v[16:19]
    ds_read_b64_tr_b16 v[120:121], v242 offset:16384
    v_cvt_pk_bf16_f32 v153, v170, v171
    v_sub_f32 v172, v12, v58
    v_sub_f32 v173, v13, v58
    v_mfma_f32_16x16x32_bf16 v[20:23], v[128:131], a[92:95], v[20:23]
    ds_read_b64_tr_b16 v[122:123], v242 offset:20480
    v_cvt_pk_bf16_f32 v154, v172, v173
    v_sub_f32 v174, v14, v58
    v_sub_f32 v175, v15, v58
    v_mfma_f32_16x16x32_bf16 v[24:27], v[132:135], a[88:91], v[24:27]
    ds_read_b64_tr_b16 v[124:125], v243 offset:16384
    v_cvt_pk_bf16_f32 v155, v174, v175
    buffer_store_dwordx4 v[152:155], v254, s[16:19], 0 offen offset:1024 sc1
    v_mul_f32 v60, v160, v160
    v_mfma_f32_16x16x32_bf16 v[28:31], v[132:135], a[92:95], v[28:31]
    ds_read_b64_tr_b16 v[126:127], v243 offset:20480
    v_mul_f32 v62, v168, v168
    v_mul_f32 v61, v161, v161
    s_waitcnt lgkmcnt(4)
    v_mfma_f32_16x16x32_bf16 v[16:19], v[112:115], a[96:99], v[16:19]
    ds_read_b64_tr_b16 v[128:129], v242 offset:17408
    v_mul_f32 v63, v169, v169
    v_fmac_f32 v60, v162, v162
    v_fmac_f32 v62, v170, v170
    v_mfma_f32_16x16x32_bf16 v[20:23], v[112:115], a[100:103], v[20:23]
    ds_read_b64_tr_b16 v[130:131], v242 offset:21504
    v_fmac_f32 v61, v163, v163
    v_fmac_f32 v63, v171, v171
    v_fmac_f32 v60, v164, v164
    v_mfma_f32_16x16x32_bf16 v[24:27], v[116:119], a[96:99], v[24:27]
    ds_read_b64_tr_b16 v[132:133], v243 offset:17408
    v_fmac_f32 v62, v172, v172
    v_fmac_f32 v61, v165, v165
    v_fmac_f32 v63, v173, v173
    v_mfma_f32_16x16x32_bf16 v[28:31], v[116:119], a[100:103], v[28:31]
    ds_read_b64_tr_b16 v[134:135], v243 offset:21504
    v_fmac_f32 v60, v166, v166
    v_fmac_f32 v62, v174, v174
    s_waitcnt lgkmcnt(4)
    v_mfma_f32_16x16x32_bf16 v[16:19], v[120:123], a[104:107], v[16:19]
    ds_read_b64_tr_b16 v[112:113], v242 offset:24576
    v_fmac_f32 v61, v167, v167
    v_mfma_f32_16x16x32_bf16 v[20:23], v[120:123], a[108:111], v[20:23]
    ds_read_b64_tr_b16 v[114:115], v242 offset:28672
    v_fmac_f32 v63, v175, v175
    v_mfma_f32_16x16x32_bf16 v[24:27], v[124:127], a[104:107], v[24:27]
    ds_read_b64_tr_b16 v[116:117], v243 offset:24576
    v_mfma_f32_16x16x32_bf16 v[28:31], v[124:127], a[108:111], v[28:31]
    ds_read_b64_tr_b16 v[118:119], v243 offset:28672
    s_waitcnt lgkmcnt(4)
    v_mfma_f32_16x16x32_bf16 v[16:19], v[128:131], a[112:115], v[16:19]
    ds_read_b64_tr_b16 v[120:121], v242 offset:25600
    v_mfma_f32_16x16x32_bf16 v[20:23], v[128:131], a[116:119], v[20:23]
    ds_read_b64_tr_b16 v[122:123], v242 offset:29696
    v_mfma_f32_16x16x32_bf16 v[24:27], v[132:135], a[112:115], v[24:27]
    ds_read_b64_tr_b16 v[124:125], v243 offset:25600
    v_mfma_f32_16x16x32_bf16 v[28:31], v[132:135], a[116:119], v[28:31]
    ds_read_b64_tr_b16 v[126:127], v243 offset:29696
    s_waitcnt lgkmcnt(4)
    v_mfma_f32_16x16x32_bf16 v[16:19], v[112:115], a[120:123], v[16:19]
    ds_read_b64_tr_b16 v[128:129], v242 offset:32768
    v_mfma_f32_16x16x32_bf16 v[20:23], v[112:115], a[124:127], v[20:23]
    ds_read_b64_tr_b16 v[130:131], v242 offset:36864
    v_mfma_f32_16x16x32_bf16 v[24:27], v[116:119], a[120:123], v[24:27]
    ds_read_b64_tr_b16 v[132:133], v243 offset:32768
    v_mfma_f32_16x16x32_bf16 v[28:31], v[116:119], a[124:127], v[28:31]
    ds_read_b64_tr_b16 v[134:135], v243 offset:36864
    s_waitcnt lgkmcnt(4)
    v_mfma_f32_16x16x32_bf16 v[16:19], v[120:123], a[128:131], v[16:19]
    ds_read_b64_tr_b16 v[112:113], v242 offset:33792
    v_mfma_f32_16x16x32_bf16 v[20:23], v[120:123], a[132:135], v[20:23]
    ds_read_b64_tr_b16 v[114:115], v242 offset:37888
    v_mfma_f32_16x16x32_bf16 v[24:27], v[124:127], a[128:131], v[24:27]
    ds_read_b64_tr_b16 v[116:117], v243 offset:33792
    v_mfma_f32_16x16x32_bf16 v[28:31], v[124:127], a[132:135], v[28:31]
    ds_read_b64_tr_b16 v[118:119], v243 offset:37888
    s_waitcnt lgkmcnt(4)
    v_mfma_f32_16x16x32_bf16 v[16:19], v[128:131], a[136:139], v[16:19]
    ds_read_b64_tr_b16 v[120:121], v242 offset:40960
    v_mfma_f32_16x16x32_bf16 v[20:23], v[128:131], a[140:143], v[20:23]
    ds_read_b64_tr_b16 v[122:123], v242 offset:45056
    v_mfma_f32_16x16x32_bf16 v[24:27], v[132:135], a[136:139], v[24:27]
    ds_read_b64_tr_b16 v[124:125], v243 offset:40960
    v_mfma_f32_16x16x32_bf16 v[28:31], v[132:135], a[140:143], v[28:31]
    ds_read_b64_tr_b16 v[126:127], v243 offset:45056
    s_waitcnt lgkmcnt(4)
    v_mfma_f32_16x16x32_bf16 v[16:19], v[112:115], a[144:147], v[16:19]
    ds_read_b64_tr_b16 v[128:129], v242 offset:41984
    v_mfma_f32_16x16x32_bf16 v[20:23], v[112:115], a[148:151], v[20:23]
    ds_read_b64_tr_b16 v[130:131], v242 offset:46080
    v_mfma_f32_16x16x32_bf16 v[24:27], v[116:119], a[144:147], v[24:27]
    ds_read_b64_tr_b16 v[132:133], v243 offset:41984
    v_mfma_f32_16x16x32_bf16 v[28:31], v[116:119], a[148:151], v[28:31]
    ds_read_b64_tr_b16 v[134:135], v243 offset:46080
    s_waitcnt lgkmcnt(4)
    v_mfma_f32_16x16x32_bf16 v[16:19], v[120:123], a[152:155], v[16:19]
    ds_read_b64_tr_b16 v[112:113], v242 offset:49152
    v_mfma_f32_16x16x32_bf16 v[20:23], v[120:123], a[156:159], v[20:23]
    ds_read_b64_tr_b16 v[114:115], v242 offset:53248
    v_mfma_f32_16x16x32_bf16 v[24:27], v[124:127], a[152:155], v[24:27]
    ds_read_b64_tr_b16 v[116:117], v243 offset:49152
    v_mfma_f32_16x16x32_bf16 v[28:31], v[124:127], a[156:159], v[28:31]
    ds_read_b64_tr_b16 v[118:119], v243 offset:53248
    s_waitcnt lgkmcnt(4)
    v_mfma_f32_16x16x32_bf16 v[16:19], v[128:131], a[160:163], v[16:19]
    ds_read_b64_tr_b16 v[120:121], v242 offset:50176
    v_mfma_f32_16x16x32_bf16 v[20:23], v[128:131], a[164:167], v[20:23]
    ds_read_b64_tr_b16 v[122:123], v242 offset:54272
    v_mfma_f32_16x16x32_bf16 v[24:27], v[132:135], a[160:163], v[24:27]
    ds_read_b64_tr_b16 v[124:125], v243 offset:50176
    v_mfma_f32_16x16x32_bf16 v[28:31], v[132:135], a[164:167], v[28:31]
    ds_read_b64_tr_b16 v[126:127], v243 offset:54272
    s_waitcnt lgkmcnt(4)
    v_mfma_f32_16x16x32_bf16 v[16:19], v[112:115], a[168:171], v[16:19]
    ds_read_b64_tr_b16 v[128:129], v242 offset:57344
    v_mfma_f32_16x16x32_bf16 v[20:23], v[112:115], a[172:175], v[20:23]
    ds_read_b64_tr_b16 v[130:131], v242 offset:61440
    v_mfma_f32_16x16x32_bf16 v[24:27], v[116:119], a[168:171], v[24:27]
    ds_read_b64_tr_b16 v[132:133], v243 offset:57344
    v_mfma_f32_16x16x32_bf16 v[28:31], v[116:119], a[172:175], v[28:31]
    ds_read_b64_tr_b16 v[134:135], v243 offset:61440
    s_waitcnt lgkmcnt(4)
    v_mfma_f32_16x16x32_bf16 v[16:19], v[120:123], a[176:179], v[16:19]
    ds_read_b64_tr_b16 v[112:113], v242 offset:58368
    v_mfma_f32_16x16x32_bf16 v[20:23], v[120:123], a[180:183], v[20:23]
    ds_read_b64_tr_b16 v[114:115], v242 offset:62464
    v_mfma_f32_16x16x32_bf16 v[24:27], v[124:127], a[176:179], v[24:27]
    ds_read_b64_tr_b16 v[116:117], v243 offset:58368
    v_mfma_f32_16x16x32_bf16 v[28:31], v[124:127], a[180:183], v[28:31]
    ds_read_b64_tr_b16 v[118:119], v243 offset:62464
    s_waitcnt vmcnt(0)
    s_barrier
    s_cmp_ge_u32 s28, 1
    s_cbranch_scc1 L_sig22
    s_mov_b64 exec, 1
    buffer_atomic_add v253, v252, s[20:23], s54 offen sc1
    s_mov_b64 exec, -1
L_sig22:
    s_waitcnt lgkmcnt(4)
    v_mfma_f32_16x16x32_bf16 v[16:19], v[128:131], a[184:187], v[16:19]
    ds_read_b64_tr_b16 v[120:121], v238 offset:0
    v_mfma_f32_16x16x32_bf16 v[20:23], v[128:131], a[188:191], v[20:23]
    ds_read_b64_tr_b16 v[122:123], v238 offset:4096
    v_mfma_f32_16x16x32_bf16 v[24:27], v[132:135], a[184:187], v[24:27]
    ds_read_b64_tr_b16 v[124:125], v239 offset:0
    v_mfma_f32_16x16x32_bf16 v[28:31], v[132:135], a[188:191], v[28:31]
    ds_read_b64_tr_b16 v[126:127], v239 offset:4096
    s_waitcnt lgkmcnt(4)
    v_mfma_f32_16x16x32_bf16 v[16:19], v[112:115], a[192:195], v[16:19]
    ds_read_b64_tr_b16 v[128:129], v238 offset:1024
    s_mov_b32 m0, s50
    v_mfma_f32_16x16x32_bf16 v[20:23], v[112:115], a[196:199], v[20:23]
    ds_read_b64_tr_b16 v[130:131], v238 offset:5120
    s_add_u32 s50, s50, 28672
    v_mfma_f32_16x16x32_bf16 v[24:27], v[116:119], a[192:195], v[24:27]
    ds_read_b64_tr_b16 v[132:133], v239 offset:1024
    buffer_load_dwordx4 v224, s[4:7], s53 offen offset:0 lds
    v_mfma_f32_16x16x32_bf16 v[28:31], v[116:119], a[196:199], v[28:31]
    ds_read_b64_tr_b16 v[134:135], v239 offset:5120
    s_waitcnt lgkmcnt(4)
    v_mfma_f32_16x16x32_bf16 v[16:19], v[120:123], a[0:3], v[16:19]
    ds_read_b64_tr_b16 v[112:113], v238 offset:8192
    buffer_load_dwordx4 v225, s[4:7], s53 offen offset:1024 lds
    v_mfma_f32_16x16x32_bf16 v[20:23], v[120:123], a[4:7], v[20:23]
    ds_read_b64_tr_b16 v[114:115], v238 offset:12288
    v_mfma_f32_16x16x32_bf16 v[24:27], v[124:127], a[0:3], v[24:27]
    ds_read_b64_tr_b16 v[116:117], v239 offset:8192
    v_mfma_f32_16x16x32_bf16 v[28:31], v[124:127], a[4:7], v[28:31]
    ds_read_b64_tr_b16 v[118:119], v239 offset:12288
    s_waitcnt lgkmcnt(4)
    v_mfma_f32_16x16x32_bf16 v[16:19], v[128:131], a[8:11], v[16:19]
    ds_read_b64_tr_b16 v[120:121], v238 offset:9216
    buffer_load_dwordx4 v226, s[4:7], s53 offen offset:2048 lds
    v_mfma_f32_16x16x32_bf16 v[20:23], v[128:131], a[12:15], v[20:23]
    ds_read_b64_tr_b16 v[122:123], v238 offset:13312
    v_mfma_f32_16x16x32_bf16 v[24:27], v[132:135], a[8:11], v[24:27]
    ds_read_b64_tr_b16 v[124:125], v239 offset:9216
    v_mfma_f32_16x16x32_bf16 v[28:31], v[132:135], a[12:15], v[28:31]
    ds_read_b64_tr_b16 v[126:127], v239 offset:13312
    s_waitcnt lgkmcnt(4)
    v_mfma_f32_16x16x32_bf16 v[16:19], v[112:115], a[16:19], v[16:19]
    ds_read_b64_tr_b16 v[128:129], v238 offset:16384
    buffer_load_dwordx4 v227, s[4:7], s53 offen offset:3072 lds
    v_mfma_f32_16x16x32_bf16 v[20:23], v[112:115], a[20:23], v[20:23]
    ds_read_b64_tr_b16 v[130:131], v238 offset:20480
    v_mfma_f32_16x16x32_bf16 v[24:27], v[116:119], a[16:19], v[24:27]
    ds_read_b64_tr_b16 v[132:133], v239 offset:16384
    v_mfma_f32_16x16x32_bf16 v[28:31], v[116:119], a[20:23], v[28:31]
    ds_read_b64_tr_b16 v[134:135], v239 offset:20480
    s_waitcnt lgkmcnt(4)
    v_mfma_f32_16x16x32_bf16 v[16:19], v[120:123], a[24:27], v[16:19]
    ds_read_b64_tr_b16 v[112:113], v238 offset:17408
    s_add_u32 m0, m0, 4096
    v_mfma_f32_16x16x32_bf16 v[20:23], v[120:123], a[28:31], v[20:23]
    ds_read_b64_tr_b16 v[114:115], v238 offset:21504
    buffer_load_dwordx4 v228, s[4:7], s53 offen offset:0 lds
    v_mfma_f32_16x16x32_bf16 v[24:27], v[124:127], a[24:27], v[24:27]
    ds_read_b64_tr_b16 v[116:117], v239 offset:17408
    s_cmp_ge_u32 s50, s51
    s_cselect_b32 s3, 114688, 0
    v_mfma_f32_16x16x32_bf16 v[28:31], v[124:127], a[28:31], v[28:31]
    ds_read_b64_tr_b16 v[118:119], v239 offset:21504
    s_waitcnt lgkmcnt(4)
    v_mfma_f32_16x16x32_bf16 v[16:19], v[128:131], a[32:35], v[16:19]
    ds_read_b64_tr_b16 v[120:121], v238 offset:24576
    s_sub_u32 s50, s50, s3
    v_mfma_f32_16x16x32_bf16 v[20:23], v[128:131], a[36:39], v[20:23]
    ds_read_b64_tr_b16 v[122:123], v238 offset:28672
    buffer_load_dwordx4 v229, s[4:7], s53 offen offset:1024 lds
    v_mfma_f32_16x16x32_bf16 v[24:27], v[132:135], a[32:35], v[24:27]
    ds_read_b64_tr_b16 v[124:125], v239 offset:24576
    v_mfma_f32_16x16x32_bf16 v[28:31], v[132:135], a[36:39], v[28:31]
    ds_read_b64_tr_b16 v[126:127], v239 offset:28672
    s_waitcnt lgkmcnt(4)
    v_mfma_f32_16x16x32_bf16 v[16:19], v[112:115], a[40:43], v[16:19]
    ds_read_b64_tr_b16 v[128:129], v238 offset:25600
    buffer_load_dwordx4 v230, s[4:7], s53 offen offset:2048 lds
    v_mfma_f32_16x16x32_bf16 v[20:23], v[112:115], a[44:47], v[20:23]
    ds_read_b64_tr_b16 v[130:131], v238 offset:29696
    v_readlane_b32 s3, v235, s48
    v_mfma_f32_16x16x32_bf16 v[24:27], v[116:119], a[40:43], v[24:27]
    ds_read_b64_tr_b16 v[132:133], v239 offset:25600
    s_mul_i32 s53, s3, 229376
    v_mfma_f32_16x16x32_bf16 v[28:31], v[116:119], a[44:47], v[28:31]
    ds_read_b64_tr_b16 v[134:135], v239 offset:29696
    s_waitcnt lgkmcnt(4)
    v_mfma_f32_16x16x32_bf16 v[16:19], v[120:123], a[48:51], v[16:19]
    ds_read_b64_tr_b16 v[112:113], v238 offset:32768
    s_add_u32 s48, s48, 1
    v_mfma_f32_16x16x32_bf16 v[20:23], v[120:123], a[52:55], v[20:23]
    ds_read_b64_tr_b16 v[114:115], v238 offset:36864
    v_mfma_f32_16x16x32_bf16 v[24:27], v[124:127], a[48:51], v[24:27]
    ds_read_b64_tr_b16 v[116:117], v239 offset:32768
    v_mfma_f32_16x16x32_bf16 v[28:31], v[124:127], a[52:55], v[28:31]
    ds_read_b64_tr_b16 v[118:119], v239 offset:36864
    s_waitcnt lgkmcnt(4)
    v_mfma_f32_16x16x32_bf16 v[16:19], v[128:131], a[56:59], v[16:19]
    ds_read_b64_tr_b16 v[120:121], v238 offset:33792
    v_mfma_f32_16x16x32_bf16 v[20:23], v[128:131], a[60:63], v[20:23]
    ds_read_b64_tr_b16 v[122:123], v238 offset:37888
    v_mfma_f32_16x16x32_bf16 v[24:27], v[132:135], a[56:59], v[24:27]
    ds_read_b64_tr_b16 v[124:125], v239 offset:33792
    v_mfma_f32_16x16x32_bf16 v[28:31], v[132:135], a[60:63], v[28:31]
    ds_read_b64_tr_b16 v[126:127], v239 offset:37888
    s_waitcnt lgkmcnt(4)
    v_mfma_f32_16x16x32_bf16 v[16:19], v[112:115], a[64:67], v[16:19]
    ds_read_b64_tr_b16 v[128:129], v238 offset:40960
    v_mfma_f32_16x16x32_bf16 v[20:23], v[112:115], a[68:71], v[20:23]
    ds_read_b64_tr_b16 v[130:131], v238 offset:45056
    v_mfma_f32_16x16x32_bf16 v[24:27], v[116:119], a[64:67], v[24:27]
    ds_read_b64_tr_b16 v[132:133], v239 offset:40960
    v_mfma_f32_16x16x32_bf16 v[28:31], v[116:119], a[68:71], v[28:31]
    ds_read_b64_tr_b16 v[134:135], v239 offset:45056
    s_waitcnt lgkmcnt(4)
    v_mfma_f32_16x16x32_bf16 v[16:19], v[120:123], a[200:203], v[16:19]
    ds_read_b64_tr_b16 v[112:113], v238 offset:41984
    v_mfma_f32_16x16x32_bf16 v[20:23], v[120:123], a[204:207], v[20:23]
    ds_read_b64_tr_b16 v[114:115], v238 offset:46080
    v_mfma_f32_16x16x32_bf16 v[24:27], v[124:127], a[200:203], v[24:27]
    ds_read_b64_tr_b16 v[116:117], v239 offset:41984
    v_mfma_f32_16x16x32_bf16 v[28:31], v[124:127], a[204:207], v[28:31]
    ds_read_b64_tr_b16 v[118:119], v239 offset:46080
    s_waitcnt lgkmcnt(4)
    v_mfma_f32_16x16x32_bf16 v[16:19], v[128:131], a[208:211], v[16:19]
    ds_read_b64_tr_b16 v[120:121], v238 offset:49152
    v_mfma_f32_16x16x32_bf16 v[20:23], v[128:131], a[212:215], v[20:23]
    ds_read_b64_tr_b16 v[122:123], v238 offset:53248
    v_mfma_f32_16x16x32_bf16 v[24:27], v[132:135], a[208:211], v[24:27]
    ds_read_b64_tr_b16 v[124:125], v239 offset:49152
    v_mfma_f32_16x16x32_bf16 v[28:31], v[132:135], a[212:215], v[28:31]
    ds_read_b64_tr_b16 v[126:127], v239 offset:53248
    s_waitcnt lgkmcnt(4)
    v_mfma_f32_16x16x32_bf16 v[16:19], v[112:115], a[216:219], v[16:19]
    ds_read_b64_tr_b16 v[128:129], v238 offset:50176
    v_mfma_f32_16x16x32_bf16 v[20:23], v[112:115], a[220:223], v[20:23]
    ds_read_b64_tr_b16 v[130:131], v238 offset:54272
    v_mfma_f32_16x16x32_bf16 v[24:27], v[116:119], a[216:219], v[24:27]
    ds_read_b64_tr_b16 v[132:133], v239 offset:50176
    v_mfma_f32_16x16x32_bf16 v[28:31], v[116:119], a[220:223], v[28:31]
    ds_read_b64_tr_b16 v[134:135], v239 offset:54272
    s_waitcnt lgkmcnt(4)
    v_mfma_f32_16x16x32_bf16 v[16:19], v[120:123], a[224:227], v[16:19]
    ds_read_b64_tr_b16 v[112:113], v238 offset:57344
    v_mfma_f32_16x16x32_bf16 v[20:23], v[120:123], a[228:231], v[20:23]
    ds_read_b64_tr_b16 v[114:115], v238 offset:61440
    v_mfma_f32_16x16x32_bf16 v[24:27], v[124:127], a[224:227], v[24:27]
    ds_read_b64_tr_b16 v[116:117], v239 offset:57344
    v_mfma_f32_16x16x32_bf16 v[28:31], v[124:127], a[228:231], v[28:31]
    ds_read_b64_tr_b16 v[118:119], v239 offset:61440
    s_waitcnt lgkmcnt(4)
    v_mfma_f32_16x16x32_bf16 v[16:19], v[128:131], a[232:235], v[16:19]
    ds_read_b64_tr_b16 v[120:121], v238 offset:58368
    v_mfma_f32_16x16x32_bf16 v[20:23], v[128:131], a[236:239], v[20:23]
    ds_read_b64_tr_b16 v[122:123], v238 offset:62464
    v_mfma_f32_16x16x32_bf16 v[24:27], v[132:135], a[232:235], v[24:27]
    ds_read_b64_tr_b16 v[124:125], v239 offset:58368
    v_mfma_f32_16x16x32_bf16 v[28:31], v[132:135], a[236:239], v[28:31]
    ds_read_b64_tr_b16 v[126:127], v239 offset:62464
    s_waitcnt lgkmcnt(4)
    v_mfma_f32_16x16x32_bf16 v[16:19], v[112:115], a[240:243], v[16:19]
    v_mfma_f32_16x16x32_bf16 v[20:23], v[112:115], a[244:247], v[20:23]
    v_mfma_f32_16x16x32_bf16 v[24:27], v[116:119], a[240:243], v[24:27]
    v_mfma_f32_16x16x32_bf16 v[28:31], v[116:119], a[244:247], v[28:31]
    s_waitcnt lgkmcnt(0)
    v_mfma_f32_16x16x32_bf16 v[16:19], v[120:123], a[248:251], v[16:19]
    v_mfma_f32_16x16x32_bf16 v[20:23], v[120:123], a[252:255], v[20:23]
    v_mfma_f32_16x16x32_bf16 v[24:27], v[124:127], a[248:251], v[24:27]
    v_mfma_f32_16x16x32_bf16 v[28:31], v[124:127], a[252:255], v[28:31]
    buffer_load_dword v237, v252, s[20:23], s43 offen sc1
    s_nop 3
    v_pk_add_f32 v[160:161], v[16:17], v[56:57] op_sel_hi:[1,0] neg_lo:[0,1] neg_hi:[0,1]
    v_cvt_pk_bf16_f32 v148, v160, v161
    v_pk_add_f32 v[162:163], v[18:19], v[56:57] op_sel_hi:[1,0] neg_lo:[0,1] neg_hi:[0,1]
    v_cvt_pk_bf16_f32 v149, v162, v163
    v_pk_add_f32 v[164:165], v[24:25], v[56:57] op_sel_hi:[1,0] neg_lo:[0,1] neg_hi:[0,1]
    v_cvt_pk_bf16_f32 v150, v164, v165
    v_pk_add_f32 v[166:167], v[26:27], v[56:57] op_sel_hi:[1,0] neg_lo:[0,1] neg_hi:[0,1]
    v_cvt_pk_bf16_f32 v151, v166, v167
    buffer_store_dwordx4 v[148:151], v254, s[16:19], s55 offen offset:0 sc1
    v_pk_add_f32 v[168:169], v[20:21], v[58:59] op_sel_hi:[1,0] neg_lo:[0,1] neg_hi:[0,1]
    v_cvt_pk_bf16_f32 v156, v168, v169
    v_pk_add_f32 v[170:171], v[22:23], v[58:59] op_sel_hi:[1,0] neg_lo:[0,1] neg_hi:[0,1]
    v_cvt_pk_bf16_f32 v157, v170, v171
    v_pk_add_f32 v[172:173], v[28:29], v[58:59] op_sel_hi:[1,0] neg_lo:[0,1] neg_hi:[0,1]
    v_cvt_pk_bf16_f32 v158, v172, v173
    v_pk_add_f32 v[174:175], v[30:31], v[58:59] op_sel_hi:[1,0] neg_lo:[0,1] neg_hi:[0,1]
    v_cvt_pk_bf16_f32 v159, v174, v175
    buffer_store_dwordx4 v[156:159], v254, s[16:19], s55 offen offset:1024 sc1
    v_fmac_f32 v60, v160, v160
    v_fmac_f32 v62, v168, v168
    v_fmac_f32 v61, v161, v161
    v_fmac_f32 v63, v169, v169
    v_fmac_f32 v60, v162, v162
    v_fmac_f32 v62, v170, v170
    v_fmac_f32 v61, v163, v163
    v_fmac_f32 v63, v171, v171
    v_fmac_f32 v60, v164, v164
    v_fmac_f32 v62, v172, v172
    v_fmac_f32 v61, v165, v165
    v_fmac_f32 v63, v173, v173
    v_fmac_f32 v60, v166, v166
    v_fmac_f32 v62, v174, v174
    v_fmac_f32 v61, v167, v167
    v_fmac_f32 v63, v175, v175
    v_add_f32 v60, v60, v61
    v_add_f32 v62, v62, v63
    s_nop 1
    v_permlane16_swap_b32 v60, v62
    v_add_f32 v60, v60, v62
    v_mov_b32 v61, v60
    s_nop 1
    v_permlane32_swap_b32 v60, v61
    v_add_f32 v60, v60, v61
    buffer_store_dword v60, v64, s[24:27], 0 offen sc1
    s_add_u32 s54, s54, 278528
L_ph4:
    s_waitcnt vmcnt(3)
    v_cmp_gt_u32 vcc, 16, v237
    s_cbranch_vccz L_chk23
    s_mov_b64 exec, 1
    s_mov_b32 s3, 0x40000
L_poll24:
    buffer_load_dword v237, v252, s[20:23], s43 offen sc1
    s_sub_u32 s3, s3, 1
    s_cbranch_scc1 L_poll24_y
    s_waitcnt vmcnt(0)
    v_cmp_gt_u32 vcc, 16, v237
    s_cbranch_vccz L_poll24_y
    s_sleep 1
    s_branch L_poll24
L_poll24_y:
    s_waitcnt vmcnt(0)
    s_mov_b64 exec, -1
L_poll24_x:
L_chk23:
    buffer_load_dwordx4 a[56:59], v254, s[12:15], s42 offen offset:0 sc1
    buffer_load_dwordx4 a[60:63], v254, s[12:15], s42 offen offset:1024 sc1
    buffer_load_dwordx4 a[64:67], v254, s[12:15], s42 offen offset:2048 sc1
    buffer_load_dwordx4 a[68:71], v254, s[12:15], s42 offen offset:3072 sc1
    s_add_u32 s42, s42, 0x40000
    s_barrier
    buffer_load_dwordx4 a[72:75], v254, s[12:15], s42 offen offset:0 sc1
    buffer_load_dwordx4 a[76:79], v254, s[12:15], s42 offen offset:1024 sc1
    buffer_load_dwordx4 a[80:83], v254, s[12:15], s42 offen offset:2048 sc1
    buffer_load_dwordx4 a[84:87], v254, s[12:15], s42 offen offset:3072 sc1
    v_readlane_b32 s3, v235, s49
    s_nop 0
    s_mul_i32 s42, s3, 131072
    s_add_u32 s49, s49, 1
    s_mov_b32 m0, s50
    s_add_u32 s50, s50, 28672
    buffer_load_dwordx4 v224, s[4:7], s53 offen offset:0 lds
    buffer_load_dwordx4 v225, s[4:7], s53 offen offset:1024 lds
    buffer_load_dwordx4 v226, s[4:7], s53 offen offset:2048 lds
    buffer_load_dwordx4 v227, s[4:7], s53 offen offset:3072 lds
    s_add_u32 m0, m0, 4096
    s_nop 0
    buffer_load_dwordx4 v228, s[4:7], s53 offen offset:0 lds
    s_cmp_ge_u32 s50, s51
    s_cselect_b32 s3, 114688, 0
    s_sub_u32 s50, s50, s3
    buffer_load_dwordx4 v229, s[4:7], s53 offen offset:1024 lds
    buffer_load_dwordx4 v230, s[4:7], s53 offen offset:2048 lds
    v_readlane_b32 s3, v235, s48
    s_nop 0
    s_mul_i32 s53, s3, 229376
    s_add_u32 s48, s48, 1
    ds_read_b64_tr_b16 a[0:1], v233 offset:0
    ds_read_b64_tr_b16 a[2:3], v233 offset:3584
    ds_read_b64_tr_b16 a[4:5], v233 offset:14336
    ds_read_b64_tr_b16 a[6:7], v233 offset:17920
    ds_read_b64_tr_b16 a[8:9], v233 offset:32
    ds_read_b64_tr_b16 a[10:11], v233 offset:3616
    ds_read_b64_tr_b16 a[12:13], v233 offset:14368
    ds_read_b64_tr_b16 a[14:15], v233 offset:17952
    ds_read_b64_tr_b16 a[16:17], v233 offset:64
    ds_read_b64_tr_b16 a[18:19], v233 offset:3648
    ds_read_b64_tr_b16 a[20:21], v233 offset:14400
    ds_read_b64_tr_b16 a[22:23], v233 offset:17984
    ds_read_b64_tr_b16 a[24:25], v233 offset:96
    ds_read_b64_tr_b16 a[26:27], v233 offset:3680
    ds_read_b64_tr_b16 a[28:29], v233 offset:14432
    ds_read_b64_tr_b16 a[30:31], v233 offset:18016
    ds_read_b64_tr_b16 a[32:33], v233 offset:128
    ds_read_b64_tr_b16 a[34:35], v233 offset:3712
    ds_read_b64_tr_b16 a[36:37], v233 offset:14464
    ds_read_b64_tr_b16 a[38:39], v233 offset:18048
    ds_read_b64_tr_b16 a[40:41], v233 offset:160
    ds_read_b64_tr_b16 a[42:43], v233 offset:3744
    ds_read_b64_tr_b16 a[44:45], v233 offset:14496
    ds_read_b64_tr_b16 a[46:47], v233 offset:18080
    ds_read_b64_tr_b16 a[48:49], v234 offset:0
    ds_read_b64_tr_b16 a[50:51], v234 offset:3584
    ds_read_b64_tr_b16 a[52:53], v234 offset:14336
    v_accvgpr_write_b32 a224, v0
    v_accvgpr_write_b32 a225, v1
    v_accvgpr_write_b32 a226, v2
    v_accvgpr_write_b32 a227, v3
    v_accvgpr_write_b32 a228, v4
    v_accvgpr_write_b32 a229, v5
    v_accvgpr_write_b32 a230, v6
    v_accvgpr_write_b32 a231, v7
    v_accvgpr_write_b32 a232, v8
    v_accvgpr_write_b32 a233, v9
    v_accvgpr_write_b32 a234, v10
    v_accvgpr_write_b32 a235, v11
    v_accvgpr_write_b32 a236, v12
    v_accvgpr_write_b32 a237, v13
    v_accvgpr_write_b32 a238, v14
    v_accvgpr_write_b32 a239, v15
    v_accvgpr_write_b32 a240, v16
    v_accvgpr_write_b32 a241, v17
    v_accvgpr_write_b32 a242, v18
    v_accvgpr_write_b32 a243, v19
    v_accvgpr_write_b32 a244, v20
    v_accvgpr_write_b32 a245, v21
    v_accvgpr_write_b32 a246, v22
    v_accvgpr_write_b32 a247, v23
    v_accvgpr_write_b32 a248, v24
    v_accvgpr_write_b32 a249, v25
    v_accvgpr_write_b32 a250, v26
    v_accvgpr_write_b32 a251, v27
    v_accvgpr_write_b32 a252, v28
    v_accvgpr_write_b32 a253, v29
    v_accvgpr_write_b32 a254, v30
    v_accvgpr_write_b32 a255, v31
    s_add_u32 s43, s43, 278528
    s_waitcnt vmcnt(11)
    s_barrier
    s_cmp_ge_u32 s28, 1
    s_cbranch_scc1 L_sig25
    s_mov_b64 exec, 1
    buffer_atomic_add v253, v252, s[20:23], s54 offen sc1
    s_mov_b64 exec, -1
L_sig25:
    s_waitcnt lgkmcnt(15)
    v_mfma_f32_16x16x32_bf16 v[0:3], a[0:3], a[56:59], 0
    ds_read_b64_tr_b16 a[54:55], v234 offset:17920
    s_lshl_b32 s34, s2, 2
    v_mfma_f32_16x16x32_bf16 v[4:7], a[0:3], a[60:63], 0
    s_add_u32 s34, s34, s28
    s_and_b32 s35, s34, 255
    v_mfma_f32_16x16x32_bf16 v[8:11], a[0:3], a[64:67], 0
    s_mul_i32 s35, s35, 896
    s_lshr_b32 s38, s34, 9
    v_mfma_f32_16x16x32_bf16 v[12:15], a[0:3], a[68:71], 0
    ds_read_b64_tr_b16 a[0:1], v233 offset:7168
    s_mul_i32 s38, s38, 458752
    v_mfma_f32_16x16x32_bf16 v[16:19], a[4:7], a[56:59], 0
    s_add_u32 s35, s35, s38
    s_bitcmp1_b32 s34, 8
    s_cselect_b32 s36, s74, s72
    s_cselect_b32 s37, s75, s73
    v_mfma_f32_16x16x32_bf16 v[20:23], a[4:7], a[60:63], 0
    ds_read_b64_tr_b16 a[2:3], v233 offset:10752
    s_sub_u32 s38, 7340032, s35
    v_mfma_f32_16x16x32_bf16 v[24:27], a[4:7], a[64:67], 0
    s_add_u32 s84, s36, s35
    s_addc_u32 s85, s37, 0
    v_mfma_f32_16x16x32_bf16 v[28:31], a[4:7], a[68:71], 0
    ds_read_b64_tr_b16 a[4:5], v233 offset:21504
    s_mov_b32 s86, s38
    v_mfma_f32_16x16x32_bf16 v[32:35], a[8:11], a[56:59], 0
    s_mov_b32 s87, 0x20000
    s_mov_b32 s35, 0x24924925
    v_mfma_f32_16x16x32_bf16 v[36:39], a[8:11], a[60:63], 0
    ds_read_b64_tr_b16 a[6:7], v233 offset:25088
    v_mul_hi_u32 v241, v255, s35
    v_mfma_f32_16x16x32_bf16 v[40:43], a[8:11], a[64:67], 0
    v_mul_u32_u24 v242, 7, v241
    v_sub_u32 v242, v255, v242
    v_mfma_f32_16x16x32_bf16 v[44:47], a[8:11], a[68:71], 0
    ds_read_b64_tr_b16 a[8:9], v233 offset:7200
    v_mul_u32_u24 v241, 917504, v241
    v_mfma_f32_16x16x32_bf16 v[48:51], a[12:15], a[56:59], 0
    v_lshl_add_u32 v240, v242, 7, v241
    v_lshrrev_b32 v236, 3, v255
    v_mfma_f32_16x16x32_bf16 v[52:55], a[12:15], a[60:63], 0
    ds_read_b64_tr_b16 a[10:11], v233 offset:10784
    s_lshl_b32 s34, s28, 3
    v_mfma_f32_16x16x32_bf16 v[56:59], a[12:15], a[64:67], 0
    v_add_u32 v236, s34, v236
    v_mul_u32_u24 v236, 2048, v236
    v_mfma_f32_16x16x32_bf16 v[60:63], a[12:15], a[68:71], 0
    ds_read_b64_tr_b16 a[12:13], v233 offset:21536
    s_waitcnt lgkmcnt(15)
    v_mfma_f32_16x16x32_bf16 v[64:67], a[16:19], a[56:59], 0
    v_lshrrev_b32 v237, 4, v255
    v_lshlrev_b32 v237, 1, v237
    v_mfma_f32_16x16x32_bf16 v[68:71], a[16:19], a[60:63], 0
    ds_read_b64_tr_b16 a[14:15], v233 offset:25120
    v_and_b32 v246, 7, v255
    v_mfma_f32_16x16x32_bf16 v[72:75], a[16:19], a[64:67], 0
    v_xor_b32 v246, v246, v237
    v_lshl_add_u32 v246, v246, 4, v236
    v_mfma_f32_16x16x32_bf16 v[76:79], a[16:19], a[68:71], 0
    ds_read_b64_tr_b16 a[16:17], v233 offset:7232
    s_xor_b32 s34, s30, 1
    v_mfma_f32_16x16x32_bf16 v[80:83], a[20:23], a[56:59], 0
    s_sub_i32 s34, s34, s30
    s_lshl_b32 s34, s34, 7
    v_mfma_f32_16x16x32_bf16 v[84:87], a[20:23], a[60:63], 0
    ds_read_b64_tr_b16 a[18:19], v233 offset:10816
    s_add_u32 s34, s34, 2048
    v_mfma_f32_16x16x32_bf16 v[88:91], a[20:23], a[64:67], 0
    v_add_u32 v245, s34, v246
    v_add_u32 v247, 3072, v246
    v_mfma_f32_16x16x32_bf16 v[92:95], a[20:23], a[68:71], 0
    ds_read_b64_tr_b16 a[20:21], v233 offset:21568
    v_add_u32 v246, 2048, v246
    v_mfma_f32_16x16x32_bf16 v[96:99], a[24:27], a[56:59], 0
    buffer_load_dwordx4 a[88:91], v254, s[12:15], s42 offen offset:0 sc1
    s_lshl_b32 s35, s30, 7
    v_mfma_f32_16x16x32_bf16 v[100:103], a[24:27], a[60:63], 0
    ds_read_b64_tr_b16 a[22:23], v233 offset:25152
    s_sub_u32 s36, 7343104, s35
    v_mfma_f32_16x16x32_bf16 v[104:107], a[24:27], a[64:67], 0
    s_sub_u32 s38, s76, 3072
    s_subb_u32 s39, s77, 0
    v_mfma_f32_16x16x32_bf16 v[108:111], a[24:27], a[68:71], 0
    ds_read_b64_tr_b16 a[24:25], v233 offset:7264
    s_add_u32 s8, s38, s35
    s_addc_u32 s9, s39, 0
    v_mfma_f32_16x16x32_bf16 v[112:115], a[28:31], a[56:59], 0
    s_mov_b32 s10, s36
    s_mov_b32 s11, 0x20000
    v_mfma_f32_16x16x32_bf16 v[116:119], a[28:31], a[60:63], 0
    ds_read_b64_tr_b16 a[26:27], v233 offset:10848
    s_lshl_b32 s40, s28, 11
    v_mfma_f32_16x16x32_bf16 v[120:123], a[28:31], a[64:67], 0
    s_lshl_b32 s34, s29, 2
    s_add_u32 s34, s34, s28
    v_mfma_f32_16x16x32_bf16 v[124:127], a[28:31], a[68:71], 0
    ds_read_b64_tr_b16 a[28:29], v233 offset:21600
    s_waitcnt lgkmcnt(15)
    v_mfma_f32_16x16x32_bf16 v[128:131], a[32:35], a[56:59], 0
    buffer_load_dwordx4 a[92:95], v254, s[12:15], s42 offen offset:1024 sc1
    s_lshl_b32 s41, s34, 11
    v_mfma_f32_16x16x32_bf16 v[132:135], a[32:35], a[60:63], 0
    ds_read_b64_tr_b16 a[30:31], v233 offset:25184
    s_and_b32 s34, s41, 0xffff
    v_mfma_f32_16x16x32_bf16 v[136:139], a[32:35], a[64:67], 0
    s_lshr_b32 s35, s29, 3
    s_mul_i32 s35, s35, 7340032
    v_mfma_f32_16x16x32_bf16 v[140:143], a[32:35], a[68:71], 0
    ds_read_b64_tr_b16 a[32:33], v233 offset:7296
    s_add_u32 s34, s34, s35
    v_mfma_f32_16x16x32_bf16 v[144:147], a[36:39], a[56:59], 0
    s_add_u32 s34, s34, 0x1a00000
    s_add_u32 s24, s82, s34
    s_addc_u32 s25, s83, 0
    v_mfma_f32_16x16x32_bf16 v[148:151], a[36:39], a[60:63], 0
    ds_read_b64_tr_b16 a[34:35], v233 offset:10880
    s_mov_b32 s26, 0x700000
    v_mfma_f32_16x16x32_bf16 v[152:155], a[36:39], a[64:67], 0
    s_mov_b32 s27, 0x20000
    v_mov_b32 v236, 0
    v_mfma_f32_16x16x32_bf16 v[156:159], a[36:39], a[68:71], 0
    ds_read_b64_tr_b16 a[36:37], v233 offset:21632
    v_mov_b32 v237, 8
    v_mfma_f32_16x16x32_bf16 v[160:163], a[40:43], a[56:59], 0
    buffer_load_dwordx4 a[96:99], v254, s[12:15], s42 offen offset:2048 sc1
    v_mov_b32 v244, 0
    v_mfma_f32_16x16x32_bf16 v[164:167], a[40:43], a[60:63], 0
    ds_read_b64_tr_b16 a[38:39], v233 offset:25216
    v_cmp_gt_u32 vcc, 14, v255
    v_mfma_f32_16x16x32_bf16 v[168:171], a[40:43], a[64:67], 0
    v_add_u32 v238, 1, v244
    v_cndmask_b32 v236, 14, v236, vcc
    v_mfma_f32_16x16x32_bf16 v[172:175], a[40:43], a[68:71], 0
    ds_read_b64_tr_b16 a[40:41], v233 offset:7328
    v_cndmask_b32 v244, v238, v244, vcc
    v_mfma_f32_16x16x32_bf16 v[176:179], a[44:47], a[56:59], 0
    v_cmp_gt_u32 vcc, 28, v255
    v_add_u32 v238, 1, v244
    v_mfma_f32_16x16x32_bf16 v[180:183], a[44:47], a[60:63], 0
    ds_read_b64_tr_b16 a[42:43], v233 offset:10912
    v_cndmask_b32 v236, 28, v236, vcc
    v_mfma_f32_16x16x32_bf16 v[184:187], a[44:47], a[64:67], 0
    v_cndmask_b32 v244, v238, v244, vcc
    v_cmp_gt_u32 vcc, 42, v255
    v_mfma_f32_16x16x32_bf16 v[188:191], a[44:47], a[68:71], 0
    ds_read_b64_tr_b16 a[44:45], v233 offset:21664
    v_mfma_f32_16x16x32_bf16 v[192:195], a[48:51], a[56:59], 0
    s_add_u32 s46, s46, 28672
    s_cmp_ge_u32 s46, 155648
    s_cselect_b32 s46, 40960, s46
    v_mfma_f32_16x16x32_bf16 v[196:199], a[48:51], a[60:63], 0
    ds_read_b64_tr_b16 a[46:47], v233 offset:25248
    buffer_load_dwordx4 a[100:103], v254, s[12:15], s42 offen offset:3072 sc1
    v_mfma_f32_16x16x32_bf16 v[200:203], a[48:51], a[64:67], 0
    s_add_u32 s42, s42, 0x40000
    v_add_u32 v238, 1, v244
    v_mfma_f32_16x16x32_bf16 v[204:207], a[48:51], a[68:71], 0
    ds_read_b64_tr_b16 a[48:49], v234 offset:7168
    v_cndmask_b32 v236, 42, v236, vcc
    v_mfma_f32_16x16x32_bf16 v[208:211], a[52:55], a[56:59], 0
    v_cndmask_b32 v244, v238, v244, vcc
    v_cndmask_b32 v237, 1, v237, vcc
    v_mfma_f32_16x16x32_bf16 v[212:215], a[52:55], a[60:63], 0
    ds_read_b64_tr_b16 a[50:51], v234 offset:10752
    v_sub_u32 v236, v255, v236
    v_mfma_f32_16x16x32_bf16 v[216:219], a[52:55], a[64:67], 0
    s_lshr_b32 s34, s30, 1
    s_add_u32 s34, s34, s29
    v_mfma_f32_16x16x32_bf16 v[220:223], a[52:55], a[68:71], 0
    ds_read_b64_tr_b16 a[52:53], v234 offset:21504
    s_waitcnt vmcnt(11) lgkmcnt(15)
    v_mfma_f32_16x16x32_bf16 v[0:3], a[0:3], a[72:75], v[0:3]
    ds_read_b64_tr_b16 a[54:55], v234 offset:25088
    s_and_b32 s34, s34, 3
    s_lshl_b32 s34, s34, 1
    v_subrev_u32 v238, s34, v236
    v_and_b32 v238, 7, v238
    v_sub_u32 v239, v236, v238
    v_lshlrev_b32 v238, 2, v238
    s_mov_b32 s35, 0xeeee44
    v_bfe_i32 v238, s35, v238, 4
    v_cmp_le_u32 s[36:37], v239, v237
    s_nop 0
    s_nop 0
    v_cndmask_b32_e64 v238, 0, v238, s[36:37]
    v_add_u32 v236, v236, v238
    v_lshrrev_b32 v237, 1, v236
    v_and_b32 v238, 1, v236
    v_lshl_add_u32 v238, v238, 2, v244
    s_bfe_u32 s37, s30, 0x10000
    s_mul_i32 s37, s37, 7
    s_lshl2_add_u32 s37, s58, s37
    v_cndmask_b32 v237, v236, v237, vcc
    v_cndmask_b32 v238, 3, v238, vcc
    v_add_u32 v237, s37, v237
    v_and_b32 v237, 15, v237
    v_mad_u32_u24 v237, v237, 7, v238
    v_lshlrev_b32 v244, 16, v237
    s_nop 0
    v_readlane_b32 s64, v244, 0
    v_readlane_b32 s65, v244, 1
    v_readlane_b32 s66, v244, 2
    v_readlane_b32 s67, v244, 3
    v_readlane_b32 s68, v244, 4
    v_readlane_b32 s69, v244, 5
    v_readlane_b32 s71, v244, 6
    v_readlane_b32 s72, v244, 7
    s_lshl_b32 s34, s2, 2
    s_add_u32 s34, s34, s28
    s_mul_i32 s34, s34, 7168
    s_add_u32 s34, s34, 3072
    s_lshl_b32 s35, s30, 7
    s_sub_u32 s45, s34, s35
    v_lshlrev_b32 v238, 7, v255
    v_cmp_gt_u32 vcc, 12, v255
    v_mov_b32 v239, 0x1000000
    s_nop 0
    v_cndmask_b32 v238, v239, v238, vcc
    s_lshr_b32 s34, s57, 13
    s_lshl_b32 s34, s34, 13
    s_and_b32 s35, s28, 1
    s_lshl_b32 s35, s35, 8
    s_add_u32 s34, s34, s35
    s_add_u32 s34, s34, 0x1800000
    s_add_u32 s92, s82, s34
    s_addc_u32 s93, s83, 0
    s_mov_b32 s94, 0x2000
    s_mov_b32 s95, 0x20000
    v_lshlrev_b32 v236, 2, v255
    s_mov_b32 s44, 4096
    v_add_u32 v233, s46, v231
    v_mfma_f32_16x16x32_bf16 v[4:7], a[0:3], a[76:79], v[4:7]
    v_add_u32 v234, s46, v232
    v_mfma_f32_16x16x32_bf16 v[8:11], a[0:3], a[80:83], v[8:11]
    s_waitcnt vmcnt(4)
    s_barrier
    v_mfma_f32_16x16x32_bf16 v[12:15], a[0:3], a[84:87], v[12:15]
    ds_read_b64_tr_b16 a[0:1], v233 offset:0
    v_mfma_f32_16x16x32_bf16 v[16:19], a[4:7], a[72:75], v[16:19]
    buffer_load_dwordx4 a[104:107], v254, s[12:15], s42 offen offset:0 sc1
    v_mfma_f32_16x16x32_bf16 v[20:23], a[4:7], a[76:79], v[20:23]
    ds_read_b64_tr_b16 a[2:3], v233 offset:3584
    v_mfma_f32_16x16x32_bf16 v[24:27], a[4:7], a[80:83], v[24:27]
    v_mfma_f32_16x16x32_bf16 v[28:31], a[4:7], a[84:87], v[28:31]
    ds_read_b64_tr_b16 a[4:5], v233 offset:14336
    v_mfma_f32_16x16x32_bf16 v[32:35], a[8:11], a[72:75], v[32:35]
    s_mov_b32 m0, s50
    s_add_u32 s50, s50, 28672
    v_mfma_f32_16x16x32_bf16 v[36:39], a[8:11], a[76:79], v[36:39]
    ds_read_b64_tr_b16 a[6:7], v233 offset:17920
    buffer_load_dwordx4 v224, s[4:7], s53 offen offset:0 lds
    v_mfma_f32_16x16x32_bf16 v[40:43], a[8:11], a[80:83], v[40:43]
    v_mfma_f32_16x16x32_bf16 v[44:47], a[8:11], a[84:87], v[44:47]
    ds_read_b64_tr_b16 a[8:9], v233 offset:32
    v_mfma_f32_16x16x32_bf16 v[48:51], a[12:15], a[72:75], v[48:51]
    buffer_load_dwordx4 a[108:111], v254, s[12:15], s42 offen offset:1024 sc1
    v_mfma_f32_16x16x32_bf16 v[52:55], a[12:15], a[76:79], v[52:55]
    ds_read_b64_tr_b16 a[10:11], v233 offset:3616
    v_mfma_f32_16x16x32_bf16 v[56:59], a[12:15], a[80:83], v[56:59]
    v_mfma_f32_16x16x32_bf16 v[60:63], a[12:15], a[84:87], v[60:63]
    ds_read_b64_tr_b16 a[12:13], v233 offset:14368
    s_waitcnt lgkmcnt(15)
    v_mfma_f32_16x16x32_bf16 v[64:67], a[16:19], a[72:75], v[64:67]
    buffer_load_dwordx4 v225, s[4:7], s53 offen offset:1024 lds
    v_mfma_f32_16x16x32_bf16 v[68:71], a[16:19], a[76:79], v[68:71]
    ds_read_b64_tr_b16 a[14:15], v233 offset:17952
    v_mfma_f32_16x16x32_bf16 v[72:75], a[16:19], a[80:83], v[72:75]
    v_mfma_f32_16x16x32_bf16 v[76:79], a[16:19], a[84:87], v[76:79]
    ds_read_b64_tr_b16 a[16:17], v233 offset:64
    v_mfma_f32_16x16x32_bf16 v[80:83], a[20:23], a[72:75], v[80:83]
    buffer_load_dwordx4 a[112:115], v254, s[12:15], s42 offen offset:2048 sc1
    v_mfma_f32_16x16x32_bf16 v[84:87], a[20:23], a[76:79], v[84:87]
    ds_read_b64_tr_b16 a[18:19], v233 offset:3648
    v_mfma_f32_16x16x32_bf16 v[88:91], a[20:23], a[80:83], v[88:91]
    v_mfma_f32_16x16x32_bf16 v[92:95], a[20:23], a[84:87], v[92:95]
    ds_read_b64_tr_b16 a[20:21], v233 offset:14400
    v_mfma_f32_16x16x32_bf16 v[96:99], a[24:27], a[72:75], v[96:99]
    buffer_load_dwordx4 v226, s[4:7], s53 offen offset:2048 lds
    v_mfma_f32_16x16x32_bf16 v[100:103], a[24:27], a[76:79], v[100:103]
    ds_read_b64_tr_b16 a[22:23], v233 offset:17984
    v_mfma_f32_16x16x32_bf16 v[104:107], a[24:27], a[80:83], v[104:107]
    v_mfma_f32_16x16x32_bf16 v[108:111], a[24:27], a[84:87], v[108:111]
    ds_read_b64_tr_b16 a[24:25], v233 offset:96
    v_mfma_f32_16x16x32_bf16 v[112:115], a[28:31], a[72:75], v[112:115]
    buffer_load_dwordx4 a[116:119], v254, s[12:15], s42 offen offset:3072 sc1
    v_readlane_b32 s3, v235, s49
    v_mfma_f32_16x16x32_bf16 v[116:119], a[28:31], a[76:79], v[116:119]
    ds_read_b64_tr_b16 a[26:27], v233 offset:3680
    s_mul_i32 s42, s3, 131072
    v_mfma_f32_16x16x32_bf16 v[120:123], a[28:31], a[80:83], v[120:123]
    s_add_u32 s49, s49, 1
    v_mfma_f32_16x16x32_bf16 v[124:127], a[28:31], a[84:87], v[124:127]
    ds_read_b64_tr_b16 a[28:29], v233 offset:14432
    s_waitcnt lgkmcnt(15)
    v_mfma_f32_16x16x32_bf16 v[128:131], a[32:35], a[72:75], v[128:131]
    buffer_load_dwordx4 v227, s[4:7], s53 offen offset:3072 lds
    v_mfma_f32_16x16x32_bf16 v[132:135], a[32:35], a[76:79], v[132:135]
    ds_read_b64_tr_b16 a[30:31], v233 offset:18016
    v_mfma_f32_16x16x32_bf16 v[136:139], a[32:35], a[80:83], v[136:139]
    v_mfma_f32_16x16x32_bf16 v[140:143], a[32:35], a[84:87], v[140:143]
    ds_read_b64_tr_b16 a[32:33], v233 offset:128
    v_mfma_f32_16x16x32_bf16 v[144:147], a[36:39], a[72:75], v[144:147]
    v_mfma_f32_16x16x32_bf16 v[148:151], a[36:39], a[76:79], v[148:151]
    ds_read_b64_tr_b16 a[34:35], v233 offset:3712
    v_mfma_f32_16x16x32_bf16 v[152:155], a[36:39], a[80:83], v[152:155]
    v_mfma_f32_16x16x32_bf16 v[156:159], a[36:39], a[84:87], v[156:159]
    ds_read_b64_tr_b16 a[36:37], v233 offset:14464
    v_mfma_f32_16x16x32_bf16 v[160:163], a[40:43], a[72:75], v[160:163]
    s_add_u32 m0, m0, 4096
    v_mfma_f32_16x16x32_bf16 v[164:167], a[40:43], a[76:79], v[164:167]
    ds_read_b64_tr_b16 a[38:39], v233 offset:18048
    buffer_load_dwordx4 v228, s[4:7], s53 offen offset:0 lds
    v_mfma_f32_16x16x32_bf16 v[168:171], a[40:43], a[80:83], v[168:171]
    s_cmp_ge_u32 s50, s51
    s_cselect_b32 s3, 114688, 0
    v_mfma_f32_16x16x32_bf16 v[172:175], a[40:43], a[84:87], v[172:175]
    ds_read_b64_tr_b16 a[40:41], v233 offset:160
    s_sub_u32 s50, s50, s3
    v_mfma_f32_16x16x32_bf16 v[176:179], a[44:47], a[72:75], v[176:179]
    v_mfma_f32_16x16x32_bf16 v[180:183], a[44:47], a[76:79], v[180:183]
    ds_read_b64_tr_b16 a[42:43], v233 offset:3744
    v_mfma_f32_16x16x32_bf16 v[184:187], a[44:47], a[80:83], v[184:187]
    buffer_load_dwordx4 v229, s[4:7], s53 offen offset:1024 lds
    v_mfma_f32_16x16x32_bf16 v[188:191], a[44:47], a[84:87], v[188:191]
    ds_read_b64_tr_b16 a[44:45], v233 offset:14496
    v_mfma_f32_16x16x32_bf16 v[192:195], a[48:51], a[72:75], v[192:195]
    v_mfma_f32_16x16x32_bf16 v[196:199], a[48:51], a[76:79], v[196:199]
    ds_read_b64_tr_b16 a[46:47], v233 offset:18080
    v_mfma_f32_16x16x32_bf16 v[200:203], a[48:51], a[80:83], v[200:203]
    v_mfma_f32_16x16x32_bf16 v[204:207], a[48:51], a[84:87], v[204:207]
    ds_read_b64_tr_b16 a[48:49], v234 offset:0
    v_mfma_f32_16x16x32_bf16 v[208:211], a[52:55], a[72:75], v[208:211]
    buffer_load_dwordx4 v230, s[4:7], s53 offen offset:2048 lds
    v_readlane_b32 s3, v235, s48
    v_mfma_f32_16x16x32_bf16 v[212:215], a[52:55], a[76:79], v[212:215]
    ds_read_b64_tr_b16 a[50:51], v234 offset:3584
    s_mul_i32 s53, s3, 229376
    v_mfma_f32_16x16x32_bf16 v[216:219], a[52:55], a[80:83], v[216:219]
    s_add_u32 s48, s48, 1
    v_mfma_f32_16x16x32_bf16 v[220:223], a[52:55], a[84:87], v[220:223]
    ds_read_b64_tr_b16 a[52:53], v234 offset:14336
    s_waitcnt vmcnt(11) lgkmcnt(15)
    v_mfma_f32_16x16x32_bf16 v[0:3], a[0:3], a[88:91], v[0:3]
    ds_read_b64_tr_b16 a[54:55], v234 offset:17920
    v_mfma_f32_16x16x32_bf16 v[4:7], a[0:3], a[92:95], v[4:7]
    v_mfma_f32_16x16x32_bf16 v[8:11], a[0:3], a[96:99], v[8:11]
    v_mfma_f32_16x16x32_bf16 v[12:15], a[0:3], a[100:103], v[12:15]
    ds_read_b64_tr_b16 a[0:1], v233 offset:7168
    v_mfma_f32_16x16x32_bf16 v[16:19], a[4:7], a[88:91], v[16:19]
    buffer_load_dwordx4 a[56:59], v254, s[12:15], s42 offen offset:0 sc1
    v_mfma_f32_16x16x32_bf16 v[20:23], a[4:7], a[92:95], v[20:23]
    ds_read_b64_tr_b16 a[2:3], v233 offset:10752
    v_mfma_f32_16x16x32_bf16 v[24:27], a[4:7], a[96:99], v[24:27]
    s_mov_b32 m0, s50
    s_add_u32 s50, s50, 28672
    v_mfma_f32_16x16x32_bf16 v[28:31], a[4:7], a[100:103], v[28:31]
    ds_read_b64_tr_b16 a[4:5], v233 offset:21504
    buffer_load_dwordx4 v224, s[4:7], s53 offen offset:0 lds
    v_mfma_f32_16x16x32_bf16 v[32:35], a[8:11], a[88:91], v[32:35]
    v_mfma_f32_16x16x32_bf16 v[36:39], a[8:11], a[92:95], v[36:39]
    ds_read_b64_tr_b16 a[6:7], v233 offset:25088
    v_mfma_f32_16x16x32_bf16 v[40:43], a[8:11], a[96:99], v[40:43]
    v_mfma_f32_16x16x32_bf16 v[44:47], a[8:11], a[100:103], v[44:47]
    ds_read_b64_tr_b16 a[8:9], v233 offset:7200
    v_mfma_f32_16x16x32_bf16 v[48:51], a[12:15], a[88:91], v[48:51]
    buffer_load_dwordx4 a[60:63], v254, s[12:15], s42 offen offset:1024 sc1
    v_mfma_f32_16x16x32_bf16 v[52:55], a[12:15], a[92:95], v[52:55]
    ds_read_b64_tr_b16 a[10:11], v233 offset:10784
    v_mfma_f32_16x16x32_bf16 v[56:59], a[12:15], a[96:99], v[56:59]
    buffer_load_dwordx4 v225, s[4:7], s53 offen offset:1024 lds
    v_mfma_f32_16x16x32_bf16 v[60:63], a[12:15], a[100:103], v[60:63]
    ds_read_b64_tr_b16 a[12:13], v233 offset:21536
    s_waitcnt lgkmcnt(15)
    v_mfma_f32_16x16x32_bf16 v[64:67], a[16:19], a[88:91], v[64:67]
    v_mfma_f32_16x16x32_bf16 v[68:71], a[16:19], a[92:95], v[68:71]
    ds_read_b64_tr_b16 a[14:15], v233 offset:25120
    v_mfma_f32_16x16x32_bf16 v[72:75], a[16:19], a[96:99], v[72:75]
    v_mfma_f32_16x16x32_bf16 v[76:79], a[16:19], a[100:103], v[76:79]
    ds_read_b64_tr_b16 a[16:17], v233 offset:7232
    v_mfma_f32_16x16x32_bf16 v[80:83], a[20:23], a[88:91], v[80:83]
    buffer_load_dwordx4 a[64:67], v254, s[12:15], s42 offen offset:2048 sc1
    v_mfma_f32_16x16x32_bf16 v[84:87], a[20:23], a[92:95], v[84:87]
    ds_read_b64_tr_b16 a[18:19], v233 offset:10816
    v_mfma_f32_16x16x32_bf16 v[88:91], a[20:23], a[96:99], v[88:91]
    buffer_load_dwordx4 v226, s[4:7], s53 offen offset:2048 lds
    v_mfma_f32_16x16x32_bf16 v[92:95], a[20:23], a[100:103], v[92:95]
    ds_read_b64_tr_b16 a[20:21], v233 offset:21568
    v_mfma_f32_16x16x32_bf16 v[96:99], a[24:27], a[88:91], v[96:99]
    v_mfma_f32_16x16x32_bf16 v[100:103], a[24:27], a[92:95], v[100:103]
    ds_read_b64_tr_b16 a[22:23], v233 offset:25152
    v_mfma_f32_16x16x32_bf16 v[104:107], a[24:27], a[96:99], v[104:107]
    v_mfma_f32_16x16x32_bf16 v[108:111], a[24:27], a[100:103], v[108:111]
    ds_read_b64_tr_b16 a[24:25], v233 offset:7264
    v_mfma_f32_16x16x32_bf16 v[112:115], a[28:31], a[88:91], v[112:115]
    buffer_load_dwordx4 a[68:71], v254, s[12:15], s42 offen offset:3072 sc1
    s_add_u32 s42, s42, 0x40000
    v_mfma_f32_16x16x32_bf16 v[116:119], a[28:31], a[92:95], v[116:119]
    ds_read_b64_tr_b16 a[26:27], v233 offset:10848
    v_mfma_f32_16x16x32_bf16 v[120:123], a[28:31], a[96:99], v[120:123]
    s_mov_b32 s88, 3670016
    s_bfm_b64 exec, 14, 0
    buffer_load_dword v239, v240, s[84:87], s88 offen
    s_mov_b64 exec, -1
    v_mfma_f32_16x16x32_bf16 v[124:127], a[28:31], a[100:103], v[124:127]
    ds_read_b64_tr_b16 a[28:29], v233 offset:21600
    s_waitcnt lgkmcnt(15)
    v_mfma_f32_16x16x32_bf16 v[128:131], a[32:35], a[88:91], v[128:131]
    s_add_u32 s88, s88, 1835008
    s_cmp_lg_u32 s88, 7340032
    s_cselect_b32 s88, s88, 229376
    v_mfma_f32_16x16x32_bf16 v[132:135], a[32:35], a[92:95], v[132:135]
    ds_read_b64_tr_b16 a[30:31], v233 offset:25184
    v_mfma_f32_16x16x32_bf16 v[136:139], a[32:35], a[96:99], v[136:139]
    v_mfma_f32_16x16x32_bf16 v[140:143], a[32:35], a[100:103], v[140:143]
    ds_read_b64_tr_b16 a[32:33], v233 offset:7296
    v_mfma_f32_16x16x32_bf16 v[144:147], a[36:39], a[88:91], v[144:147]
    v_mfma_f32_16x16x32_bf16 v[148:151], a[36:39], a[92:95], v[148:151]
    ds_read_b64_tr_b16 a[34:35], v233 offset:10880
    v_mfma_f32_16x16x32_bf16 v[152:155], a[36:39], a[96:99], v[152:155]
    v_mfma_f32_16x16x32_bf16 v[156:159], a[36:39], a[100:103], v[156:159]
    ds_read_b64_tr_b16 a[36:37], v233 offset:21632
    v_mfma_f32_16x16x32_bf16 v[160:163], a[40:43], a[88:91], v[160:163]
    v_mfma_f32_16x16x32_bf16 v[164:167], a[40:43], a[92:95], v[164:167]
    ds_read_b64_tr_b16 a[38:39], v233 offset:25216
    v_mfma_f32_16x16x32_bf16 v[168:171], a[40:43], a[96:99], v[168:171]
    v_mfma_f32_16x16x32_bf16 v[172:175], a[40:43], a[100:103], v[172:175]
    ds_read_b64_tr_b16 a[40:41], v233 offset:7328
    v_mfma_f32_16x16x32_bf16 v[176:179], a[44:47], a[88:91], v[176:179]
    v_mfma_f32_16x16x32_bf16 v[180:183], a[44:47], a[92:95], v[180:183]
    ds_read_b64_tr_b16 a[42:43], v233 offset:10912
    v_mfma_f32_16x16x32_bf16 v[184:187], a[44:47], a[96:99], v[184:187]
    v_mfma_f32_16x16x32_bf16 v[188:191], a[44:47], a[100:103], v[188:191]
    ds_read_b64_tr_b16 a[44:45], v233 offset:21664
    v_mfma_f32_16x16x32_bf16 v[192:195], a[48:51], a[88:91], v[192:195]
    s_add_u32 s46, s46, 28672
    s_cmp_ge_u32 s46, 155648
    s_cselect_b32 s46, 40960, s46
    v_mfma_f32_16x16x32_bf16 v[196:199], a[48:51], a[92:95], v[196:199]
    ds_read_b64_tr_b16 a[46:47], v233 offset:25248
    v_mfma_f32_16x16x32_bf16 v[200:203], a[48:51], a[96:99], v[200:203]
    v_mfma_f32_16x16x32_bf16 v[204:207], a[48:51], a[100:103], v[204:207]
    ds_read_b64_tr_b16 a[48:49], v234 offset:7168
    v_mfma_f32_16x16x32_bf16 v[208:211], a[52:55], a[88:91], v[208:211]
    v_mfma_f32_16x16x32_bf16 v[212:215], a[52:55], a[92:95], v[212:215]
    ds_read_b64_tr_b16 a[50:51], v234 offset:10752
    v_mfma_f32_16x16x32_bf16 v[216:219], a[52:55], a[96:99], v[216:219]
    v_mfma_f32_16x16x32_bf16 v[220:223], a[52:55], a[100:103], v[220:223]
    ds_read_b64_tr_b16 a[52:53], v234 offset:21504
    s_waitcnt vmcnt(12) lgkmcnt(15)
    v_mfma_f32_16x16x32_bf16 v[0:3], a[0:3], a[104:107], v[0:3]
    ds_read_b64_tr_b16 a[54:55], v234 offset:25088
    v_add_u32 v233, s46, v231
    v_mfma_f32_16x16x32_bf16 v[4:7], a[0:3], a[108:111], v[4:7]
    v_add_u32 v234, s46, v232
    v_mfma_f32_16x16x32_bf16 v[8:11], a[0:3], a[112:115], v[8:11]
    s_waitcnt vmcnt(8)
    s_barrier
    v_mfma_f32_16x16x32_bf16 v[12:15], a[0:3], a[116:119], v[12:15]
    ds_read_b64_tr_b16 a[0:1], v233 offset:0
    v_mfma_f32_16x16x32_bf16 v[16:19], a[4:7], a[104:107], v[16:19]
    buffer_load_dwordx4 a[72:75], v254, s[12:15], s42 offen offset:0 sc1
    v_mfma_f32_16x16x32_bf16 v[20:23], a[4:7], a[108:111], v[20:23]
    ds_read_b64_tr_b16 a[2:3], v233 offset:3584
    v_mfma_f32_16x16x32_bf16 v[24:27], a[4:7], a[112:115], v[24:27]
    v_mfma_f32_16x16x32_bf16 v[28:31], a[4:7], a[116:119], v[28:31]
    ds_read_b64_tr_b16 a[4:5], v233 offset:14336
    v_mfma_f32_16x16x32_bf16 v[32:35], a[8:11], a[104:107], v[32:35]
    v_mfma_f32_16x16x32_bf16 v[36:39], a[8:11], a[108:111], v[36:39]
    ds_read_b64_tr_b16 a[6:7], v233 offset:17920
    v_mfma_f32_16x16x32_bf16 v[40:43], a[8:11], a[112:115], v[40:43]
    v_mfma_f32_16x16x32_bf16 v[44:47], a[8:11], a[116:119], v[44:47]
    ds_read_b64_tr_b16 a[8:9], v233 offset:32
    v_mfma_f32_16x16x32_bf16 v[48:51], a[12:15], a[104:107], v[48:51]
    buffer_load_dwordx4 a[76:79], v254, s[12:15], s42 offen offset:1024 sc1
    v_mfma_f32_16x16x32_bf16 v[52:55], a[12:15], a[108:111], v[52:55]
    ds_read_b64_tr_b16 a[10:11], v233 offset:3616
    v_mfma_f32_16x16x32_bf16 v[56:59], a[12:15], a[112:115], v[56:59]
    v_mfma_f32_16x16x32_bf16 v[60:63], a[12:15], a[116:119], v[60:63]
    ds_read_b64_tr_b16 a[12:13], v233 offset:14368
    s_waitcnt lgkmcnt(15)
    v_mfma_f32_16x16x32_bf16 v[64:67], a[16:19], a[104:107], v[64:67]
    v_mfma_f32_16x16x32_bf16 v[68:71], a[16:19], a[108:111], v[68:71]
    ds_read_b64_tr_b16 a[14:15], v233 offset:17952
    v_mfma_f32_16x16x32_bf16 v[72:75], a[16:19], a[112:115], v[72:75]
    v_mfma_f32_16x16x32_bf16 v[76:79], a[16:19], a[116:119], v[76:79]
    ds_read_b64_tr_b16 a[16:17], v233 offset:64
    v_mfma_f32_16x16x32_bf16 v[80:83], a[20:23], a[104:107], v[80:83]
    buffer_load_dwordx4 a[80:83], v254, s[12:15], s42 offen offset:2048 sc1
    v_mfma_f32_16x16x32_bf16 v[84:87], a[20:23], a[108:111], v[84:87]
    ds_read_b64_tr_b16 a[18:19], v233 offset:3648
    v_mfma_f32_16x16x32_bf16 v[88:91], a[20:23], a[112:115], v[88:91]
    v_mfma_f32_16x16x32_bf16 v[92:95], a[20:23], a[116:119], v[92:95]
    ds_read_b64_tr_b16 a[20:21], v233 offset:14400
    v_mfma_f32_16x16x32_bf16 v[96:99], a[24:27], a[104:107], v[96:99]
    v_mfma_f32_16x16x32_bf16 v[100:103], a[24:27], a[108:111], v[100:103]
    ds_read_b64_tr_b16 a[22:23], v233 offset:17984
    v_mfma_f32_16x16x32_bf16 v[104:107], a[24:27], a[112:115], v[104:107]
    v_mfma_f32_16x16x32_bf16 v[108:111], a[24:27], a[116:119], v[108:111]
    ds_read_b64_tr_b16 a[24:25], v233 offset:96
    v_mfma_f32_16x16x32_bf16 v[112:115], a[28:31], a[104:107], v[112:115]
    buffer_load_dwordx4 a[84:87], v254, s[12:15], s42 offen offset:3072 sc1
    v_readlane_b32 s3, v235, s49
    v_mfma_f32_16x16x32_bf16 v[116:119], a[28:31], a[108:111], v[116:119]
    ds_read_b64_tr_b16 a[26:27], v233 offset:3680
    s_mul_i32 s42, s3, 131072
    v_mfma_f32_16x16x32_bf16 v[120:123], a[28:31], a[112:115], v[120:123]
    s_add_u32 s49, s49, 1
    v_mfma_f32_16x16x32_bf16 v[124:127], a[28:31], a[116:119], v[124:127]
    ds_read_b64_tr_b16 a[28:29], v233 offset:14432
    s_waitcnt lgkmcnt(15)
    v_mfma_f32_16x16x32_bf16 v[128:131], a[32:35], a[104:107], v[128:131]
    v_mfma_f32_16x16x32_bf16 v[132:135], a[32:35], a[108:111], v[132:135]
    ds_read_b64_tr_b16 a[30:31], v233 offset:18016
    v_mfma_f32_16x16x32_bf16 v[136:139], a[32:35], a[112:115], v[136:139]
    v_mfma_f32_16x16x32_bf16 v[140:143], a[32:35], a[116:119], v[140:143]
    ds_read_b64_tr_b16 a[32:33], v233 offset:128
    v_mfma_f32_16x16x32_bf16 v[144:147], a[36:39], a[104:107], v[144:147]
    buffer_load_dwordx4 v227, s[4:7], s53 offen offset:3072 lds
    v_mfma_f32_16x16x32_bf16 v[148:151], a[36:39], a[108:111], v[148:151]
    ds_read_b64_tr_b16 a[34:35], v233 offset:3712
    v_mfma_f32_16x16x32_bf16 v[152:155], a[36:39], a[112:115], v[152:155]
    v_mfma_f32_16x16x32_bf16 v[156:159], a[36:39], a[116:119], v[156:159]
    ds_read_b64_tr_b16 a[36:37], v233 offset:14464
    v_mfma_f32_16x16x32_bf16 v[160:163], a[40:43], a[104:107], v[160:163]
    v_mfma_f32_16x16x32_bf16 v[164:167], a[40:43], a[108:111], v[164:167]
    ds_read_b64_tr_b16 a[38:39], v233 offset:18048
    v_mfma_f32_16x16x32_bf16 v[168:171], a[40:43], a[112:115], v[168:171]
    s_add_u32 m0, m0, 4096
    v_mfma_f32_16x16x32_bf16 v[172:175], a[40:43], a[116:119], v[172:175]
    ds_read_b64_tr_b16 a[40:41], v233 offset:160
    buffer_load_dwordx4 v228, s[4:7], s53 offen offset:0 lds
    v_mfma_f32_16x16x32_bf16 v[176:179], a[44:47], a[104:107], v[176:179]
    s_cmp_ge_u32 s50, s51
    s_cselect_b32 s3, 114688, 0
    v_mfma_f32_16x16x32_bf16 v[180:183], a[44:47], a[108:111], v[180:183]
    ds_read_b64_tr_b16 a[42:43], v233 offset:3744
    s_sub_u32 s50, s50, s3
    v_mfma_f32_16x16x32_bf16 v[184:187], a[44:47], a[112:115], v[184:187]
    v_mfma_f32_16x16x32_bf16 v[188:191], a[44:47], a[116:119], v[188:191]
    ds_read_b64_tr_b16 a[44:45], v233 offset:14496
    v_mfma_f32_16x16x32_bf16 v[192:195], a[48:51], a[104:107], v[192:195]
    buffer_load_dwordx4 v229, s[4:7], s53 offen offset:1024 lds
    v_mfma_f32_16x16x32_bf16 v[196:199], a[48:51], a[108:111], v[196:199]
    ds_read_b64_tr_b16 a[46:47], v233 offset:18080
    v_mfma_f32_16x16x32_bf16 v[200:203], a[48:51], a[112:115], v[200:203]
    v_mfma_f32_16x16x32_bf16 v[204:207], a[48:51], a[116:119], v[204:207]
    ds_read_b64_tr_b16 a[48:49], v234 offset:0
    v_mfma_f32_16x16x32_bf16 v[208:211], a[52:55], a[104:107], v[208:211]
    v_mfma_f32_16x16x32_bf16 v[212:215], a[52:55], a[108:111], v[212:215]
    ds_read_b64_tr_b16 a[50:51], v234 offset:3584
    v_mfma_f32_16x16x32_bf16 v[216:219], a[52:55], a[112:115], v[216:219]
    buffer_load_dwordx4 v230, s[4:7], s53 offen offset:2048 lds
    v_readlane_b32 s3, v235, s48
    v_mfma_f32_16x16x32_bf16 v[220:223], a[52:55], a[116:119], v[220:223]
    ds_read_b64_tr_b16 a[52:53], v234 offset:14336
    s_mul_i32 s53, s3, 229376
    s_add_u32 s48, s48, 1
    s_mov_b32 s33, 5
.p2align 3
L_loop_1:
    s_waitcnt vmcnt(9) lgkmcnt(15)
    v_mfma_f32_16x16x32_bf16 v[0:3], a[0:3], a[56:59], v[0:3]
    ds_read_b64_tr_b16 a[54:55], v234 offset:17920
    v_mfma_f32_16x16x32_bf16 v[4:7], a[0:3], a[60:63], v[4:7]
    v_mfma_f32_16x16x32_bf16 v[8:11], a[0:3], a[64:67], v[8:11]
    v_mfma_f32_16x16x32_bf16 v[12:15], a[0:3], a[68:71], v[12:15]
    ds_read_b64_tr_b16 a[0:1], v233 offset:7168
    v_mfma_f32_16x16x32_bf16 v[16:19], a[4:7], a[56:59], v[16:19]
    buffer_load_dwordx4 a[88:91], v254, s[12:15], s42 offen offset:0 sc1
    v_mfma_f32_16x16x32_bf16 v[20:23], a[4:7], a[60:63], v[20:23]
    ds_read_b64_tr_b16 a[2:3], v233 offset:10752
    v_mfma_f32_16x16x32_bf16 v[24:27], a[4:7], a[64:67], v[24:27]
    s_mov_b32 m0, s50
    v_mfma_f32_16x16x32_bf16 v[28:31], a[4:7], a[68:71], v[28:31]
    ds_read_b64_tr_b16 a[4:5], v233 offset:21504
    v_mfma_f32_16x16x32_bf16 v[32:35], a[8:11], a[56:59], v[32:35]
    s_add_u32 s50, s50, 28672
    v_mfma_f32_16x16x32_bf16 v[36:39], a[8:11], a[60:63], v[36:39]
    ds_read_b64_tr_b16 a[6:7], v233 offset:25088
    v_mfma_f32_16x16x32_bf16 v[40:43], a[8:11], a[64:67], v[40:43]
    buffer_load_dwordx4 v224, s[4:7], s53 offen offset:0 lds
    v_mfma_f32_16x16x32_bf16 v[44:47], a[8:11], a[68:71], v[44:47]
    ds_read_b64_tr_b16 a[8:9], v233 offset:7200
    v_mfma_f32_16x16x32_bf16 v[48:51], a[12:15], a[56:59], v[48:51]
    buffer_load_dwordx4 a[92:95], v254, s[12:15], s42 offen offset:1024 sc1
    v_mfma_f32_16x16x32_bf16 v[52:55], a[12:15], a[60:63], v[52:55]
    ds_read_b64_tr_b16 a[10:11], v233 offset:10784
    v_mfma_f32_16x16x32_bf16 v[56:59], a[12:15], a[64:67], v[56:59]
    buffer_load_dwordx4 v225, s[4:7], s53 offen offset:1024 lds
    v_mfma_f32_16x16x32_bf16 v[60:63], a[12:15], a[68:71], v[60:63]
    ds_read_b64_tr_b16 a[12:13], v233 offset:21536
    s_waitcnt lgkmcnt(15)
    v_mfma_f32_16x16x32_bf16 v[64:67], a[16:19], a[56:59], v[64:67]
    v_mfma_f32_16x16x32_bf16 v[68:71], a[16:19], a[60:63], v[68:71]
    ds_read_b64_tr_b16 a[14:15], v233 offset:25120
    v_mfma_f32_16x16x32_bf16 v[72:75], a[16:19], a[64:67], v[72:75]
    v_mfma_f32_16x16x32_bf16 v[76:79], a[16:19], a[68:71], v[76:79]
    ds_read_b64_tr_b16 a[16:17], v233 offset:7232
    v_mfma_f32_16x16x32_bf16 v[80:83], a[20:23], a[56:59], v[80:83]
    buffer_load_dwordx4 a[96:99], v254, s[12:15], s42 offen offset:2048 sc1
    v_mfma_f32_16x16x32_bf16 v[84:87], a[20:23], a[60:63], v[84:87]
    ds_read_b64_tr_b16 a[18:19], v233 offset:10816
    v_mfma_f32_16x16x32_bf16 v[88:91], a[20:23], a[64:67], v[88:91]
    buffer_load_dwordx4 v226, s[4:7], s53 offen offset:2048 lds
    v_mfma_f32_16x16x32_bf16 v[92:95], a[20:23], a[68:71], v[92:95]
    ds_read_b64_tr_b16 a[20:21], v233 offset:21568
    v_mfma_f32_16x16x32_bf16 v[96:99], a[24:27], a[56:59], v[96:99]
    v_mfma_f32_16x16x32_bf16 v[100:103], a[24:27], a[60:63], v[100:103]
    ds_read_b64_tr_b16 a[22:23], v233 offset:25152
    v_mfma_f32_16x16x32_bf16 v[104:107], a[24:27], a[64:67], v[104:107]
    v_mfma_f32_16x16x32_bf16 v[108:111], a[24:27], a[68:71], v[108:111]
    ds_read_b64_tr_b16 a[24:25], v233 offset:7264
    v_mfma_f32_16x16x32_bf16 v[112:115], a[28:31], a[56:59], v[112:115]
    buffer_load_dwordx4 a[100:103], v254, s[12:15], s42 offen offset:3072 sc1
    v_mfma_f32_16x16x32_bf16 v[116:119], a[28:31], a[60:63], v[116:119]
    ds_read_b64_tr_b16 a[26:27], v233 offset:10848
    v_mfma_f32_16x16x32_bf16 v[120:123], a[28:31], a[64:67], v[120:123]
    s_add_u32 s42, s42, 0x40000
    v_mfma_f32_16x16x32_bf16 v[124:127], a[28:31], a[68:71], v[124:127]
    ds_read_b64_tr_b16 a[28:29], v233 offset:21600
    s_waitcnt lgkmcnt(15)
    v_mfma_f32_16x16x32_bf16 v[128:131], a[32:35], a[56:59], v[128:131]
    s_bfm_b64 exec, 14, 0
    s_waitcnt vmcnt(15)
    buffer_load_dword v239, v240, s[84:87], s88 offen
    s_mov_b64 exec, -1
    v_mfma_f32_16x16x32_bf16 v[132:135], a[32:35], a[60:63], v[132:135]
    ds_read_b64_tr_b16 a[30:31], v233 offset:25184
    v_mfma_f32_16x16x32_bf16 v[136:139], a[32:35], a[64:67], v[136:139]
    s_add_u32 s88, s88, 1835008
    v_mfma_f32_16x16x32_bf16 v[140:143], a[32:35], a[68:71], v[140:143]
    ds_read_b64_tr_b16 a[32:33], v233 offset:7296
    v_mfma_f32_16x16x32_bf16 v[144:147], a[36:39], a[56:59], v[144:147]
    s_cmp_lg_u32 s88, 7340032
    s_cselect_b32 s88, s88, 229376
    v_mfma_f32_16x16x32_bf16 v[148:151], a[36:39], a[60:63], v[148:151]
    ds_read_b64_tr_b16 a[34:35], v233 offset:10880
    v_mfma_f32_16x16x32_bf16 v[152:155], a[36:39], a[64:67], v[152:155]
    v_mfma_f32_16x16x32_bf16 v[156:159], a[36:39], a[68:71], v[156:159]
    ds_read_b64_tr_b16 a[36:37], v233 offset:21632
    v_mfma_f32_16x16x32_bf16 v[160:163], a[40:43], a[56:59], v[160:163]
    v_mfma_f32_16x16x32_bf16 v[164:167], a[40:43], a[60:63], v[164:167]
    ds_read_b64_tr_b16 a[38:39], v233 offset:25216
    v_mfma_f32_16x16x32_bf16 v[168:171], a[40:43], a[64:67], v[168:171]
    v_mfma_f32_16x16x32_bf16 v[172:175], a[40:43], a[68:71], v[172:175]
    ds_read_b64_tr_b16 a[40:41], v233 offset:7328
    v_mfma_f32_16x16x32_bf16 v[176:179], a[44:47], a[56:59], v[176:179]
    v_mfma_f32_16x16x32_bf16 v[180:183], a[44:47], a[60:63], v[180:183]
    ds_read_b64_tr_b16 a[42:43], v233 offset:10912
    v_mfma_f32_16x16x32_bf16 v[184:187], a[44:47], a[64:67], v[184:187]
    v_mfma_f32_16x16x32_bf16 v[188:191], a[44:47], a[68:71], v[188:191]
    ds_read_b64_tr_b16 a[44:45], v233 offset:21664
    v_mfma_f32_16x16x32_bf16 v[192:195], a[48:51], a[56:59], v[192:195]
    s_add_u32 s46, s46, 28672
    v_mfma_f32_16x16x32_bf16 v[196:199], a[48:51], a[60:63], v[196:199]
    ds_read_b64_tr_b16 a[46:47], v233 offset:25248
    v_mfma_f32_16x16x32_bf16 v[200:203], a[48:51], a[64:67], v[200:203]
    s_cmp_ge_u32 s46, 155648
    s_cselect_b32 s46, 40960, s46
    v_mfma_f32_16x16x32_bf16 v[204:207], a[48:51], a[68:71], v[204:207]
    ds_read_b64_tr_b16 a[48:49], v234 offset:7168
    v_mfma_f32_16x16x32_bf16 v[208:211], a[52:55], a[56:59], v[208:211]
    v_mfma_f32_16x16x32_bf16 v[212:215], a[52:55], a[60:63], v[212:215]
    ds_read_b64_tr_b16 a[50:51], v234 offset:10752
    v_mfma_f32_16x16x32_bf16 v[216:219], a[52:55], a[64:67], v[216:219]
    v_mfma_f32_16x16x32_bf16 v[220:223], a[52:55], a[68:71], v[220:223]
    ds_read_b64_tr_b16 a[52:53], v234 offset:21504
    s_waitcnt vmcnt(12) lgkmcnt(15)
    v_mfma_f32_16x16x32_bf16 v[0:3], a[0:3], a[72:75], v[0:3]
    ds_read_b64_tr_b16 a[54:55], v234 offset:25088
    v_add_u32 v233, s46, v231
    v_mfma_f32_16x16x32_bf16 v[4:7], a[0:3], a[76:79], v[4:7]
    v_add_u32 v234, s46, v232
    v_mfma_f32_16x16x32_bf16 v[8:11], a[0:3], a[80:83], v[8:11]
    s_waitcnt vmcnt(8)
    s_barrier
    v_mfma_f32_16x16x32_bf16 v[12:15], a[0:3], a[84:87], v[12:15]
    ds_read_b64_tr_b16 a[0:1], v233 offset:0
    v_mfma_f32_16x16x32_bf16 v[16:19], a[4:7], a[72:75], v[16:19]
    buffer_load_dwordx4 a[104:107], v254, s[12:15], s42 offen offset:0 sc1
    v_mfma_f32_16x16x32_bf16 v[20:23], a[4:7], a[76:79], v[20:23]
    ds_read_b64_tr_b16 a[2:3], v233 offset:3584
    v_mfma_f32_16x16x32_bf16 v[24:27], a[4:7], a[80:83], v[24:27]
    v_mfma_f32_16x16x32_bf16 v[28:31], a[4:7], a[84:87], v[28:31]
    ds_read_b64_tr_b16 a[4:5], v233 offset:14336
    v_mfma_f32_16x16x32_bf16 v[32:35], a[8:11], a[72:75], v[32:35]
    v_mfma_f32_16x16x32_bf16 v[36:39], a[8:11], a[76:79], v[36:39]
    ds_read_b64_tr_b16 a[6:7], v233 offset:17920
    v_mfma_f32_16x16x32_bf16 v[40:43], a[8:11], a[80:83], v[40:43]
    v_mfma_f32_16x16x32_bf16 v[44:47], a[8:11], a[84:87], v[44:47]
    ds_read_b64_tr_b16 a[8:9], v233 offset:32
    v_mfma_f32_16x16x32_bf16 v[48:51], a[12:15], a[72:75], v[48:51]
    buffer_load_dwordx4 a[108:111], v254, s[12:15], s42 offen offset:1024 sc1
    v_mfma_f32_16x16x32_bf16 v[52:55], a[12:15], a[76:79], v[52:55]
    ds_read_b64_tr_b16 a[10:11], v233 offset:3616
    v_mfma_f32_16x16x32_bf16 v[56:59], a[12:15], a[80:83], v[56:59]
    v_mfma_f32_16x16x32_bf16 v[60:63], a[12:15], a[84:87], v[60:63]
    ds_read_b64_tr_b16 a[12:13], v233 offset:14368
    s_waitcnt lgkmcnt(15)
    v_mfma_f32_16x16x32_bf16 v[64:67], a[16:19], a[72:75], v[64:67]
    v_mfma_f32_16x16x32_bf16 v[68:71], a[16:19], a[76:79], v[68:71]
    ds_read_b64_tr_b16 a[14:15], v233 offset:17952
    v_mfma_f32_16x16x32_bf16 v[72:75], a[16:19], a[80:83], v[72:75]
    v_mfma_f32_16x16x32_bf16 v[76:79], a[16:19], a[84:87], v[76:79]
    ds_read_b64_tr_b16 a[16:17], v233 offset:64
    v_mfma_f32_16x16x32_bf16 v[80:83], a[20:23], a[72:75], v[80:83]
    buffer_load_dwordx4 a[112:115], v254, s[12:15], s42 offen offset:2048 sc1
    v_mfma_f32_16x16x32_bf16 v[84:87], a[20:23], a[76:79], v[84:87]
    ds_read_b64_tr_b16 a[18:19], v233 offset:3648
    v_mfma_f32_16x16x32_bf16 v[88:91], a[20:23], a[80:83], v[88:91]
    v_mfma_f32_16x16x32_bf16 v[92:95], a[20:23], a[84:87], v[92:95]
    ds_read_b64_tr_b16 a[20:21], v233 offset:14400
    v_mfma_f32_16x16x32_bf16 v[96:99], a[24:27], a[72:75], v[96:99]
    v_mfma_f32_16x16x32_bf16 v[100:103], a[24:27], a[76:79], v[100:103]
    ds_read_b64_tr_b16 a[22:23], v233 offset:17984
    v_mfma_f32_16x16x32_bf16 v[104:107], a[24:27], a[80:83], v[104:107]
    v_mfma_f32_16x16x32_bf16 v[108:111], a[24:27], a[84:87], v[108:111]
    ds_read_b64_tr_b16 a[24:25], v233 offset:96
    v_mfma_f32_16x16x32_bf16 v[112:115], a[28:31], a[72:75], v[112:115]
    buffer_load_dwordx4 a[116:119], v254, s[12:15], s42 offen offset:3072 sc1
    v_mfma_f32_16x16x32_bf16 v[116:119], a[28:31], a[76:79], v[116:119]
    ds_read_b64_tr_b16 a[26:27], v233 offset:3680
    v_mfma_f32_16x16x32_bf16 v[120:123], a[28:31], a[80:83], v[120:123]
    v_readlane_b32 s3, v235, s49
    v_mfma_f32_16x16x32_bf16 v[124:127], a[28:31], a[84:87], v[124:127]
    ds_read_b64_tr_b16 a[28:29], v233 offset:14432
    s_waitcnt lgkmcnt(15)
    v_mfma_f32_16x16x32_bf16 v[128:131], a[32:35], a[72:75], v[128:131]
    s_mul_i32 s42, s3, 131072
    v_mfma_f32_16x16x32_bf16 v[132:135], a[32:35], a[76:79], v[132:135]
    ds_read_b64_tr_b16 a[30:31], v233 offset:18016
    v_mfma_f32_16x16x32_bf16 v[136:139], a[32:35], a[80:83], v[136:139]
    s_add_u32 s49, s49, 1
    v_mfma_f32_16x16x32_bf16 v[140:143], a[32:35], a[84:87], v[140:143]
    ds_read_b64_tr_b16 a[32:33], v233 offset:128
    v_mfma_f32_16x16x32_bf16 v[144:147], a[36:39], a[72:75], v[144:147]
    buffer_load_dword v237, v252, s[20:23], s43 offen sc1
    v_mfma_f32_16x16x32_bf16 v[148:151], a[36:39], a[76:79], v[148:151]
    ds_read_b64_tr_b16 a[34:35], v233 offset:3712
    v_mfma_f32_16x16x32_bf16 v[152:155], a[36:39], a[80:83], v[152:155]
    buffer_load_dwordx4 v227, s[4:7], s53 offen offset:3072 lds
    v_mfma_f32_16x16x32_bf16 v[156:159], a[36:39], a[84:87], v[156:159]
    ds_read_b64_tr_b16 a[36:37], v233 offset:14464
    v_mfma_f32_16x16x32_bf16 v[160:163], a[40:43], a[72:75], v[160:163]
    v_mfma_f32_16x16x32_bf16 v[164:167], a[40:43], a[76:79], v[164:167]
    ds_read_b64_tr_b16 a[38:39], v233 offset:18048
    v_mfma_f32_16x16x32_bf16 v[168:171], a[40:43], a[80:83], v[168:171]
    s_add_u32 m0, m0, 4096
    v_mfma_f32_16x16x32_bf16 v[172:175], a[40:43], a[84:87], v[172:175]
    ds_read_b64_tr_b16 a[40:41], v233 offset:160
    v_mfma_f32_16x16x32_bf16 v[176:179], a[44:47], a[72:75], v[176:179]
    buffer_load_dwordx4 v228, s[4:7], s53 offen offset:0 lds
    v_mfma_f32_16x16x32_bf16 v[180:183], a[44:47], a[76:79], v[180:183]
    ds_read_b64_tr_b16 a[42:43], v233 offset:3744
    v_mfma_f32_16x16x32_bf16 v[184:187], a[44:47], a[80:83], v[184:187]
    s_cmp_ge_u32 s50, s51
    s_cselect_b32 s3, 114688, 0
    v_mfma_f32_16x16x32_bf16 v[188:191], a[44:47], a[84:87], v[188:191]
    ds_read_b64_tr_b16 a[44:45], v233 offset:14496
    v_mfma_f32_16x16x32_bf16 v[192:195], a[48:51], a[72:75], v[192:195]
    s_sub_u32 s50, s50, s3
    v_mfma_f32_16x16x32_bf16 v[196:199], a[48:51], a[76:79], v[196:199]
    ds_read_b64_tr_b16 a[46:47], v233 offset:18080
    v_mfma_f32_16x16x32_bf16 v[200:203], a[48:51], a[80:83], v[200:203]
    buffer_load_dwordx4 v229, s[4:7], s53 offen offset:1024 lds
    v_mfma_f32_16x16x32_bf16 v[204:207], a[48:51], a[84:87], v[204:207]
    ds_read_b64_tr_b16 a[48:49], v234 offset:0
    v_mfma_f32_16x16x32_bf16 v[208:211], a[52:55], a[72:75], v[208:211]
    v_mfma_f32_16x16x32_bf16 v[212:215], a[52:55], a[76:79], v[212:215]
    ds_read_b64_tr_b16 a[50:51], v234 offset:3584
    v_mfma_f32_16x16x32_bf16 v[216:219], a[52:55], a[80:83], v[216:219]
    buffer_load_dwordx4 v230, s[4:7], s53 offen offset:2048 lds
    v_mfma_f32_16x16x32_bf16 v[220:223], a[52:55], a[84:87], v[220:223]
    ds_read_b64_tr_b16 a[52:53], v234 offset:14336
    s_waitcnt vmcnt(10) lgkmcnt(15)
    v_mfma_f32_16x16x32_bf16 v[0:3], a[0:3], a[88:91], v[0:3]
    ds_read_b64_tr_b16 a[54:55], v234 offset:17920
    v_mfma_f32_16x16x32_bf16 v[4:7], a[0:3], a[92:95], v[4:7]
    v_readlane_b32 s3, v235, s48
    v_mfma_f32_16x16x32_bf16 v[8:11], a[0:3], a[96:99], v[8:11]
    s_mul_i32 s53, s3, 229376
    v_mfma_f32_16x16x32_bf16 v[12:15], a[0:3], a[100:103], v[12:15]
    ds_read_b64_tr_b16 a[0:1], v233 offset:7168
    v_mfma_f32_16x16x32_bf16 v[16:19], a[4:7], a[88:91], v[16:19]
    s_add_u32 s48, s48, 1
    v_mfma_f32_16x16x32_bf16 v[20:23], a[4:7], a[92:95], v[20:23]
    ds_read_b64_tr_b16 a[2:3], v233 offset:10752
    v_mfma_f32_16x16x32_bf16 v[24:27], a[4:7], a[96:99], v[24:27]
    buffer_load_dwordx4 a[56:59], v254, s[12:15], s42 offen offset:0 sc1
    v_mfma_f32_16x16x32_bf16 v[28:31], a[4:7], a[100:103], v[28:31]
    ds_read_b64_tr_b16 a[4:5], v233 offset:21504
    v_mfma_f32_16x16x32_bf16 v[32:35], a[8:11], a[88:91], v[32:35]
    s_mov_b32 m0, s50
    v_mfma_f32_16x16x32_bf16 v[36:39], a[8:11], a[92:95], v[36:39]
    ds_read_b64_tr_b16 a[6:7], v233 offset:25088
    v_mfma_f32_16x16x32_bf16 v[40:43], a[8:11], a[96:99], v[40:43]
    s_add_u32 s50, s50, 28672
    v_mfma_f32_16x16x32_bf16 v[44:47], a[8:11], a[100:103], v[44:47]
    ds_read_b64_tr_b16 a[8:9], v233 offset:7200
    v_mfma_f32_16x16x32_bf16 v[48:51], a[12:15], a[88:91], v[48:51]
    buffer_load_dwordx4 v224, s[4:7], s53 offen offset:0 lds
    v_mfma_f32_16x16x32_bf16 v[52:55], a[12:15], a[92:95], v[52:55]
    ds_read_b64_tr_b16 a[10:11], v233 offset:10784
    v_mfma_f32_16x16x32_bf16 v[56:59], a[12:15], a[96:99], v[56:59]
    buffer_load_dwordx4 a[60:63], v254, s[12:15], s42 offen offset:1024 sc1
    v_mfma_f32_16x16x32_bf16 v[60:63], a[12:15], a[100:103], v[60:63]
    ds_read_b64_tr_b16 a[12:13], v233 offset:21536
    s_waitcnt lgkmcnt(15)
    v_mfma_f32_16x16x32_bf16 v[64:67], a[16:19], a[88:91], v[64:67]
    buffer_load_dwordx4 v225, s[4:7], s53 offen offset:1024 lds
    v_mfma_f32_16x16x32_bf16 v[68:71], a[16:19], a[92:95], v[68:71]
    ds_read_b64_tr_b16 a[14:15], v233 offset:25120
    v_mfma_f32_16x16x32_bf16 v[72:75], a[16:19], a[96:99], v[72:75]
    v_mfma_f32_16x16x32_bf16 v[76:79], a[16:19], a[100:103], v[76:79]
    ds_read_b64_tr_b16 a[16:17], v233 offset:7232
    v_mfma_f32_16x16x32_bf16 v[80:83], a[20:23], a[88:91], v[80:83]
    buffer_load_dwordx4 a[64:67], v254, s[12:15], s42 offen offset:2048 sc1
    v_mfma_f32_16x16x32_bf16 v[84:87], a[20:23], a[92:95], v[84:87]
    ds_read_b64_tr_b16 a[18:19], v233 offset:10816
    v_mfma_f32_16x16x32_bf16 v[88:91], a[20:23], a[96:99], v[88:91]
    buffer_load_dwordx4 v226, s[4:7], s53 offen offset:2048 lds
    v_mfma_f32_16x16x32_bf16 v[92:95], a[20:23], a[100:103], v[92:95]
    ds_read_b64_tr_b16 a[20:21], v233 offset:21568
    v_mfma_f32_16x16x32_bf16 v[96:99], a[24:27], a[88:91], v[96:99]
    v_mfma_f32_16x16x32_bf16 v[100:103], a[24:27], a[92:95], v[100:103]
    ds_read_b64_tr_b16 a[22:23], v233 offset:25152
    v_mfma_f32_16x16x32_bf16 v[104:107], a[24:27], a[96:99], v[104:107]
    v_mfma_f32_16x16x32_bf16 v[108:111], a[24:27], a[100:103], v[108:111]
    ds_read_b64_tr_b16 a[24:25], v233 offset:7264
    v_mfma_f32_16x16x32_bf16 v[112:115], a[28:31], a[88:91], v[112:115]
    buffer_load_dwordx4 a[68:71], v254, s[12:15], s42 offen offset:3072 sc1
    v_mfma_f32_16x16x32_bf16 v[116:119], a[28:31], a[92:95], v[116:119]
    ds_read_b64_tr_b16 a[26:27], v233 offset:10848
    v_mfma_f32_16x16x32_bf16 v[120:123], a[28:31], a[96:99], v[120:123]
    s_add_u32 s42, s42, 0x40000
    v_mfma_f32_16x16x32_bf16 v[124:127], a[28:31], a[100:103], v[124:127]
    ds_read_b64_tr_b16 a[28:29], v233 offset:21600
    s_waitcnt lgkmcnt(15)
    v_mfma_f32_16x16x32_bf16 v[128:131], a[32:35], a[88:91], v[128:131]
    s_waitcnt vmcnt(16)
    buffer_load_dword v239, v238, s[8:11], s45 offen
    v_mfma_f32_16x16x32_bf16 v[132:135], a[32:35], a[92:95], v[132:135]
    ds_read_b64_tr_b16 a[30:31], v233 offset:25184
    v_mfma_f32_16x16x32_bf16 v[136:139], a[32:35], a[96:99], v[136:139]
    s_add_u32 s45, s45, 1536
    v_mfma_f32_16x16x32_bf16 v[140:143], a[32:35], a[100:103], v[140:143]
    ds_read_b64_tr_b16 a[32:33], v233 offset:7296
    v_mfma_f32_16x16x32_bf16 v[144:147], a[36:39], a[88:91], v[144:147]
    v_mfma_f32_16x16x32_bf16 v[148:151], a[36:39], a[92:95], v[148:151]
    ds_read_b64_tr_b16 a[34:35], v233 offset:10880
    v_mfma_f32_16x16x32_bf16 v[152:155], a[36:39], a[96:99], v[152:155]
    v_mfma_f32_16x16x32_bf16 v[156:159], a[36:39], a[100:103], v[156:159]
    ds_read_b64_tr_b16 a[36:37], v233 offset:21632
    v_mfma_f32_16x16x32_bf16 v[160:163], a[40:43], a[88:91], v[160:163]
    v_mfma_f32_16x16x32_bf16 v[164:167], a[40:43], a[92:95], v[164:167]
    ds_read_b64_tr_b16 a[38:39], v233 offset:25216
    v_mfma_f32_16x16x32_bf16 v[168:171], a[40:43], a[96:99], v[168:171]
    v_mfma_f32_16x16x32_bf16 v[172:175], a[40:43], a[100:103], v[172:175]
    ds_read_b64_tr_b16 a[40:41], v233 offset:7328
    v_mfma_f32_16x16x32_bf16 v[176:179], a[44:47], a[88:91], v[176:179]
    v_mfma_f32_16x16x32_bf16 v[180:183], a[44:47], a[92:95], v[180:183]
    ds_read_b64_tr_b16 a[42:43], v233 offset:10912
    v_mfma_f32_16x16x32_bf16 v[184:187], a[44:47], a[96:99], v[184:187]
    v_mfma_f32_16x16x32_bf16 v[188:191], a[44:47], a[100:103], v[188:191]
    ds_read_b64_tr_b16 a[44:45], v233 offset:21664
    v_mfma_f32_16x16x32_bf16 v[192:195], a[48:51], a[88:91], v[192:195]
    s_add_u32 s46, s46, 28672
    v_mfma_f32_16x16x32_bf16 v[196:199], a[48:51], a[92:95], v[196:199]
    ds_read_b64_tr_b16 a[46:47], v233 offset:25248
    v_mfma_f32_16x16x32_bf16 v[200:203], a[48:51], a[96:99], v[200:203]
    s_cmp_ge_u32 s46, 155648
    s_cselect_b32 s46, 40960, s46
    v_mfma_f32_16x16x32_bf16 v[204:207], a[48:51], a[100:103], v[204:207]
    ds_read_b64_tr_b16 a[48:49], v234 offset:7168
    v_mfma_f32_16x16x32_bf16 v[208:211], a[52:55], a[88:91], v[208:211]
    v_mfma_f32_16x16x32_bf16 v[212:215], a[52:55], a[92:95], v[212:215]
    ds_read_b64_tr_b16 a[50:51], v234 offset:10752
    v_mfma_f32_16x16x32_bf16 v[216:219], a[52:55], a[96:99], v[216:219]
    v_mfma_f32_16x16x32_bf16 v[220:223], a[52:55], a[100:103], v[220:223]
    ds_read_b64_tr_b16 a[52:53], v234 offset:21504
    s_waitcnt vmcnt(13) lgkmcnt(15)
    v_mfma_f32_16x16x32_bf16 v[0:3], a[0:3], a[104:107], v[0:3]
    ds_read_b64_tr_b16 a[54:55], v234 offset:25088
    v_add_u32 v233, s46, v231
    v_mfma_f32_16x16x32_bf16 v[4:7], a[0:3], a[108:111], v[4:7]
    v_add_u32 v234, s46, v232
    v_mfma_f32_16x16x32_bf16 v[8:11], a[0:3], a[112:115], v[8:11]
    s_waitcnt vmcnt(8)
    s_barrier
    v_mfma_f32_16x16x32_bf16 v[12:15], a[0:3], a[116:119], v[12:15]
    v_cmp_gt_u32 vcc, 16, v237
    s_cbranch_vccz L_chk26
    s_mov_b64 exec, 1
    s_mov_b32 s3, 0x40000
L_poll27:
    buffer_load_dword v237, v252, s[20:23], s43 offen sc1
    s_sub_u32 s3, s3, 1
    s_cbranch_scc1 L_poll27_y
    s_waitcnt vmcnt(0)
    v_cmp_gt_u32 vcc, 16, v237
    s_cbranch_vccz L_poll27_y
    s_sleep 1
    s_branch L_poll27
L_poll27_y:
    s_waitcnt vmcnt(0)
    s_mov_b64 exec, -1
L_poll27_x:
L_chk26:
    ds_read_b64_tr_b16 a[0:1], v233 offset:0
    v_mfma_f32_16x16x32_bf16 v[16:19], a[4:7], a[104:107], v[16:19]
    buffer_load_dwordx4 a[72:75], v254, s[12:15], s42 offen offset:0 sc1
    v_mfma_f32_16x16x32_bf16 v[20:23], a[4:7], a[108:111], v[20:23]
    ds_read_b64_tr_b16 a[2:3], v233 offset:3584
    v_mfma_f32_16x16x32_bf16 v[24:27], a[4:7], a[112:115], v[24:27]
    v_mfma_f32_16x16x32_bf16 v[28:31], a[4:7], a[116:119], v[28:31]
    ds_read_b64_tr_b16 a[4:5], v233 offset:14336
    v_mfma_f32_16x16x32_bf16 v[32:35], a[8:11], a[104:107], v[32:35]
    v_mfma_f32_16x16x32_bf16 v[36:39], a[8:11], a[108:111], v[36:39]
    ds_read_b64_tr_b16 a[6:7], v233 offset:17920
    v_mfma_f32_16x16x32_bf16 v[40:43], a[8:11], a[112:115], v[40:43]
    v_mfma_f32_16x16x32_bf16 v[44:47], a[8:11], a[116:119], v[44:47]
    ds_read_b64_tr_b16 a[8:9], v233 offset:32
    v_mfma_f32_16x16x32_bf16 v[48:51], a[12:15], a[104:107], v[48:51]
    buffer_load_dwordx4 a[76:79], v254, s[12:15], s42 offen offset:1024 sc1
    v_mfma_f32_16x16x32_bf16 v[52:55], a[12:15], a[108:111], v[52:55]
    ds_read_b64_tr_b16 a[10:11], v233 offset:3616
    v_mfma_f32_16x16x32_bf16 v[56:59], a[12:15], a[112:115], v[56:59]
    v_mfma_f32_16x16x32_bf16 v[60:63], a[12:15], a[116:119], v[60:63]
    ds_read_b64_tr_b16 a[12:13], v233 offset:14368
    s_waitcnt lgkmcnt(15)
    v_mfma_f32_16x16x32_bf16 v[64:67], a[16:19], a[104:107], v[64:67]
    v_mfma_f32_16x16x32_bf16 v[68:71], a[16:19], a[108:111], v[68:71]
    ds_read_b64_tr_b16 a[14:15], v233 offset:17952
    v_mfma_f32_16x16x32_bf16 v[72:75], a[16:19], a[112:115], v[72:75]
    v_mfma_f32_16x16x32_bf16 v[76:79], a[16:19], a[116:119], v[76:79]
    ds_read_b64_tr_b16 a[16:17], v233 offset:64
    v_mfma_f32_16x16x32_bf16 v[80:83], a[20:23], a[104:107], v[80:83]
    buffer_load_dwordx4 a[80:83], v254, s[12:15], s42 offen offset:2048 sc1
    v_mfma_f32_16x16x32_bf16 v[84:87], a[20:23], a[108:111], v[84:87]
    ds_read_b64_tr_b16 a[18:19], v233 offset:3648
    v_mfma_f32_16x16x32_bf16 v[88:91], a[20:23], a[112:115], v[88:91]
    v_mfma_f32_16x16x32_bf16 v[92:95], a[20:23], a[116:119], v[92:95]
    ds_read_b64_tr_b16 a[20:21], v233 offset:14400
    v_mfma_f32_16x16x32_bf16 v[96:99], a[24:27], a[104:107], v[96:99]
    v_mfma_f32_16x16x32_bf16 v[100:103], a[24:27], a[108:111], v[100:103]
    ds_read_b64_tr_b16 a[22:23], v233 offset:17984
    v_mfma_f32_16x16x32_bf16 v[104:107], a[24:27], a[112:115], v[104:107]
    v_mfma_f32_16x16x32_bf16 v[108:111], a[24:27], a[116:119], v[108:111]
    ds_read_b64_tr_b16 a[24:25], v233 offset:96
    v_mfma_f32_16x16x32_bf16 v[112:115], a[28:31], a[104:107], v[112:115]
    buffer_load_dwordx4 a[84:87], v254, s[12:15], s42 offen offset:3072 sc1
    v_mfma_f32_16x16x32_bf16 v[116:119], a[28:31], a[108:111], v[116:119]
    ds_read_b64_tr_b16 a[26:27], v233 offset:3680
    v_mfma_f32_16x16x32_bf16 v[120:123], a[28:31], a[112:115], v[120:123]
    v_readlane_b32 s3, v235, s49
    v_mfma_f32_16x16x32_bf16 v[124:127], a[28:31], a[116:119], v[124:127]
    ds_read_b64_tr_b16 a[28:29], v233 offset:14432
    s_waitcnt lgkmcnt(15)
    v_mfma_f32_16x16x32_bf16 v[128:131], a[32:35], a[104:107], v[128:131]
    s_mul_i32 s42, s3, 131072
    v_mfma_f32_16x16x32_bf16 v[132:135], a[32:35], a[108:111], v[132:135]
    ds_read_b64_tr_b16 a[30:31], v233 offset:18016
    v_mfma_f32_16x16x32_bf16 v[136:139], a[32:35], a[112:115], v[136:139]
    s_add_u32 s49, s49, 1
    v_mfma_f32_16x16x32_bf16 v[140:143], a[32:35], a[116:119], v[140:143]
    ds_read_b64_tr_b16 a[32:33], v233 offset:128
    v_mfma_f32_16x16x32_bf16 v[144:147], a[36:39], a[104:107], v[144:147]
    buffer_load_dwordx4 v227, s[4:7], s53 offen offset:3072 lds
    v_mfma_f32_16x16x32_bf16 v[148:151], a[36:39], a[108:111], v[148:151]
    ds_read_b64_tr_b16 a[34:35], v233 offset:3712
    v_mfma_f32_16x16x32_bf16 v[152:155], a[36:39], a[112:115], v[152:155]
    v_mfma_f32_16x16x32_bf16 v[156:159], a[36:39], a[116:119], v[156:159]
    ds_read_b64_tr_b16 a[36:37], v233 offset:14464
    v_mfma_f32_16x16x32_bf16 v[160:163], a[40:43], a[104:107], v[160:163]
    v_mfma_f32_16x16x32_bf16 v[164:167], a[40:43], a[108:111], v[164:167]
    ds_read_b64_tr_b16 a[38:39], v233 offset:18048
    v_mfma_f32_16x16x32_bf16 v[168:171], a[40:43], a[112:115], v[168:171]
    s_add_u32 m0, m0, 4096
    v_mfma_f32_16x16x32_bf16 v[172:175], a[40:43], a[116:119], v[172:175]
    ds_read_b64_tr_b16 a[40:41], v233 offset:160
    v_mfma_f32_16x16x32_bf16 v[176:179], a[44:47], a[104:107], v[176:179]
    buffer_load_dwordx4 v228, s[4:7], s53 offen offset:0 lds
    v_mfma_f32_16x16x32_bf16 v[180:183], a[44:47], a[108:111], v[180:183]
    ds_read_b64_tr_b16 a[42:43], v233 offset:3744
    v_mfma_f32_16x16x32_bf16 v[184:187], a[44:47], a[112:115], v[184:187]
    s_cmp_ge_u32 s50, s51
    s_cselect_b32 s3, 114688, 0
    v_mfma_f32_16x16x32_bf16 v[188:191], a[44:47], a[116:119], v[188:191]
    ds_read_b64_tr_b16 a[44:45], v233 offset:14496
    v_mfma_f32_16x16x32_bf16 v[192:195], a[48:51], a[104:107], v[192:195]
    s_sub_u32 s50, s50, s3
    v_mfma_f32_16x16x32_bf16 v[196:199], a[48:51], a[108:111], v[196:199]
    ds_read_b64_tr_b16 a[46:47], v233 offset:18080
    v_mfma_f32_16x16x32_bf16 v[200:203], a[48:51], a[112:115], v[200:203]
    buffer_load_dwordx4 v229, s[4:7], s53 offen offset:1024 lds
    v_mfma_f32_16x16x32_bf16 v[204:207], a[48:51], a[116:119], v[204:207]
    ds_read_b64_tr_b16 a[48:49], v234 offset:0
    v_mfma_f32_16x16x32_bf16 v[208:211], a[52:55], a[104:107], v[208:211]
    v_mfma_f32_16x16x32_bf16 v[212:215], a[52:55], a[108:111], v[212:215]
    ds_read_b64_tr_b16 a[50:51], v234 offset:3584
    v_mfma_f32_16x16x32_bf16 v[216:219], a[52:55], a[112:115], v[216:219]
    buffer_load_dwordx4 v230, s[4:7], s53 offen offset:2048 lds
    v_mfma_f32_16x16x32_bf16 v[220:223], a[52:55], a[116:119], v[220:223]
    ds_read_b64_tr_b16 a[52:53], v234 offset:14336
    v_readlane_b32 s3, v235, s48
    s_nop 0
    s_mul_i32 s53, s3, 229376
    s_add_u32 s48, s48, 1
    s_sub_u32 s33, s33, 1
    s_cmp_lg_u32 s33, 0
    s_cbranch_scc1 L_loop_1
    s_waitcnt vmcnt(9) lgkmcnt(15)
    v_mfma_f32_16x16x32_bf16 v[0:3], a[0:3], a[56:59], v[0:3]
    ds_read_b64_tr_b16 a[54:55], v234 offset:17920
    buffer_load_dword a120, v236, s[92:95], 0 offen offset:0 sc1
    v_mfma_f32_16x16x32_bf16 v[4:7], a[0:3], a[60:63], v[4:7]
    buffer_load_dword a121, v236, s[92:95], 0 offen offset:512 sc1
    buffer_load_dword a122, v236, s[92:95], 0 offen offset:1024 sc1
    v_mfma_f32_16x16x32_bf16 v[8:11], a[0:3], a[64:67], v[8:11]
    buffer_load_dword a123, v236, s[92:95], 0 offen offset:1536 sc1
    buffer_load_dword a124, v236, s[92:95], 0 offen offset:2048 sc1
    v_mfma_f32_16x16x32_bf16 v[12:15], a[0:3], a[68:71], v[12:15]
    ds_read_b64_tr_b16 a[0:1], v233 offset:7168
    buffer_load_dword a125, v236, s[92:95], 0 offen offset:2560 sc1
    v_mfma_f32_16x16x32_bf16 v[16:19], a[4:7], a[56:59], v[16:19]
    buffer_load_dwordx4 a[88:91], v254, s[12:15], s42 offen offset:0 sc1
    buffer_load_dword a126, v236, s[92:95], 0 offen offset:3072 sc1
    v_mfma_f32_16x16x32_bf16 v[20:23], a[4:7], a[60:63], v[20:23]
    ds_read_b64_tr_b16 a[2:3], v233 offset:10752
    buffer_load_dword a127, v236, s[92:95], 0 offen offset:3584 sc1
    v_mfma_f32_16x16x32_bf16 v[24:27], a[4:7], a[64:67], v[24:27]
    buffer_load_dword a128, v236, s[92:95], s44 offen offset:0 sc1
    buffer_load_dword a129, v236, s[92:95], s44 offen offset:512 sc1
    v_mfma_f32_16x16x32_bf16 v[28:31], a[4:7], a[68:71], v[28:31]
    ds_read_b64_tr_b16 a[4:5], v233 offset:21504
    buffer_load_dword a130, v236, s[92:95], s44 offen offset:1024 sc1
    v_mfma_f32_16x16x32_bf16 v[32:35], a[8:11], a[56:59], v[32:35]
    s_mov_b32 m0, s50
    s_add_u32 s50, s50, 28672
    v_mfma_f32_16x16x32_bf16 v[36:39], a[8:11], a[60:63], v[36:39]
    ds_read_b64_tr_b16 a[6:7], v233 offset:25088
    buffer_load_dwordx4 v224, s[4:7], s53 offen offset:0 lds
    v_mfma_f32_16x16x32_bf16 v[40:43], a[8:11], a[64:67], v[40:43]
    buffer_load_dword a131, v236, s[92:95], s44 offen offset:1536 sc1
    buffer_load_dword a132, v236, s[92:95], s44 offen offset:2048 sc1
    v_mfma_f32_16x16x32_bf16 v[44:47], a[8:11], a[68:71], v[44:47]
    ds_read_b64_tr_b16 a[8:9], v233 offset:7200
    buffer_load_dword a133, v236, s[92:95], s44 offen offset:2560 sc1
    v_mfma_f32_16x16x32_bf16 v[48:51], a[12:15], a[56:59], v[48:51]
    buffer_load_dwordx4 a[92:95], v254, s[12:15], s42 offen offset:1024 sc1
    buffer_load_dword a134, v236, s[92:95], s44 offen offset:3072 sc1
    v_mfma_f32_16x16x32_bf16 v[52:55], a[12:15], a[60:63], v[52:55]
    ds_read_b64_tr_b16 a[10:11], v233 offset:10784
    buffer_load_dword a135, v236, s[92:95], s44 offen offset:3584 sc1
    v_mfma_f32_16x16x32_bf16 v[56:59], a[12:15], a[64:67], v[56:59]
    v_mfma_f32_16x16x32_bf16 v[60:63], a[12:15], a[68:71], v[60:63]
    ds_read_b64_tr_b16 a[12:13], v233 offset:21536
    s_waitcnt lgkmcnt(15)
    v_mfma_f32_16x16x32_bf16 v[64:67], a[16:19], a[56:59], v[64:67]
    v_mfma_f32_16x16x32_bf16 v[68:71], a[16:19], a[60:63], v[68:71]
    ds_read_b64_tr_b16 a[14:15], v233 offset:25120
    v_mfma_f32_16x16x32_bf16 v[72:75], a[16:19], a[64:67], v[72:75]
    buffer_load_dwordx4 v225, s[4:7], s53 offen offset:1024 lds
    v_mfma_f32_16x16x32_bf16 v[76:79], a[16:19], a[68:71], v[76:79]
    ds_read_b64_tr_b16 a[16:17], v233 offset:7232
    v_mfma_f32_16x16x32_bf16 v[80:83], a[20:23], a[56:59], v[80:83]
    buffer_load_dwordx4 a[96:99], v254, s[12:15], s42 offen offset:2048 sc1
    v_mfma_f32_16x16x32_bf16 v[84:87], a[20:23], a[60:63], v[84:87]
    ds_read_b64_tr_b16 a[18:19], v233 offset:10816
    v_mfma_f32_16x16x32_bf16 v[88:91], a[20:23], a[64:67], v[88:91]
    v_mfma_f32_16x16x32_bf16 v[92:95], a[20:23], a[68:71], v[92:95]
    ds_read_b64_tr_b16 a[20:21], v233 offset:21568
    v_mfma_f32_16x16x32_bf16 v[96:99], a[24:27], a[56:59], v[96:99]
    v_mfma_f32_16x16x32_bf16 v[100:103], a[24:27], a[60:63], v[100:103]
    ds_read_b64_tr_b16 a[22:23], v233 offset:25152
    v_mfma_f32_16x16x32_bf16 v[104:107], a[24:27], a[64:67], v[104:107]
    v_mfma_f32_16x16x32_bf16 v[108:111], a[24:27], a[68:71], v[108:111]
    ds_read_b64_tr_b16 a[24:25], v233 offset:7264
    v_mfma_f32_16x16x32_bf16 v[112:115], a[28:31], a[56:59], v[112:115]
    buffer_load_dwordx4 a[100:103], v254, s[12:15], s42 offen offset:3072 sc1
    s_add_u32 s42, s42, 0x40000
    v_mfma_f32_16x16x32_bf16 v[116:119], a[28:31], a[60:63], v[116:119]
    ds_read_b64_tr_b16 a[26:27], v233 offset:10848
    v_mfma_f32_16x16x32_bf16 v[120:123], a[28:31], a[64:67], v[120:123]
    v_mfma_f32_16x16x32_bf16 v[124:127], a[28:31], a[68:71], v[124:127]
    ds_read_b64_tr_b16 a[28:29], v233 offset:21600
    s_waitcnt lgkmcnt(15)
    v_mfma_f32_16x16x32_bf16 v[128:131], a[32:35], a[56:59], v[128:131]
    buffer_load_dwordx4 v226, s[4:7], s53 offen offset:2048 lds
    v_mfma_f32_16x16x32_bf16 v[132:135], a[32:35], a[60:63], v[132:135]
    ds_read_b64_tr_b16 a[30:31], v233 offset:25184
    v_mfma_f32_16x16x32_bf16 v[136:139], a[32:35], a[64:67], v[136:139]
    v_mfma_f32_16x16x32_bf16 v[140:143], a[32:35], a[68:71], v[140:143]
    ds_read_b64_tr_b16 a[32:33], v233 offset:7296
    v_mfma_f32_16x16x32_bf16 v[144:147], a[36:39], a[56:59], v[144:147]
    v_mfma_f32_16x16x32_bf16 v[148:151], a[36:39], a[60:63], v[148:151]
    ds_read_b64_tr_b16 a[34:35], v233 offset:10880
    v_mfma_f32_16x16x32_bf16 v[152:155], a[36:39], a[64:67], v[152:155]
    v_mfma_f32_16x16x32_bf16 v[156:159], a[36:39], a[68:71], v[156:159]
    ds_read_b64_tr_b16 a[36:37], v233 offset:21632
    v_mfma_f32_16x16x32_bf16 v[160:163], a[40:43], a[56:59], v[160:163]
    buffer_load_dwordx4 v227, s[4:7], s53 offen offset:3072 lds
    v_mfma_f32_16x16x32_bf16 v[164:167], a[40:43], a[60:63], v[164:167]
    ds_read_b64_tr_b16 a[38:39], v233 offset:25216
    v_mfma_f32_16x16x32_bf16 v[168:171], a[40:43], a[64:67], v[168:171]
    v_mfma_f32_16x16x32_bf16 v[172:175], a[40:43], a[68:71], v[172:175]
    ds_read_b64_tr_b16 a[40:41], v233 offset:7328
    v_mfma_f32_16x16x32_bf16 v[176:179], a[44:47], a[56:59], v[176:179]
    v_mfma_f32_16x16x32_bf16 v[180:183], a[44:47], a[60:63], v[180:183]
    ds_read_b64_tr_b16 a[42:43], v233 offset:10912
    v_mfma_f32_16x16x32_bf16 v[184:187], a[44:47], a[64:67], v[184:187]
    v_mfma_f32_16x16x32_bf16 v[188:191], a[44:47], a[68:71], v[188:191]
    ds_read_b64_tr_b16 a[44:45], v233 offset:21664
    v_mfma_f32_16x16x32_bf16 v[192:195], a[48:51], a[56:59], v[192:195]
    s_add_u32 s46, s46, 28672
    s_cmp_ge_u32 s46, 155648
    s_cselect_b32 s46, 40960, s46
    v_mfma_f32_16x16x32_bf16 v[196:199], a[48:51], a[60:63], v[196:199]
    ds_read_b64_tr_b16 a[46:47], v233 offset:25248
    s_add_u32 m0, m0, 4096
    v_mfma_f32_16x16x32_bf16 v[200:203], a[48:51], a[64:67], v[200:203]
    buffer_load_dwordx4 v228, s[4:7], s53 offen offset:0 lds
    s_cmp_ge_u32 s50, s51
    s_cselect_b32 s3, 114688, 0
    v_mfma_f32_16x16x32_bf16 v[204:207], a[48:51], a[68:71], v[204:207]
    ds_read_b64_tr_b16 a[48:49], v234 offset:7168
    s_sub_u32 s50, s50, s3
    v_mfma_f32_16x16x32_bf16 v[208:211], a[52:55], a[56:59], v[208:211]
    v_mfma_f32_16x16x32_bf16 v[212:215], a[52:55], a[60:63], v[212:215]
    ds_read_b64_tr_b16 a[50:51], v234 offset:10752
    v_mfma_f32_16x16x32_bf16 v[216:219], a[52:55], a[64:67], v[216:219]
    v_mfma_f32_16x16x32_bf16 v[220:223], a[52:55], a[68:71], v[220:223]
    ds_read_b64_tr_b16 a[52:53], v234 offset:21504
    s_waitcnt vmcnt(29) lgkmcnt(15)
    v_mfma_f32_16x16x32_bf16 v[0:3], a[0:3], a[72:75], v[0:3]
    ds_read_b64_tr_b16 a[54:55], v234 offset:25088
    v_add_u32 v233, s46, v231
    v_mfma_f32_16x16x32_bf16 v[4:7], a[0:3], a[76:79], v[4:7]
    v_add_u32 v234, s46, v232
    v_mfma_f32_16x16x32_bf16 v[8:11], a[0:3], a[80:83], v[8:11]
    s_waitcnt vmcnt(25)
    s_barrier
    v_mfma_f32_16x16x32_bf16 v[12:15], a[0:3], a[84:87], v[12:15]
    ds_read_b64_tr_b16 a[0:1], v233 offset:0
    v_mfma_f32_16x16x32_bf16 v[16:19], a[4:7], a[72:75], v[16:19]
    buffer_load_dwordx4 a[104:107], v254, s[12:15], s42 offen offset:0 sc1
    v_mfma_f32_16x16x32_bf16 v[20:23], a[4:7], a[76:79], v[20:23]
    ds_read_b64_tr_b16 a[2:3], v233 offset:3584
    v_mfma_f32_16x16x32_bf16 v[24:27], a[4:7], a[80:83], v[24:27]
    v_mfma_f32_16x16x32_bf16 v[28:31], a[4:7], a[84:87], v[28:31]
    ds_read_b64_tr_b16 a[4:5], v233 offset:14336
    v_mfma_f32_16x16x32_bf16 v[32:35], a[8:11], a[72:75], v[32:35]
    buffer_load_dwordx4 v229, s[4:7], s53 offen offset:1024 lds
    v_mfma_f32_16x16x32_bf16 v[36:39], a[8:11], a[76:79], v[36:39]
    ds_read_b64_tr_b16 a[6:7], v233 offset:17920
    v_mfma_f32_16x16x32_bf16 v[40:43], a[8:11], a[80:83], v[40:43]
    v_mfma_f32_16x16x32_bf16 v[44:47], a[8:11], a[84:87], v[44:47]
    ds_read_b64_tr_b16 a[8:9], v233 offset:32
    v_mfma_f32_16x16x32_bf16 v[48:51], a[12:15], a[72:75], v[48:51]
    buffer_load_dwordx4 a[108:111], v254, s[12:15], s42 offen offset:1024 sc1
    v_mfma_f32_16x16x32_bf16 v[52:55], a[12:15], a[76:79], v[52:55]
    ds_read_b64_tr_b16 a[10:11], v233 offset:3616
    v_mfma_f32_16x16x32_bf16 v[56:59], a[12:15], a[80:83], v[56:59]
    v_mfma_f32_16x16x32_bf16 v[60:63], a[12:15], a[84:87], v[60:63]
    ds_read_b64_tr_b16 a[12:13], v233 offset:14368
    s_waitcnt lgkmcnt(15)
    v_mfma_f32_16x16x32_bf16 v[64:67], a[16:19], a[72:75], v[64:67]
    v_mfma_f32_16x16x32_bf16 v[68:71], a[16:19], a[76:79], v[68:71]
    ds_read_b64_tr_b16 a[14:15], v233 offset:17952
    v_mfma_f32_16x16x32_bf16 v[72:75], a[16:19], a[80:83], v[72:75]
    buffer_load_dwordx4 v230, s[4:7], s53 offen offset:2048 lds
    v_readlane_b32 s3, v235, s48
    v_mfma_f32_16x16x32_bf16 v[76:79], a[16:19], a[84:87], v[76:79]
    ds_read_b64_tr_b16 a[16:17], v233 offset:64
    s_mul_i32 s53, s3, 229376
    v_mfma_f32_16x16x32_bf16 v[80:83], a[20:23], a[72:75], v[80:83]
    s_add_u32 s48, s48, 1
    buffer_load_dwordx4 a[112:115], v254, s[12:15], s42 offen offset:2048 sc1
    v_mfma_f32_16x16x32_bf16 v[84:87], a[20:23], a[76:79], v[84:87]
    ds_read_b64_tr_b16 a[18:19], v233 offset:3648
    v_mfma_f32_16x16x32_bf16 v[88:91], a[20:23], a[80:83], v[88:91]
    v_mfma_f32_16x16x32_bf16 v[92:95], a[20:23], a[84:87], v[92:95]
    ds_read_b64_tr_b16 a[20:21], v233 offset:14400
    v_mfma_f32_16x16x32_bf16 v[96:99], a[24:27], a[72:75], v[96:99]
    v_mfma_f32_16x16x32_bf16 v[100:103], a[24:27], a[76:79], v[100:103]
    ds_read_b64_tr_b16 a[22:23], v233 offset:17984
    v_mfma_f32_16x16x32_bf16 v[104:107], a[24:27], a[80:83], v[104:107]
    v_mfma_f32_16x16x32_bf16 v[108:111], a[24:27], a[84:87], v[108:111]
    ds_read_b64_tr_b16 a[24:25], v233 offset:96
    v_mfma_f32_16x16x32_bf16 v[112:115], a[28:31], a[72:75], v[112:115]
    buffer_load_dwordx4 a[116:119], v254, s[12:15], s42 offen offset:3072 sc1
    v_readlane_b32 s3, v235, s49
    v_mfma_f32_16x16x32_bf16 v[116:119], a[28:31], a[76:79], v[116:119]
    ds_read_b64_tr_b16 a[26:27], v233 offset:3680
    s_mul_i32 s42, s3, 131072
    v_mfma_f32_16x16x32_bf16 v[120:123], a[28:31], a[80:83], v[120:123]
    s_add_u32 s49, s49, 1
    v_mfma_f32_16x16x32_bf16 v[124:127], a[28:31], a[84:87], v[124:127]
    ds_read_b64_tr_b16 a[28:29], v233 offset:14432
    s_waitcnt lgkmcnt(15)
    v_mfma_f32_16x16x32_bf16 v[128:131], a[32:35], a[72:75], v[128:131]
    s_mov_b32 m0, s50
    s_add_u32 s50, s50, 28672
    v_mfma_f32_16x16x32_bf16 v[132:135], a[32:35], a[76:79], v[132:135]
    ds_read_b64_tr_b16 a[30:31], v233 offset:18016
    buffer_load_dwordx4 v224, s[4:7], s53 offen offset:0 lds
    v_mfma_f32_16x16x32_bf16 v[136:139], a[32:35], a[80:83], v[136:139]
    v_mfma_f32_16x16x32_bf16 v[140:143], a[32:35], a[84:87], v[140:143]
    ds_read_b64_tr_b16 a[32:33], v233 offset:128
    v_mfma_f32_16x16x32_bf16 v[144:147], a[36:39], a[72:75], v[144:147]
    v_mfma_f32_16x16x32_bf16 v[148:151], a[36:39], a[76:79], v[148:151]
    ds_read_b64_tr_b16 a[34:35], v233 offset:3712
    v_mfma_f32_16x16x32_bf16 v[152:155], a[36:39], a[80:83], v[152:155]
    v_mfma_f32_16x16x32_bf16 v[156:159], a[36:39], a[84:87], v[156:159]
    ds_read_b64_tr_b16 a[36:37], v233 offset:14464
    v_mfma_f32_16x16x32_bf16 v[160:163], a[40:43], a[72:75], v[160:163]
    buffer_load_dwordx4 v225, s[4:7], s53 offen offset:1024 lds
    v_mfma_f32_16x16x32_bf16 v[164:167], a[40:43], a[76:79], v[164:167]
    ds_read_b64_tr_b16 a[38:39], v233 offset:18048
    v_mfma_f32_16x16x32_bf16 v[168:171], a[40:43], a[80:83], v[168:171]
    v_mfma_f32_16x16x32_bf16 v[172:175], a[40:43], a[84:87], v[172:175]
    ds_read_b64_tr_b16 a[40:41], v233 offset:160
    v_mfma_f32_16x16x32_bf16 v[176:179], a[44:47], a[72:75], v[176:179]
    v_mfma_f32_16x16x32_bf16 v[180:183], a[44:47], a[76:79], v[180:183]
    ds_read_b64_tr_b16 a[42:43], v233 offset:3744
    v_mfma_f32_16x16x32_bf16 v[184:187], a[44:47], a[80:83], v[184:187]
    v_mfma_f32_16x16x32_bf16 v[188:191], a[44:47], a[84:87], v[188:191]
    ds_read_b64_tr_b16 a[44:45], v233 offset:14496
    v_mfma_f32_16x16x32_bf16 v[192:195], a[48:51], a[72:75], v[192:195]
    buffer_load_dwordx4 v226, s[4:7], s53 offen offset:2048 lds
    v_mfma_f32_16x16x32_bf16 v[196:199], a[48:51], a[76:79], v[196:199]
    ds_read_b64_tr_b16 a[46:47], v233 offset:18080
    v_mfma_f32_16x16x32_bf16 v[200:203], a[48:51], a[80:83], v[200:203]
    v_mfma_f32_16x16x32_bf16 v[204:207], a[48:51], a[84:87], v[204:207]
    ds_read_b64_tr_b16 a[48:49], v234 offset:0
    v_mfma_f32_16x16x32_bf16 v[208:211], a[52:55], a[72:75], v[208:211]
    v_mfma_f32_16x16x32_bf16 v[212:215], a[52:55], a[76:79], v[212:215]
    ds_read_b64_tr_b16 a[50:51], v234 offset:3584
    v_mfma_f32_16x16x32_bf16 v[216:219], a[52:55], a[80:83], v[216:219]
    v_mfma_f32_16x16x32_bf16 v[220:223], a[52:55], a[84:87], v[220:223]
    ds_read_b64_tr_b16 a[52:53], v234 offset:14336
    s_waitcnt vmcnt(12) lgkmcnt(15)
    v_mfma_f32_16x16x32_bf16 v[0:3], a[0:3], a[88:91], v[0:3]
    ds_read_b64_tr_b16 a[54:55], v234 offset:17920
    v_mfma_f32_16x16x32_bf16 v[4:7], a[0:3], a[92:95], v[4:7]
    buffer_load_dwordx4 v227, s[4:7], s53 offen offset:3072 lds
    v_mfma_f32_16x16x32_bf16 v[8:11], a[0:3], a[96:99], v[8:11]
    v_mfma_f32_16x16x32_bf16 v[12:15], a[0:3], a[100:103], v[12:15]
    ds_read_b64_tr_b16 a[0:1], v233 offset:7168
    v_mfma_f32_16x16x32_bf16 v[16:19], a[4:7], a[88:91], v[16:19]
    buffer_load_dwordx4 a[56:59], v254, s[12:15], s42 offen offset:0 sc1
    v_mfma_f32_16x16x32_bf16 v[20:23], a[4:7], a[92:95], v[20:23]
    ds_read_b64_tr_b16 a[2:3], v233 offset:10752
    v_mfma_f32_16x16x32_bf16 v[24:27], a[4:7], a[96:99], v[24:27]
    v_mfma_f32_16x16x32_bf16 v[28:31], a[4:7], a[100:103], v[28:31]
    ds_read_b64_tr_b16 a[4:5], v233 offset:21504
    s_add_u32 m0, m0, 4096
    v_mfma_f32_16x16x32_bf16 v[32:35], a[8:11], a[88:91], v[32:35]
    buffer_load_dwordx4 v228, s[4:7], s53 offen offset:0 lds
    s_cmp_ge_u32 s50, s51
    s_cselect_b32 s3, 114688, 0
    v_mfma_f32_16x16x32_bf16 v[36:39], a[8:11], a[92:95], v[36:39]
    ds_read_b64_tr_b16 a[6:7], v233 offset:25088
    s_sub_u32 s50, s50, s3
    v_mfma_f32_16x16x32_bf16 v[40:43], a[8:11], a[96:99], v[40:43]
    buffer_load_dwordx4 a[60:63], v254, s[12:15], s42 offen offset:1024 sc1
    v_mfma_f32_16x16x32_bf16 v[44:47], a[8:11], a[100:103], v[44:47]
    ds_read_b64_tr_b16 a[8:9], v233 offset:7200
    v_mfma_f32_16x16x32_bf16 v[48:51], a[12:15], a[88:91], v[48:51]
    v_mfma_f32_16x16x32_bf16 v[52:55], a[12:15], a[92:95], v[52:55]
    ds_read_b64_tr_b16 a[10:11], v233 offset:10784
    buffer_load_dwordx4 v229, s[4:7], s53 offen offset:1024 lds
    v_mfma_f32_16x16x32_bf16 v[56:59], a[12:15], a[96:99], v[56:59]
    v_mfma_f32_16x16x32_bf16 v[60:63], a[12:15], a[100:103], v[60:63]
    ds_read_b64_tr_b16 a[12:13], v233 offset:21536
    s_waitcnt lgkmcnt(15)
    v_mfma_f32_16x16x32_bf16 v[64:67], a[16:19], a[88:91], v[64:67]
    buffer_load_dwordx4 a[64:67], v254, s[12:15], s42 offen offset:2048 sc1
    v_mfma_f32_16x16x32_bf16 v[68:71], a[16:19], a[92:95], v[68:71]
    ds_read_b64_tr_b16 a[14:15], v233 offset:25120
    v_mfma_f32_16x16x32_bf16 v[72:75], a[16:19], a[96:99], v[72:75]
    v_mfma_f32_16x16x32_bf16 v[76:79], a[16:19], a[100:103], v[76:79]
    ds_read_b64_tr_b16 a[16:17], v233 offset:7232
    buffer_load_dwordx4 v230, s[4:7], s53 offen offset:2048 lds
    v_mfma_f32_16x16x32_bf16 v[80:83], a[20:23], a[88:91], v[80:83]
    v_readlane_b32 s3, v235, s48
    s_nop 0
    s_mul_i32 s53, s3, 229376
    v_mfma_f32_16x16x32_bf16 v[84:87], a[20:23], a[92:95], v[84:87]
    ds_read_b64_tr_b16 a[18:19], v233 offset:10816
    s_add_u32 s48, s48, 1
    v_mfma_f32_16x16x32_bf16 v[88:91], a[20:23], a[96:99], v[88:91]
    buffer_load_dwordx4 a[68:71], v254, s[12:15], s42 offen offset:3072 sc1
    s_add_u32 s42, s42, 0x40000
    v_mfma_f32_16x16x32_bf16 v[92:95], a[20:23], a[100:103], v[92:95]
    ds_read_b64_tr_b16 a[20:21], v233 offset:21568
    v_mfma_f32_16x16x32_bf16 v[96:99], a[24:27], a[88:91], v[96:99]
    s_lshr_b32 s35, s32, 1
    s_mul_i32 s35, s35, 7
    v_mfma_f32_16x16x32_bf16 v[100:103], a[24:27], a[92:95], v[100:103]
    ds_read_b64_tr_b16 a[22:23], v233 offset:25152
    s_lshr_b32 s36, s31, 2
    v_mfma_f32_16x16x32_bf16 v[104:107], a[24:27], a[96:99], v[104:107]
    s_mul_i32 s36, s36, 112
    s_add_u32 s35, s35, s36
    v_mfma_f32_16x16x32_bf16 v[108:111], a[24:27], a[100:103], v[108:111]
    ds_read_b64_tr_b16 a[24:25], v233 offset:7264
    s_lshl_b32 s35, s35, 16
    v_mfma_f32_16x16x32_bf16 v[112:115], a[28:31], a[88:91], v[112:115]
    buffer_load_dwordx4 a[72:75], v254, s[12:15], s42 offen offset:0 sc1
    s_and_b32 s36, s57, 0xffff
    v_mfma_f32_16x16x32_bf16 v[116:119], a[28:31], a[92:95], v[116:119]
    ds_read_b64_tr_b16 a[26:27], v233 offset:10848
    s_add_u32 s35, s35, s36
    v_mfma_f32_16x16x32_bf16 v[120:123], a[28:31], a[96:99], v[120:123]
    s_add_u32 s35, s35, 0x1a00000
    s_add_u32 s16, s82, s35
    s_addc_u32 s17, s83, 0
    v_mfma_f32_16x16x32_bf16 v[124:127], a[28:31], a[100:103], v[124:127]
    ds_read_b64_tr_b16 a[28:29], v233 offset:21600
    s_waitcnt lgkmcnt(15)
    v_mfma_f32_16x16x32_bf16 v[128:131], a[32:35], a[88:91], v[128:131]
    s_mov_b32 s18, 0x70000
    s_mov_b32 s19, 0x20000
    v_mfma_f32_16x16x32_bf16 v[132:135], a[32:35], a[92:95], v[132:135]
    ds_read_b64_tr_b16 a[30:31], v233 offset:25184
    s_and_b32 s34, s32, 1
    v_mfma_f32_16x16x32_bf16 v[136:139], a[32:35], a[96:99], v[136:139]
    buffer_load_dwordx4 a[76:79], v254, s[12:15], s42 offen offset:1024 sc1
    s_lshl_b32 s54, s34, 18
    v_mfma_f32_16x16x32_bf16 v[140:143], a[32:35], a[100:103], v[140:143]
    ds_read_b64_tr_b16 a[32:33], v233 offset:7296
    s_lshl_b32 s55, s34, 9
    v_mfma_f32_16x16x32_bf16 v[144:147], a[36:39], a[88:91], v[144:147]
    s_add_u32 s55, s55, 0x30000
    s_lshl_b32 s35, s31, 2
    v_mfma_f32_16x16x32_bf16 v[148:151], a[36:39], a[92:95], v[148:151]
    ds_read_b64_tr_b16 a[34:35], v233 offset:10880
    s_add_u32 s35, s35, 64
    v_mfma_f32_16x16x32_bf16 v[152:155], a[36:39], a[96:99], v[152:155]
    s_mul_i32 s56, s35, 4352
    v_accvgpr_read_b32 v236, a120
    v_mfma_f32_16x16x32_bf16 v[156:159], a[36:39], a[100:103], v[156:159]
    ds_read_b64_tr_b16 a[36:37], v233 offset:21632
    v_accvgpr_read_b32 v237, a121
    v_mfma_f32_16x16x32_bf16 v[160:163], a[40:43], a[88:91], v[160:163]
    v_accvgpr_read_b32 v238, a122
    v_accvgpr_read_b32 v239, a123
    v_mfma_f32_16x16x32_bf16 v[164:167], a[40:43], a[92:95], v[164:167]
    ds_read_b64_tr_b16 a[38:39], v233 offset:25216
    v_add_f32 v236, v236, v238
    v_mfma_f32_16x16x32_bf16 v[168:171], a[40:43], a[96:99], v[168:171]
    v_add_f32 v237, v237, v239
    v_accvgpr_read_b32 v238, a124
    v_mfma_f32_16x16x32_bf16 v[172:175], a[40:43], a[100:103], v[172:175]
    ds_read_b64_tr_b16 a[40:41], v233 offset:7328
    v_accvgpr_read_b32 v239, a125
    v_mfma_f32_16x16x32_bf16 v[176:179], a[44:47], a[88:91], v[176:179]
    v_add_f32 v236, v236, v238
    v_add_f32 v237, v237, v239
    v_mfma_f32_16x16x32_bf16 v[180:183], a[44:47], a[92:95], v[180:183]
    ds_read_b64_tr_b16 a[42:43], v233 offset:10912
    v_accvgpr_read_b32 v238, a126
    v_mfma_f32_16x16x32_bf16 v[184:187], a[44:47], a[96:99], v[184:187]
    v_accvgpr_read_b32 v239, a127
    v_add_f32 v236, v236, v238
    v_mfma_f32_16x16x32_bf16 v[188:191], a[44:47], a[100:103], v[188:191]
    ds_read_b64_tr_b16 a[44:45], v233 offset:21664
    v_mfma_f32_16x16x32_bf16 v[192:195], a[48:51], a[88:91], v[192:195]
    s_add_u32 s46, s46, 28672
    s_cmp_ge_u32 s46, 155648
    s_cselect_b32 s46, 40960, s46
    v_mfma_f32_16x16x32_bf16 v[196:199], a[48:51], a[92:95], v[196:199]
    ds_read_b64_tr_b16 a[46:47], v233 offset:25248
    v_add_f32 v237, v237, v239
    v_mfma_f32_16x16x32_bf16 v[200:203], a[48:51], a[96:99], v[200:203]
    v_accvgpr_read_b32 v238, a128
    v_accvgpr_read_b32 v239, a129
    v_mfma_f32_16x16x32_bf16 v[204:207], a[48:51], a[100:103], v[204:207]
    ds_read_b64_tr_b16 a[48:49], v234 offset:7168
    v_add_f32 v236, v236, v238
    v_mfma_f32_16x16x32_bf16 v[208:211], a[52:55], a[88:91], v[208:211]
    v_add_f32 v237, v237, v239
    v_accvgpr_read_b32 v238, a130
    v_mfma_f32_16x16x32_bf16 v[212:215], a[52:55], a[92:95], v[212:215]
    ds_read_b64_tr_b16 a[50:51], v234 offset:10752
    v_accvgpr_read_b32 v239, a131
    v_mfma_f32_16x16x32_bf16 v[216:219], a[52:55], a[96:99], v[216:219]
    v_add_f32 v236, v236, v238
    v_add_f32 v237, v237, v239
    v_mfma_f32_16x16x32_bf16 v[220:223], a[52:55], a[100:103], v[220:223]
    ds_read_b64_tr_b16 a[52:53], v234 offset:21504
    s_waitcnt vmcnt(13) lgkmcnt(15)
    v_mfma_f32_16x16x32_bf16 v[0:3], a[0:3], a[104:107], v[0:3]
    ds_read_b64_tr_b16 a[54:55], v234 offset:25088
    v_accvgpr_read_b32 v238, a132
    v_accvgpr_read_b32 v239, a133
    v_add_f32 v236, v236, v238
    v_add_f32 v237, v237, v239
    v_accvgpr_read_b32 v238, a134
    v_accvgpr_read_b32 v239, a135
    v_add_f32 v236, v236, v238
    v_add_f32 v237, v237, v239
    v_add_f32 v236, v236, v237
    v_mov_b32 v237, 0x3727c5ac
    v_fmac_f32 v237, 0x3a800000, v236
    v_rsq_f32 v236, v237
    v_and_b32 v237, 15, v255
    v_lshlrev_b32 v237, 2, v237
    v_mul_f32 v236, 0xbfb8aa3b, v236
    ds_bpermute_b32 v240, v237, v236 offset:0
    ds_bpermute_b32 v241, v237, v236 offset:64
    ds_bpermute_b32 v242, v237, v236 offset:128
    ds_bpermute_b32 v243, v237, v236 offset:192
    v_add_u32 v233, s46, v231
    v_mfma_f32_16x16x32_bf16 v[4:7], a[0:3], a[108:111], v[4:7]
    v_add_u32 v234, s46, v232
    v_mfma_f32_16x16x32_bf16 v[8:11], a[0:3], a[112:115], v[8:11]
    s_barrier
    v_mfma_f32_16x16x32_bf16 v[12:15], a[0:3], a[116:119], v[12:15]
    v_add_u32 v224, 40960, v231
    v_mfma_f32_16x16x32_bf16 v[16:19], a[4:7], a[104:107], v[16:19]
    v_add_u32 v225, 40960, v232
    buffer_load_dwordx4 a[80:83], v254, s[12:15], s42 offen offset:2048 sc1
    v_mfma_f32_16x16x32_bf16 v[20:23], a[4:7], a[108:111], v[20:23]
    v_mfma_f32_16x16x32_bf16 v[24:27], a[4:7], a[112:115], v[24:27]
    v_mfma_f32_16x16x32_bf16 v[28:31], a[4:7], a[116:119], v[28:31]
    v_mfma_f32_16x16x32_bf16 v[32:35], a[8:11], a[104:107], v[32:35]
    v_mfma_f32_16x16x32_bf16 v[36:39], a[8:11], a[108:111], v[36:39]
    v_mfma_f32_16x16x32_bf16 v[40:43], a[8:11], a[112:115], v[40:43]
    buffer_load_dwordx4 a[84:87], v254, s[12:15], s42 offen offset:3072 sc1
    v_readlane_b32 s3, v235, s49
    v_mfma_f32_16x16x32_bf16 v[44:47], a[8:11], a[116:119], v[44:47]
    s_mul_i32 s42, s3, 131072
    s_add_u32 s49, s49, 1
    v_mfma_f32_16x16x32_bf16 v[48:51], a[12:15], a[104:107], v[48:51]
    v_mfma_f32_16x16x32_bf16 v[52:55], a[12:15], a[108:111], v[52:55]
    v_mfma_f32_16x16x32_bf16 v[56:59], a[12:15], a[112:115], v[56:59]
    v_mfma_f32_16x16x32_bf16 v[60:63], a[12:15], a[116:119], v[60:63]
    s_waitcnt lgkmcnt(15)
    v_mfma_f32_16x16x32_bf16 v[64:67], a[16:19], a[104:107], v[64:67]
    buffer_load_dwordx4 a[88:91], v254, s[12:15], s42 offen offset:0 sc1
    v_mfma_f32_16x16x32_bf16 v[68:71], a[16:19], a[108:111], v[68:71]
    v_mfma_f32_16x16x32_bf16 v[72:75], a[16:19], a[112:115], v[72:75]
    v_mfma_f32_16x16x32_bf16 v[76:79], a[16:19], a[116:119], v[76:79]
    v_mfma_f32_16x16x32_bf16 v[80:83], a[20:23], a[104:107], v[80:83]
    v_mfma_f32_16x16x32_bf16 v[84:87], a[20:23], a[108:111], v[84:87]
    v_mfma_f32_16x16x32_bf16 v[88:91], a[20:23], a[112:115], v[88:91]
    buffer_load_dwordx4 a[92:95], v254, s[12:15], s42 offen offset:1024 sc1
    v_mfma_f32_16x16x32_bf16 v[92:95], a[20:23], a[116:119], v[92:95]
    v_mfma_f32_16x16x32_bf16 v[96:99], a[24:27], a[104:107], v[96:99]
    v_mfma_f32_16x16x32_bf16 v[100:103], a[24:27], a[108:111], v[100:103]
    v_mfma_f32_16x16x32_bf16 v[104:107], a[24:27], a[112:115], v[104:107]
    v_mfma_f32_16x16x32_bf16 v[108:111], a[24:27], a[116:119], v[108:111]
    v_mfma_f32_16x16x32_bf16 v[112:115], a[28:31], a[104:107], v[112:115]
    buffer_load_dwordx4 a[96:99], v254, s[12:15], s42 offen offset:2048 sc1
    v_mfma_f32_16x16x32_bf16 v[116:119], a[28:31], a[108:111], v[116:119]
    v_mfma_f32_16x16x32_bf16 v[120:123], a[28:31], a[112:115], v[120:123]
    v_mfma_f32_16x16x32_bf16 v[124:127], a[28:31], a[116:119], v[124:127]
    s_waitcnt lgkmcnt(8)
    v_mfma_f32_16x16x32_bf16 v[128:131], a[32:35], a[104:107], v[128:131]
    v_mfma_f32_16x16x32_bf16 v[132:135], a[32:35], a[108:111], v[132:135]
    v_mfma_f32_16x16x32_bf16 v[136:139], a[32:35], a[112:115], v[136:139]
    buffer_load_dwordx4 a[100:103], v254, s[12:15], s42 offen offset:3072 sc1
    s_add_u32 s42, s42, 0x40000
    v_mfma_f32_16x16x32_bf16 v[140:143], a[32:35], a[116:119], v[140:143]
    v_mfma_f32_16x16x32_bf16 v[144:147], a[36:39], a[104:107], v[144:147]
    s_waitcnt vmcnt(9)
    s_barrier
    v_mfma_f32_16x16x32_bf16 v[148:151], a[36:39], a[108:111], v[148:151]
    ds_read_b64_tr_b16 a[136:137], v233 offset:0
    v_mfma_f32_16x16x32_bf16 v[152:155], a[36:39], a[112:115], v[152:155]
    ds_read_b64_tr_b16 a[138:139], v233 offset:3584
    v_mfma_f32_16x16x32_bf16 v[156:159], a[36:39], a[116:119], v[156:159]
    ds_read_b64_tr_b16 a[140:141], v233 offset:7168
    v_mfma_f32_16x16x32_bf16 v[160:163], a[40:43], a[104:107], v[160:163]
    ds_read_b64_tr_b16 a[142:143], v233 offset:10752
    v_mfma_f32_16x16x32_bf16 v[164:167], a[40:43], a[108:111], v[164:167]
    ds_read_b64_tr_b16 a[144:145], v224 offset:0
    v_mfma_f32_16x16x32_bf16 v[168:171], a[40:43], a[112:115], v[168:171]
    ds_read_b64_tr_b16 a[146:147], v224 offset:3584
    v_mfma_f32_16x16x32_bf16 v[172:175], a[40:43], a[116:119], v[172:175]
    ds_read_b64_tr_b16 a[148:149], v224 offset:7168
    v_mfma_f32_16x16x32_bf16 v[176:179], a[44:47], a[104:107], v[176:179]
    ds_read_b64_tr_b16 a[150:151], v224 offset:10752
    v_mfma_f32_16x16x32_bf16 v[180:183], a[44:47], a[108:111], v[180:183]
    ds_read_b64_tr_b16 a[152:153], v233 offset:14336
    v_mfma_f32_16x16x32_bf16 v[184:187], a[44:47], a[112:115], v[184:187]
    ds_read_b64_tr_b16 a[154:155], v233 offset:17920
    v_mfma_f32_16x16x32_bf16 v[188:191], a[44:47], a[116:119], v[188:191]
    ds_read_b64_tr_b16 a[156:157], v233 offset:21504
    s_waitcnt lgkmcnt(15)
    v_mfma_f32_16x16x32_bf16 v[192:195], a[48:51], a[104:107], v[192:195]
    ds_read_b64_tr_b16 a[158:159], v233 offset:25088
    v_mfma_f32_16x16x32_bf16 v[196:199], a[48:51], a[108:111], v[196:199]
    ds_read_b64_tr_b16 a[160:161], v224 offset:14336
    v_mfma_f32_16x16x32_bf16 v[200:203], a[48:51], a[112:115], v[200:203]
    ds_read_b64_tr_b16 a[162:163], v224 offset:17920
    v_mfma_f32_16x16x32_bf16 v[204:207], a[48:51], a[116:119], v[204:207]
    ds_read_b64_tr_b16 a[164:165], v224 offset:21504
    v_mfma_f32_16x16x32_bf16 v[208:211], a[52:55], a[104:107], v[208:211]
    ds_read_b64_tr_b16 a[166:167], v224 offset:25088
    v_mfma_f32_16x16x32_bf16 v[212:215], a[52:55], a[108:111], v[212:215]
    ds_read_b64_tr_b16 a[168:169], v233 offset:32
    v_mfma_f32_16x16x32_bf16 v[216:219], a[52:55], a[112:115], v[216:219]
    ds_read_b64_tr_b16 a[170:171], v233 offset:3616
    v_mfma_f32_16x16x32_bf16 v[220:223], a[52:55], a[116:119], v[220:223]
    ds_read_b64_tr_b16 a[172:173], v233 offset:7200
    s_mov_b32 s36, 1.0
    s_mov_b32 s37, 1.0
    buffer_load_dwordx4 a[104:107], v254, s[12:15], s42 offen offset:0 sc1
    buffer_load_dwordx4 a[108:111], v254, s[12:15], s42 offen offset:1024 sc1
    buffer_load_dwordx4 a[112:115], v254, s[12:15], s42 offen offset:2048 sc1
    buffer_load_dwordx4 a[116:119], v254, s[12:15], s42 offen offset:3072 sc1
    v_readlane_b32 s3, v235, s49
    s_nop 0
    s_mul_i32 s42, s3, 131072
    s_add_u32 s49, s49, 1
    s_waitcnt lgkmcnt(15)
    v_mfma_f32_16x16x32_bf16 v[0:3], a[136:139], a[56:59], v[0:3]
    ds_read_b64_tr_b16 a[174:175], v233 offset:10784
    v_mfma_f32_16x16x32_bf16 v[4:7], a[136:139], a[60:63], v[4:7]
    s_add_u32 m0, s40, 0
    s_nop 0
    buffer_load_dwordx4 v247, s[8:11], s64 offen offset:0 lds
    v_mfma_f32_16x16x32_bf16 v[8:11], a[136:139], a[64:67], v[8:11]
    ds_read_b64_tr_b16 a[176:177], v224 offset:32
    s_waitcnt vmcnt(13)
    v_mfma_f32_16x16x32_bf16 v[12:15], a[136:139], a[68:71], v[12:15]
    s_waitcnt vmcnt(12)
    v_mfma_f32_16x16x32_bf16 v[0:3], a[140:143], a[72:75], v[0:3]
    ds_read_b64_tr_b16 a[178:179], v224 offset:3616
    s_waitcnt vmcnt(11)
    v_mfma_f32_16x16x32_bf16 v[4:7], a[140:143], a[76:79], v[4:7]
    buffer_load_dwordx4 v245, s[8:11], s64 offen offset:1024 lds
    s_waitcnt vmcnt(11)
    v_mfma_f32_16x16x32_bf16 v[8:11], a[140:143], a[80:83], v[8:11]
    ds_read_b64_tr_b16 a[180:181], v224 offset:7200
    s_waitcnt vmcnt(10)
    v_mfma_f32_16x16x32_bf16 v[12:15], a[140:143], a[84:87], v[12:15]
    s_waitcnt lgkmcnt(15)
    s_waitcnt vmcnt(9)
    v_mfma_f32_16x16x32_bf16 v[0:3], a[144:147], a[88:91], v[0:3]
    ds_read_b64_tr_b16 a[182:183], v224 offset:10784
    s_waitcnt vmcnt(8)
    v_mfma_f32_16x16x32_bf16 v[4:7], a[144:147], a[92:95], v[4:7]
    s_add_u32 m0, s40, 8192
    s_nop 0
    buffer_load_dwordx4 v247, s[8:11], s65 offen offset:0 lds
    s_waitcnt vmcnt(8)
    v_mfma_f32_16x16x32_bf16 v[8:11], a[144:147], a[96:99], v[8:11]
    ds_read_b64_tr_b16 a[184:185], v233 offset:14368
    s_waitcnt vmcnt(7)
    v_mfma_f32_16x16x32_bf16 v[12:15], a[144:147], a[100:103], v[12:15]
    s_waitcnt vmcnt(6)
    v_mfma_f32_16x16x32_bf16 v[0:3], a[148:151], a[104:107], v[0:3]
    ds_read_b64_tr_b16 a[186:187], v233 offset:17952
    s_waitcnt vmcnt(5)
    v_mfma_f32_16x16x32_bf16 v[4:7], a[148:151], a[108:111], v[4:7]
    buffer_load_dwordx4 v245, s[8:11], s65 offen offset:1024 lds
    s_waitcnt vmcnt(5)
    v_mfma_f32_16x16x32_bf16 v[8:11], a[148:151], a[112:115], v[8:11]
    ds_read_b64_tr_b16 a[188:189], v233 offset:21536
    s_waitcnt vmcnt(4)
    v_mfma_f32_16x16x32_bf16 v[12:15], a[148:151], a[116:119], v[12:15]
    s_waitcnt lgkmcnt(15)
    v_mfma_f32_16x16x32_bf16 v[16:19], a[152:155], a[56:59], v[16:19]
    ds_read_b64_tr_b16 a[190:191], v233 offset:25120
    v_mfma_f32_16x16x32_bf16 v[20:23], a[152:155], a[60:63], v[20:23]
    s_add_u32 m0, s40, 16384
    s_nop 0
    buffer_load_dwordx4 v247, s[8:11], s66 offen offset:0 lds
    v_mfma_f32_16x16x32_bf16 v[24:27], a[152:155], a[64:67], v[24:27]
    ds_read_b64_tr_b16 a[192:193], v224 offset:14368
    v_mfma_f32_16x16x32_bf16 v[28:31], a[152:155], a[68:71], v[28:31]
    v_mfma_f32_16x16x32_bf16 v[16:19], a[156:159], a[72:75], v[16:19]
    ds_read_b64_tr_b16 a[194:195], v224 offset:17952
    v_mfma_f32_16x16x32_bf16 v[20:23], a[156:159], a[76:79], v[20:23]
    buffer_load_dwordx4 v245, s[8:11], s66 offen offset:1024 lds
    v_mfma_f32_16x16x32_bf16 v[24:27], a[156:159], a[80:83], v[24:27]
    ds_read_b64_tr_b16 a[196:197], v224 offset:21536
    v_mfma_f32_16x16x32_bf16 v[28:31], a[156:159], a[84:87], v[28:31]
    s_waitcnt lgkmcnt(15)
    v_mfma_f32_16x16x32_bf16 v[16:19], a[160:163], a[88:91], v[16:19]
    ds_read_b64_tr_b16 a[198:199], v224 offset:25120
    v_mfma_f32_16x16x32_bf16 v[20:23], a[160:163], a[92:95], v[20:23]
    s_add_u32 m0, s40, 24576
    s_nop 0
    buffer_load_dwordx4 v247, s[8:11], s67 offen offset:0 lds
    v_mfma_f32_16x16x32_bf16 v[24:27], a[160:163], a[96:99], v[24:27]
    ds_read_b64_tr_b16 a[200:201], v233 offset:64
    v_mfma_f32_16x16x32_bf16 v[28:31], a[160:163], a[100:103], v[28:31]
    v_mfma_f32_16x16x32_bf16 v[16:19], a[164:167], a[104:107], v[16:19]
    ds_read_b64_tr_b16 a[202:203], v233 offset:3648
    v_mfma_f32_16x16x32_bf16 v[20:23], a[164:167], a[108:111], v[20:23]
    buffer_load_dwordx4 v245, s[8:11], s67 offen offset:1024 lds
    v_mfma_f32_16x16x32_bf16 v[24:27], a[164:167], a[112:115], v[24:27]
    ds_read_b64_tr_b16 a[204:205], v233 offset:7232
    v_mfma_f32_16x16x32_bf16 v[28:31], a[164:167], a[116:119], v[28:31]
    v_pk_mul_f32 v[0:1], v[0:1], v[240:241] op_sel:[0,0] op_sel_hi:[1,0]
    v_pk_mul_f32 v[2:3], v[2:3], v[240:241] op_sel:[0,0] op_sel_hi:[1,0]
    v_pk_mul_f32 v[4:5], v[4:5], v[240:241] op_sel:[0,1] op_sel_hi:[1,1]
    v_pk_mul_f32 v[6:7], v[6:7], v[240:241] op_sel:[0,1] op_sel_hi:[1,1]
    v_pk_mul_f32 v[8:9], v[8:9], v[242:243] op_sel:[0,0] op_sel_hi:[1,0]
    v_pk_mul_f32 v[10:11], v[10:11], v[242:243] op_sel:[0,0] op_sel_hi:[1,0]
    v_pk_mul_f32 v[12:13], v[12:13], v[242:243] op_sel:[0,1] op_sel_hi:[1,1]
    v_pk_mul_f32 v[14:15], v[14:15], v[242:243] op_sel:[0,1] op_sel_hi:[1,1]
    ds_read_b64_tr_b16 a[206:207], v233 offset:10816
    ds_read_b64_tr_b16 a[208:209], v224 offset:64
    ds_read_b64_tr_b16 a[210:211], v224 offset:3648
    ds_read_b64_tr_b16 a[212:213], v224 offset:7232
    s_waitcnt lgkmcnt(15)
    v_mfma_f32_16x16x32_bf16 v[32:35], a[168:171], a[56:59], v[32:35]
    v_exp_f32 v0, v0
    v_mfma_f32_16x16x32_bf16 v[36:39], a[168:171], a[60:63], v[36:39]
    v_exp_f32 v1, v1
    v_mfma_f32_16x16x32_bf16 v[40:43], a[168:171], a[64:67], v[40:43]
    v_exp_f32 v2, v2
    v_mfma_f32_16x16x32_bf16 v[44:47], a[168:171], a[68:71], v[44:47]
    v_exp_f32 v3, v3
    v_mfma_f32_16x16x32_bf16 v[32:35], a[172:175], a[72:75], v[32:35]
    v_exp_f32 v4, v4
    v_mfma_f32_16x16x32_bf16 v[36:39], a[172:175], a[76:79], v[36:39]
    v_exp_f32 v5, v5
    v_mfma_f32_16x16x32_bf16 v[40:43], a[172:175], a[80:83], v[40:43]
    v_exp_f32 v6, v6
    v_mfma_f32_16x16x32_bf16 v[44:47], a[172:175], a[84:87], v[44:47]
    v_exp_f32 v7, v7
    v_mfma_f32_16x16x32_bf16 v[32:35], a[176:179], a[88:91], v[32:35]
    v_exp_f32 v8, v8
    v_mfma_f32_16x16x32_bf16 v[36:39], a[176:179], a[92:95], v[36:39]
    v_exp_f32 v9, v9
    v_mfma_f32_16x16x32_bf16 v[40:43], a[176:179], a[96:99], v[40:43]
    v_exp_f32 v10, v10
    v_mfma_f32_16x16x32_bf16 v[44:47], a[176:179], a[100:103], v[44:47]
    v_exp_f32 v11, v11
    v_mfma_f32_16x16x32_bf16 v[32:35], a[180:183], a[104:107], v[32:35]
    v_exp_f32 v12, v12
    v_mfma_f32_16x16x32_bf16 v[36:39], a[180:183], a[108:111], v[36:39]
    v_exp_f32 v13, v13
    v_mfma_f32_16x16x32_bf16 v[40:43], a[180:183], a[112:115], v[40:43]
    v_exp_f32 v14, v14
    v_mfma_f32_16x16x32_bf16 v[44:47], a[180:183], a[116:119], v[44:47]
    v_exp_f32 v15, v15
    v_pk_add_f32 v[0:1], v[0:1], s[36:37]
    v_pk_add_f32 v[2:3], v[2:3], s[36:37]
    v_pk_add_f32 v[4:5], v[4:5], s[36:37]
    v_pk_add_f32 v[6:7], v[6:7], s[36:37]
    v_pk_add_f32 v[8:9], v[8:9], s[36:37]
    v_pk_add_f32 v[10:11], v[10:11], s[36:37]
    v_pk_add_f32 v[12:13], v[12:13], s[36:37]
    v_pk_add_f32 v[14:15], v[14:15], s[36:37]
    ds_read_b64_tr_b16 a[214:215], v224 offset:10816
    ds_read_b64_tr_b16 a[136:137], v233 offset:14400
    ds_read_b64_tr_b16 a[138:139], v233 offset:17984
    ds_read_b64_tr_b16 a[140:141], v233 offset:21568
    s_waitcnt lgkmcnt(15)
    v_mfma_f32_16x16x32_bf16 v[48:51], a[184:187], a[56:59], v[48:51]
    v_rcp_f32 v0, v0
    v_mfma_f32_16x16x32_bf16 v[52:55], a[184:187], a[60:63], v[52:55]
    v_rcp_f32 v1, v1
    v_mfma_f32_16x16x32_bf16 v[56:59], a[184:187], a[64:67], v[56:59]
    v_rcp_f32 v2, v2
    v_mfma_f32_16x16x32_bf16 v[60:63], a[184:187], a[68:71], v[60:63]
    v_rcp_f32 v3, v3
    v_mfma_f32_16x16x32_bf16 v[48:51], a[188:191], a[72:75], v[48:51]
    v_rcp_f32 v4, v4
    v_mfma_f32_16x16x32_bf16 v[52:55], a[188:191], a[76:79], v[52:55]
    v_rcp_f32 v5, v5
    v_mfma_f32_16x16x32_bf16 v[56:59], a[188:191], a[80:83], v[56:59]
    v_rcp_f32 v6, v6
    v_mfma_f32_16x16x32_bf16 v[60:63], a[188:191], a[84:87], v[60:63]
    v_rcp_f32 v7, v7
    s_waitcnt lgkmcnt(11)
    v_mfma_f32_16x16x32_bf16 v[48:51], a[192:195], a[88:91], v[48:51]
    v_rcp_f32 v8, v8
    v_mfma_f32_16x16x32_bf16 v[52:55], a[192:195], a[92:95], v[52:55]
    v_rcp_f32 v9, v9
    v_mfma_f32_16x16x32_bf16 v[56:59], a[192:195], a[96:99], v[56:59]
    v_rcp_f32 v10, v10
    v_mfma_f32_16x16x32_bf16 v[60:63], a[192:195], a[100:103], v[60:63]
    v_rcp_f32 v11, v11
    v_mfma_f32_16x16x32_bf16 v[48:51], a[196:199], a[104:107], v[48:51]
    v_rcp_f32 v12, v12
    v_mfma_f32_16x16x32_bf16 v[52:55], a[196:199], a[108:111], v[52:55]
    v_rcp_f32 v13, v13
    v_mfma_f32_16x16x32_bf16 v[56:59], a[196:199], a[112:115], v[56:59]
    v_rcp_f32 v14, v14
    v_mfma_f32_16x16x32_bf16 v[60:63], a[196:199], a[116:119], v[60:63]
    v_rcp_f32 v15, v15
    v_pk_mul_f32 v[16:17], v[16:17], v[0:1]
    v_pk_mul_f32 v[18:19], v[18:19], v[2:3]
    v_pk_mul_f32 v[20:21], v[20:21], v[4:5]
    v_pk_mul_f32 v[22:23], v[22:23], v[6:7]
    v_pk_mul_f32 v[24:25], v[24:25], v[8:9]
    v_pk_mul_f32 v[26:27], v[26:27], v[10:11]
    v_pk_mul_f32 v[28:29], v[28:29], v[12:13]
    v_pk_mul_f32 v[30:31], v[30:31], v[14:15]
    v_cvt_pk_bf16_f32 v0, v16, v17
    ds_read_b64_tr_b16 a[142:143], v233 offset:25152
    v_cvt_pk_bf16_f32 v1, v18, v19
    v_cvt_pk_bf16_f32 v4, v20, v21
    ds_read_b64_tr_b16 a[144:145], v224 offset:14400
    v_cvt_pk_bf16_f32 v5, v22, v23
    v_cvt_pk_bf16_f32 v8, v24, v25
    ds_read_b64_tr_b16 a[146:147], v224 offset:17984
    v_cvt_pk_bf16_f32 v9, v26, v27
    v_cvt_pk_bf16_f32 v12, v28, v29
    ds_read_b64_tr_b16 a[148:149], v224 offset:21568
    v_cvt_pk_bf16_f32 v13, v30, v31
    v_bfe_u32 v226, v255, 4, 1
    ds_read_b64_tr_b16 a[150:151], v224 offset:25152
    v_lshlrev_b32 v226, 10, v226
    v_lshrrev_b32 v227, 5, v255
    ds_read_b64_tr_b16 a[152:153], v233 offset:96
    v_lshl_add_u32 v226, v227, 8, v226
    v_and_b32 v227, 15, v255
    ds_read_b64_tr_b16 a[154:155], v233 offset:3680
    v_lshl_add_u32 v226, v227, 4, v226
    v_pk_mul_f32 v[32:33], v[32:33], v[240:241] op_sel:[0,0] op_sel_hi:[1,0]
    v_pk_mul_f32 v[34:35], v[34:35], v[240:241] op_sel:[0,0] op_sel_hi:[1,0]
    v_pk_mul_f32 v[36:37], v[36:37], v[240:241] op_sel:[0,1] op_sel_hi:[1,1]
    v_pk_mul_f32 v[38:39], v[38:39], v[240:241] op_sel:[0,1] op_sel_hi:[1,1]
    v_pk_mul_f32 v[40:41], v[40:41], v[242:243] op_sel:[0,0] op_sel_hi:[1,0]
    v_pk_mul_f32 v[42:43], v[42:43], v[242:243] op_sel:[0,0] op_sel_hi:[1,0]
    v_pk_mul_f32 v[44:45], v[44:45], v[242:243] op_sel:[0,1] op_sel_hi:[1,1]
    v_pk_mul_f32 v[46:47], v[46:47], v[242:243] op_sel:[0,1] op_sel_hi:[1,1]
    ds_read_b64_tr_b16 a[156:157], v233 offset:7264
    ds_read_b64_tr_b16 a[158:159], v233 offset:10848
    ds_read_b64_tr_b16 a[160:161], v224 offset:96
    ds_read_b64_tr_b16 a[162:163], v224 offset:3680
    s_waitcnt lgkmcnt(15)
    v_mfma_f32_16x16x32_bf16 v[64:67], a[200:203], a[56:59], v[64:67]
    v_exp_f32 v32, v32
    v_mfma_f32_16x16x32_bf16 v[68:71], a[200:203], a[60:63], v[68:71]
    v_exp_f32 v33, v33
    v_mfma_f32_16x16x32_bf16 v[72:75], a[200:203], a[64:67], v[72:75]
    v_exp_f32 v34, v34
    v_mfma_f32_16x16x32_bf16 v[76:79], a[200:203], a[68:71], v[76:79]
    v_exp_f32 v35, v35
    v_mfma_f32_16x16x32_bf16 v[64:67], a[204:207], a[72:75], v[64:67]
    v_exp_f32 v36, v36
    v_mfma_f32_16x16x32_bf16 v[68:71], a[204:207], a[76:79], v[68:71]
    v_exp_f32 v37, v37
    v_mfma_f32_16x16x32_bf16 v[72:75], a[204:207], a[80:83], v[72:75]
    v_exp_f32 v38, v38
    v_mfma_f32_16x16x32_bf16 v[76:79], a[204:207], a[84:87], v[76:79]
    v_exp_f32 v39, v39
    s_waitcnt lgkmcnt(14)
    v_mfma_f32_16x16x32_bf16 v[64:67], a[208:211], a[88:91], v[64:67]
    v_exp_f32 v40, v40
    v_mfma_f32_16x16x32_bf16 v[68:71], a[208:211], a[92:95], v[68:71]
    v_exp_f32 v41, v41
    v_mfma_f32_16x16x32_bf16 v[72:75], a[208:211], a[96:99], v[72:75]
    v_exp_f32 v42, v42
    v_mfma_f32_16x16x32_bf16 v[76:79], a[208:211], a[100:103], v[76:79]
    v_exp_f32 v43, v43
    v_mfma_f32_16x16x32_bf16 v[64:67], a[212:215], a[104:107], v[64:67]
    v_exp_f32 v44, v44
    v_mfma_f32_16x16x32_bf16 v[68:71], a[212:215], a[108:111], v[68:71]
    v_exp_f32 v45, v45
    v_mfma_f32_16x16x32_bf16 v[72:75], a[212:215], a[112:115], v[72:75]
    v_exp_f32 v46, v46
    v_mfma_f32_16x16x32_bf16 v[76:79], a[212:215], a[116:119], v[76:79]
    v_exp_f32 v47, v47
    v_pk_add_f32 v[32:33], v[32:33], s[36:37]
    v_pk_add_f32 v[34:35], v[34:35], s[36:37]
    v_pk_add_f32 v[36:37], v[36:37], s[36:37]
    v_pk_add_f32 v[38:39], v[38:39], s[36:37]
    v_pk_add_f32 v[40:41], v[40:41], s[36:37]
    v_pk_add_f32 v[42:43], v[42:43], s[36:37]
    v_pk_add_f32 v[44:45], v[44:45], s[36:37]
    v_pk_add_f32 v[46:47], v[46:47], s[36:37]
    ds_read_b64_tr_b16 a[164:165], v224 offset:7264
    ds_read_b64_tr_b16 a[166:167], v224 offset:10848
    ds_read_b64_tr_b16 a[168:169], v233 offset:14432
    ds_read_b64_tr_b16 a[170:171], v233 offset:18016
    s_waitcnt lgkmcnt(14)
    v_mfma_f32_16x16x32_bf16 v[80:83], a[136:139], a[56:59], v[80:83]
    v_rcp_f32 v32, v32
    v_mfma_f32_16x16x32_bf16 v[84:87], a[136:139], a[60:63], v[84:87]
    v_rcp_f32 v33, v33
    v_mfma_f32_16x16x32_bf16 v[88:91], a[136:139], a[64:67], v[88:91]
    v_rcp_f32 v34, v34
    v_mfma_f32_16x16x32_bf16 v[92:95], a[136:139], a[68:71], v[92:95]
    v_rcp_f32 v35, v35
    v_mfma_f32_16x16x32_bf16 v[80:83], a[140:143], a[72:75], v[80:83]
    v_rcp_f32 v36, v36
    v_mfma_f32_16x16x32_bf16 v[84:87], a[140:143], a[76:79], v[84:87]
    v_rcp_f32 v37, v37
    v_mfma_f32_16x16x32_bf16 v[88:91], a[140:143], a[80:83], v[88:91]
    v_rcp_f32 v38, v38
    v_mfma_f32_16x16x32_bf16 v[92:95], a[140:143], a[84:87], v[92:95]
    v_rcp_f32 v39, v39
    s_waitcnt lgkmcnt(10)
    v_mfma_f32_16x16x32_bf16 v[80:83], a[144:147], a[88:91], v[80:83]
    v_rcp_f32 v40, v40
    v_mfma_f32_16x16x32_bf16 v[84:87], a[144:147], a[92:95], v[84:87]
    v_rcp_f32 v41, v41
    v_mfma_f32_16x16x32_bf16 v[88:91], a[144:147], a[96:99], v[88:91]
    v_rcp_f32 v42, v42
    v_mfma_f32_16x16x32_bf16 v[92:95], a[144:147], a[100:103], v[92:95]
    v_rcp_f32 v43, v43
    v_mfma_f32_16x16x32_bf16 v[80:83], a[148:151], a[104:107], v[80:83]
    v_rcp_f32 v44, v44
    v_mfma_f32_16x16x32_bf16 v[84:87], a[148:151], a[108:111], v[84:87]
    v_rcp_f32 v45, v45
    v_mfma_f32_16x16x32_bf16 v[88:91], a[148:151], a[112:115], v[88:91]
    v_rcp_f32 v46, v46
    v_mfma_f32_16x16x32_bf16 v[92:95], a[148:151], a[116:119], v[92:95]
    v_rcp_f32 v47, v47
    v_pk_mul_f32 v[48:49], v[48:49], v[32:33]
    v_pk_mul_f32 v[50:51], v[50:51], v[34:35]
    v_pk_mul_f32 v[52:53], v[52:53], v[36:37]
    v_pk_mul_f32 v[54:55], v[54:55], v[38:39]
    v_pk_mul_f32 v[56:57], v[56:57], v[40:41]
    v_pk_mul_f32 v[58:59], v[58:59], v[42:43]
    v_pk_mul_f32 v[60:61], v[60:61], v[44:45]
    v_pk_mul_f32 v[62:63], v[62:63], v[46:47]
    v_cvt_pk_bf16_f32 v2, v48, v49
    ds_read_b64_tr_b16 a[172:173], v233 offset:21600
    v_cvt_pk_bf16_f32 v3, v50, v51
    v_cvt_pk_bf16_f32 v6, v52, v53
    ds_read_b64_tr_b16 a[174:175], v233 offset:25184
    v_cvt_pk_bf16_f32 v7, v54, v55
    buffer_store_dwordx4 v[0:3], v254, s[16:19], s54 offen offset:0 sc1
    ds_read_b64_tr_b16 a[176:177], v224 offset:14432
    buffer_store_dwordx4 v[4:7], v254, s[16:19], s54 offen offset:1024 sc1
    v_cvt_pk_bf16_f32 v10, v56, v57
    ds_read_b64_tr_b16 a[178:179], v224 offset:18016
    v_cvt_pk_bf16_f32 v11, v58, v59
    v_cvt_pk_bf16_f32 v14, v60, v61
    ds_read_b64_tr_b16 a[180:181], v224 offset:21600
    v_cvt_pk_bf16_f32 v15, v62, v63
    buffer_store_dwordx4 v[8:11], v254, s[16:19], s54 offen offset:2048 sc1
    ds_read_b64_tr_b16 a[182:183], v224 offset:25184
    buffer_store_dwordx4 v[12:15], v254, s[16:19], s54 offen offset:3072 sc1
    s_add_u32 s54, s54, 0x10000
    ds_read_b64_tr_b16 a[184:185], v233 offset:128
    v_pk_mul_f32 v[64:65], v[64:65], v[240:241] op_sel:[0,0] op_sel_hi:[1,0]
    v_pk_mul_f32 v[66:67], v[66:67], v[240:241] op_sel:[0,0] op_sel_hi:[1,0]
    v_pk_mul_f32 v[68:69], v[68:69], v[240:241] op_sel:[0,1] op_sel_hi:[1,1]
    v_pk_mul_f32 v[70:71], v[70:71], v[240:241] op_sel:[0,1] op_sel_hi:[1,1]
    v_pk_mul_f32 v[72:73], v[72:73], v[242:243] op_sel:[0,0] op_sel_hi:[1,0]
    v_pk_mul_f32 v[74:75], v[74:75], v[242:243] op_sel:[0,0] op_sel_hi:[1,0]
    v_pk_mul_f32 v[76:77], v[76:77], v[242:243] op_sel:[0,1] op_sel_hi:[1,1]
    v_pk_mul_f32 v[78:79], v[78:79], v[242:243] op_sel:[0,1] op_sel_hi:[1,1]
    ds_read_b64_tr_b16 a[186:187], v233 offset:3712
    ds_read_b64_tr_b16 a[188:189], v233 offset:7296
    ds_read_b64_tr_b16 a[190:191], v233 offset:10880
    ds_read_b64_tr_b16 a[192:193], v224 offset:128
    s_waitcnt lgkmcnt(15)
    v_mfma_f32_16x16x32_bf16 v[96:99], a[152:155], a[56:59], v[96:99]
    v_exp_f32 v64, v64
    v_mfma_f32_16x16x32_bf16 v[100:103], a[152:155], a[60:63], v[100:103]
    v_exp_f32 v65, v65
    v_mfma_f32_16x16x32_bf16 v[104:107], a[152:155], a[64:67], v[104:107]
    v_exp_f32 v66, v66
    v_mfma_f32_16x16x32_bf16 v[108:111], a[152:155], a[68:71], v[108:111]
    v_exp_f32 v67, v67
    v_mfma_f32_16x16x32_bf16 v[96:99], a[156:159], a[72:75], v[96:99]
    v_exp_f32 v68, v68
    v_mfma_f32_16x16x32_bf16 v[100:103], a[156:159], a[76:79], v[100:103]
    v_exp_f32 v69, v69
    v_mfma_f32_16x16x32_bf16 v[104:107], a[156:159], a[80:83], v[104:107]
    v_exp_f32 v70, v70
    v_mfma_f32_16x16x32_bf16 v[108:111], a[156:159], a[84:87], v[108:111]
    v_exp_f32 v71, v71
    s_waitcnt lgkmcnt(13)
    v_mfma_f32_16x16x32_bf16 v[96:99], a[160:163], a[88:91], v[96:99]
    v_exp_f32 v72, v72
    v_mfma_f32_16x16x32_bf16 v[100:103], a[160:163], a[92:95], v[100:103]
    v_exp_f32 v73, v73
    v_mfma_f32_16x16x32_bf16 v[104:107], a[160:163], a[96:99], v[104:107]
    v_exp_f32 v74, v74
    v_mfma_f32_16x16x32_bf16 v[108:111], a[160:163], a[100:103], v[108:111]
    v_exp_f32 v75, v75
    v_mfma_f32_16x16x32_bf16 v[96:99], a[164:167], a[104:107], v[96:99]
    v_exp_f32 v76, v76
    v_mfma_f32_16x16x32_bf16 v[100:103], a[164:167], a[108:111], v[100:103]
    v_exp_f32 v77, v77
    v_mfma_f32_16x16x32_bf16 v[104:107], a[164:167], a[112:115], v[104:107]
    v_exp_f32 v78, v78
    v_mfma_f32_16x16x32_bf16 v[108:111], a[164:167], a[116:119], v[108:111]
    v_exp_f32 v79, v79
    v_pk_add_f32 v[64:65], v[64:65], s[36:37]
    v_pk_add_f32 v[66:67], v[66:67], s[36:37]
    v_pk_add_f32 v[68:69], v[68:69], s[36:37]
    v_pk_add_f32 v[70:71], v[70:71], s[36:37]
    v_pk_add_f32 v[72:73], v[72:73], s[36:37]
    v_pk_add_f32 v[74:75], v[74:75], s[36:37]
    v_pk_add_f32 v[76:77], v[76:77], s[36:37]
    v_pk_add_f32 v[78:79], v[78:79], s[36:37]
    ds_read_b64_tr_b16 a[194:195], v224 offset:3712
    ds_read_b64_tr_b16 a[196:197], v224 offset:7296
    ds_read_b64_tr_b16 a[198:199], v224 offset:10880
    ds_read_b64_tr_b16 a[200:201], v233 offset:14464
    s_waitcnt lgkmcnt(13)
    v_mfma_f32_16x16x32_bf16 v[112:115], a[168:171], a[56:59], v[112:115]
    v_rcp_f32 v64, v64
    v_mfma_f32_16x16x32_bf16 v[116:119], a[168:171], a[60:63], v[116:119]
    v_rcp_f32 v65, v65
    v_mfma_f32_16x16x32_bf16 v[120:123], a[168:171], a[64:67], v[120:123]
    v_rcp_f32 v66, v66
    v_mfma_f32_16x16x32_bf16 v[124:127], a[168:171], a[68:71], v[124:127]
    v_rcp_f32 v67, v67
    v_mfma_f32_16x16x32_bf16 v[112:115], a[172:175], a[72:75], v[112:115]
    v_rcp_f32 v68, v68
    v_mfma_f32_16x16x32_bf16 v[116:119], a[172:175], a[76:79], v[116:119]
    v_rcp_f32 v69, v69
    v_mfma_f32_16x16x32_bf16 v[120:123], a[172:175], a[80:83], v[120:123]
    v_rcp_f32 v70, v70
    v_mfma_f32_16x16x32_bf16 v[124:127], a[172:175], a[84:87], v[124:127]
    v_rcp_f32 v71, v71
    s_waitcnt lgkmcnt(9)
    v_mfma_f32_16x16x32_bf16 v[112:115], a[176:179], a[88:91], v[112:115]
    v_rcp_f32 v72, v72
    v_mfma_f32_16x16x32_bf16 v[116:119], a[176:179], a[92:95], v[116:119]
    v_rcp_f32 v73, v73
    v_mfma_f32_16x16x32_bf16 v[120:123], a[176:179], a[96:99], v[120:123]
    v_rcp_f32 v74, v74
    v_mfma_f32_16x16x32_bf16 v[124:127], a[176:179], a[100:103], v[124:127]
    v_rcp_f32 v75, v75
    v_mfma_f32_16x16x32_bf16 v[112:115], a[180:183], a[104:107], v[112:115]
    v_rcp_f32 v76, v76
    v_mfma_f32_16x16x32_bf16 v[116:119], a[180:183], a[108:111], v[116:119]
    v_rcp_f32 v77, v77
    v_mfma_f32_16x16x32_bf16 v[120:123], a[180:183], a[112:115], v[120:123]
    v_rcp_f32 v78, v78
    v_mfma_f32_16x16x32_bf16 v[124:127], a[180:183], a[116:119], v[124:127]
    v_rcp_f32 v79, v79
    v_pk_mul_f32 v[80:81], v[80:81], v[64:65]
    v_pk_mul_f32 v[82:83], v[82:83], v[66:67]
    v_pk_mul_f32 v[84:85], v[84:85], v[68:69]
    v_pk_mul_f32 v[86:87], v[86:87], v[70:71]
    v_pk_mul_f32 v[88:89], v[88:89], v[72:73]
    v_pk_mul_f32 v[90:91], v[90:91], v[74:75]
    v_pk_mul_f32 v[92:93], v[92:93], v[76:77]
    v_pk_mul_f32 v[94:95], v[94:95], v[78:79]
    v_cvt_pk_bf16_f32 v64, v80, v81
    ds_read_b64_tr_b16 a[202:203], v233 offset:18048
    v_cvt_pk_bf16_f32 v65, v82, v83
    v_cvt_pk_bf16_f32 v68, v84, v85
    ds_read_b64_tr_b16 a[204:205], v233 offset:21632
    v_cvt_pk_bf16_f32 v69, v86, v87
    v_cvt_pk_bf16_f32 v72, v88, v89
    ds_read_b64_tr_b16 a[206:207], v233 offset:25216
    v_cvt_pk_bf16_f32 v73, v90, v91
    v_cvt_pk_bf16_f32 v76, v92, v93
    ds_read_b64_tr_b16 a[208:209], v224 offset:14464
    v_cvt_pk_bf16_f32 v77, v94, v95
    ds_read_b64_tr_b16 a[210:211], v224 offset:18048
    ds_read_b64_tr_b16 a[212:213], v224 offset:21632
    ds_read_b64_tr_b16 a[214:215], v224 offset:25216
    s_waitcnt vmcnt(0)
    s_barrier
    s_cmp_ge_u32 s28, 1
    s_cbranch_scc1 L_sig36
    s_mov_b64 exec, 1
    buffer_atomic_add v253, v252, s[20:23], s56 offen sc1
    s_mov_b64 exec, -1
L_sig36:
    v_pk_mul_f32 v[96:97], v[96:97], v[240:241] op_sel:[0,0] op_sel_hi:[1,0]
    v_pk_mul_f32 v[98:99], v[98:99], v[240:241] op_sel:[0,0] op_sel_hi:[1,0]
    v_pk_mul_f32 v[100:101], v[100:101], v[240:241] op_sel:[0,1] op_sel_hi:[1,1]
    v_pk_mul_f32 v[102:103], v[102:103], v[240:241] op_sel:[0,1] op_sel_hi:[1,1]
    v_pk_mul_f32 v[104:105], v[104:105], v[242:243] op_sel:[0,0] op_sel_hi:[1,0]
    v_pk_mul_f32 v[106:107], v[106:107], v[242:243] op_sel:[0,0] op_sel_hi:[1,0]
    v_pk_mul_f32 v[108:109], v[108:109], v[242:243] op_sel:[0,1] op_sel_hi:[1,1]
    v_pk_mul_f32 v[110:111], v[110:111], v[242:243] op_sel:[0,1] op_sel_hi:[1,1]
    ds_read_b64_tr_b16 a[136:137], v233 offset:160
    ds_read_b64_tr_b16 a[138:139], v233 offset:3744
    ds_read_b64_tr_b16 a[140:141], v233 offset:7328
    ds_read_b64_tr_b16 a[142:143], v233 offset:10912
    s_waitcnt lgkmcnt(15)
    v_mfma_f32_16x16x32_bf16 v[128:131], a[184:187], a[56:59], v[128:131]
    v_exp_f32 v96, v96
    v_mfma_f32_16x16x32_bf16 v[132:135], a[184:187], a[60:63], v[132:135]
    v_exp_f32 v97, v97
    v_mfma_f32_16x16x32_bf16 v[136:139], a[184:187], a[64:67], v[136:139]
    v_exp_f32 v98, v98
    v_mfma_f32_16x16x32_bf16 v[140:143], a[184:187], a[68:71], v[140:143]
    v_exp_f32 v99, v99
    v_mfma_f32_16x16x32_bf16 v[128:131], a[188:191], a[72:75], v[128:131]
    v_exp_f32 v100, v100
    v_mfma_f32_16x16x32_bf16 v[132:135], a[188:191], a[76:79], v[132:135]
    v_exp_f32 v101, v101
    v_mfma_f32_16x16x32_bf16 v[136:139], a[188:191], a[80:83], v[136:139]
    v_exp_f32 v102, v102
    v_mfma_f32_16x16x32_bf16 v[140:143], a[188:191], a[84:87], v[140:143]
    v_exp_f32 v103, v103
    s_waitcnt lgkmcnt(12)
    v_mfma_f32_16x16x32_bf16 v[128:131], a[192:195], a[88:91], v[128:131]
    v_exp_f32 v104, v104
    v_mfma_f32_16x16x32_bf16 v[132:135], a[192:195], a[92:95], v[132:135]
    v_exp_f32 v105, v105
    v_mfma_f32_16x16x32_bf16 v[136:139], a[192:195], a[96:99], v[136:139]
    v_exp_f32 v106, v106
    v_mfma_f32_16x16x32_bf16 v[140:143], a[192:195], a[100:103], v[140:143]
    v_exp_f32 v107, v107
    v_mfma_f32_16x16x32_bf16 v[128:131], a[196:199], a[104:107], v[128:131]
    v_exp_f32 v108, v108
    v_mfma_f32_16x16x32_bf16 v[132:135], a[196:199], a[108:111], v[132:135]
    v_exp_f32 v109, v109
    v_mfma_f32_16x16x32_bf16 v[136:139], a[196:199], a[112:115], v[136:139]
    v_exp_f32 v110, v110
    v_mfma_f32_16x16x32_bf16 v[140:143], a[196:199], a[116:119], v[140:143]
    v_exp_f32 v111, v111
    v_pk_add_f32 v[96:97], v[96:97], s[36:37]
    v_pk_add_f32 v[98:99], v[98:99], s[36:37]
    v_pk_add_f32 v[100:101], v[100:101], s[36:37]
    v_pk_add_f32 v[102:103], v[102:103], s[36:37]
    v_pk_add_f32 v[104:105], v[104:105], s[36:37]
    v_pk_add_f32 v[106:107], v[106:107], s[36:37]
    v_pk_add_f32 v[108:109], v[108:109], s[36:37]
    v_pk_add_f32 v[110:111], v[110:111], s[36:37]
    ds_read_b64_tr_b16 a[144:145], v224 offset:160
    ds_read_b64_tr_b16 a[146:147], v224 offset:3744
    ds_read_b64_tr_b16 a[148:149], v224 offset:7328
    ds_read_b64_tr_b16 a[150:151], v224 offset:10912
    s_waitcnt lgkmcnt(12)
    v_mfma_f32_16x16x32_bf16 v[144:147], a[200:203], a[56:59], v[144:147]
    v_rcp_f32 v96, v96
    v_mfma_f32_16x16x32_bf16 v[148:151], a[200:203], a[60:63], v[148:151]
    v_rcp_f32 v97, v97
    v_mfma_f32_16x16x32_bf16 v[152:155], a[200:203], a[64:67], v[152:155]
    v_rcp_f32 v98, v98
    v_mfma_f32_16x16x32_bf16 v[156:159], a[200:203], a[68:71], v[156:159]
    v_rcp_f32 v99, v99
    v_mfma_f32_16x16x32_bf16 v[144:147], a[204:207], a[72:75], v[144:147]
    v_rcp_f32 v100, v100
    v_mfma_f32_16x16x32_bf16 v[148:151], a[204:207], a[76:79], v[148:151]
    v_rcp_f32 v101, v101
    v_mfma_f32_16x16x32_bf16 v[152:155], a[204:207], a[80:83], v[152:155]
    v_rcp_f32 v102, v102
    v_mfma_f32_16x16x32_bf16 v[156:159], a[204:207], a[84:87], v[156:159]
    v_rcp_f32 v103, v103
    s_waitcnt lgkmcnt(8)
    v_mfma_f32_16x16x32_bf16 v[144:147], a[208:211], a[88:91], v[144:147]
    v_rcp_f32 v104, v104
    v_mfma_f32_16x16x32_bf16 v[148:151], a[208:211], a[92:95], v[148:151]
    v_rcp_f32 v105, v105
    v_mfma_f32_16x16x32_bf16 v[152:155], a[208:211], a[96:99], v[152:155]
    v_rcp_f32 v106, v106
    v_mfma_f32_16x16x32_bf16 v[156:159], a[208:211], a[100:103], v[156:159]
    v_rcp_f32 v107, v107
    v_mfma_f32_16x16x32_bf16 v[144:147], a[212:215], a[104:107], v[144:147]
    v_rcp_f32 v108, v108
    v_mfma_f32_16x16x32_bf16 v[148:151], a[212:215], a[108:111], v[148:151]
    v_rcp_f32 v109, v109
    v_mfma_f32_16x16x32_bf16 v[152:155], a[212:215], a[112:115], v[152:155]
    v_rcp_f32 v110, v110
    v_mfma_f32_16x16x32_bf16 v[156:159], a[212:215], a[116:119], v[156:159]
    v_rcp_f32 v111, v111
    v_pk_mul_f32 v[112:113], v[112:113], v[96:97]
    v_pk_mul_f32 v[114:115], v[114:115], v[98:99]
    v_pk_mul_f32 v[116:117], v[116:117], v[100:101]
    v_pk_mul_f32 v[118:119], v[118:119], v[102:103]
    v_pk_mul_f32 v[120:121], v[120:121], v[104:105]
    v_pk_mul_f32 v[122:123], v[122:123], v[106:107]
    v_pk_mul_f32 v[124:125], v[124:125], v[108:109]
    v_pk_mul_f32 v[126:127], v[126:127], v[110:111]
    v_cvt_pk_bf16_f32 v66, v112, v113
    ds_read_b64_tr_b16 a[152:153], v233 offset:14496
    v_cvt_pk_bf16_f32 v67, v114, v115
    v_cvt_pk_bf16_f32 v70, v116, v117
    ds_read_b64_tr_b16 a[154:155], v233 offset:18080
    v_cvt_pk_bf16_f32 v71, v118, v119
    buffer_store_dwordx4 v[64:67], v254, s[16:19], s54 offen offset:0 sc1
    ds_read_b64_tr_b16 a[156:157], v233 offset:21664
    buffer_store_dwordx4 v[68:71], v254, s[16:19], s54 offen offset:1024 sc1
    v_cvt_pk_bf16_f32 v74, v120, v121
    ds_read_b64_tr_b16 a[158:159], v233 offset:25248
    v_cvt_pk_bf16_f32 v75, v122, v123
    v_cvt_pk_bf16_f32 v78, v124, v125
    ds_read_b64_tr_b16 a[160:161], v224 offset:14496
    v_cvt_pk_bf16_f32 v79, v126, v127
    buffer_store_dwordx4 v[72:75], v254, s[16:19], s54 offen offset:2048 sc1
    ds_read_b64_tr_b16 a[162:163], v224 offset:18080
    buffer_store_dwordx4 v[76:79], v254, s[16:19], s54 offen offset:3072 sc1
    s_add_u32 s54, s54, 0x10000
    ds_read_b64_tr_b16 a[164:165], v224 offset:21664
    ds_read_b64_tr_b16 a[166:167], v224 offset:25248
    v_pk_mul_f32 v[128:129], v[128:129], v[240:241] op_sel:[0,0] op_sel_hi:[1,0]
    v_pk_mul_f32 v[130:131], v[130:131], v[240:241] op_sel:[0,0] op_sel_hi:[1,0]
    v_pk_mul_f32 v[132:133], v[132:133], v[240:241] op_sel:[0,1] op_sel_hi:[1,1]
    v_pk_mul_f32 v[134:135], v[134:135], v[240:241] op_sel:[0,1] op_sel_hi:[1,1]
    v_pk_mul_f32 v[136:137], v[136:137], v[242:243] op_sel:[0,0] op_sel_hi:[1,0]
    v_pk_mul_f32 v[138:139], v[138:139], v[242:243] op_sel:[0,0] op_sel_hi:[1,0]
    v_pk_mul_f32 v[140:141], v[140:141], v[242:243] op_sel:[0,1] op_sel_hi:[1,1]
    v_pk_mul_f32 v[142:143], v[142:143], v[242:243] op_sel:[0,1] op_sel_hi:[1,1]
    ds_read_b64_tr_b16 a[168:169], v234 offset:0
    ds_read_b64_tr_b16 a[170:171], v234 offset:3584
    ds_read_b64_tr_b16 a[172:173], v234 offset:7168
    ds_read_b64_tr_b16 a[174:175], v234 offset:10752
    s_waitcnt lgkmcnt(15)
    v_mfma_f32_16x16x32_bf16 v[160:163], a[136:139], a[56:59], v[160:163]
    v_exp_f32 v128, v128
    v_mfma_f32_16x16x32_bf16 v[164:167], a[136:139], a[60:63], v[164:167]
    v_exp_f32 v129, v129
    v_mfma_f32_16x16x32_bf16 v[168:171], a[136:139], a[64:67], v[168:171]
    v_exp_f32 v130, v130
    v_mfma_f32_16x16x32_bf16 v[172:175], a[136:139], a[68:71], v[172:175]
    v_exp_f32 v131, v131
    v_mfma_f32_16x16x32_bf16 v[160:163], a[140:143], a[72:75], v[160:163]
    v_exp_f32 v132, v132
    v_mfma_f32_16x16x32_bf16 v[164:167], a[140:143], a[76:79], v[164:167]
    v_exp_f32 v133, v133
    v_mfma_f32_16x16x32_bf16 v[168:171], a[140:143], a[80:83], v[168:171]
    v_exp_f32 v134, v134
    v_mfma_f32_16x16x32_bf16 v[172:175], a[140:143], a[84:87], v[172:175]
    v_exp_f32 v135, v135
    s_waitcnt lgkmcnt(12)
    v_mfma_f32_16x16x32_bf16 v[160:163], a[144:147], a[88:91], v[160:163]
    v_exp_f32 v136, v136
    v_mfma_f32_16x16x32_bf16 v[164:167], a[144:147], a[92:95], v[164:167]
    v_exp_f32 v137, v137
    v_mfma_f32_16x16x32_bf16 v[168:171], a[144:147], a[96:99], v[168:171]
    v_exp_f32 v138, v138
    v_mfma_f32_16x16x32_bf16 v[172:175], a[144:147], a[100:103], v[172:175]
    v_exp_f32 v139, v139
    v_mfma_f32_16x16x32_bf16 v[160:163], a[148:151], a[104:107], v[160:163]
    v_exp_f32 v140, v140
    v_mfma_f32_16x16x32_bf16 v[164:167], a[148:151], a[108:111], v[164:167]
    v_exp_f32 v141, v141
    v_mfma_f32_16x16x32_bf16 v[168:171], a[148:151], a[112:115], v[168:171]
    v_exp_f32 v142, v142
    v_mfma_f32_16x16x32_bf16 v[172:175], a[148:151], a[116:119], v[172:175]
    v_exp_f32 v143, v143
    v_pk_add_f32 v[128:129], v[128:129], s[36:37]
    v_pk_add_f32 v[130:131], v[130:131], s[36:37]
    v_pk_add_f32 v[132:133], v[132:133], s[36:37]
    v_pk_add_f32 v[134:135], v[134:135], s[36:37]
    v_pk_add_f32 v[136:137], v[136:137], s[36:37]
    v_pk_add_f32 v[138:139], v[138:139], s[36:37]
    v_pk_add_f32 v[140:141], v[140:141], s[36:37]
    v_pk_add_f32 v[142:143], v[142:143], s[36:37]
    ds_read_b64_tr_b16 a[176:177], v225 offset:0
    ds_read_b64_tr_b16 a[178:179], v225 offset:3584
    ds_read_b64_tr_b16 a[180:181], v225 offset:7168
    ds_read_b64_tr_b16 a[182:183], v225 offset:10752
    s_waitcnt lgkmcnt(12)
    v_mfma_f32_16x16x32_bf16 v[176:179], a[152:155], a[56:59], v[176:179]
    v_rcp_f32 v128, v128
    v_mfma_f32_16x16x32_bf16 v[180:183], a[152:155], a[60:63], v[180:183]
    v_rcp_f32 v129, v129
    v_mfma_f32_16x16x32_bf16 v[184:187], a[152:155], a[64:67], v[184:187]
    v_rcp_f32 v130, v130
    v_mfma_f32_16x16x32_bf16 v[188:191], a[152:155], a[68:71], v[188:191]
    v_rcp_f32 v131, v131
    v_mfma_f32_16x16x32_bf16 v[176:179], a[156:159], a[72:75], v[176:179]
    v_rcp_f32 v132, v132
    v_mfma_f32_16x16x32_bf16 v[180:183], a[156:159], a[76:79], v[180:183]
    v_rcp_f32 v133, v133
    v_mfma_f32_16x16x32_bf16 v[184:187], a[156:159], a[80:83], v[184:187]
    v_rcp_f32 v134, v134
    v_mfma_f32_16x16x32_bf16 v[188:191], a[156:159], a[84:87], v[188:191]
    v_rcp_f32 v135, v135
    s_waitcnt lgkmcnt(8)
    v_mfma_f32_16x16x32_bf16 v[176:179], a[160:163], a[88:91], v[176:179]
    v_rcp_f32 v136, v136
    v_mfma_f32_16x16x32_bf16 v[180:183], a[160:163], a[92:95], v[180:183]
    v_rcp_f32 v137, v137
    v_mfma_f32_16x16x32_bf16 v[184:187], a[160:163], a[96:99], v[184:187]
    v_rcp_f32 v138, v138
    v_mfma_f32_16x16x32_bf16 v[188:191], a[160:163], a[100:103], v[188:191]
    v_rcp_f32 v139, v139
    v_mfma_f32_16x16x32_bf16 v[176:179], a[164:167], a[104:107], v[176:179]
    v_rcp_f32 v140, v140
    v_mfma_f32_16x16x32_bf16 v[180:183], a[164:167], a[108:111], v[180:183]
    v_rcp_f32 v141, v141
    v_mfma_f32_16x16x32_bf16 v[184:187], a[164:167], a[112:115], v[184:187]
    v_rcp_f32 v142, v142
    v_mfma_f32_16x16x32_bf16 v[188:191], a[164:167], a[116:119], v[188:191]
    v_rcp_f32 v143, v143
    v_pk_mul_f32 v[144:145], v[144:145], v[128:129]
    v_pk_mul_f32 v[146:147], v[146:147], v[130:131]
    v_pk_mul_f32 v[148:149], v[148:149], v[132:133]
    v_pk_mul_f32 v[150:151], v[150:151], v[134:135]
    v_pk_mul_f32 v[152:153], v[152:153], v[136:137]
    v_pk_mul_f32 v[154:155], v[154:155], v[138:139]
    v_pk_mul_f32 v[156:157], v[156:157], v[140:141]
    v_pk_mul_f32 v[158:159], v[158:159], v[142:143]
    v_cvt_pk_bf16_f32 v128, v144, v145
    ds_read_b64_tr_b16 a[184:185], v234 offset:14336
    v_cvt_pk_bf16_f32 v129, v146, v147
    v_cvt_pk_bf16_f32 v132, v148, v149
    ds_read_b64_tr_b16 a[186:187], v234 offset:17920
    v_cvt_pk_bf16_f32 v133, v150, v151
    v_cvt_pk_bf16_f32 v136, v152, v153
    ds_read_b64_tr_b16 a[188:189], v234 offset:21504
    v_cvt_pk_bf16_f32 v137, v154, v155
    v_cvt_pk_bf16_f32 v140, v156, v157
    ds_read_b64_tr_b16 a[190:191], v234 offset:25088
    v_cvt_pk_bf16_f32 v141, v158, v159
    ds_read_b64_tr_b16 a[192:193], v225 offset:14336
    ds_read_b64_tr_b16 a[194:195], v225 offset:17920
    ds_read_b64_tr_b16 a[196:197], v225 offset:21504
    ds_read_b64_tr_b16 a[198:199], v225 offset:25088
    s_add_u32 s56, s56, 4352
    s_waitcnt vmcnt(0)
    s_barrier
    s_cmp_ge_u32 s28, 1
    s_cbranch_scc1 L_sig37
    s_mov_b64 exec, 1
    buffer_atomic_add v253, v252, s[20:23], s56 offen sc1
    s_mov_b64 exec, -1
L_sig37:
    v_pk_mul_f32 v[160:161], v[160:161], v[240:241] op_sel:[0,0] op_sel_hi:[1,0]
    v_pk_mul_f32 v[162:163], v[162:163], v[240:241] op_sel:[0,0] op_sel_hi:[1,0]
    v_pk_mul_f32 v[164:165], v[164:165], v[240:241] op_sel:[0,1] op_sel_hi:[1,1]
    v_pk_mul_f32 v[166:167], v[166:167], v[240:241] op_sel:[0,1] op_sel_hi:[1,1]
    v_pk_mul_f32 v[168:169], v[168:169], v[242:243] op_sel:[0,0] op_sel_hi:[1,0]
    v_pk_mul_f32 v[170:171], v[170:171], v[242:243] op_sel:[0,0] op_sel_hi:[1,0]
    v_pk_mul_f32 v[172:173], v[172:173], v[242:243] op_sel:[0,1] op_sel_hi:[1,1]
    v_pk_mul_f32 v[174:175], v[174:175], v[242:243] op_sel:[0,1] op_sel_hi:[1,1]
    s_waitcnt lgkmcnt(12)
    v_mfma_f32_16x16x32_bf16 v[192:195], a[168:171], a[56:59], v[192:195]
    v_exp_f32 v160, v160
    v_mfma_f32_16x16x32_bf16 v[196:199], a[168:171], a[60:63], v[196:199]
    v_exp_f32 v161, v161
    v_mfma_f32_16x16x32_bf16 v[200:203], a[168:171], a[64:67], v[200:203]
    v_exp_f32 v162, v162
    v_mfma_f32_16x16x32_bf16 v[204:207], a[168:171], a[68:71], v[204:207]
    v_exp_f32 v163, v163
    v_mfma_f32_16x16x32_bf16 v[192:195], a[172:175], a[72:75], v[192:195]
    v_exp_f32 v164, v164
    v_mfma_f32_16x16x32_bf16 v[196:199], a[172:175], a[76:79], v[196:199]
    v_exp_f32 v165, v165
    v_mfma_f32_16x16x32_bf16 v[200:203], a[172:175], a[80:83], v[200:203]
    v_exp_f32 v166, v166
    v_mfma_f32_16x16x32_bf16 v[204:207], a[172:175], a[84:87], v[204:207]
    v_exp_f32 v167, v167
    s_waitcnt lgkmcnt(8)
    v_mfma_f32_16x16x32_bf16 v[192:195], a[176:179], a[88:91], v[192:195]
    v_exp_f32 v168, v168
    v_mfma_f32_16x16x32_bf16 v[196:199], a[176:179], a[92:95], v[196:199]
    v_exp_f32 v169, v169
    v_mfma_f32_16x16x32_bf16 v[200:203], a[176:179], a[96:99], v[200:203]
    v_exp_f32 v170, v170
    v_mfma_f32_16x16x32_bf16 v[204:207], a[176:179], a[100:103], v[204:207]
    v_exp_f32 v171, v171
    v_mfma_f32_16x16x32_bf16 v[192:195], a[180:183], a[104:107], v[192:195]
    v_exp_f32 v172, v172
    v_mfma_f32_16x16x32_bf16 v[196:199], a[180:183], a[108:111], v[196:199]
    v_exp_f32 v173, v173
    v_mfma_f32_16x16x32_bf16 v[200:203], a[180:183], a[112:115], v[200:203]
    v_exp_f32 v174, v174
    v_mfma_f32_16x16x32_bf16 v[204:207], a[180:183], a[116:119], v[204:207]
    v_exp_f32 v175, v175
    v_pk_add_f32 v[160:161], v[160:161], s[36:37]
    v_pk_add_f32 v[162:163], v[162:163], s[36:37]
    v_pk_add_f32 v[164:165], v[164:165], s[36:37]
    v_pk_add_f32 v[166:167], v[166:167], s[36:37]
    v_pk_add_f32 v[168:169], v[168:169], s[36:37]
    v_pk_add_f32 v[170:171], v[170:171], s[36:37]
    v_pk_add_f32 v[172:173], v[172:173], s[36:37]
    v_pk_add_f32 v[174:175], v[174:175], s[36:37]
    s_waitcnt lgkmcnt(4)
    v_mfma_f32_16x16x32_bf16 v[208:211], a[184:187], a[56:59], v[208:211]
    v_rcp_f32 v160, v160
    v_mfma_f32_16x16x32_bf16 v[212:215], a[184:187], a[60:63], v[212:215]
    v_rcp_f32 v161, v161
    v_mfma_f32_16x16x32_bf16 v[216:219], a[184:187], a[64:67], v[216:219]
    v_rcp_f32 v162, v162
    v_mfma_f32_16x16x32_bf16 v[220:223], a[184:187], a[68:71], v[220:223]
    v_rcp_f32 v163, v163
    v_mfma_f32_16x16x32_bf16 v[208:211], a[188:191], a[72:75], v[208:211]
    v_rcp_f32 v164, v164
    v_mfma_f32_16x16x32_bf16 v[212:215], a[188:191], a[76:79], v[212:215]
    v_rcp_f32 v165, v165
    v_mfma_f32_16x16x32_bf16 v[216:219], a[188:191], a[80:83], v[216:219]
    v_rcp_f32 v166, v166
    v_mfma_f32_16x16x32_bf16 v[220:223], a[188:191], a[84:87], v[220:223]
    v_rcp_f32 v167, v167
    s_waitcnt lgkmcnt(0)
    v_mfma_f32_16x16x32_bf16 v[208:211], a[192:195], a[88:91], v[208:211]
    v_rcp_f32 v168, v168
    v_mfma_f32_16x16x32_bf16 v[212:215], a[192:195], a[92:95], v[212:215]
    v_rcp_f32 v169, v169
    v_mfma_f32_16x16x32_bf16 v[216:219], a[192:195], a[96:99], v[216:219]
    v_rcp_f32 v170, v170
    v_mfma_f32_16x16x32_bf16 v[220:223], a[192:195], a[100:103], v[220:223]
    v_rcp_f32 v171, v171
    v_mfma_f32_16x16x32_bf16 v[208:211], a[196:199], a[104:107], v[208:211]
    v_rcp_f32 v172, v172
    v_mfma_f32_16x16x32_bf16 v[212:215], a[196:199], a[108:111], v[212:215]
    v_rcp_f32 v173, v173
    v_mfma_f32_16x16x32_bf16 v[216:219], a[196:199], a[112:115], v[216:219]
    v_rcp_f32 v174, v174
    v_mfma_f32_16x16x32_bf16 v[220:223], a[196:199], a[116:119], v[220:223]
    v_rcp_f32 v175, v175
    v_pk_mul_f32 v[176:177], v[176:177], v[160:161]
    v_pk_mul_f32 v[178:179], v[178:179], v[162:163]
    v_pk_mul_f32 v[180:181], v[180:181], v[164:165]
    v_pk_mul_f32 v[182:183], v[182:183], v[166:167]
    v_pk_mul_f32 v[184:185], v[184:185], v[168:169]
    v_pk_mul_f32 v[186:187], v[186:187], v[170:171]
    v_pk_mul_f32 v[188:189], v[188:189], v[172:173]
    v_pk_mul_f32 v[190:191], v[190:191], v[174:175]
    v_cvt_pk_bf16_f32 v130, v176, v177
    v_cvt_pk_bf16_f32 v131, v178, v179
    v_cvt_pk_bf16_f32 v134, v180, v181
    v_cvt_pk_bf16_f32 v135, v182, v183
    buffer_store_dwordx4 v[128:131], v254, s[16:19], s54 offen offset:0 sc1
    buffer_store_dwordx4 v[132:135], v254, s[16:19], s54 offen offset:1024 sc1
    v_cvt_pk_bf16_f32 v138, v184, v185
    v_cvt_pk_bf16_f32 v139, v186, v187
    v_cvt_pk_bf16_f32 v142, v188, v189
    v_cvt_pk_bf16_f32 v143, v190, v191
    buffer_store_dwordx4 v[136:139], v254, s[16:19], s54 offen offset:2048 sc1
    buffer_store_dwordx4 v[140:143], v254, s[16:19], s54 offen offset:3072 sc1
    s_add_u32 s54, s54, 0x10000
    v_pk_mul_f32 v[192:193], v[192:193], v[240:241] op_sel:[0,0] op_sel_hi:[1,0]
    v_pk_mul_f32 v[194:195], v[194:195], v[240:241] op_sel:[0,0] op_sel_hi:[1,0]
    v_pk_mul_f32 v[196:197], v[196:197], v[240:241] op_sel:[0,1] op_sel_hi:[1,1]
    v_pk_mul_f32 v[198:199], v[198:199], v[240:241] op_sel:[0,1] op_sel_hi:[1,1]
    v_pk_mul_f32 v[200:201], v[200:201], v[242:243] op_sel:[0,0] op_sel_hi:[1,0]
    v_pk_mul_f32 v[202:203], v[202:203], v[242:243] op_sel:[0,0] op_sel_hi:[1,0]
    v_pk_mul_f32 v[204:205], v[204:205], v[242:243] op_sel:[0,1] op_sel_hi:[1,1]
    v_pk_mul_f32 v[206:207], v[206:207], v[242:243] op_sel:[0,1] op_sel_hi:[1,1]
    v_exp_f32 v192, v192
    v_exp_f32 v193, v193
    v_exp_f32 v194, v194
    v_exp_f32 v195, v195
    v_exp_f32 v196, v196
    v_exp_f32 v197, v197
    v_exp_f32 v198, v198
    v_exp_f32 v199, v199
    v_exp_f32 v200, v200
    v_exp_f32 v201, v201
    v_exp_f32 v202, v202
    v_exp_f32 v203, v203
    v_exp_f32 v204, v204
    v_exp_f32 v205, v205
    v_exp_f32 v206, v206
    v_exp_f32 v207, v207
    v_pk_add_f32 v[192:193], v[192:193], s[36:37]
    v_pk_add_f32 v[194:195], v[194:195], s[36:37]
    v_pk_add_f32 v[196:197], v[196:197], s[36:37]
    v_pk_add_f32 v[198:199], v[198:199], s[36:37]
    v_pk_add_f32 v[200:201], v[200:201], s[36:37]
    v_pk_add_f32 v[202:203], v[202:203], s[36:37]
    v_pk_add_f32 v[204:205], v[204:205], s[36:37]
    v_pk_add_f32 v[206:207], v[206:207], s[36:37]
    v_rcp_f32 v192, v192
    v_rcp_f32 v193, v193
    v_rcp_f32 v194, v194
    v_rcp_f32 v195, v195
    v_rcp_f32 v196, v196
    v_rcp_f32 v197, v197
    v_rcp_f32 v198, v198
    v_rcp_f32 v199, v199
    v_rcp_f32 v200, v200
    v_rcp_f32 v201, v201
    v_rcp_f32 v202, v202
    v_rcp_f32 v203, v203
    v_rcp_f32 v204, v204
    v_rcp_f32 v205, v205
    v_rcp_f32 v206, v206
    v_rcp_f32 v207, v207
    v_pk_mul_f32 v[208:209], v[208:209], v[192:193]
    v_pk_mul_f32 v[210:211], v[210:211], v[194:195]
    v_pk_mul_f32 v[212:213], v[212:213], v[196:197]
    v_pk_mul_f32 v[214:215], v[214:215], v[198:199]
    v_pk_mul_f32 v[216:217], v[216:217], v[200:201]
    v_pk_mul_f32 v[218:219], v[218:219], v[202:203]
    v_pk_mul_f32 v[220:221], v[220:221], v[204:205]
    v_pk_mul_f32 v[222:223], v[222:223], v[206:207]
    v_cvt_pk_bf16_f32 v192, v208, v209
    v_cvt_pk_bf16_f32 v193, v210, v211
    v_cvt_pk_bf16_f32 v194, v212, v213
    v_cvt_pk_bf16_f32 v195, v214, v215
    s_nop 0
    v_permlane16_swap_b32 v192, v194
    v_permlane16_swap_b32 v193, v195
    buffer_store_dwordx4 v[192:195], v226, s[16:19], s55 offen offset:0 sc1
    v_cvt_pk_bf16_f32 v200, v216, v217
    v_cvt_pk_bf16_f32 v201, v218, v219
    v_cvt_pk_bf16_f32 v202, v220, v221
    v_cvt_pk_bf16_f32 v203, v222, v223
    s_nop 0
    v_permlane16_swap_b32 v200, v202
    v_permlane16_swap_b32 v201, v203
    buffer_store_dwordx4 v[200:203], v226, s[16:19], s55 offen offset:2048 sc1
L_ph5:
    s_lshr_b32 s90, s29, 1
    s_lshl_b32 s90, s90, 2
    s_add_u32 s90, s90, 64
    s_mul_i32 s90, s90, 4352
    buffer_load_dword v237, v252, s[20:23], s90 offen sc1
    s_barrier
    ds_read_b64_tr_b16 v[96:97], v248 offset:0
    ds_read_b64_tr_b16 v[98:99], v248 offset:4096
    ds_read_b64_tr_b16 v[100:101], v249 offset:0
    ds_read_b64_tr_b16 v[102:103], v249 offset:4096
    ds_read_b64_tr_b16 v[104:105], v250 offset:0
    ds_read_b64_tr_b16 v[106:107], v250 offset:4096
    ds_read_b64_tr_b16 v[108:109], v251 offset:0
    ds_read_b64_tr_b16 v[110:111], v251 offset:4096
    ds_read_b64_tr_b16 v[112:113], v248 offset:1024
    ds_read_b64_tr_b16 v[114:115], v248 offset:5120
    ds_read_b64_tr_b16 v[116:117], v249 offset:1024
    ds_read_b64_tr_b16 v[118:119], v249 offset:5120
    ds_read_b64_tr_b16 v[120:121], v250 offset:1024
    ds_read_b64_tr_b16 v[122:123], v250 offset:5120
    ds_read_b64_tr_b16 v[124:125], v251 offset:1024
    ds_read_b64_tr_b16 v[126:127], v251 offset:5120
    s_add_u32 s43, s90, 4352
    s_add_u32 s56, s56, 4352
    s_lshl_b32 s34, s29, 13
    s_lshl_b32 s35, s28, 7
    s_add_u32 s34, s34, s35
    s_add_u32 s34, s34, 0x1800000
    s_add_u32 s12, s82, s34
    s_addc_u32 s13, s83, 0
    s_mov_b32 s14, 0x2000
    s_mov_b32 s15, 0x20000
    v_and_b32 v242, 31, v255
    v_lshlrev_b32 v242, 2, v242
    v_lshrrev_b32 v241, 5, v255
    v_lshl_add_u32 v242, v241, 12, v242
    s_waitcnt vmcnt(0)
    v_cmp_gt_u32 vcc, 32, v237
    s_cbranch_vccz L_chk38
    s_mov_b64 exec, 1
    s_mov_b32 s3, 0x40000
L_poll39:
    buffer_load_dword v237, v252, s[20:23], s90 offen sc1
    s_sub_u32 s3, s3, 1
    s_cbranch_scc1 L_poll39_y
    s_waitcnt vmcnt(0)
    v_cmp_gt_u32 vcc, 32, v237
    s_cbranch_vccz L_poll39_y
    s_sleep 1
    s_branch L_poll39
L_poll39_y:
    s_waitcnt vmcnt(0)
    s_mov_b64 exec, -1
L_poll39_x:
L_chk38:
    buffer_load_dwordx4 a[0:3], v254, s[24:27], s64 offen offset:0 sc1
    buffer_load_dwordx4 a[4:7], v254, s[24:27], s64 offen offset:1024 sc1
    buffer_load_dwordx4 a[8:11], v254, s[24:27], s65 offen offset:0 sc1
    buffer_load_dwordx4 a[12:15], v254, s[24:27], s65 offen offset:1024 sc1
    s_add_u32 m0, s40, 32768
    s_nop 0
    buffer_load_dwordx4 v247, s[8:11], s68 offen offset:0 lds
    buffer_load_dwordx4 v245, s[8:11], s68 offen offset:1024 lds
    buffer_load_dwordx4 a[16:19], v254, s[24:27], s66 offen offset:0 sc1
    buffer_load_dwordx4 a[20:23], v254, s[24:27], s66 offen offset:1024 sc1
    s_add_u32 m0, s40, 40960
    s_nop 0
    buffer_load_dwordx4 v247, s[8:11], s69 offen offset:0 lds
    buffer_load_dwordx4 v245, s[8:11], s69 offen offset:1024 lds
    buffer_load_dwordx4 a[24:27], v254, s[24:27], s67 offen offset:0 sc1
    buffer_load_dwordx4 a[28:31], v254, s[24:27], s67 offen offset:1024 sc1
    s_add_u32 m0, s40, 49152
    s_nop 0
    buffer_load_dwordx4 v247, s[8:11], s71 offen offset:0 lds
    buffer_load_dwordx4 v245, s[8:11], s71 offen offset:1024 lds
    s_waitcnt vmcnt(12) lgkmcnt(8)
    v_mfma_f32_16x16x32_bf16 v[0:3], v[96:99], a[0:3], 0
    v_add_u32 v236, 32768, v248
    v_add_u32 v237, 32768, v249
    v_mfma_f32_16x16x32_bf16 v[4:7], v[96:99], a[4:7], 0
    ds_read_b64_tr_b16 v[96:97], v248 offset:8192
    v_add_u32 v238, 32768, v250
    v_mfma_f32_16x16x32_bf16 v[8:11], v[100:103], a[0:3], 0
    ds_read_b64_tr_b16 v[98:99], v248 offset:12288
    v_add_u32 v239, 32768, v251
    v_mfma_f32_16x16x32_bf16 v[12:15], v[100:103], a[4:7], 0
    ds_read_b64_tr_b16 v[100:101], v249 offset:8192
    v_readlane_b32 s73, v244, 8
    v_mfma_f32_16x16x32_bf16 v[16:19], v[104:107], a[0:3], 0
    ds_read_b64_tr_b16 v[102:103], v249 offset:12288
    buffer_load_dwordx4 a[32:35], v254, s[24:27], s68 offen offset:0 sc1
    v_mfma_f32_16x16x32_bf16 v[20:23], v[104:107], a[4:7], 0
    ds_read_b64_tr_b16 v[104:105], v250 offset:8192
    buffer_load_dwordx4 a[36:39], v254, s[24:27], s68 offen offset:1024 sc1
    v_mfma_f32_16x16x32_bf16 v[24:27], v[108:111], a[0:3], 0
    ds_read_b64_tr_b16 v[106:107], v250 offset:12288
    s_add_u32 m0, s40, 57344
    v_mfma_f32_16x16x32_bf16 v[28:31], v[108:111], a[4:7], 0
    ds_read_b64_tr_b16 v[108:109], v251 offset:8192
    s_waitcnt lgkmcnt(7)
    v_mfma_f32_16x16x32_bf16 v[32:35], v[112:115], a[0:3], 0
    ds_read_b64_tr_b16 v[110:111], v251 offset:12288
    buffer_load_dwordx4 v247, s[8:11], s72 offen offset:0 lds
    v_mfma_f32_16x16x32_bf16 v[36:39], v[112:115], a[4:7], 0
    ds_read_b64_tr_b16 v[112:113], v248 offset:9216
    buffer_load_dwordx4 v245, s[8:11], s72 offen offset:1024 lds
    v_mfma_f32_16x16x32_bf16 v[40:43], v[116:119], a[0:3], 0
    ds_read_b64_tr_b16 v[114:115], v248 offset:13312
    v_mfma_f32_16x16x32_bf16 v[44:47], v[116:119], a[4:7], 0
    ds_read_b64_tr_b16 v[116:117], v249 offset:9216
    v_mfma_f32_16x16x32_bf16 v[48:51], v[120:123], a[0:3], 0
    ds_read_b64_tr_b16 v[118:119], v249 offset:13312
    v_mfma_f32_16x16x32_bf16 v[52:55], v[120:123], a[4:7], 0
    ds_read_b64_tr_b16 v[120:121], v250 offset:9216
    v_mfma_f32_16x16x32_bf16 v[56:59], v[124:127], a[0:3], 0
    ds_read_b64_tr_b16 v[122:123], v250 offset:13312
    v_mfma_f32_16x16x32_bf16 v[60:63], v[124:127], a[4:7], 0
    ds_read_b64_tr_b16 v[124:125], v251 offset:9216
    ds_read_b64_tr_b16 v[126:127], v251 offset:13312
    s_waitcnt vmcnt(14) lgkmcnt(8)
    v_mfma_f32_16x16x32_bf16 v[0:3], v[96:99], a[8:11], v[0:3]
    v_readlane_b32 s74, v244, 9
    buffer_load_dwordx4 a[40:43], v254, s[24:27], s69 offen offset:0 sc1
    v_mfma_f32_16x16x32_bf16 v[4:7], v[96:99], a[12:15], v[4:7]
    ds_read_b64_tr_b16 v[96:97], v248 offset:16384
    buffer_load_dwordx4 a[44:47], v254, s[24:27], s69 offen offset:1024 sc1
    v_mfma_f32_16x16x32_bf16 v[8:11], v[100:103], a[8:11], v[8:11]
    ds_read_b64_tr_b16 v[98:99], v248 offset:20480
    s_add_u32 m0, s40, 65536
    v_mfma_f32_16x16x32_bf16 v[12:15], v[100:103], a[12:15], v[12:15]
    ds_read_b64_tr_b16 v[100:101], v249 offset:16384
    buffer_load_dwordx4 v247, s[8:11], s73 offen offset:0 lds
    v_mfma_f32_16x16x32_bf16 v[16:19], v[104:107], a[8:11], v[16:19]
    ds_read_b64_tr_b16 v[102:103], v249 offset:20480
    buffer_load_dwordx4 v245, s[8:11], s73 offen offset:1024 lds
    v_mfma_f32_16x16x32_bf16 v[20:23], v[104:107], a[12:15], v[20:23]
    ds_read_b64_tr_b16 v[104:105], v250 offset:16384
    v_mfma_f32_16x16x32_bf16 v[24:27], v[108:111], a[8:11], v[24:27]
    ds_read_b64_tr_b16 v[106:107], v250 offset:20480
    v_mfma_f32_16x16x32_bf16 v[28:31], v[108:111], a[12:15], v[28:31]
    ds_read_b64_tr_b16 v[108:109], v251 offset:16384
    s_waitcnt lgkmcnt(7)
    v_mfma_f32_16x16x32_bf16 v[32:35], v[112:115], a[8:11], v[32:35]
    ds_read_b64_tr_b16 v[110:111], v251 offset:20480
    v_mfma_f32_16x16x32_bf16 v[36:39], v[112:115], a[12:15], v[36:39]
    ds_read_b64_tr_b16 v[112:113], v248 offset:17408
    v_mfma_f32_16x16x32_bf16 v[40:43], v[116:119], a[8:11], v[40:43]
    ds_read_b64_tr_b16 v[114:115], v248 offset:21504
    v_mfma_f32_16x16x32_bf16 v[44:47], v[116:119], a[12:15], v[44:47]
    ds_read_b64_tr_b16 v[116:117], v249 offset:17408
    v_mfma_f32_16x16x32_bf16 v[48:51], v[120:123], a[8:11], v[48:51]
    ds_read_b64_tr_b16 v[118:119], v249 offset:21504
    v_mfma_f32_16x16x32_bf16 v[52:55], v[120:123], a[12:15], v[52:55]
    ds_read_b64_tr_b16 v[120:121], v250 offset:17408
    v_mfma_f32_16x16x32_bf16 v[56:59], v[124:127], a[8:11], v[56:59]
    ds_read_b64_tr_b16 v[122:123], v250 offset:21504
    v_mfma_f32_16x16x32_bf16 v[60:63], v[124:127], a[12:15], v[60:63]
    ds_read_b64_tr_b16 v[124:125], v251 offset:17408
    ds_read_b64_tr_b16 v[126:127], v251 offset:21504
    s_waitcnt vmcnt(14) lgkmcnt(8)
    v_mfma_f32_16x16x32_bf16 v[0:3], v[96:99], a[16:19], v[0:3]
    v_readlane_b32 s75, v244, 10
    buffer_load_dwordx4 a[48:51], v254, s[24:27], s71 offen offset:0 sc1
    v_mfma_f32_16x16x32_bf16 v[4:7], v[96:99], a[20:23], v[4:7]
    ds_read_b64_tr_b16 v[96:97], v248 offset:24576
    buffer_load_dwordx4 a[52:55], v254, s[24:27], s71 offen offset:1024 sc1
    v_mfma_f32_16x16x32_bf16 v[8:11], v[100:103], a[16:19], v[8:11]
    ds_read_b64_tr_b16 v[98:99], v248 offset:28672
    s_add_u32 m0, s40, 73728
    v_mfma_f32_16x16x32_bf16 v[12:15], v[100:103], a[20:23], v[12:15]
    ds_read_b64_tr_b16 v[100:101], v249 offset:24576
    buffer_load_dwordx4 v247, s[8:11], s74 offen offset:0 lds
    v_mfma_f32_16x16x32_bf16 v[16:19], v[104:107], a[16:19], v[16:19]
    ds_read_b64_tr_b16 v[102:103], v249 offset:28672
    buffer_load_dwordx4 v245, s[8:11], s74 offen offset:1024 lds
    v_mfma_f32_16x16x32_bf16 v[20:23], v[104:107], a[20:23], v[20:23]
    ds_read_b64_tr_b16 v[104:105], v250 offset:24576
    v_mfma_f32_16x16x32_bf16 v[24:27], v[108:111], a[16:19], v[24:27]
    ds_read_b64_tr_b16 v[106:107], v250 offset:28672
    v_mfma_f32_16x16x32_bf16 v[28:31], v[108:111], a[20:23], v[28:31]
    ds_read_b64_tr_b16 v[108:109], v251 offset:24576
    s_waitcnt lgkmcnt(7)
    v_mfma_f32_16x16x32_bf16 v[32:35], v[112:115], a[16:19], v[32:35]
    ds_read_b64_tr_b16 v[110:111], v251 offset:28672
    v_mfma_f32_16x16x32_bf16 v[36:39], v[112:115], a[20:23], v[36:39]
    ds_read_b64_tr_b16 v[112:113], v248 offset:25600
    v_mfma_f32_16x16x32_bf16 v[40:43], v[116:119], a[16:19], v[40:43]
    ds_read_b64_tr_b16 v[114:115], v248 offset:29696
    v_mfma_f32_16x16x32_bf16 v[44:47], v[116:119], a[20:23], v[44:47]
    ds_read_b64_tr_b16 v[116:117], v249 offset:25600
    v_mfma_f32_16x16x32_bf16 v[48:51], v[120:123], a[16:19], v[48:51]
    ds_read_b64_tr_b16 v[118:119], v249 offset:29696
    v_mfma_f32_16x16x32_bf16 v[52:55], v[120:123], a[20:23], v[52:55]
    ds_read_b64_tr_b16 v[120:121], v250 offset:25600
    v_mfma_f32_16x16x32_bf16 v[56:59], v[124:127], a[16:19], v[56:59]
    ds_read_b64_tr_b16 v[122:123], v250 offset:29696
    v_mfma_f32_16x16x32_bf16 v[60:63], v[124:127], a[20:23], v[60:63]
    ds_read_b64_tr_b16 v[124:125], v251 offset:25600
    ds_read_b64_tr_b16 v[126:127], v251 offset:29696
    s_waitcnt vmcnt(14) lgkmcnt(8)
    v_mfma_f32_16x16x32_bf16 v[0:3], v[96:99], a[24:27], v[0:3]
    v_readlane_b32 s76, v244, 11
    buffer_load_dwordx4 a[56:59], v254, s[24:27], s72 offen offset:0 sc1
    v_mfma_f32_16x16x32_bf16 v[4:7], v[96:99], a[28:31], v[4:7]
    buffer_load_dwordx4 a[60:63], v254, s[24:27], s72 offen offset:1024 sc1
    s_add_u32 m0, s40, 81920
    s_nop 0
    buffer_load_dwordx4 v247, s[8:11], s75 offen offset:0 lds
    buffer_load_dwordx4 v245, s[8:11], s75 offen offset:1024 lds
    s_waitcnt vmcnt(12)
    s_barrier
    s_cmp_ge_u32 s28, 1
    s_cbranch_scc1 L_sig40
    s_mov_b64 exec, 1
    buffer_atomic_add v253, v252, s[20:23], s56 offen sc1
    s_mov_b64 exec, -1
L_sig40:
    ds_read_b64_tr_b16 v[96:97], v236 offset:0
    v_mfma_f32_16x16x32_bf16 v[8:11], v[100:103], a[24:27], v[8:11]
    ds_read_b64_tr_b16 v[98:99], v236 offset:4096
    v_mfma_f32_16x16x32_bf16 v[12:15], v[100:103], a[28:31], v[12:15]
    ds_read_b64_tr_b16 v[100:101], v237 offset:0
    v_mfma_f32_16x16x32_bf16 v[16:19], v[104:107], a[24:27], v[16:19]
    ds_read_b64_tr_b16 v[102:103], v237 offset:4096
    v_mfma_f32_16x16x32_bf16 v[20:23], v[104:107], a[28:31], v[20:23]
    ds_read_b64_tr_b16 v[104:105], v238 offset:0
    v_mfma_f32_16x16x32_bf16 v[24:27], v[108:111], a[24:27], v[24:27]
    ds_read_b64_tr_b16 v[106:107], v238 offset:4096
    v_mfma_f32_16x16x32_bf16 v[28:31], v[108:111], a[28:31], v[28:31]
    ds_read_b64_tr_b16 v[108:109], v239 offset:0
    s_waitcnt lgkmcnt(7)
    v_mfma_f32_16x16x32_bf16 v[32:35], v[112:115], a[24:27], v[32:35]
    ds_read_b64_tr_b16 v[110:111], v239 offset:4096
    v_mfma_f32_16x16x32_bf16 v[36:39], v[112:115], a[28:31], v[36:39]
    ds_read_b64_tr_b16 v[112:113], v236 offset:1024
    v_mfma_f32_16x16x32_bf16 v[40:43], v[116:119], a[24:27], v[40:43]
    ds_read_b64_tr_b16 v[114:115], v236 offset:5120
    v_mfma_f32_16x16x32_bf16 v[44:47], v[116:119], a[28:31], v[44:47]
    ds_read_b64_tr_b16 v[116:117], v237 offset:1024
    v_mfma_f32_16x16x32_bf16 v[48:51], v[120:123], a[24:27], v[48:51]
    ds_read_b64_tr_b16 v[118:119], v237 offset:5120
    v_mfma_f32_16x16x32_bf16 v[52:55], v[120:123], a[28:31], v[52:55]
    ds_read_b64_tr_b16 v[120:121], v238 offset:1024
    v_mfma_f32_16x16x32_bf16 v[56:59], v[124:127], a[24:27], v[56:59]
    ds_read_b64_tr_b16 v[122:123], v238 offset:5120
    v_mfma_f32_16x16x32_bf16 v[60:63], v[124:127], a[28:31], v[60:63]
    ds_read_b64_tr_b16 v[124:125], v239 offset:1024
    ds_read_b64_tr_b16 v[126:127], v239 offset:5120
    s_waitcnt lgkmcnt(8)
    v_mfma_f32_16x16x32_bf16 v[0:3], v[96:99], a[32:35], v[0:3]
    v_add_u32 v232, 65536, v248
    v_add_u32 v233, 65536, v249
    v_mfma_f32_16x16x32_bf16 v[4:7], v[96:99], a[36:39], v[4:7]
    ds_read_b64_tr_b16 v[96:97], v236 offset:8192
    v_add_u32 v234, 65536, v250
    v_mfma_f32_16x16x32_bf16 v[8:11], v[100:103], a[32:35], v[8:11]
    ds_read_b64_tr_b16 v[98:99], v236 offset:12288
    v_add_u32 v235, 65536, v251
    v_mfma_f32_16x16x32_bf16 v[12:15], v[100:103], a[36:39], v[12:15]
    ds_read_b64_tr_b16 v[100:101], v237 offset:8192
    v_readlane_b32 s77, v244, 12
    v_mfma_f32_16x16x32_bf16 v[16:19], v[104:107], a[32:35], v[16:19]
    ds_read_b64_tr_b16 v[102:103], v237 offset:12288
    buffer_load_dwordx4 a[0:3], v254, s[24:27], s73 offen offset:0 sc1
    v_mfma_f32_16x16x32_bf16 v[20:23], v[104:107], a[36:39], v[20:23]
    ds_read_b64_tr_b16 v[104:105], v238 offset:8192
    buffer_load_dwordx4 a[4:7], v254, s[24:27], s73 offen offset:1024 sc1
    v_mfma_f32_16x16x32_bf16 v[24:27], v[108:111], a[32:35], v[24:27]
    ds_read_b64_tr_b16 v[106:107], v238 offset:12288
    s_add_u32 m0, s40, 90112
    v_mfma_f32_16x16x32_bf16 v[28:31], v[108:111], a[36:39], v[28:31]
    ds_read_b64_tr_b16 v[108:109], v239 offset:8192
    s_waitcnt lgkmcnt(7)
    v_mfma_f32_16x16x32_bf16 v[32:35], v[112:115], a[32:35], v[32:35]
    ds_read_b64_tr_b16 v[110:111], v239 offset:12288
    buffer_load_dwordx4 v247, s[8:11], s76 offen offset:0 lds
    v_mfma_f32_16x16x32_bf16 v[36:39], v[112:115], a[36:39], v[36:39]
    ds_read_b64_tr_b16 v[112:113], v236 offset:9216
    buffer_load_dwordx4 v245, s[8:11], s76 offen offset:1024 lds
    v_mfma_f32_16x16x32_bf16 v[40:43], v[116:119], a[32:35], v[40:43]
    ds_read_b64_tr_b16 v[114:115], v236 offset:13312
    v_mov_b32 v128, v255
    v_mfma_f32_16x16x32_bf16 v[44:47], v[116:119], a[36:39], v[44:47]
    ds_read_b64_tr_b16 v[116:117], v237 offset:9216
    v_subrev_u32 v130, s70, v128
    v_mfma_f32_16x16x32_bf16 v[48:51], v[120:123], a[32:35], v[48:51]
    ds_read_b64_tr_b16 v[118:119], v237 offset:13312
    v_and_b32 v130, 7, v130
    v_mfma_f32_16x16x32_bf16 v[52:55], v[120:123], a[36:39], v[52:55]
    ds_read_b64_tr_b16 v[120:121], v238 offset:9216
    v_sub_u32 v131, v128, v130
    v_mfma_f32_16x16x32_bf16 v[56:59], v[124:127], a[32:35], v[56:59]
    ds_read_b64_tr_b16 v[122:123], v238 offset:13312
    v_lshlrev_b32 v130, 2, v130
    v_mfma_f32_16x16x32_bf16 v[60:63], v[124:127], a[36:39], v[60:63]
    ds_read_b64_tr_b16 v[124:125], v239 offset:9216
    ds_read_b64_tr_b16 v[126:127], v239 offset:13312
    s_waitcnt vmcnt(14) lgkmcnt(8)
    v_mfma_f32_16x16x32_bf16 v[0:3], v[96:99], a[40:43], v[0:3]
    v_readlane_b32 s59, v244, 13
    buffer_load_dwordx4 a[8:11], v254, s[24:27], s74 offen offset:0 sc1
    v_mfma_f32_16x16x32_bf16 v[4:7], v[96:99], a[44:47], v[4:7]
    ds_read_b64_tr_b16 v[96:97], v236 offset:16384
    buffer_load_dwordx4 a[12:15], v254, s[24:27], s74 offen offset:1024 sc1
    v_mfma_f32_16x16x32_bf16 v[8:11], v[100:103], a[40:43], v[8:11]
    ds_read_b64_tr_b16 v[98:99], v236 offset:20480
    s_add_u32 m0, s40, 98304
    v_mfma_f32_16x16x32_bf16 v[12:15], v[100:103], a[44:47], v[12:15]
    ds_read_b64_tr_b16 v[100:101], v237 offset:16384
    buffer_load_dwordx4 v247, s[8:11], s77 offen offset:0 lds
    v_mfma_f32_16x16x32_bf16 v[16:19], v[104:107], a[40:43], v[16:19]
    ds_read_b64_tr_b16 v[102:103], v237 offset:20480
    buffer_load_dwordx4 v245, s[8:11], s77 offen offset:1024 lds
    v_mfma_f32_16x16x32_bf16 v[20:23], v[104:107], a[44:47], v[20:23]
    ds_read_b64_tr_b16 v[104:105], v238 offset:16384
    s_mov_b32 s35, 0xeeee44
    v_mfma_f32_16x16x32_bf16 v[24:27], v[108:111], a[40:43], v[24:27]
    ds_read_b64_tr_b16 v[106:107], v238 offset:20480
    v_bfe_i32 v130, s35, v130, 4
    v_mfma_f32_16x16x32_bf16 v[28:31], v[108:111], a[44:47], v[28:31]
    ds_read_b64_tr_b16 v[108:109], v239 offset:16384
    s_waitcnt lgkmcnt(7)
    v_mfma_f32_16x16x32_bf16 v[32:35], v[112:115], a[40:43], v[32:35]
    ds_read_b64_tr_b16 v[110:111], v239 offset:20480
    v_cmp_ge_u32 s[36:37], 6, v131
    v_mfma_f32_16x16x32_bf16 v[36:39], v[112:115], a[44:47], v[36:39]
    ds_read_b64_tr_b16 v[112:113], v236 offset:17408
    s_nop 0
    v_mfma_f32_16x16x32_bf16 v[40:43], v[116:119], a[40:43], v[40:43]
    ds_read_b64_tr_b16 v[114:115], v236 offset:21504
    v_cndmask_b32_e64 v130, 0, v130, s[36:37]
    v_mfma_f32_16x16x32_bf16 v[44:47], v[116:119], a[44:47], v[44:47]
    ds_read_b64_tr_b16 v[116:117], v237 offset:17408
    v_add_u32 v128, v128, v130
    v_mfma_f32_16x16x32_bf16 v[48:51], v[120:123], a[40:43], v[48:51]
    ds_read_b64_tr_b16 v[118:119], v237 offset:21504
    s_mov_b32 s35, 0x2aaaaaab
    v_mfma_f32_16x16x32_bf16 v[52:55], v[120:123], a[44:47], v[52:55]
    ds_read_b64_tr_b16 v[120:121], v238 offset:17408
    v_mul_hi_u32 v129, v128, s35
    v_mfma_f32_16x16x32_bf16 v[56:59], v[124:127], a[40:43], v[56:59]
    ds_read_b64_tr_b16 v[122:123], v238 offset:21504
    v_mul_u32_u24 v130, 6, v129
    v_mfma_f32_16x16x32_bf16 v[60:63], v[124:127], a[44:47], v[60:63]
    ds_read_b64_tr_b16 v[124:125], v239 offset:17408
    ds_read_b64_tr_b16 v[126:127], v239 offset:21504
    s_waitcnt vmcnt(14) lgkmcnt(8)
    v_mfma_f32_16x16x32_bf16 v[0:3], v[96:99], a[48:51], v[0:3]
    v_readlane_b32 s64, v244, 14
    buffer_load_dwordx4 a[16:19], v254, s[24:27], s75 offen offset:0 sc1
    v_mfma_f32_16x16x32_bf16 v[4:7], v[96:99], a[52:55], v[4:7]
    ds_read_b64_tr_b16 v[96:97], v236 offset:24576
    buffer_load_dwordx4 a[20:23], v254, s[24:27], s75 offen offset:1024 sc1
    v_mfma_f32_16x16x32_bf16 v[8:11], v[100:103], a[48:51], v[8:11]
    ds_read_b64_tr_b16 v[98:99], v236 offset:28672
    s_add_u32 m0, s40, 106496
    v_mfma_f32_16x16x32_bf16 v[12:15], v[100:103], a[52:55], v[12:15]
    ds_read_b64_tr_b16 v[100:101], v237 offset:24576
    buffer_load_dwordx4 v247, s[8:11], s59 offen offset:0 lds
    v_mfma_f32_16x16x32_bf16 v[16:19], v[104:107], a[48:51], v[16:19]
    ds_read_b64_tr_b16 v[102:103], v237 offset:28672
    buffer_load_dwordx4 v245, s[8:11], s59 offen offset:1024 lds
    v_mfma_f32_16x16x32_bf16 v[20:23], v[104:107], a[52:55], v[20:23]
    ds_read_b64_tr_b16 v[104:105], v238 offset:24576
    v_sub_u32 v130, v128, v130
    v_mfma_f32_16x16x32_bf16 v[24:27], v[108:111], a[48:51], v[24:27]
    ds_read_b64_tr_b16 v[106:107], v238 offset:28672
    v_cmp_gt_u32 vcc, 12, v255
    v_mfma_f32_16x16x32_bf16 v[28:31], v[108:111], a[52:55], v[28:31]
    ds_read_b64_tr_b16 v[108:109], v239 offset:24576
    s_waitcnt lgkmcnt(7)
    v_mfma_f32_16x16x32_bf16 v[32:35], v[112:115], a[48:51], v[32:35]
    ds_read_b64_tr_b16 v[110:111], v239 offset:28672
    v_add_u32 v131, 5, v130
    v_mfma_f32_16x16x32_bf16 v[36:39], v[112:115], a[52:55], v[36:39]
    ds_read_b64_tr_b16 v[112:113], v236 offset:25600
    v_lshrrev_b32 v131, 3, v131
    v_mfma_f32_16x16x32_bf16 v[40:43], v[116:119], a[48:51], v[40:43]
    ds_read_b64_tr_b16 v[114:115], v236 offset:29696
    v_add_u32 v130, v130, v131
    v_mfma_f32_16x16x32_bf16 v[44:47], v[116:119], a[52:55], v[44:47]
    ds_read_b64_tr_b16 v[116:117], v237 offset:25600
    v_subrev_u32 v131, 12, v255
    v_mfma_f32_16x16x32_bf16 v[48:51], v[120:123], a[48:51], v[48:51]
    ds_read_b64_tr_b16 v[118:119], v237 offset:29696
    v_cndmask_b32 v129, v131, v129, vcc
    v_mfma_f32_16x16x32_bf16 v[52:55], v[120:123], a[52:55], v[52:55]
    ds_read_b64_tr_b16 v[120:121], v238 offset:25600
    v_cndmask_b32 v130, 3, v130, vcc
    v_mfma_f32_16x16x32_bf16 v[56:59], v[124:127], a[48:51], v[56:59]
    ds_read_b64_tr_b16 v[122:123], v238 offset:29696
    s_lshl_b32 s35, s58, 2
    v_mfma_f32_16x16x32_bf16 v[60:63], v[124:127], a[52:55], v[60:63]
    ds_read_b64_tr_b16 v[124:125], v239 offset:25600
    ds_read_b64_tr_b16 v[126:127], v239 offset:29696
    s_waitcnt vmcnt(14) lgkmcnt(8)
    v_mfma_f32_16x16x32_bf16 v[0:3], v[96:99], a[56:59], v[0:3]
    v_readlane_b32 s65, v244, 15
    buffer_load_dwordx4 a[24:27], v254, s[24:27], s76 offen offset:0 sc1
    v_mfma_f32_16x16x32_bf16 v[4:7], v[96:99], a[60:63], v[4:7]
    s_waitcnt vmcnt(9)
    s_barrier
    ds_read_b64_tr_b16 v[96:97], v232 offset:0
    v_mfma_f32_16x16x32_bf16 v[8:11], v[100:103], a[56:59], v[8:11]
    ds_read_b64_tr_b16 v[98:99], v232 offset:4096
    buffer_load_dwordx4 a[28:31], v254, s[24:27], s76 offen offset:1024 sc1
    v_mfma_f32_16x16x32_bf16 v[12:15], v[100:103], a[60:63], v[12:15]
    ds_read_b64_tr_b16 v[100:101], v233 offset:0
    s_add_u32 m0, s40, 114688
    v_mfma_f32_16x16x32_bf16 v[16:19], v[104:107], a[56:59], v[16:19]
    ds_read_b64_tr_b16 v[102:103], v233 offset:4096
    buffer_load_dwordx4 v247, s[8:11], s64 offen offset:0 lds
    v_mfma_f32_16x16x32_bf16 v[20:23], v[104:107], a[60:63], v[20:23]
    ds_read_b64_tr_b16 v[104:105], v234 offset:0
    buffer_load_dwordx4 v245, s[8:11], s64 offen offset:1024 lds
    v_mfma_f32_16x16x32_bf16 v[24:27], v[108:111], a[56:59], v[24:27]
    ds_read_b64_tr_b16 v[106:107], v234 offset:4096
    s_add_u32 s35, s35, 14
    v_mfma_f32_16x16x32_bf16 v[28:31], v[108:111], a[60:63], v[28:31]
    ds_read_b64_tr_b16 v[108:109], v235 offset:0
    s_waitcnt lgkmcnt(7)
    v_mfma_f32_16x16x32_bf16 v[32:35], v[112:115], a[56:59], v[32:35]
    ds_read_b64_tr_b16 v[110:111], v235 offset:4096
    v_add_u32 v129, s35, v129
    v_mfma_f32_16x16x32_bf16 v[36:39], v[112:115], a[60:63], v[36:39]
    ds_read_b64_tr_b16 v[112:113], v232 offset:1024
    v_and_b32 v129, 15, v129
    v_mfma_f32_16x16x32_bf16 v[40:43], v[116:119], a[56:59], v[40:43]
    ds_read_b64_tr_b16 v[114:115], v232 offset:5120
    v_mad_u32_u24 v129, v129, 7, v130
    v_mfma_f32_16x16x32_bf16 v[44:47], v[116:119], a[60:63], v[44:47]
    ds_read_b64_tr_b16 v[116:117], v233 offset:1024
    v_lshlrev_b32 v228, 16, v129
    v_mfma_f32_16x16x32_bf16 v[48:51], v[120:123], a[56:59], v[48:51]
    ds_read_b64_tr_b16 v[118:119], v233 offset:5120
    v_mfma_f32_16x16x32_bf16 v[52:55], v[120:123], a[60:63], v[52:55]
    ds_read_b64_tr_b16 v[120:121], v234 offset:1024
    v_mfma_f32_16x16x32_bf16 v[56:59], v[124:127], a[56:59], v[56:59]
    ds_read_b64_tr_b16 v[122:123], v234 offset:5120
    v_mfma_f32_16x16x32_bf16 v[60:63], v[124:127], a[60:63], v[60:63]
    ds_read_b64_tr_b16 v[124:125], v235 offset:1024
    ds_read_b64_tr_b16 v[126:127], v235 offset:5120
    s_waitcnt lgkmcnt(8)
    v_mfma_f32_16x16x32_bf16 v[0:3], v[96:99], a[0:3], v[0:3]
    v_add_u32 v236, 98304, v248
    v_add_u32 v237, 98304, v249
    v_mfma_f32_16x16x32_bf16 v[4:7], v[96:99], a[4:7], v[4:7]
    ds_read_b64_tr_b16 v[96:97], v232 offset:8192
    v_add_u32 v238, 98304, v250
    v_mfma_f32_16x16x32_bf16 v[8:11], v[100:103], a[0:3], v[8:11]
    ds_read_b64_tr_b16 v[98:99], v232 offset:12288
    v_add_u32 v239, 98304, v251
    v_mfma_f32_16x16x32_bf16 v[12:15], v[100:103], a[4:7], v[12:15]
    ds_read_b64_tr_b16 v[100:101], v233 offset:8192
    buffer_load_dword v243, v252, s[20:23], s43 offen sc1
    v_mfma_f32_16x16x32_bf16 v[16:19], v[104:107], a[0:3], v[16:19]
    ds_read_b64_tr_b16 v[102:103], v233 offset:12288
    v_readlane_b32 s66, v244, 16
    v_mfma_f32_16x16x32_bf16 v[20:23], v[104:107], a[4:7], v[20:23]
    ds_read_b64_tr_b16 v[104:105], v234 offset:8192
    buffer_load_dwordx4 a[32:35], v254, s[24:27], s77 offen offset:0 sc1
    v_mfma_f32_16x16x32_bf16 v[24:27], v[108:111], a[0:3], v[24:27]
    ds_read_b64_tr_b16 v[106:107], v234 offset:12288
    buffer_load_dwordx4 a[36:39], v254, s[24:27], s77 offen offset:1024 sc1
    v_mfma_f32_16x16x32_bf16 v[28:31], v[108:111], a[4:7], v[28:31]
    ds_read_b64_tr_b16 v[108:109], v235 offset:8192
    s_waitcnt lgkmcnt(7)
    v_mfma_f32_16x16x32_bf16 v[32:35], v[112:115], a[0:3], v[32:35]
    ds_read_b64_tr_b16 v[110:111], v235 offset:12288
    s_add_u32 m0, s40, 122880
    v_mfma_f32_16x16x32_bf16 v[36:39], v[112:115], a[4:7], v[36:39]
    ds_read_b64_tr_b16 v[112:113], v232 offset:9216
    buffer_load_dwordx4 v247, s[8:11], s65 offen offset:0 lds
    v_mfma_f32_16x16x32_bf16 v[40:43], v[116:119], a[0:3], v[40:43]
    ds_read_b64_tr_b16 v[114:115], v232 offset:13312
    buffer_load_dwordx4 v245, s[8:11], s65 offen offset:1024 lds
    v_mfma_f32_16x16x32_bf16 v[44:47], v[116:119], a[4:7], v[44:47]
    ds_read_b64_tr_b16 v[116:117], v233 offset:9216
    v_mfma_f32_16x16x32_bf16 v[48:51], v[120:123], a[0:3], v[48:51]
    ds_read_b64_tr_b16 v[118:119], v233 offset:13312
    v_mfma_f32_16x16x32_bf16 v[52:55], v[120:123], a[4:7], v[52:55]
    ds_read_b64_tr_b16 v[120:121], v234 offset:9216
    v_mfma_f32_16x16x32_bf16 v[56:59], v[124:127], a[0:3], v[56:59]
    ds_read_b64_tr_b16 v[122:123], v234 offset:13312
    v_mfma_f32_16x16x32_bf16 v[60:63], v[124:127], a[4:7], v[60:63]
    ds_read_b64_tr_b16 v[124:125], v235 offset:9216
    ds_read_b64_tr_b16 v[126:127], v235 offset:13312
    s_waitcnt vmcnt(15) lgkmcnt(8)
    v_mfma_f32_16x16x32_bf16 v[0:3], v[96:99], a[8:11], v[0:3]
    v_readlane_b32 s67, v244, 17
    buffer_load_dwordx4 a[40:43], v254, s[24:27], s59 offen offset:0 sc1
    v_mfma_f32_16x16x32_bf16 v[4:7], v[96:99], a[12:15], v[4:7]
    ds_read_b64_tr_b16 v[96:97], v232 offset:16384
    buffer_load_dwordx4 a[44:47], v254, s[24:27], s59 offen offset:1024 sc1
    v_mfma_f32_16x16x32_bf16 v[8:11], v[100:103], a[8:11], v[8:11]
    ds_read_b64_tr_b16 v[98:99], v232 offset:20480
    s_add_u32 m0, s40, 131072
    v_mfma_f32_16x16x32_bf16 v[12:15], v[100:103], a[12:15], v[12:15]
    ds_read_b64_tr_b16 v[100:101], v233 offset:16384
    buffer_load_dwordx4 v247, s[8:11], s66 offen offset:0 lds
    v_mfma_f32_16x16x32_bf16 v[16:19], v[104:107], a[8:11], v[16:19]
    ds_read_b64_tr_b16 v[102:103], v233 offset:20480
    buffer_load_dwordx4 v245, s[8:11], s66 offen offset:1024 lds
    v_mfma_f32_16x16x32_bf16 v[20:23], v[104:107], a[12:15], v[20:23]
    ds_read_b64_tr_b16 v[104:105], v234 offset:16384
    v_mfma_f32_16x16x32_bf16 v[24:27], v[108:111], a[8:11], v[24:27]
    ds_read_b64_tr_b16 v[106:107], v234 offset:20480
    v_mfma_f32_16x16x32_bf16 v[28:31], v[108:111], a[12:15], v[28:31]
    ds_read_b64_tr_b16 v[108:109], v235 offset:16384
    s_waitcnt lgkmcnt(7)
    v_mfma_f32_16x16x32_bf16 v[32:35], v[112:115], a[8:11], v[32:35]
    ds_read_b64_tr_b16 v[110:111], v235 offset:20480
    v_mfma_f32_16x16x32_bf16 v[36:39], v[112:115], a[12:15], v[36:39]
    ds_read_b64_tr_b16 v[112:113], v232 offset:17408
    v_mfma_f32_16x16x32_bf16 v[40:43], v[116:119], a[8:11], v[40:43]
    ds_read_b64_tr_b16 v[114:115], v232 offset:21504
    v_mfma_f32_16x16x32_bf16 v[44:47], v[116:119], a[12:15], v[44:47]
    ds_read_b64_tr_b16 v[116:117], v233 offset:17408
    v_mfma_f32_16x16x32_bf16 v[48:51], v[120:123], a[8:11], v[48:51]
    ds_read_b64_tr_b16 v[118:119], v233 offset:21504
    v_mfma_f32_16x16x32_bf16 v[52:55], v[120:123], a[12:15], v[52:55]
    ds_read_b64_tr_b16 v[120:121], v234 offset:17408
    v_mfma_f32_16x16x32_bf16 v[56:59], v[124:127], a[8:11], v[56:59]
    ds_read_b64_tr_b16 v[122:123], v234 offset:21504
    v_mfma_f32_16x16x32_bf16 v[60:63], v[124:127], a[12:15], v[60:63]
    ds_read_b64_tr_b16 v[124:125], v235 offset:17408
    ds_read_b64_tr_b16 v[126:127], v235 offset:21504
    s_waitcnt vmcnt(8)
    v_cmp_gt_u32 vcc, 32, v243
    s_cbranch_vccz L_chk41
    s_mov_b64 exec, 1
    s_mov_b32 s3, 0x40000
L_poll42:
    buffer_load_dword v243, v252, s[20:23], s43 offen sc1
    s_sub_u32 s3, s3, 1
    s_cbranch_scc1 L_poll42_y
    s_waitcnt vmcnt(0)
    v_cmp_gt_u32 vcc, 32, v243
    s_cbranch_vccz L_poll42_y
    s_sleep 1
    s_branch L_poll42
L_poll42_y:
    s_waitcnt vmcnt(0)
    s_mov_b64 exec, -1
L_poll42_x:
L_chk41:
    s_add_u32 s43, s43, 4352
    s_waitcnt lgkmcnt(8)
    v_mfma_f32_16x16x32_bf16 v[0:3], v[96:99], a[16:19], v[0:3]
    v_readlane_b32 s68, v244, 18
    buffer_load_dwordx4 a[48:51], v254, s[24:27], s64 offen offset:0 sc1
    v_mfma_f32_16x16x32_bf16 v[4:7], v[96:99], a[20:23], v[4:7]
    ds_read_b64_tr_b16 v[96:97], v232 offset:24576
    buffer_load_dwordx4 a[52:55], v254, s[24:27], s64 offen offset:1024 sc1
    v_mfma_f32_16x16x32_bf16 v[8:11], v[100:103], a[16:19], v[8:11]
    ds_read_b64_tr_b16 v[98:99], v232 offset:28672
    s_add_u32 m0, s40, 139264
    v_mfma_f32_16x16x32_bf16 v[12:15], v[100:103], a[20:23], v[12:15]
    ds_read_b64_tr_b16 v[100:101], v233 offset:24576
    buffer_load_dwordx4 v247, s[8:11], s67 offen offset:0 lds
    v_mfma_f32_16x16x32_bf16 v[16:19], v[104:107], a[16:19], v[16:19]
    ds_read_b64_tr_b16 v[102:103], v233 offset:28672
    buffer_load_dwordx4 v245, s[8:11], s67 offen offset:1024 lds
    v_mfma_f32_16x16x32_bf16 v[20:23], v[104:107], a[20:23], v[20:23]
    ds_read_b64_tr_b16 v[104:105], v234 offset:24576
    v_mfma_f32_16x16x32_bf16 v[24:27], v[108:111], a[16:19], v[24:27]
    ds_read_b64_tr_b16 v[106:107], v234 offset:28672
    v_mfma_f32_16x16x32_bf16 v[28:31], v[108:111], a[20:23], v[28:31]
    ds_read_b64_tr_b16 v[108:109], v235 offset:24576
    s_waitcnt lgkmcnt(7)
    v_mfma_f32_16x16x32_bf16 v[32:35], v[112:115], a[16:19], v[32:35]
    ds_read_b64_tr_b16 v[110:111], v235 offset:28672
    v_mfma_f32_16x16x32_bf16 v[36:39], v[112:115], a[20:23], v[36:39]
    ds_read_b64_tr_b16 v[112:113], v232 offset:25600
    v_mfma_f32_16x16x32_bf16 v[40:43], v[116:119], a[16:19], v[40:43]
    ds_read_b64_tr_b16 v[114:115], v232 offset:29696
    v_mfma_f32_16x16x32_bf16 v[44:47], v[116:119], a[20:23], v[44:47]
    ds_read_b64_tr_b16 v[116:117], v233 offset:25600
    v_mfma_f32_16x16x32_bf16 v[48:51], v[120:123], a[16:19], v[48:51]
    ds_read_b64_tr_b16 v[118:119], v233 offset:29696
    v_mfma_f32_16x16x32_bf16 v[52:55], v[120:123], a[20:23], v[52:55]
    ds_read_b64_tr_b16 v[120:121], v234 offset:25600
    v_mfma_f32_16x16x32_bf16 v[56:59], v[124:127], a[16:19], v[56:59]
    ds_read_b64_tr_b16 v[122:123], v234 offset:29696
    v_mfma_f32_16x16x32_bf16 v[60:63], v[124:127], a[20:23], v[60:63]
    ds_read_b64_tr_b16 v[124:125], v235 offset:25600
    ds_read_b64_tr_b16 v[126:127], v235 offset:29696
    s_waitcnt lgkmcnt(8)
    v_mfma_f32_16x16x32_bf16 v[0:3], v[96:99], a[24:27], v[0:3]
    v_readlane_b32 s69, v244, 19
    buffer_load_dwordx4 a[56:59], v254, s[24:27], s65 offen offset:0 sc1
    v_mfma_f32_16x16x32_bf16 v[4:7], v[96:99], a[28:31], v[4:7]
    s_waitcnt vmcnt(9)
    s_barrier
    ds_read_b64_tr_b16 v[96:97], v236 offset:0
    v_mfma_f32_16x16x32_bf16 v[8:11], v[100:103], a[24:27], v[8:11]
    ds_read_b64_tr_b16 v[98:99], v236 offset:4096
    buffer_load_dwordx4 a[60:63], v254, s[24:27], s65 offen offset:1024 sc1
    v_mfma_f32_16x16x32_bf16 v[12:15], v[100:103], a[28:31], v[12:15]
    ds_read_b64_tr_b16 v[100:101], v237 offset:0
    s_add_u32 m0, s40, 147456
    v_mfma_f32_16x16x32_bf16 v[16:19], v[104:107], a[24:27], v[16:19]
    ds_read_b64_tr_b16 v[102:103], v237 offset:4096
    buffer_load_dwordx4 v247, s[8:11], s68 offen offset:0 lds
    v_mfma_f32_16x16x32_bf16 v[20:23], v[104:107], a[28:31], v[20:23]
    ds_read_b64_tr_b16 v[104:105], v238 offset:0
    buffer_load_dwordx4 v245, s[8:11], s68 offen offset:1024 lds
    v_mfma_f32_16x16x32_bf16 v[24:27], v[108:111], a[24:27], v[24:27]
    ds_read_b64_tr_b16 v[106:107], v238 offset:4096
    v_mfma_f32_16x16x32_bf16 v[28:31], v[108:111], a[28:31], v[28:31]
    ds_read_b64_tr_b16 v[108:109], v239 offset:0
    s_waitcnt lgkmcnt(7)
    v_mfma_f32_16x16x32_bf16 v[32:35], v[112:115], a[24:27], v[32:35]
    ds_read_b64_tr_b16 v[110:111], v239 offset:4096
    v_mfma_f32_16x16x32_bf16 v[36:39], v[112:115], a[28:31], v[36:39]
    ds_read_b64_tr_b16 v[112:113], v236 offset:1024
    v_mfma_f32_16x16x32_bf16 v[40:43], v[116:119], a[24:27], v[40:43]
    ds_read_b64_tr_b16 v[114:115], v236 offset:5120
    v_mfma_f32_16x16x32_bf16 v[44:47], v[116:119], a[28:31], v[44:47]
    ds_read_b64_tr_b16 v[116:117], v237 offset:1024
    v_mfma_f32_16x16x32_bf16 v[48:51], v[120:123], a[24:27], v[48:51]
    ds_read_b64_tr_b16 v[118:119], v237 offset:5120
    v_mfma_f32_16x16x32_bf16 v[52:55], v[120:123], a[28:31], v[52:55]
    ds_read_b64_tr_b16 v[120:121], v238 offset:1024
    v_mfma_f32_16x16x32_bf16 v[56:59], v[124:127], a[24:27], v[56:59]
    ds_read_b64_tr_b16 v[122:123], v238 offset:5120
    v_mfma_f32_16x16x32_bf16 v[60:63], v[124:127], a[28:31], v[60:63]
    ds_read_b64_tr_b16 v[124:125], v239 offset:1024
    ds_read_b64_tr_b16 v[126:127], v239 offset:5120
    s_waitcnt lgkmcnt(8)
    v_mfma_f32_16x16x32_bf16 v[0:3], v[96:99], a[32:35], v[0:3]
    v_add_u32 v232, 131072, v248
    v_add_u32 v233, 131072, v249
    v_mfma_f32_16x16x32_bf16 v[4:7], v[96:99], a[36:39], v[4:7]
    ds_read_b64_tr_b16 v[96:97], v236 offset:8192
    v_add_u32 v234, 131072, v250
    v_mfma_f32_16x16x32_bf16 v[8:11], v[100:103], a[32:35], v[8:11]
    ds_read_b64_tr_b16 v[98:99], v236 offset:12288
    v_add_u32 v235, 131072, v251
    v_mfma_f32_16x16x32_bf16 v[12:15], v[100:103], a[36:39], v[12:15]
    ds_read_b64_tr_b16 v[100:101], v237 offset:8192
    v_readlane_b32 s71, v244, 20
    v_mfma_f32_16x16x32_bf16 v[16:19], v[104:107], a[32:35], v[16:19]
    ds_read_b64_tr_b16 v[102:103], v237 offset:12288
    buffer_load_dwordx4 a[0:3], v254, s[24:27], s66 offen offset:0 sc1
    v_mfma_f32_16x16x32_bf16 v[20:23], v[104:107], a[36:39], v[20:23]
    ds_read_b64_tr_b16 v[104:105], v238 offset:8192
    buffer_load_dwordx4 a[4:7], v254, s[24:27], s66 offen offset:1024 sc1
    v_mfma_f32_16x16x32_bf16 v[24:27], v[108:111], a[32:35], v[24:27]
    ds_read_b64_tr_b16 v[106:107], v238 offset:12288
    s_add_u32 m0, s40, 155648
    v_mfma_f32_16x16x32_bf16 v[28:31], v[108:111], a[36:39], v[28:31]
    ds_read_b64_tr_b16 v[108:109], v239 offset:8192
    s_waitcnt lgkmcnt(7)
    v_mfma_f32_16x16x32_bf16 v[32:35], v[112:115], a[32:35], v[32:35]
    ds_read_b64_tr_b16 v[110:111], v239 offset:12288
    buffer_load_dwordx4 v247, s[8:11], s69 offen offset:0 lds
    v_mfma_f32_16x16x32_bf16 v[36:39], v[112:115], a[36:39], v[36:39]
    ds_read_b64_tr_b16 v[112:113], v236 offset:9216
    buffer_load_dwordx4 v245, s[8:11], s69 offen offset:1024 lds
    v_mfma_f32_16x16x32_bf16 v[40:43], v[116:119], a[32:35], v[40:43]
    ds_read_b64_tr_b16 v[114:115], v236 offset:13312
    v_lshrrev_b32 v128, 3, v255
    v_mfma_f32_16x16x32_bf16 v[44:47], v[116:119], a[36:39], v[44:47]
    ds_read_b64_tr_b16 v[116:117], v237 offset:9216
    v_and_b32 v129, 4, v128
    v_mfma_f32_16x16x32_bf16 v[48:51], v[120:123], a[32:35], v[48:51]
    ds_read_b64_tr_b16 v[118:119], v237 offset:13312
    v_add_u32 v128, v128, v129
    v_mfma_f32_16x16x32_bf16 v[52:55], v[120:123], a[36:39], v[52:55]
    ds_read_b64_tr_b16 v[120:121], v238 offset:9216
    s_and_b32 s34, s28, 1
    v_mfma_f32_16x16x32_bf16 v[56:59], v[124:127], a[32:35], v[56:59]
    ds_read_b64_tr_b16 v[122:123], v238 offset:13312
    s_lshl_b32 s34, s34, 4
    v_mfma_f32_16x16x32_bf16 v[60:63], v[124:127], a[36:39], v[60:63]
    ds_read_b64_tr_b16 v[124:125], v239 offset:9216
    ds_read_b64_tr_b16 v[126:127], v239 offset:13312
    s_waitcnt vmcnt(14) lgkmcnt(8)
    v_mfma_f32_16x16x32_bf16 v[0:3], v[96:99], a[40:43], v[0:3]
    v_readlane_b32 s72, v244, 21
    buffer_load_dwordx4 a[8:11], v254, s[24:27], s67 offen offset:0 sc1
    v_mfma_f32_16x16x32_bf16 v[4:7], v[96:99], a[44:47], v[4:7]
    ds_read_b64_tr_b16 v[96:97], v236 offset:16384
    buffer_load_dwordx4 a[12:15], v254, s[24:27], s67 offen offset:1024 sc1
    v_mfma_f32_16x16x32_bf16 v[8:11], v[100:103], a[40:43], v[8:11]
    ds_read_b64_tr_b16 v[98:99], v236 offset:20480
    s_add_u32 m0, s40, 0
    v_mfma_f32_16x16x32_bf16 v[12:15], v[100:103], a[44:47], v[12:15]
    ds_read_b64_tr_b16 v[100:101], v237 offset:16384
    buffer_load_dwordx4 v247, s[8:11], s71 offen offset:0 lds
    v_mfma_f32_16x16x32_bf16 v[16:19], v[104:107], a[40:43], v[16:19]
    ds_read_b64_tr_b16 v[102:103], v237 offset:20480
    buffer_load_dwordx4 v245, s[8:11], s71 offen offset:1024 lds
    v_mfma_f32_16x16x32_bf16 v[20:23], v[104:107], a[44:47], v[20:23]
    ds_read_b64_tr_b16 v[104:105], v238 offset:16384
    s_lshr_b32 s35, s28, 1
    v_mfma_f32_16x16x32_bf16 v[24:27], v[108:111], a[40:43], v[24:27]
    ds_read_b64_tr_b16 v[106:107], v238 offset:20480
    s_lshl_b32 s35, s35, 2
    v_mfma_f32_16x16x32_bf16 v[28:31], v[108:111], a[44:47], v[28:31]
    ds_read_b64_tr_b16 v[108:109], v239 offset:16384
    s_waitcnt lgkmcnt(7)
    v_mfma_f32_16x16x32_bf16 v[32:35], v[112:115], a[40:43], v[32:35]
    ds_read_b64_tr_b16 v[110:111], v239 offset:20480
    s_add_u32 s34, s34, s35
    v_mfma_f32_16x16x32_bf16 v[36:39], v[112:115], a[44:47], v[36:39]
    ds_read_b64_tr_b16 v[112:113], v236 offset:17408
    v_add_u32 v128, s34, v128
    v_mfma_f32_16x16x32_bf16 v[40:43], v[116:119], a[40:43], v[40:43]
    ds_read_b64_tr_b16 v[114:115], v236 offset:21504
    v_mul_u32_u24 v128, 2048, v128
    v_mfma_f32_16x16x32_bf16 v[44:47], v[116:119], a[44:47], v[44:47]
    ds_read_b64_tr_b16 v[116:117], v237 offset:17408
    v_lshrrev_b32 v129, 4, v255
    v_mfma_f32_16x16x32_bf16 v[48:51], v[120:123], a[40:43], v[48:51]
    ds_read_b64_tr_b16 v[118:119], v237 offset:21504
    v_lshlrev_b32 v129, 1, v129
    v_mfma_f32_16x16x32_bf16 v[52:55], v[120:123], a[44:47], v[52:55]
    ds_read_b64_tr_b16 v[120:121], v238 offset:17408
    v_and_b32 v226, 7, v255
    v_mfma_f32_16x16x32_bf16 v[56:59], v[124:127], a[40:43], v[56:59]
    ds_read_b64_tr_b16 v[122:123], v238 offset:21504
    v_xor_b32 v226, v226, v129
    v_mfma_f32_16x16x32_bf16 v[60:63], v[124:127], a[44:47], v[60:63]
    ds_read_b64_tr_b16 v[124:125], v239 offset:17408
    ds_read_b64_tr_b16 v[126:127], v239 offset:21504
    s_waitcnt vmcnt(14) lgkmcnt(8)
    v_mfma_f32_16x16x32_bf16 v[0:3], v[96:99], a[48:51], v[0:3]
    v_readlane_b32 s73, v244, 22
    buffer_load_dwordx4 a[16:19], v254, s[24:27], s68 offen offset:0 sc1
    v_mfma_f32_16x16x32_bf16 v[4:7], v[96:99], a[52:55], v[4:7]
    ds_read_b64_tr_b16 v[96:97], v236 offset:24576
    buffer_load_dwordx4 a[20:23], v254, s[24:27], s68 offen offset:1024 sc1
    v_mfma_f32_16x16x32_bf16 v[8:11], v[100:103], a[48:51], v[8:11]
    ds_read_b64_tr_b16 v[98:99], v236 offset:28672
    s_add_u32 m0, s40, 8192
    v_mfma_f32_16x16x32_bf16 v[12:15], v[100:103], a[52:55], v[12:15]
    ds_read_b64_tr_b16 v[100:101], v237 offset:24576
    buffer_load_dwordx4 v247, s[8:11], s72 offen offset:0 lds
    v_mfma_f32_16x16x32_bf16 v[16:19], v[104:107], a[48:51], v[16:19]
    ds_read_b64_tr_b16 v[102:103], v237 offset:28672
    buffer_load_dwordx4 v245, s[8:11], s72 offen offset:1024 lds
    v_mfma_f32_16x16x32_bf16 v[20:23], v[104:107], a[52:55], v[20:23]
    ds_read_b64_tr_b16 v[104:105], v238 offset:24576
    v_lshl_add_u32 v226, v226, 4, v128
    v_mfma_f32_16x16x32_bf16 v[24:27], v[108:111], a[48:51], v[24:27]
    ds_read_b64_tr_b16 v[106:107], v238 offset:28672
    s_xor_b32 s34, s30, 1
    v_mfma_f32_16x16x32_bf16 v[28:31], v[108:111], a[52:55], v[28:31]
    ds_read_b64_tr_b16 v[108:109], v239 offset:24576
    s_waitcnt lgkmcnt(7)
    v_mfma_f32_16x16x32_bf16 v[32:35], v[112:115], a[48:51], v[32:35]
    ds_read_b64_tr_b16 v[110:111], v239 offset:28672
    s_sub_i32 s34, s34, s30
    v_mfma_f32_16x16x32_bf16 v[36:39], v[112:115], a[52:55], v[36:39]
    ds_read_b64_tr_b16 v[112:113], v236 offset:25600
    s_lshl_b32 s34, s34, 7
    v_mfma_f32_16x16x32_bf16 v[40:43], v[116:119], a[48:51], v[40:43]
    ds_read_b64_tr_b16 v[114:115], v236 offset:29696
    s_add_u32 s34, s34, 2048
    v_mfma_f32_16x16x32_bf16 v[44:47], v[116:119], a[52:55], v[44:47]
    ds_read_b64_tr_b16 v[116:117], v237 offset:25600
    v_add_u32 v225, s34, v226
    v_mfma_f32_16x16x32_bf16 v[48:51], v[120:123], a[48:51], v[48:51]
    ds_read_b64_tr_b16 v[118:119], v237 offset:29696
    v_add_u32 v227, 3072, v226
    v_mfma_f32_16x16x32_bf16 v[52:55], v[120:123], a[52:55], v[52:55]
    ds_read_b64_tr_b16 v[120:121], v238 offset:25600
    v_add_u32 v226, 2048, v226
    v_mfma_f32_16x16x32_bf16 v[56:59], v[124:127], a[48:51], v[56:59]
    ds_read_b64_tr_b16 v[122:123], v238 offset:29696
    v_mfma_f32_16x16x32_bf16 v[60:63], v[124:127], a[52:55], v[60:63]
    ds_read_b64_tr_b16 v[124:125], v239 offset:25600
    ds_read_b64_tr_b16 v[126:127], v239 offset:29696
    s_waitcnt vmcnt(14) lgkmcnt(8)
    v_mfma_f32_16x16x32_bf16 v[0:3], v[96:99], a[56:59], v[0:3]
    v_readlane_b32 s74, v244, 23
    buffer_load_dwordx4 a[24:27], v254, s[24:27], s69 offen offset:0 sc1
    v_mfma_f32_16x16x32_bf16 v[4:7], v[96:99], a[60:63], v[4:7]
    s_waitcnt vmcnt(9)
    s_barrier
    ds_read_b64_tr_b16 v[96:97], v232 offset:0
    v_mfma_f32_16x16x32_bf16 v[8:11], v[100:103], a[56:59], v[8:11]
    ds_read_b64_tr_b16 v[98:99], v232 offset:4096
    buffer_load_dwordx4 a[28:31], v254, s[24:27], s69 offen offset:1024 sc1
    v_mfma_f32_16x16x32_bf16 v[12:15], v[100:103], a[60:63], v[12:15]
    ds_read_b64_tr_b16 v[100:101], v233 offset:0
    s_add_u32 m0, s40, 16384
    v_mfma_f32_16x16x32_bf16 v[16:19], v[104:107], a[56:59], v[16:19]
    ds_read_b64_tr_b16 v[102:103], v233 offset:4096
    buffer_load_dwordx4 v247, s[8:11], s73 offen offset:0 lds
    v_mfma_f32_16x16x32_bf16 v[20:23], v[104:107], a[60:63], v[20:23]
    ds_read_b64_tr_b16 v[104:105], v234 offset:0
    buffer_load_dwordx4 v245, s[8:11], s73 offen offset:1024 lds
    v_mfma_f32_16x16x32_bf16 v[24:27], v[108:111], a[56:59], v[24:27]
    ds_read_b64_tr_b16 v[106:107], v234 offset:4096
    v_mfma_f32_16x16x32_bf16 v[28:31], v[108:111], a[60:63], v[28:31]
    ds_read_b64_tr_b16 v[108:109], v235 offset:0
    s_waitcnt lgkmcnt(7)
    v_mfma_f32_16x16x32_bf16 v[32:35], v[112:115], a[56:59], v[32:35]
    ds_read_b64_tr_b16 v[110:111], v235 offset:4096
    v_mfma_f32_16x16x32_bf16 v[36:39], v[112:115], a[60:63], v[36:39]
    ds_read_b64_tr_b16 v[112:113], v232 offset:1024
    v_mfma_f32_16x16x32_bf16 v[40:43], v[116:119], a[56:59], v[40:43]
    ds_read_b64_tr_b16 v[114:115], v232 offset:5120
    v_mfma_f32_16x16x32_bf16 v[44:47], v[116:119], a[60:63], v[44:47]
    ds_read_b64_tr_b16 v[116:117], v233 offset:1024
    v_mfma_f32_16x16x32_bf16 v[48:51], v[120:123], a[56:59], v[48:51]
    ds_read_b64_tr_b16 v[118:119], v233 offset:5120
    v_mfma_f32_16x16x32_bf16 v[52:55], v[120:123], a[60:63], v[52:55]
    ds_read_b64_tr_b16 v[120:121], v234 offset:1024
    v_mfma_f32_16x16x32_bf16 v[56:59], v[124:127], a[56:59], v[56:59]
    ds_read_b64_tr_b16 v[122:123], v234 offset:5120
    v_mfma_f32_16x16x32_bf16 v[60:63], v[124:127], a[60:63], v[60:63]
    ds_read_b64_tr_b16 v[124:125], v235 offset:1024
    ds_read_b64_tr_b16 v[126:127], v235 offset:5120
    s_waitcnt lgkmcnt(8)
    v_mfma_f32_16x16x32_bf16 v[0:3], v[96:99], a[0:3], v[0:3]
    v_add_u32 v236, 0, v248
    v_add_u32 v237, 0, v249
    v_mfma_f32_16x16x32_bf16 v[4:7], v[96:99], a[4:7], v[4:7]
    ds_read_b64_tr_b16 v[96:97], v232 offset:8192
    v_add_u32 v238, 0, v250
    v_mfma_f32_16x16x32_bf16 v[8:11], v[100:103], a[0:3], v[8:11]
    ds_read_b64_tr_b16 v[98:99], v232 offset:12288
    v_add_u32 v239, 0, v251
    v_mfma_f32_16x16x32_bf16 v[12:15], v[100:103], a[4:7], v[12:15]
    ds_read_b64_tr_b16 v[100:101], v233 offset:8192
    v_readlane_b32 s75, v244, 24
    v_mfma_f32_16x16x32_bf16 v[16:19], v[104:107], a[0:3], v[16:19]
    ds_read_b64_tr_b16 v[102:103], v233 offset:12288
    buffer_load_dwordx4 a[32:35], v254, s[24:27], s71 offen offset:0 sc1
    v_mfma_f32_16x16x32_bf16 v[20:23], v[104:107], a[4:7], v[20:23]
    ds_read_b64_tr_b16 v[104:105], v234 offset:8192
    buffer_load_dwordx4 a[36:39], v254, s[24:27], s71 offen offset:1024 sc1
    v_mfma_f32_16x16x32_bf16 v[24:27], v[108:111], a[0:3], v[24:27]
    ds_read_b64_tr_b16 v[106:107], v234 offset:12288
    s_add_u32 m0, s40, 24576
    v_mfma_f32_16x16x32_bf16 v[28:31], v[108:111], a[4:7], v[28:31]
    ds_read_b64_tr_b16 v[108:109], v235 offset:8192
    s_waitcnt lgkmcnt(7)
    v_mfma_f32_16x16x32_bf16 v[32:35], v[112:115], a[0:3], v[32:35]
    ds_read_b64_tr_b16 v[110:111], v235 offset:12288
    buffer_load_dwordx4 v247, s[8:11], s74 offen offset:0 lds
    v_mfma_f32_16x16x32_bf16 v[36:39], v[112:115], a[4:7], v[36:39]
    ds_read_b64_tr_b16 v[112:113], v232 offset:9216
    buffer_load_dwordx4 v245, s[8:11], s74 offen offset:1024 lds
    v_mfma_f32_16x16x32_bf16 v[40:43], v[116:119], a[0:3], v[40:43]
    ds_read_b64_tr_b16 v[114:115], v232 offset:13312
    buffer_load_dword a64, v242, s[12:15], 0 offen offset:0 sc1
    v_mfma_f32_16x16x32_bf16 v[44:47], v[116:119], a[4:7], v[44:47]
    ds_read_b64_tr_b16 v[116:117], v233 offset:9216
    buffer_load_dword a65, v242, s[12:15], 0 offen offset:512 sc1
    v_mfma_f32_16x16x32_bf16 v[48:51], v[120:123], a[0:3], v[48:51]
    ds_read_b64_tr_b16 v[118:119], v233 offset:13312
    buffer_load_dword a66, v242, s[12:15], 0 offen offset:1024 sc1
    v_mfma_f32_16x16x32_bf16 v[52:55], v[120:123], a[4:7], v[52:55]
    ds_read_b64_tr_b16 v[120:121], v234 offset:9216
    buffer_load_dword a67, v242, s[12:15], 0 offen offset:1536 sc1
    v_mfma_f32_16x16x32_bf16 v[56:59], v[124:127], a[0:3], v[56:59]
    ds_read_b64_tr_b16 v[122:123], v234 offset:13312
    buffer_load_dword a68, v242, s[12:15], 0 offen offset:2048 sc1
    v_mfma_f32_16x16x32_bf16 v[60:63], v[124:127], a[4:7], v[60:63]
    ds_read_b64_tr_b16 v[124:125], v235 offset:9216
    ds_read_b64_tr_b16 v[126:127], v235 offset:13312
    s_waitcnt vmcnt(19) lgkmcnt(8)
    v_mfma_f32_16x16x32_bf16 v[0:3], v[96:99], a[8:11], v[0:3]
    v_readlane_b32 s76, v244, 25
    buffer_load_dwordx4 a[40:43], v254, s[24:27], s72 offen offset:0 sc1
    v_mfma_f32_16x16x32_bf16 v[4:7], v[96:99], a[12:15], v[4:7]
    ds_read_b64_tr_b16 v[96:97], v232 offset:16384
    buffer_load_dwordx4 a[44:47], v254, s[24:27], s72 offen offset:1024 sc1
    v_mfma_f32_16x16x32_bf16 v[8:11], v[100:103], a[8:11], v[8:11]
    ds_read_b64_tr_b16 v[98:99], v232 offset:20480
    s_add_u32 m0, s40, 32768
    v_mfma_f32_16x16x32_bf16 v[12:15], v[100:103], a[12:15], v[12:15]
    ds_read_b64_tr_b16 v[100:101], v233 offset:16384
    buffer_load_dwordx4 v247, s[8:11], s75 offen offset:0 lds
    v_mfma_f32_16x16x32_bf16 v[16:19], v[104:107], a[8:11], v[16:19]
    ds_read_b64_tr_b16 v[102:103], v233 offset:20480
    buffer_load_dwordx4 v245, s[8:11], s75 offen offset:1024 lds
    v_mfma_f32_16x16x32_bf16 v[20:23], v[104:107], a[12:15], v[20:23]
    ds_read_b64_tr_b16 v[104:105], v234 offset:16384
    buffer_load_dword a69, v242, s[12:15], 0 offen offset:2560 sc1
    v_mfma_f32_16x16x32_bf16 v[24:27], v[108:111], a[8:11], v[24:27]
    ds_read_b64_tr_b16 v[106:107], v234 offset:20480
    buffer_load_dword a70, v242, s[12:15], 0 offen offset:3072 sc1
    v_mfma_f32_16x16x32_bf16 v[28:31], v[108:111], a[12:15], v[28:31]
    ds_read_b64_tr_b16 v[108:109], v235 offset:16384
    s_waitcnt lgkmcnt(7)
    v_mfma_f32_16x16x32_bf16 v[32:35], v[112:115], a[8:11], v[32:35]
    ds_read_b64_tr_b16 v[110:111], v235 offset:20480
    buffer_load_dword a71, v242, s[12:15], 0 offen offset:3584 sc1
    v_mfma_f32_16x16x32_bf16 v[36:39], v[112:115], a[12:15], v[36:39]
    ds_read_b64_tr_b16 v[112:113], v232 offset:17408
    v_mfma_f32_16x16x32_bf16 v[40:43], v[116:119], a[8:11], v[40:43]
    ds_read_b64_tr_b16 v[114:115], v232 offset:21504
    v_mfma_f32_16x16x32_bf16 v[44:47], v[116:119], a[12:15], v[44:47]
    ds_read_b64_tr_b16 v[116:117], v233 offset:17408
    v_mfma_f32_16x16x32_bf16 v[48:51], v[120:123], a[8:11], v[48:51]
    ds_read_b64_tr_b16 v[118:119], v233 offset:21504
    v_mfma_f32_16x16x32_bf16 v[52:55], v[120:123], a[12:15], v[52:55]
    ds_read_b64_tr_b16 v[120:121], v234 offset:17408
    v_mfma_f32_16x16x32_bf16 v[56:59], v[124:127], a[8:11], v[56:59]
    ds_read_b64_tr_b16 v[122:123], v234 offset:21504
    v_mfma_f32_16x16x32_bf16 v[60:63], v[124:127], a[12:15], v[60:63]
    ds_read_b64_tr_b16 v[124:125], v235 offset:17408
    ds_read_b64_tr_b16 v[126:127], v235 offset:21504
    s_waitcnt vmcnt(22) lgkmcnt(8)
    v_mfma_f32_16x16x32_bf16 v[0:3], v[96:99], a[16:19], v[0:3]
    v_readlane_b32 s77, v244, 26
    buffer_load_dwordx4 a[48:51], v254, s[24:27], s73 offen offset:0 sc1
    v_mfma_f32_16x16x32_bf16 v[4:7], v[96:99], a[20:23], v[4:7]
    ds_read_b64_tr_b16 v[96:97], v232 offset:24576
    buffer_load_dwordx4 a[52:55], v254, s[24:27], s73 offen offset:1024 sc1
    v_mfma_f32_16x16x32_bf16 v[8:11], v[100:103], a[16:19], v[8:11]
    ds_read_b64_tr_b16 v[98:99], v232 offset:28672
    s_add_u32 m0, s40, 40960
    v_mfma_f32_16x16x32_bf16 v[12:15], v[100:103], a[20:23], v[12:15]
    ds_read_b64_tr_b16 v[100:101], v233 offset:24576
    buffer_load_dwordx4 v247, s[8:11], s76 offen offset:0 lds
    v_mfma_f32_16x16x32_bf16 v[16:19], v[104:107], a[16:19], v[16:19]
    ds_read_b64_tr_b16 v[102:103], v233 offset:28672
    buffer_load_dwordx4 v245, s[8:11], s76 offen offset:1024 lds
    v_mfma_f32_16x16x32_bf16 v[20:23], v[104:107], a[20:23], v[20:23]
    ds_read_b64_tr_b16 v[104:105], v234 offset:24576
    v_mfma_f32_16x16x32_bf16 v[24:27], v[108:111], a[16:19], v[24:27]
    ds_read_b64_tr_b16 v[106:107], v234 offset:28672
    v_mfma_f32_16x16x32_bf16 v[28:31], v[108:111], a[20:23], v[28:31]
    ds_read_b64_tr_b16 v[108:109], v235 offset:24576
    s_waitcnt lgkmcnt(7)
    v_mfma_f32_16x16x32_bf16 v[32:35], v[112:115], a[16:19], v[32:35]
    ds_read_b64_tr_b16 v[110:111], v235 offset:28672
    v_mfma_f32_16x16x32_bf16 v[36:39], v[112:115], a[20:23], v[36:39]
    ds_read_b64_tr_b16 v[112:113], v232 offset:25600
    v_mfma_f32_16x16x32_bf16 v[40:43], v[116:119], a[16:19], v[40:43]
    ds_read_b64_tr_b16 v[114:115], v232 offset:29696
    v_mfma_f32_16x16x32_bf16 v[44:47], v[116:119], a[20:23], v[44:47]
    ds_read_b64_tr_b16 v[116:117], v233 offset:25600
    v_mfma_f32_16x16x32_bf16 v[48:51], v[120:123], a[16:19], v[48:51]
    ds_read_b64_tr_b16 v[118:119], v233 offset:29696
    v_mfma_f32_16x16x32_bf16 v[52:55], v[120:123], a[20:23], v[52:55]
    ds_read_b64_tr_b16 v[120:121], v234 offset:25600
    v_mfma_f32_16x16x32_bf16 v[56:59], v[124:127], a[16:19], v[56:59]
    ds_read_b64_tr_b16 v[122:123], v234 offset:29696
    v_mfma_f32_16x16x32_bf16 v[60:63], v[124:127], a[20:23], v[60:63]
    ds_read_b64_tr_b16 v[124:125], v235 offset:25600
    ds_read_b64_tr_b16 v[126:127], v235 offset:29696
    s_waitcnt vmcnt(22) lgkmcnt(8)
    v_mfma_f32_16x16x32_bf16 v[0:3], v[96:99], a[24:27], v[0:3]
    v_readlane_b32 s59, v244, 27
    buffer_load_dwordx4 a[56:59], v254, s[24:27], s74 offen offset:0 sc1
    v_mfma_f32_16x16x32_bf16 v[4:7], v[96:99], a[28:31], v[4:7]
    s_waitcnt vmcnt(17)
    s_barrier
    ds_read_b64_tr_b16 v[96:97], v236 offset:0
    v_mfma_f32_16x16x32_bf16 v[8:11], v[100:103], a[24:27], v[8:11]
    ds_read_b64_tr_b16 v[98:99], v236 offset:4096
    buffer_load_dwordx4 a[60:63], v254, s[24:27], s74 offen offset:1024 sc1
    v_mfma_f32_16x16x32_bf16 v[12:15], v[100:103], a[28:31], v[12:15]
    ds_read_b64_tr_b16 v[100:101], v237 offset:0
    s_add_u32 m0, s40, 49152
    v_mfma_f32_16x16x32_bf16 v[16:19], v[104:107], a[24:27], v[16:19]
    ds_read_b64_tr_b16 v[102:103], v237 offset:4096
    buffer_load_dwordx4 v247, s[8:11], s77 offen offset:0 lds
    v_mfma_f32_16x16x32_bf16 v[20:23], v[104:107], a[28:31], v[20:23]
    ds_read_b64_tr_b16 v[104:105], v238 offset:0
    buffer_load_dwordx4 v245, s[8:11], s77 offen offset:1024 lds
    v_mfma_f32_16x16x32_bf16 v[24:27], v[108:111], a[24:27], v[24:27]
    ds_read_b64_tr_b16 v[106:107], v238 offset:4096
    v_mfma_f32_16x16x32_bf16 v[28:31], v[108:111], a[28:31], v[28:31]
    ds_read_b64_tr_b16 v[108:109], v239 offset:0
    s_waitcnt lgkmcnt(7)
    v_mfma_f32_16x16x32_bf16 v[32:35], v[112:115], a[24:27], v[32:35]
    ds_read_b64_tr_b16 v[110:111], v239 offset:4096
    v_mfma_f32_16x16x32_bf16 v[36:39], v[112:115], a[28:31], v[36:39]
    ds_read_b64_tr_b16 v[112:113], v236 offset:1024
    v_mfma_f32_16x16x32_bf16 v[40:43], v[116:119], a[24:27], v[40:43]
    ds_read_b64_tr_b16 v[114:115], v236 offset:5120
    v_mfma_f32_16x16x32_bf16 v[44:47], v[116:119], a[28:31], v[44:47]
    ds_read_b64_tr_b16 v[116:117], v237 offset:1024
    v_mfma_f32_16x16x32_bf16 v[48:51], v[120:123], a[24:27], v[48:51]
    ds_read_b64_tr_b16 v[118:119], v237 offset:5120
    v_mfma_f32_16x16x32_bf16 v[52:55], v[120:123], a[28:31], v[52:55]
    ds_read_b64_tr_b16 v[120:121], v238 offset:1024
    v_mfma_f32_16x16x32_bf16 v[56:59], v[124:127], a[24:27], v[56:59]
    ds_read_b64_tr_b16 v[122:123], v238 offset:5120
    v_mfma_f32_16x16x32_bf16 v[60:63], v[124:127], a[28:31], v[60:63]
    ds_read_b64_tr_b16 v[124:125], v239 offset:1024
    ds_read_b64_tr_b16 v[126:127], v239 offset:5120
    s_waitcnt lgkmcnt(8)
    v_mfma_f32_16x16x32_bf16 v[0:3], v[96:99], a[32:35], v[0:3]
    v_add_u32 v232, 32768, v248
    v_add_u32 v233, 32768, v249
    v_mfma_f32_16x16x32_bf16 v[4:7], v[96:99], a[36:39], v[4:7]
    ds_read_b64_tr_b16 v[96:97], v236 offset:8192
    v_add_u32 v234, 32768, v250
    v_mfma_f32_16x16x32_bf16 v[8:11], v[100:103], a[32:35], v[8:11]
    ds_read_b64_tr_b16 v[98:99], v236 offset:12288
    v_add_u32 v235, 32768, v251
    v_mfma_f32_16x16x32_bf16 v[12:15], v[100:103], a[36:39], v[12:15]
    ds_read_b64_tr_b16 v[100:101], v237 offset:8192
    v_readlane_b32 s64, v244, 28
    v_mfma_f32_16x16x32_bf16 v[16:19], v[104:107], a[32:35], v[16:19]
    ds_read_b64_tr_b16 v[102:103], v237 offset:12288
    buffer_load_dwordx4 a[0:3], v254, s[24:27], s75 offen offset:0 sc1
    v_mfma_f32_16x16x32_bf16 v[20:23], v[104:107], a[36:39], v[20:23]
    ds_read_b64_tr_b16 v[104:105], v238 offset:8192
    buffer_load_dwordx4 a[4:7], v254, s[24:27], s75 offen offset:1024 sc1
    v_mfma_f32_16x16x32_bf16 v[24:27], v[108:111], a[32:35], v[24:27]
    ds_read_b64_tr_b16 v[106:107], v238 offset:12288
    s_add_u32 m0, s40, 57344
    v_mfma_f32_16x16x32_bf16 v[28:31], v[108:111], a[36:39], v[28:31]
    ds_read_b64_tr_b16 v[108:109], v239 offset:8192
    s_waitcnt lgkmcnt(7)
    v_mfma_f32_16x16x32_bf16 v[32:35], v[112:115], a[32:35], v[32:35]
    ds_read_b64_tr_b16 v[110:111], v239 offset:12288
    buffer_load_dwordx4 v247, s[8:11], s59 offen offset:0 lds
    v_mfma_f32_16x16x32_bf16 v[36:39], v[112:115], a[36:39], v[36:39]
    ds_read_b64_tr_b16 v[112:113], v236 offset:9216
    buffer_load_dwordx4 v245, s[8:11], s59 offen offset:1024 lds
    v_mfma_f32_16x16x32_bf16 v[40:43], v[116:119], a[32:35], v[40:43]
    ds_read_b64_tr_b16 v[114:115], v236 offset:13312
    v_mfma_f32_16x16x32_bf16 v[44:47], v[116:119], a[36:39], v[44:47]
    ds_read_b64_tr_b16 v[116:117], v237 offset:9216
    v_mfma_f32_16x16x32_bf16 v[48:51], v[120:123], a[32:35], v[48:51]
    ds_read_b64_tr_b16 v[118:119], v237 offset:13312
    v_mfma_f32_16x16x32_bf16 v[52:55], v[120:123], a[36:39], v[52:55]
    ds_read_b64_tr_b16 v[120:121], v238 offset:9216
    v_mfma_f32_16x16x32_bf16 v[56:59], v[124:127], a[32:35], v[56:59]
    ds_read_b64_tr_b16 v[122:123], v238 offset:13312
    v_mfma_f32_16x16x32_bf16 v[60:63], v[124:127], a[36:39], v[60:63]
    ds_read_b64_tr_b16 v[124:125], v239 offset:9216
    ds_read_b64_tr_b16 v[126:127], v239 offset:13312
    s_waitcnt vmcnt(17) lgkmcnt(8)
    v_mfma_f32_16x16x32_bf16 v[0:3], v[96:99], a[40:43], v[0:3]
    v_readlane_b32 s65, v244, 29
    buffer_load_dwordx4 a[8:11], v254, s[24:27], s76 offen offset:0 sc1
    v_mfma_f32_16x16x32_bf16 v[4:7], v[96:99], a[44:47], v[4:7]
    ds_read_b64_tr_b16 v[96:97], v236 offset:16384
    buffer_load_dwordx4 a[12:15], v254, s[24:27], s76 offen offset:1024 sc1
    v_mfma_f32_16x16x32_bf16 v[8:11], v[100:103], a[40:43], v[8:11]
    ds_read_b64_tr_b16 v[98:99], v236 offset:20480
    s_add_u32 m0, s40, 65536
    v_mfma_f32_16x16x32_bf16 v[12:15], v[100:103], a[44:47], v[12:15]
    ds_read_b64_tr_b16 v[100:101], v237 offset:16384
    buffer_load_dwordx4 v247, s[8:11], s64 offen offset:0 lds
    v_mfma_f32_16x16x32_bf16 v[16:19], v[104:107], a[40:43], v[16:19]
    ds_read_b64_tr_b16 v[102:103], v237 offset:20480
    buffer_load_dwordx4 v245, s[8:11], s64 offen offset:1024 lds
    v_mfma_f32_16x16x32_bf16 v[20:23], v[104:107], a[44:47], v[20:23]
    ds_read_b64_tr_b16 v[104:105], v238 offset:16384
    v_mfma_f32_16x16x32_bf16 v[24:27], v[108:111], a[40:43], v[24:27]
    ds_read_b64_tr_b16 v[106:107], v238 offset:20480
    v_mfma_f32_16x16x32_bf16 v[28:31], v[108:111], a[44:47], v[28:31]
    ds_read_b64_tr_b16 v[108:109], v239 offset:16384
    s_waitcnt lgkmcnt(7)
    v_mfma_f32_16x16x32_bf16 v[32:35], v[112:115], a[40:43], v[32:35]
    ds_read_b64_tr_b16 v[110:111], v239 offset:20480
    v_mfma_f32_16x16x32_bf16 v[36:39], v[112:115], a[44:47], v[36:39]
    ds_read_b64_tr_b16 v[112:113], v236 offset:17408
    v_mfma_f32_16x16x32_bf16 v[40:43], v[116:119], a[40:43], v[40:43]
    ds_read_b64_tr_b16 v[114:115], v236 offset:21504
    v_mfma_f32_16x16x32_bf16 v[44:47], v[116:119], a[44:47], v[44:47]
    ds_read_b64_tr_b16 v[116:117], v237 offset:17408
    v_mfma_f32_16x16x32_bf16 v[48:51], v[120:123], a[40:43], v[48:51]
    ds_read_b64_tr_b16 v[118:119], v237 offset:21504
    v_mfma_f32_16x16x32_bf16 v[52:55], v[120:123], a[44:47], v[52:55]
    ds_read_b64_tr_b16 v[120:121], v238 offset:17408
    v_mfma_f32_16x16x32_bf16 v[56:59], v[124:127], a[40:43], v[56:59]
    ds_read_b64_tr_b16 v[122:123], v238 offset:21504
    v_mfma_f32_16x16x32_bf16 v[60:63], v[124:127], a[44:47], v[60:63]
    ds_read_b64_tr_b16 v[124:125], v239 offset:17408
    ds_read_b64_tr_b16 v[126:127], v239 offset:21504
    s_waitcnt vmcnt(14) lgkmcnt(8)
    v_mfma_f32_16x16x32_bf16 v[0:3], v[96:99], a[48:51], v[0:3]
    buffer_load_dword v243, v252, s[20:23], s43 offen sc1
    v_readlane_b32 s66, v244, 30
    v_mfma_f32_16x16x32_bf16 v[4:7], v[96:99], a[52:55], v[4:7]
    ds_read_b64_tr_b16 v[96:97], v236 offset:24576
    buffer_load_dwordx4 a[16:19], v254, s[24:27], s77 offen offset:0 sc1
    v_mfma_f32_16x16x32_bf16 v[8:11], v[100:103], a[48:51], v[8:11]
    ds_read_b64_tr_b16 v[98:99], v236 offset:28672
    buffer_load_dwordx4 a[20:23], v254, s[24:27], s77 offen offset:1024 sc1
    v_mfma_f32_16x16x32_bf16 v[12:15], v[100:103], a[52:55], v[12:15]
    ds_read_b64_tr_b16 v[100:101], v237 offset:24576
    s_add_u32 m0, s40, 73728
    v_mfma_f32_16x16x32_bf16 v[16:19], v[104:107], a[48:51], v[16:19]
    ds_read_b64_tr_b16 v[102:103], v237 offset:28672
    buffer_load_dwordx4 v247, s[8:11], s65 offen offset:0 lds
    v_mfma_f32_16x16x32_bf16 v[20:23], v[104:107], a[52:55], v[20:23]
    ds_read_b64_tr_b16 v[104:105], v238 offset:24576
    buffer_load_dwordx4 v245, s[8:11], s65 offen offset:1024 lds
    v_mfma_f32_16x16x32_bf16 v[24:27], v[108:111], a[48:51], v[24:27]
    ds_read_b64_tr_b16 v[106:107], v238 offset:28672
    v_mfma_f32_16x16x32_bf16 v[28:31], v[108:111], a[52:55], v[28:31]
    ds_read_b64_tr_b16 v[108:109], v239 offset:24576
    s_waitcnt lgkmcnt(7)
    v_mfma_f32_16x16x32_bf16 v[32:35], v[112:115], a[48:51], v[32:35]
    ds_read_b64_tr_b16 v[110:111], v239 offset:28672
    v_mfma_f32_16x16x32_bf16 v[36:39], v[112:115], a[52:55], v[36:39]
    ds_read_b64_tr_b16 v[112:113], v236 offset:25600
    v_mfma_f32_16x16x32_bf16 v[40:43], v[116:119], a[48:51], v[40:43]
    ds_read_b64_tr_b16 v[114:115], v236 offset:29696
    v_mfma_f32_16x16x32_bf16 v[44:47], v[116:119], a[52:55], v[44:47]
    ds_read_b64_tr_b16 v[116:117], v237 offset:25600
    v_mfma_f32_16x16x32_bf16 v[48:51], v[120:123], a[48:51], v[48:51]
    ds_read_b64_tr_b16 v[118:119], v237 offset:29696
    v_mfma_f32_16x16x32_bf16 v[52:55], v[120:123], a[52:55], v[52:55]
    ds_read_b64_tr_b16 v[120:121], v238 offset:25600
    v_mfma_f32_16x16x32_bf16 v[56:59], v[124:127], a[48:51], v[56:59]
    ds_read_b64_tr_b16 v[122:123], v238 offset:29696
    v_mfma_f32_16x16x32_bf16 v[60:63], v[124:127], a[52:55], v[60:63]
    ds_read_b64_tr_b16 v[124:125], v239 offset:25600
    ds_read_b64_tr_b16 v[126:127], v239 offset:29696
    s_waitcnt vmcnt(15) lgkmcnt(8)
    v_mfma_f32_16x16x32_bf16 v[0:3], v[96:99], a[56:59], v[0:3]
    v_readlane_b32 s67, v244, 31
    buffer_load_dwordx4 a[24:27], v254, s[24:27], s59 offen offset:0 sc1
    v_mfma_f32_16x16x32_bf16 v[4:7], v[96:99], a[60:63], v[4:7]
    s_waitcnt vmcnt(10)
    s_barrier
    ds_read_b64_tr_b16 v[96:97], v232 offset:0
    v_mfma_f32_16x16x32_bf16 v[8:11], v[100:103], a[56:59], v[8:11]
    ds_read_b64_tr_b16 v[98:99], v232 offset:4096
    buffer_load_dwordx4 a[28:31], v254, s[24:27], s59 offen offset:1024 sc1
    v_mfma_f32_16x16x32_bf16 v[12:15], v[100:103], a[60:63], v[12:15]
    ds_read_b64_tr_b16 v[100:101], v233 offset:0
    s_add_u32 m0, s40, 81920
    v_mfma_f32_16x16x32_bf16 v[16:19], v[104:107], a[56:59], v[16:19]
    ds_read_b64_tr_b16 v[102:103], v233 offset:4096
    buffer_load_dwordx4 v247, s[8:11], s66 offen offset:0 lds
    v_mfma_f32_16x16x32_bf16 v[20:23], v[104:107], a[60:63], v[20:23]
    ds_read_b64_tr_b16 v[104:105], v234 offset:0
    buffer_load_dwordx4 v245, s[8:11], s66 offen offset:1024 lds
    v_mfma_f32_16x16x32_bf16 v[24:27], v[108:111], a[56:59], v[24:27]
    ds_read_b64_tr_b16 v[106:107], v234 offset:4096
    v_mfma_f32_16x16x32_bf16 v[28:31], v[108:111], a[60:63], v[28:31]
    ds_read_b64_tr_b16 v[108:109], v235 offset:0
    s_waitcnt lgkmcnt(7)
    v_mfma_f32_16x16x32_bf16 v[32:35], v[112:115], a[56:59], v[32:35]
    ds_read_b64_tr_b16 v[110:111], v235 offset:4096
    v_mfma_f32_16x16x32_bf16 v[36:39], v[112:115], a[60:63], v[36:39]
    ds_read_b64_tr_b16 v[112:113], v232 offset:1024
    v_mfma_f32_16x16x32_bf16 v[40:43], v[116:119], a[56:59], v[40:43]
    ds_read_b64_tr_b16 v[114:115], v232 offset:5120
    v_mfma_f32_16x16x32_bf16 v[44:47], v[116:119], a[60:63], v[44:47]
    ds_read_b64_tr_b16 v[116:117], v233 offset:1024
    v_mfma_f32_16x16x32_bf16 v[48:51], v[120:123], a[56:59], v[48:51]
    ds_read_b64_tr_b16 v[118:119], v233 offset:5120
    v_mfma_f32_16x16x32_bf16 v[52:55], v[120:123], a[60:63], v[52:55]
    ds_read_b64_tr_b16 v[120:121], v234 offset:1024
    v_mfma_f32_16x16x32_bf16 v[56:59], v[124:127], a[56:59], v[56:59]
    ds_read_b64_tr_b16 v[122:123], v234 offset:5120
    v_mfma_f32_16x16x32_bf16 v[60:63], v[124:127], a[60:63], v[60:63]
    ds_read_b64_tr_b16 v[124:125], v235 offset:1024
    ds_read_b64_tr_b16 v[126:127], v235 offset:5120
    v_add_u32 v236, 65536, v248
    v_add_u32 v237, 65536, v249
    v_add_u32 v238, 65536, v250
    v_add_u32 v239, 65536, v251
    s_waitcnt vmcnt(8)
    v_cmp_gt_u32 vcc, 32, v243
    s_cbranch_vccz L_chk43
    s_mov_b64 exec, 1
    s_mov_b32 s3, 0x40000
L_poll44:
    buffer_load_dword v243, v252, s[20:23], s43 offen sc1
    s_sub_u32 s3, s3, 1
    s_cbranch_scc1 L_poll44_y
    s_waitcnt vmcnt(0)
    v_cmp_gt_u32 vcc, 32, v243
    s_cbranch_vccz L_poll44_y
    s_sleep 1
    s_branch L_poll44
L_poll44_y:
    s_waitcnt vmcnt(0)
    s_mov_b64 exec, -1
L_poll44_x:
L_chk43:
    s_add_u32 s43, s43, 4352
    s_waitcnt lgkmcnt(8)
    v_mfma_f32_16x16x32_bf16 v[0:3], v[96:99], a[0:3], v[0:3]
    v_readlane_b32 s68, v244, 32
    buffer_load_dwordx4 a[32:35], v254, s[24:27], s64 offen offset:0 sc1
    v_mfma_f32_16x16x32_bf16 v[4:7], v[96:99], a[4:7], v[4:7]
    ds_read_b64_tr_b16 v[96:97], v232 offset:8192
    buffer_load_dwordx4 a[36:39], v254, s[24:27], s64 offen offset:1024 sc1
    v_mfma_f32_16x16x32_bf16 v[8:11], v[100:103], a[0:3], v[8:11]
    ds_read_b64_tr_b16 v[98:99], v232 offset:12288
    s_add_u32 m0, s40, 90112
    v_mfma_f32_16x16x32_bf16 v[12:15], v[100:103], a[4:7], v[12:15]
    ds_read_b64_tr_b16 v[100:101], v233 offset:8192
    buffer_load_dwordx4 v247, s[8:11], s67 offen offset:0 lds
    v_mfma_f32_16x16x32_bf16 v[16:19], v[104:107], a[0:3], v[16:19]
    ds_read_b64_tr_b16 v[102:103], v233 offset:12288
    buffer_load_dwordx4 v245, s[8:11], s67 offen offset:1024 lds
    v_mfma_f32_16x16x32_bf16 v[20:23], v[104:107], a[4:7], v[20:23]
    ds_read_b64_tr_b16 v[104:105], v234 offset:8192
    v_accvgpr_read_b32 v128, a64
    v_mfma_f32_16x16x32_bf16 v[24:27], v[108:111], a[0:3], v[24:27]
    ds_read_b64_tr_b16 v[106:107], v234 offset:12288
    v_accvgpr_read_b32 v129, a65
    v_mfma_f32_16x16x32_bf16 v[28:31], v[108:111], a[4:7], v[28:31]
    ds_read_b64_tr_b16 v[108:109], v235 offset:8192
    s_waitcnt lgkmcnt(7)
    v_mfma_f32_16x16x32_bf16 v[32:35], v[112:115], a[0:3], v[32:35]
    ds_read_b64_tr_b16 v[110:111], v235 offset:12288
    v_accvgpr_read_b32 v130, a66
    v_mfma_f32_16x16x32_bf16 v[36:39], v[112:115], a[4:7], v[36:39]
    ds_read_b64_tr_b16 v[112:113], v232 offset:9216
    v_accvgpr_read_b32 v131, a67
    v_mfma_f32_16x16x32_bf16 v[40:43], v[116:119], a[0:3], v[40:43]
    ds_read_b64_tr_b16 v[114:115], v232 offset:13312
    v_add_f32 v128, v128, v130
    v_mfma_f32_16x16x32_bf16 v[44:47], v[116:119], a[4:7], v[44:47]
    ds_read_b64_tr_b16 v[116:117], v233 offset:9216
    v_add_f32 v129, v129, v131
    v_mfma_f32_16x16x32_bf16 v[48:51], v[120:123], a[0:3], v[48:51]
    ds_read_b64_tr_b16 v[118:119], v233 offset:13312
    v_accvgpr_read_b32 v130, a68
    v_mfma_f32_16x16x32_bf16 v[52:55], v[120:123], a[4:7], v[52:55]
    ds_read_b64_tr_b16 v[120:121], v234 offset:9216
    v_accvgpr_read_b32 v131, a69
    v_mfma_f32_16x16x32_bf16 v[56:59], v[124:127], a[0:3], v[56:59]
    ds_read_b64_tr_b16 v[122:123], v234 offset:13312
    v_add_f32 v128, v128, v130
    v_mfma_f32_16x16x32_bf16 v[60:63], v[124:127], a[4:7], v[60:63]
    ds_read_b64_tr_b16 v[124:125], v235 offset:9216
    ds_read_b64_tr_b16 v[126:127], v235 offset:13312
    s_waitcnt lgkmcnt(8)
    v_mfma_f32_16x16x32_bf16 v[0:3], v[96:99], a[8:11], v[0:3]
    v_readlane_b32 s69, v244, 33
    buffer_load_dwordx4 a[40:43], v254, s[24:27], s65 offen offset:0 sc1
    v_mfma_f32_16x16x32_bf16 v[4:7], v[96:99], a[12:15], v[4:7]
    ds_read_b64_tr_b16 v[96:97], v232 offset:16384
    buffer_load_dwordx4 a[44:47], v254, s[24:27], s65 offen offset:1024 sc1
    v_mfma_f32_16x16x32_bf16 v[8:11], v[100:103], a[8:11], v[8:11]
    ds_read_b64_tr_b16 v[98:99], v232 offset:20480
    s_add_u32 m0, s40, 98304
    v_mfma_f32_16x16x32_bf16 v[12:15], v[100:103], a[12:15], v[12:15]
    ds_read_b64_tr_b16 v[100:101], v233 offset:16384
    buffer_load_dwordx4 v247, s[8:11], s68 offen offset:0 lds
    v_mfma_f32_16x16x32_bf16 v[16:19], v[104:107], a[8:11], v[16:19]
    ds_read_b64_tr_b16 v[102:103], v233 offset:20480
    buffer_load_dwordx4 v245, s[8:11], s68 offen offset:1024 lds
    v_mfma_f32_16x16x32_bf16 v[20:23], v[104:107], a[12:15], v[20:23]
    ds_read_b64_tr_b16 v[104:105], v234 offset:16384
    v_add_f32 v129, v129, v131
    v_mfma_f32_16x16x32_bf16 v[24:27], v[108:111], a[8:11], v[24:27]
    ds_read_b64_tr_b16 v[106:107], v234 offset:20480
    v_accvgpr_read_b32 v130, a70
    v_mfma_f32_16x16x32_bf16 v[28:31], v[108:111], a[12:15], v[28:31]
    ds_read_b64_tr_b16 v[108:109], v235 offset:16384
    s_waitcnt lgkmcnt(7)
    v_mfma_f32_16x16x32_bf16 v[32:35], v[112:115], a[8:11], v[32:35]
    ds_read_b64_tr_b16 v[110:111], v235 offset:20480
    v_accvgpr_read_b32 v131, a71
    v_mfma_f32_16x16x32_bf16 v[36:39], v[112:115], a[12:15], v[36:39]
    ds_read_b64_tr_b16 v[112:113], v232 offset:17408
    v_add_f32 v128, v128, v130
    v_mfma_f32_16x16x32_bf16 v[40:43], v[116:119], a[8:11], v[40:43]
    ds_read_b64_tr_b16 v[114:115], v232 offset:21504
    v_add_f32 v129, v129, v131
    v_mfma_f32_16x16x32_bf16 v[44:47], v[116:119], a[12:15], v[44:47]
    ds_read_b64_tr_b16 v[116:117], v233 offset:17408
    v_add_f32 v128, v128, v129
    v_mfma_f32_16x16x32_bf16 v[48:51], v[120:123], a[8:11], v[48:51]
    ds_read_b64_tr_b16 v[118:119], v233 offset:21504
    v_mov_b32 v129, v128
    v_mfma_f32_16x16x32_bf16 v[52:55], v[120:123], a[12:15], v[52:55]
    ds_read_b64_tr_b16 v[120:121], v234 offset:17408
    v_permlane32_swap_b32 v128, v129
    v_mfma_f32_16x16x32_bf16 v[56:59], v[124:127], a[8:11], v[56:59]
    ds_read_b64_tr_b16 v[122:123], v234 offset:21504
    v_add_f32 v128, v128, v129
    v_mfma_f32_16x16x32_bf16 v[60:63], v[124:127], a[12:15], v[60:63]
    ds_read_b64_tr_b16 v[124:125], v235 offset:17408
    ds_read_b64_tr_b16 v[126:127], v235 offset:21504
    s_waitcnt vmcnt(14) lgkmcnt(8)
    v_mfma_f32_16x16x32_bf16 v[0:3], v[96:99], a[16:19], v[0:3]
    v_readlane_b32 s71, v244, 34
    buffer_load_dwordx4 a[48:51], v254, s[24:27], s66 offen offset:0 sc1
    v_mfma_f32_16x16x32_bf16 v[4:7], v[96:99], a[20:23], v[4:7]
    ds_read_b64_tr_b16 v[96:97], v232 offset:24576
    buffer_load_dwordx4 a[52:55], v254, s[24:27], s66 offen offset:1024 sc1
    v_mfma_f32_16x16x32_bf16 v[8:11], v[100:103], a[16:19], v[8:11]
    ds_read_b64_tr_b16 v[98:99], v232 offset:28672
    s_add_u32 m0, s40, 106496
    v_mfma_f32_16x16x32_bf16 v[12:15], v[100:103], a[20:23], v[12:15]
    ds_read_b64_tr_b16 v[100:101], v233 offset:24576
    buffer_load_dwordx4 v247, s[8:11], s69 offen offset:0 lds
    v_mfma_f32_16x16x32_bf16 v[16:19], v[104:107], a[16:19], v[16:19]
    ds_read_b64_tr_b16 v[102:103], v233 offset:28672
    buffer_load_dwordx4 v245, s[8:11], s69 offen offset:1024 lds
    v_mfma_f32_16x16x32_bf16 v[20:23], v[104:107], a[20:23], v[20:23]
    ds_read_b64_tr_b16 v[104:105], v234 offset:24576
    v_mov_b32 v129, 0x3727c5ac
    v_mfma_f32_16x16x32_bf16 v[24:27], v[108:111], a[16:19], v[24:27]
    ds_read_b64_tr_b16 v[106:107], v234 offset:28672
    v_fmac_f32 v129, 0x3a800000, v128
    v_mfma_f32_16x16x32_bf16 v[28:31], v[108:111], a[20:23], v[28:31]
    ds_read_b64_tr_b16 v[108:109], v235 offset:24576
    s_waitcnt lgkmcnt(7)
    v_mfma_f32_16x16x32_bf16 v[32:35], v[112:115], a[16:19], v[32:35]
    ds_read_b64_tr_b16 v[110:111], v235 offset:28672
    v_rsq_f32 v128, v129
    v_mfma_f32_16x16x32_bf16 v[36:39], v[112:115], a[20:23], v[36:39]
    ds_read_b64_tr_b16 v[112:113], v232 offset:25600
    v_and_b32 v129, 15, v255
    v_mfma_f32_16x16x32_bf16 v[40:43], v[116:119], a[16:19], v[40:43]
    ds_read_b64_tr_b16 v[114:115], v232 offset:29696
    v_lshlrev_b32 v129, 2, v129
    v_mfma_f32_16x16x32_bf16 v[44:47], v[116:119], a[20:23], v[44:47]
    ds_read_b64_tr_b16 v[116:117], v233 offset:25600
    ds_bpermute_b32 v240, v129, v128 offset:0
    v_mfma_f32_16x16x32_bf16 v[48:51], v[120:123], a[16:19], v[48:51]
    ds_read_b64_tr_b16 v[118:119], v233 offset:29696
    ds_bpermute_b32 v241, v129, v128 offset:64
    v_mfma_f32_16x16x32_bf16 v[52:55], v[120:123], a[20:23], v[52:55]
    ds_read_b64_tr_b16 v[120:121], v234 offset:25600
    s_lshl_b32 s34, s41, 5
    v_mfma_f32_16x16x32_bf16 v[56:59], v[124:127], a[16:19], v[56:59]
    ds_read_b64_tr_b16 v[122:123], v234 offset:29696
    s_lshl_b32 s35, s30, 7
    v_mfma_f32_16x16x32_bf16 v[60:63], v[124:127], a[20:23], v[60:63]
    ds_read_b64_tr_b16 v[124:125], v235 offset:25600
    ds_read_b64_tr_b16 v[126:127], v235 offset:29696
    s_waitcnt vmcnt(14) lgkmcnt(10)
    v_mfma_f32_16x16x32_bf16 v[0:3], v[96:99], a[24:27], v[0:3]
    v_readlane_b32 s72, v244, 35
    buffer_load_dwordx4 a[56:59], v254, s[24:27], s67 offen offset:0 sc1
    v_mfma_f32_16x16x32_bf16 v[4:7], v[96:99], a[28:31], v[4:7]
    s_waitcnt vmcnt(9)
    s_barrier
    ds_read_b64_tr_b16 v[96:97], v236 offset:0
    v_mfma_f32_16x16x32_bf16 v[8:11], v[100:103], a[24:27], v[8:11]
    ds_read_b64_tr_b16 v[98:99], v236 offset:4096
    buffer_load_dwordx4 a[60:63], v254, s[24:27], s67 offen offset:1024 sc1
    v_mfma_f32_16x16x32_bf16 v[12:15], v[100:103], a[28:31], v[12:15]
    ds_read_b64_tr_b16 v[100:101], v237 offset:0
    s_add_u32 m0, s40, 114688
    v_mfma_f32_16x16x32_bf16 v[16:19], v[104:107], a[24:27], v[16:19]
    ds_read_b64_tr_b16 v[102:103], v237 offset:4096
    buffer_load_dwordx4 v247, s[8:11], s71 offen offset:0 lds
    v_mfma_f32_16x16x32_bf16 v[20:23], v[104:107], a[28:31], v[20:23]
    ds_read_b64_tr_b16 v[104:105], v238 offset:0
    buffer_load_dwordx4 v245, s[8:11], s71 offen offset:1024 lds
    v_mfma_f32_16x16x32_bf16 v[24:27], v[108:111], a[24:27], v[24:27]
    ds_read_b64_tr_b16 v[106:107], v238 offset:4096
    s_add_u32 s34, s34, s35
    v_mfma_f32_16x16x32_bf16 v[28:31], v[108:111], a[28:31], v[28:31]
    ds_read_b64_tr_b16 v[108:109], v239 offset:0
    s_waitcnt lgkmcnt(7)
    v_mfma_f32_16x16x32_bf16 v[32:35], v[112:115], a[24:27], v[32:35]
    ds_read_b64_tr_b16 v[110:111], v239 offset:4096
    s_add_u32 s4, s78, s34
    s_addc_u32 s5, s79, 0
    v_mfma_f32_16x16x32_bf16 v[36:39], v[112:115], a[28:31], v[36:39]
    ds_read_b64_tr_b16 v[112:113], v236 offset:1024
    s_mov_b32 s6, 0xf880
    v_mfma_f32_16x16x32_bf16 v[40:43], v[116:119], a[24:27], v[40:43]
    ds_read_b64_tr_b16 v[114:115], v236 offset:5120
    s_mov_b32 s7, 0x20000
    v_mfma_f32_16x16x32_bf16 v[44:47], v[116:119], a[28:31], v[44:47]
    ds_read_b64_tr_b16 v[116:117], v237 offset:1024
    s_lshl_b32 s34, s29, 4
    v_mfma_f32_16x16x32_bf16 v[48:51], v[120:123], a[24:27], v[48:51]
    ds_read_b64_tr_b16 v[118:119], v237 offset:5120
    s_add_u32 s36, s34, s30
    v_mfma_f32_16x16x32_bf16 v[52:55], v[120:123], a[28:31], v[52:55]
    ds_read_b64_tr_b16 v[120:121], v238 offset:1024
    s_xor_b32 s37, s36, 1
    v_mfma_f32_16x16x32_bf16 v[56:59], v[124:127], a[24:27], v[56:59]
    ds_read_b64_tr_b16 v[122:123], v238 offset:5120
    s_lshl_b32 s34, s36, 15
    v_mfma_f32_16x16x32_bf16 v[60:63], v[124:127], a[28:31], v[60:63]
    ds_read_b64_tr_b16 v[124:125], v239 offset:1024
    ds_read_b64_tr_b16 v[126:127], v239 offset:5120
    s_waitcnt lgkmcnt(8)
    v_mfma_f32_16x16x32_bf16 v[0:3], v[96:99], a[32:35], v[0:3]
    v_add_u32 v232, 98304, v248
    v_add_u32 v233, 98304, v249
    v_mfma_f32_16x16x32_bf16 v[4:7], v[96:99], a[36:39], v[4:7]
    ds_read_b64_tr_b16 v[96:97], v236 offset:8192
    v_add_u32 v234, 98304, v250
    v_mfma_f32_16x16x32_bf16 v[8:11], v[100:103], a[32:35], v[8:11]
    ds_read_b64_tr_b16 v[98:99], v236 offset:12288
    v_add_u32 v235, 98304, v251
    v_mfma_f32_16x16x32_bf16 v[12:15], v[100:103], a[36:39], v[12:15]
    ds_read_b64_tr_b16 v[100:101], v237 offset:8192
    v_readlane_b32 s73, v244, 36
    v_mfma_f32_16x16x32_bf16 v[16:19], v[104:107], a[32:35], v[16:19]
    ds_read_b64_tr_b16 v[102:103], v237 offset:12288
    buffer_load_dwordx4 a[0:3], v254, s[24:27], s68 offen offset:0 sc1
    v_mfma_f32_16x16x32_bf16 v[20:23], v[104:107], a[36:39], v[20:23]
    ds_read_b64_tr_b16 v[104:105], v238 offset:8192
    buffer_load_dwordx4 a[4:7], v254, s[24:27], s68 offen offset:1024 sc1
    v_mfma_f32_16x16x32_bf16 v[24:27], v[108:111], a[32:35], v[24:27]
    ds_read_b64_tr_b16 v[106:107], v238 offset:12288
    s_add_u32 m0, s40, 122880
    v_mfma_f32_16x16x32_bf16 v[28:31], v[108:111], a[36:39], v[28:31]
    ds_read_b64_tr_b16 v[108:109], v239 offset:8192
    s_waitcnt lgkmcnt(7)
    v_mfma_f32_16x16x32_bf16 v[32:35], v[112:115], a[32:35], v[32:35]
    ds_read_b64_tr_b16 v[110:111], v239 offset:12288
    buffer_load_dwordx4 v247, s[8:11], s72 offen offset:0 lds
    v_mfma_f32_16x16x32_bf16 v[36:39], v[112:115], a[36:39], v[36:39]
    ds_read_b64_tr_b16 v[112:113], v236 offset:9216
    buffer_load_dwordx4 v245, s[8:11], s72 offen offset:1024 lds
    v_mfma_f32_16x16x32_bf16 v[40:43], v[116:119], a[32:35], v[40:43]
    ds_read_b64_tr_b16 v[114:115], v236 offset:13312
    s_lshl_b32 s35, s28, 13
    v_mfma_f32_16x16x32_bf16 v[44:47], v[116:119], a[36:39], v[44:47]
    ds_read_b64_tr_b16 v[116:117], v237 offset:9216
    s_add_u32 s34, s34, s35
    v_mfma_f32_16x16x32_bf16 v[48:51], v[120:123], a[32:35], v[48:51]
    ds_read_b64_tr_b16 v[118:119], v237 offset:13312
    s_add_u32 s34, s34, 0x2c00000
    v_mfma_f32_16x16x32_bf16 v[52:55], v[120:123], a[36:39], v[52:55]
    ds_read_b64_tr_b16 v[120:121], v238 offset:9216
    s_add_u32 s16, s82, s34
    s_addc_u32 s17, s83, 0
    v_mfma_f32_16x16x32_bf16 v[56:59], v[124:127], a[32:35], v[56:59]
    ds_read_b64_tr_b16 v[122:123], v238 offset:13312
    s_mov_b32 s18, 0x2000
    v_mfma_f32_16x16x32_bf16 v[60:63], v[124:127], a[36:39], v[60:63]
    ds_read_b64_tr_b16 v[124:125], v239 offset:9216
    ds_read_b64_tr_b16 v[126:127], v239 offset:13312
    s_waitcnt vmcnt(14) lgkmcnt(8)
    v_mfma_f32_16x16x32_bf16 v[0:3], v[96:99], a[40:43], v[0:3]
    v_readlane_b32 s74, v244, 37
    buffer_load_dwordx4 a[8:11], v254, s[24:27], s69 offen offset:0 sc1
    v_mfma_f32_16x16x32_bf16 v[4:7], v[96:99], a[44:47], v[4:7]
    ds_read_b64_tr_b16 v[96:97], v236 offset:16384
    buffer_load_dwordx4 a[12:15], v254, s[24:27], s69 offen offset:1024 sc1
    v_mfma_f32_16x16x32_bf16 v[8:11], v[100:103], a[40:43], v[8:11]
    ds_read_b64_tr_b16 v[98:99], v236 offset:20480
    s_add_u32 m0, s40, 131072
    v_mfma_f32_16x16x32_bf16 v[12:15], v[100:103], a[44:47], v[12:15]
    ds_read_b64_tr_b16 v[100:101], v237 offset:16384
    buffer_load_dwordx4 v247, s[8:11], s73 offen offset:0 lds
    v_mfma_f32_16x16x32_bf16 v[16:19], v[104:107], a[40:43], v[16:19]
    ds_read_b64_tr_b16 v[102:103], v237 offset:20480
    buffer_load_dwordx4 v245, s[8:11], s73 offen offset:1024 lds
    v_mfma_f32_16x16x32_bf16 v[20:23], v[104:107], a[44:47], v[20:23]
    ds_read_b64_tr_b16 v[104:105], v238 offset:16384
    s_mov_b32 s19, 0x20000
    v_mfma_f32_16x16x32_bf16 v[24:27], v[108:111], a[40:43], v[24:27]
    ds_read_b64_tr_b16 v[106:107], v238 offset:20480
    s_lshl_b32 s34, s37, 15
    v_mfma_f32_16x16x32_bf16 v[28:31], v[108:111], a[44:47], v[28:31]
    ds_read_b64_tr_b16 v[108:109], v239 offset:16384
    s_waitcnt lgkmcnt(7)
    v_mfma_f32_16x16x32_bf16 v[32:35], v[112:115], a[40:43], v[32:35]
    ds_read_b64_tr_b16 v[110:111], v239 offset:20480
    s_lshl_b32 s35, s28, 13
    v_mfma_f32_16x16x32_bf16 v[36:39], v[112:115], a[44:47], v[36:39]
    ds_read_b64_tr_b16 v[112:113], v236 offset:17408
    s_add_u32 s34, s34, s35
    v_mfma_f32_16x16x32_bf16 v[40:43], v[116:119], a[40:43], v[40:43]
    ds_read_b64_tr_b16 v[114:115], v236 offset:21504
    s_add_u32 s34, s34, 0x2c00000
    v_mfma_f32_16x16x32_bf16 v[44:47], v[116:119], a[44:47], v[44:47]
    ds_read_b64_tr_b16 v[116:117], v237 offset:17408
    s_add_u32 s12, s82, s34
    s_addc_u32 s13, s83, 0
    v_mfma_f32_16x16x32_bf16 v[48:51], v[120:123], a[40:43], v[48:51]
    ds_read_b64_tr_b16 v[118:119], v237 offset:21504
    s_mov_b32 s14, 0x2000
    v_mfma_f32_16x16x32_bf16 v[52:55], v[120:123], a[44:47], v[52:55]
    ds_read_b64_tr_b16 v[120:121], v238 offset:17408
    s_mov_b32 s15, 0x20000
    v_mfma_f32_16x16x32_bf16 v[56:59], v[124:127], a[40:43], v[56:59]
    ds_read_b64_tr_b16 v[122:123], v238 offset:21504
    s_add_u32 s36, s36, 384
    v_mfma_f32_16x16x32_bf16 v[60:63], v[124:127], a[44:47], v[60:63]
    ds_read_b64_tr_b16 v[124:125], v239 offset:17408
    ds_read_b64_tr_b16 v[126:127], v239 offset:21504
    s_waitcnt vmcnt(14) lgkmcnt(8)
    v_mfma_f32_16x16x32_bf16 v[0:3], v[96:99], a[48:51], v[0:3]
    v_readlane_b32 s75, v244, 38
    buffer_load_dwordx4 a[16:19], v254, s[24:27], s71 offen offset:0 sc1
    v_mfma_f32_16x16x32_bf16 v[4:7], v[96:99], a[52:55], v[4:7]
    ds_read_b64_tr_b16 v[96:97], v236 offset:24576
    buffer_load_dwordx4 a[20:23], v254, s[24:27], s71 offen offset:1024 sc1
    v_mfma_f32_16x16x32_bf16 v[8:11], v[100:103], a[48:51], v[8:11]
    ds_read_b64_tr_b16 v[98:99], v236 offset:28672
    s_add_u32 m0, s40, 139264
    v_mfma_f32_16x16x32_bf16 v[12:15], v[100:103], a[52:55], v[12:15]
    ds_read_b64_tr_b16 v[100:101], v237 offset:24576
    buffer_load_dwordx4 v247, s[8:11], s74 offen offset:0 lds
    v_mfma_f32_16x16x32_bf16 v[16:19], v[104:107], a[48:51], v[16:19]
    ds_read_b64_tr_b16 v[102:103], v237 offset:28672
    buffer_load_dwordx4 v245, s[8:11], s74 offen offset:1024 lds
    v_mfma_f32_16x16x32_bf16 v[20:23], v[104:107], a[52:55], v[20:23]
    ds_read_b64_tr_b16 v[104:105], v238 offset:24576
    s_mul_i32 s46, s36, 4352
    v_mfma_f32_16x16x32_bf16 v[24:27], v[108:111], a[48:51], v[24:27]
    ds_read_b64_tr_b16 v[106:107], v238 offset:28672
    s_add_u32 s37, s37, 384
    v_mfma_f32_16x16x32_bf16 v[28:31], v[108:111], a[52:55], v[28:31]
    ds_read_b64_tr_b16 v[108:109], v239 offset:24576
    s_waitcnt lgkmcnt(7)
    v_mfma_f32_16x16x32_bf16 v[32:35], v[112:115], a[48:51], v[32:35]
    ds_read_b64_tr_b16 v[110:111], v239 offset:28672
    s_mul_i32 s47, s37, 4352
    v_mfma_f32_16x16x32_bf16 v[36:39], v[112:115], a[52:55], v[36:39]
    ds_read_b64_tr_b16 v[112:113], v236 offset:25600
    s_mov_b32 s44, 32768
    v_mfma_f32_16x16x32_bf16 v[40:43], v[116:119], a[48:51], v[40:43]
    ds_read_b64_tr_b16 v[114:115], v236 offset:29696
    s_mov_b32 s45, 4096
    v_mfma_f32_16x16x32_bf16 v[44:47], v[116:119], a[52:55], v[44:47]
    ds_read_b64_tr_b16 v[116:117], v237 offset:25600
    v_and_b32 v128, 15, v255
    v_mfma_f32_16x16x32_bf16 v[48:51], v[120:123], a[48:51], v[48:51]
    ds_read_b64_tr_b16 v[118:119], v237 offset:29696
    v_lshlrev_b32 v242, 11, v128
    v_mfma_f32_16x16x32_bf16 v[52:55], v[120:123], a[52:55], v[52:55]
    ds_read_b64_tr_b16 v[120:121], v238 offset:25600
    v_bfe_u32 v128, v255, 4, 1
    v_mfma_f32_16x16x32_bf16 v[56:59], v[124:127], a[48:51], v[56:59]
    ds_read_b64_tr_b16 v[122:123], v238 offset:29696
    v_lshl_add_u32 v242, v128, 5, v242
    v_mfma_f32_16x16x32_bf16 v[60:63], v[124:127], a[52:55], v[60:63]
    ds_read_b64_tr_b16 v[124:125], v239 offset:25600
    ds_read_b64_tr_b16 v[126:127], v239 offset:29696
    s_waitcnt vmcnt(14) lgkmcnt(8)
    v_mfma_f32_16x16x32_bf16 v[0:3], v[96:99], a[56:59], v[0:3]
    v_readlane_b32 s76, v244, 39
    buffer_load_dwordx4 a[24:27], v254, s[24:27], s72 offen offset:0 sc1
    v_mfma_f32_16x16x32_bf16 v[4:7], v[96:99], a[60:63], v[4:7]
    s_waitcnt vmcnt(9)
    s_barrier
    ds_read_b64_tr_b16 v[96:97], v232 offset:0
    v_mfma_f32_16x16x32_bf16 v[8:11], v[100:103], a[56:59], v[8:11]
    ds_read_b64_tr_b16 v[98:99], v232 offset:4096
    buffer_load_dwordx4 a[28:31], v254, s[24:27], s72 offen offset:1024 sc1
    v_mfma_f32_16x16x32_bf16 v[12:15], v[100:103], a[60:63], v[12:15]
    ds_read_b64_tr_b16 v[100:101], v233 offset:0
    s_add_u32 m0, s40, 147456
    v_mfma_f32_16x16x32_bf16 v[16:19], v[104:107], a[56:59], v[16:19]
    ds_read_b64_tr_b16 v[102:103], v233 offset:4096
    buffer_load_dwordx4 v247, s[8:11], s75 offen offset:0 lds
    v_mfma_f32_16x16x32_bf16 v[20:23], v[104:107], a[60:63], v[20:23]
    ds_read_b64_tr_b16 v[104:105], v234 offset:0
    buffer_load_dwordx4 v245, s[8:11], s75 offen offset:1024 lds
    v_mfma_f32_16x16x32_bf16 v[24:27], v[108:111], a[56:59], v[24:27]
    ds_read_b64_tr_b16 v[106:107], v234 offset:4096
    v_lshrrev_b32 v128, 5, v255
    v_mfma_f32_16x16x32_bf16 v[28:31], v[108:111], a[60:63], v[28:31]
    ds_read_b64_tr_b16 v[108:109], v235 offset:0
    s_waitcnt lgkmcnt(7)
    v_mfma_f32_16x16x32_bf16 v[32:35], v[112:115], a[56:59], v[32:35]
    ds_read_b64_tr_b16 v[110:111], v235 offset:4096
    v_lshl_add_u32 v242, v128, 4, v242
    v_mfma_f32_16x16x32_bf16 v[36:39], v[112:115], a[60:63], v[36:39]
    ds_read_b64_tr_b16 v[112:113], v232 offset:1024
    s_lshl_b32 s34, s28, 12
    v_mfma_f32_16x16x32_bf16 v[40:43], v[116:119], a[56:59], v[40:43]
    ds_read_b64_tr_b16 v[114:115], v232 offset:5120
    s_add_u32 s34, s34, 32768
    v_mfma_f32_16x16x32_bf16 v[44:47], v[116:119], a[60:63], v[44:47]
    ds_read_b64_tr_b16 v[116:117], v233 offset:1024
    v_bfe_u32 v129, v255, 4, 1
    v_mfma_f32_16x16x32_bf16 v[48:51], v[120:123], a[56:59], v[48:51]
    ds_read_b64_tr_b16 v[118:119], v233 offset:5120
    v_lshl_add_u32 v128, v129, 1, v128
    v_mfma_f32_16x16x32_bf16 v[52:55], v[120:123], a[60:63], v[52:55]
    ds_read_b64_tr_b16 v[120:121], v234 offset:1024
    v_bfe_u32 v129, v255, 1, 3
    v_mfma_f32_16x16x32_bf16 v[56:59], v[124:127], a[56:59], v[56:59]
    ds_read_b64_tr_b16 v[122:123], v234 offset:5120
    v_xor_b32 v128, v128, v129
    v_mfma_f32_16x16x32_bf16 v[60:63], v[124:127], a[60:63], v[60:63]
    ds_read_b64_tr_b16 v[124:125], v235 offset:1024
    ds_read_b64_tr_b16 v[126:127], v235 offset:5120
    s_waitcnt lgkmcnt(8)
    v_mfma_f32_16x16x32_bf16 v[0:3], v[96:99], a[0:3], v[0:3]
    v_add_u32 v236, 131072, v248
    v_add_u32 v237, 131072, v249
    v_mfma_f32_16x16x32_bf16 v[4:7], v[96:99], a[4:7], v[4:7]
    ds_read_b64_tr_b16 v[96:97], v232 offset:8192
    v_add_u32 v238, 131072, v250
    v_mfma_f32_16x16x32_bf16 v[8:11], v[100:103], a[0:3], v[8:11]
    ds_read_b64_tr_b16 v[98:99], v232 offset:12288
    v_add_u32 v239, 131072, v251
    v_mfma_f32_16x16x32_bf16 v[12:15], v[100:103], a[4:7], v[12:15]
    ds_read_b64_tr_b16 v[100:101], v233 offset:8192
    v_readlane_b32 s77, v244, 40
    v_mfma_f32_16x16x32_bf16 v[16:19], v[104:107], a[0:3], v[16:19]
    ds_read_b64_tr_b16 v[102:103], v233 offset:12288
    buffer_load_dwordx4 a[32:35], v254, s[24:27], s73 offen offset:0 sc1
    v_mfma_f32_16x16x32_bf16 v[20:23], v[104:107], a[4:7], v[20:23]
    ds_read_b64_tr_b16 v[104:105], v234 offset:8192
    buffer_load_dwordx4 a[36:39], v254, s[24:27], s73 offen offset:1024 sc1
    v_mfma_f32_16x16x32_bf16 v[24:27], v[108:111], a[0:3], v[24:27]
    ds_read_b64_tr_b16 v[106:107], v234 offset:12288
    s_add_u32 m0, s40, 155648
    v_mfma_f32_16x16x32_bf16 v[28:31], v[108:111], a[4:7], v[28:31]
    ds_read_b64_tr_b16 v[108:109], v235 offset:8192
    s_waitcnt lgkmcnt(7)
    v_mfma_f32_16x16x32_bf16 v[32:35], v[112:115], a[0:3], v[32:35]
    ds_read_b64_tr_b16 v[110:111], v235 offset:12288
    buffer_load_dwordx4 v247, s[8:11], s76 offen offset:0 lds
    v_mfma_f32_16x16x32_bf16 v[36:39], v[112:115], a[4:7], v[36:39]
    ds_read_b64_tr_b16 v[112:113], v232 offset:9216
    buffer_load_dwordx4 v245, s[8:11], s76 offen offset:1024 lds
    v_mfma_f32_16x16x32_bf16 v[40:43], v[116:119], a[0:3], v[40:43]
    ds_read_b64_tr_b16 v[114:115], v232 offset:13312
    v_and_b32 v129, 15, v255
    v_mfma_f32_16x16x32_bf16 v[44:47], v[116:119], a[4:7], v[44:47]
    ds_read_b64_tr_b16 v[116:117], v233 offset:9216
    v_lshlrev_b32 v129, 7, v129
    v_mfma_f32_16x16x32_bf16 v[48:51], v[120:123], a[0:3], v[48:51]
    ds_read_b64_tr_b16 v[118:119], v233 offset:13312
    v_lshl_add_u32 v128, v128, 4, v129
    v_mfma_f32_16x16x32_bf16 v[52:55], v[120:123], a[4:7], v[52:55]
    ds_read_b64_tr_b16 v[120:121], v234 offset:9216
    v_add_u32 v229, s34, v128
    v_mfma_f32_16x16x32_bf16 v[56:59], v[124:127], a[0:3], v[56:59]
    ds_read_b64_tr_b16 v[122:123], v234 offset:13312
    v_xor_b32 v128, 64, v128
    v_mfma_f32_16x16x32_bf16 v[60:63], v[124:127], a[4:7], v[60:63]
    ds_read_b64_tr_b16 v[124:125], v235 offset:9216
    ds_read_b64_tr_b16 v[126:127], v235 offset:13312
    s_waitcnt vmcnt(14) lgkmcnt(8)
    v_mfma_f32_16x16x32_bf16 v[0:3], v[96:99], a[8:11], v[0:3]
    v_readlane_b32 s59, v244, 41
    buffer_load_dwordx4 a[40:43], v254, s[24:27], s74 offen offset:0 sc1
    v_mfma_f32_16x16x32_bf16 v[4:7], v[96:99], a[12:15], v[4:7]
    ds_read_b64_tr_b16 v[96:97], v232 offset:16384
    buffer_load_dwordx4 a[44:47], v254, s[24:27], s74 offen offset:1024 sc1
    v_mfma_f32_16x16x32_bf16 v[8:11], v[100:103], a[8:11], v[8:11]
    ds_read_b64_tr_b16 v[98:99], v232 offset:20480
    s_add_u32 m0, s40, 0
    v_mfma_f32_16x16x32_bf16 v[12:15], v[100:103], a[12:15], v[12:15]
    ds_read_b64_tr_b16 v[100:101], v233 offset:16384
    buffer_load_dwordx4 v247, s[8:11], s77 offen offset:0 lds
    v_mfma_f32_16x16x32_bf16 v[16:19], v[104:107], a[8:11], v[16:19]
    ds_read_b64_tr_b16 v[102:103], v233 offset:20480
    buffer_load_dwordx4 v245, s[8:11], s77 offen offset:1024 lds
    v_mfma_f32_16x16x32_bf16 v[20:23], v[104:107], a[12:15], v[20:23]
    ds_read_b64_tr_b16 v[104:105], v234 offset:16384
    v_add_u32 v230, s34, v128
    v_mfma_f32_16x16x32_bf16 v[24:27], v[108:111], a[8:11], v[24:27]
    ds_read_b64_tr_b16 v[106:107], v234 offset:20480
    v_lshrrev_b32 v128, 4, v255
    v_mfma_f32_16x16x32_bf16 v[28:31], v[108:111], a[12:15], v[28:31]
    ds_read_b64_tr_b16 v[108:109], v235 offset:16384
    s_waitcnt lgkmcnt(7)
    v_mfma_f32_16x16x32_bf16 v[32:35], v[112:115], a[8:11], v[32:35]
    ds_read_b64_tr_b16 v[110:111], v235 offset:20480
    v_and_b32 v129, 7, v255
    v_mfma_f32_16x16x32_bf16 v[36:39], v[112:115], a[12:15], v[36:39]
    ds_read_b64_tr_b16 v[112:113], v232 offset:17408
    v_xor_b32 v128, v128, v129
    v_mfma_f32_16x16x32_bf16 v[40:43], v[116:119], a[8:11], v[40:43]
    ds_read_b64_tr_b16 v[114:115], v232 offset:21504
    v_lshrrev_b32 v130, 3, v255
    v_mfma_f32_16x16x32_bf16 v[44:47], v[116:119], a[12:15], v[44:47]
    ds_read_b64_tr_b16 v[116:117], v233 offset:17408
    v_lshlrev_b32 v128, 4, v128
    v_mfma_f32_16x16x32_bf16 v[48:51], v[120:123], a[8:11], v[48:51]
    ds_read_b64_tr_b16 v[118:119], v233 offset:21504
    v_lshl_add_u32 v128, v130, 7, v128
    v_mfma_f32_16x16x32_bf16 v[52:55], v[120:123], a[12:15], v[52:55]
    ds_read_b64_tr_b16 v[120:121], v234 offset:17408
    v_add_u32 v224, s34, v128
    v_mfma_f32_16x16x32_bf16 v[56:59], v[124:127], a[8:11], v[56:59]
    ds_read_b64_tr_b16 v[122:123], v234 offset:21504
    v_xor_b32 v128, 64, v128
    v_mfma_f32_16x16x32_bf16 v[60:63], v[124:127], a[12:15], v[60:63]
    ds_read_b64_tr_b16 v[124:125], v235 offset:17408
    ds_read_b64_tr_b16 v[126:127], v235 offset:21504
    s_waitcnt vmcnt(14) lgkmcnt(8)
    v_mfma_f32_16x16x32_bf16 v[0:3], v[96:99], a[16:19], v[0:3]
    v_readlane_b32 s64, v244, 42
    buffer_load_dwordx4 a[48:51], v254, s[24:27], s75 offen offset:0 sc1
    v_mfma_f32_16x16x32_bf16 v[4:7], v[96:99], a[20:23], v[4:7]
    ds_read_b64_tr_b16 v[96:97], v232 offset:24576
    buffer_load_dwordx4 a[52:55], v254, s[24:27], s75 offen offset:1024 sc1
    v_mfma_f32_16x16x32_bf16 v[8:11], v[100:103], a[16:19], v[8:11]
    ds_read_b64_tr_b16 v[98:99], v232 offset:28672
    s_add_u32 m0, s40, 8192
    v_mfma_f32_16x16x32_bf16 v[12:15], v[100:103], a[20:23], v[12:15]
    ds_read_b64_tr_b16 v[100:101], v233 offset:24576
    buffer_load_dwordx4 v247, s[8:11], s59 offen offset:0 lds
    v_mfma_f32_16x16x32_bf16 v[16:19], v[104:107], a[16:19], v[16:19]
    ds_read_b64_tr_b16 v[102:103], v233 offset:28672
    buffer_load_dwordx4 v245, s[8:11], s59 offen offset:1024 lds
    v_mfma_f32_16x16x32_bf16 v[20:23], v[104:107], a[20:23], v[20:23]
    ds_read_b64_tr_b16 v[104:105], v234 offset:24576
    v_add_u32 v231, s34, v128
    v_mfma_f32_16x16x32_bf16 v[24:27], v[108:111], a[16:19], v[24:27]
    ds_read_b64_tr_b16 v[106:107], v234 offset:28672
    v_lshlrev_b32 v129, 4, v129
    v_mfma_f32_16x16x32_bf16 v[28:31], v[108:111], a[20:23], v[28:31]
    ds_read_b64_tr_b16 v[108:109], v235 offset:24576
    s_waitcnt lgkmcnt(7)
    v_mfma_f32_16x16x32_bf16 v[32:35], v[112:115], a[16:19], v[32:35]
    ds_read_b64_tr_b16 v[110:111], v235 offset:28672
    v_lshl_add_u32 v242, v130, 11, v129
    v_mfma_f32_16x16x32_bf16 v[36:39], v[112:115], a[20:23], v[36:39]
    ds_read_b64_tr_b16 v[112:113], v232 offset:25600
    s_mov_b32 s44, 16384
    v_mfma_f32_16x16x32_bf16 v[40:43], v[116:119], a[16:19], v[40:43]
    ds_read_b64_tr_b16 v[114:115], v232 offset:29696
    v_accvgpr_read_b32 v64, a224
    v_mfma_f32_16x16x32_bf16 v[44:47], v[116:119], a[20:23], v[44:47]
    ds_read_b64_tr_b16 v[116:117], v233 offset:25600
    v_accvgpr_read_b32 v65, a225
    v_mfma_f32_16x16x32_bf16 v[48:51], v[120:123], a[16:19], v[48:51]
    ds_read_b64_tr_b16 v[118:119], v233 offset:29696
    v_accvgpr_read_b32 v66, a226
    v_mfma_f32_16x16x32_bf16 v[52:55], v[120:123], a[20:23], v[52:55]
    ds_read_b64_tr_b16 v[120:121], v234 offset:25600
    v_accvgpr_read_b32 v67, a227
    v_mfma_f32_16x16x32_bf16 v[56:59], v[124:127], a[16:19], v[56:59]
    ds_read_b64_tr_b16 v[122:123], v234 offset:29696
    v_accvgpr_read_b32 v68, a228
    v_mfma_f32_16x16x32_bf16 v[60:63], v[124:127], a[20:23], v[60:63]
    ds_read_b64_tr_b16 v[124:125], v235 offset:25600
    ds_read_b64_tr_b16 v[126:127], v235 offset:29696
    s_waitcnt vmcnt(14) lgkmcnt(8)
    v_mfma_f32_16x16x32_bf16 v[0:3], v[96:99], a[24:27], v[0:3]
    v_readlane_b32 s65, v244, 43
    buffer_load_dwordx4 a[56:59], v254, s[24:27], s76 offen offset:0 sc1
    v_mfma_f32_16x16x32_bf16 v[4:7], v[96:99], a[28:31], v[4:7]
    s_waitcnt vmcnt(9)
    s_barrier
    ds_read_b64_tr_b16 v[96:97], v236 offset:0
    v_mfma_f32_16x16x32_bf16 v[8:11], v[100:103], a[24:27], v[8:11]
    ds_read_b64_tr_b16 v[98:99], v236 offset:4096
    buffer_load_dwordx4 a[60:63], v254, s[24:27], s76 offen offset:1024 sc1
    v_mfma_f32_16x16x32_bf16 v[12:15], v[100:103], a[28:31], v[12:15]
    ds_read_b64_tr_b16 v[100:101], v237 offset:0
    s_add_u32 m0, s40, 16384
    v_mfma_f32_16x16x32_bf16 v[16:19], v[104:107], a[24:27], v[16:19]
    ds_read_b64_tr_b16 v[102:103], v237 offset:4096
    buffer_load_dwordx4 v227, s[8:11], s64 offen offset:0 lds
    v_mfma_f32_16x16x32_bf16 v[20:23], v[104:107], a[28:31], v[20:23]
    ds_read_b64_tr_b16 v[104:105], v238 offset:0
    buffer_load_dwordx4 v225, s[8:11], s64 offen offset:1024 lds
    v_mfma_f32_16x16x32_bf16 v[24:27], v[108:111], a[24:27], v[24:27]
    ds_read_b64_tr_b16 v[106:107], v238 offset:4096
    v_accvgpr_read_b32 v69, a229
    v_mfma_f32_16x16x32_bf16 v[28:31], v[108:111], a[28:31], v[28:31]
    ds_read_b64_tr_b16 v[108:109], v239 offset:0
    s_waitcnt lgkmcnt(7)
    v_mfma_f32_16x16x32_bf16 v[32:35], v[112:115], a[24:27], v[32:35]
    ds_read_b64_tr_b16 v[110:111], v239 offset:4096
    v_accvgpr_read_b32 v70, a230
    v_mfma_f32_16x16x32_bf16 v[36:39], v[112:115], a[28:31], v[36:39]
    ds_read_b64_tr_b16 v[112:113], v236 offset:1024
    v_accvgpr_read_b32 v71, a231
    v_mfma_f32_16x16x32_bf16 v[40:43], v[116:119], a[24:27], v[40:43]
    ds_read_b64_tr_b16 v[114:115], v236 offset:5120
    v_accvgpr_read_b32 v72, a232
    v_mfma_f32_16x16x32_bf16 v[44:47], v[116:119], a[28:31], v[44:47]
    ds_read_b64_tr_b16 v[116:117], v237 offset:1024
    v_accvgpr_read_b32 v73, a233
    v_mfma_f32_16x16x32_bf16 v[48:51], v[120:123], a[24:27], v[48:51]
    ds_read_b64_tr_b16 v[118:119], v237 offset:5120
    v_accvgpr_read_b32 v74, a234
    v_mfma_f32_16x16x32_bf16 v[52:55], v[120:123], a[28:31], v[52:55]
    ds_read_b64_tr_b16 v[120:121], v238 offset:1024
    v_accvgpr_read_b32 v75, a235
    v_mfma_f32_16x16x32_bf16 v[56:59], v[124:127], a[24:27], v[56:59]
    ds_read_b64_tr_b16 v[122:123], v238 offset:5120
    v_accvgpr_read_b32 v76, a236
    v_mfma_f32_16x16x32_bf16 v[60:63], v[124:127], a[28:31], v[60:63]
    ds_read_b64_tr_b16 v[124:125], v239 offset:1024
    ds_read_b64_tr_b16 v[126:127], v239 offset:5120
    s_waitcnt lgkmcnt(8)
    v_mfma_f32_16x16x32_bf16 v[0:3], v[96:99], a[32:35], v[0:3]
    v_add_u32 v232, 0, v248
    v_add_u32 v233, 0, v249
    v_mfma_f32_16x16x32_bf16 v[4:7], v[96:99], a[36:39], v[4:7]
    ds_read_b64_tr_b16 v[96:97], v236 offset:8192
    v_add_u32 v234, 0, v250
    v_mfma_f32_16x16x32_bf16 v[8:11], v[100:103], a[32:35], v[8:11]
    ds_read_b64_tr_b16 v[98:99], v236 offset:12288
    v_add_u32 v235, 0, v251
    v_mfma_f32_16x16x32_bf16 v[12:15], v[100:103], a[36:39], v[12:15]
    ds_read_b64_tr_b16 v[100:101], v237 offset:8192
    v_readlane_b32 s66, v244, 44
    v_mfma_f32_16x16x32_bf16 v[16:19], v[104:107], a[32:35], v[16:19]
    ds_read_b64_tr_b16 v[102:103], v237 offset:12288
    buffer_load_dwordx4 a[0:3], v254, s[24:27], s77 offen offset:0 sc1
    v_mfma_f32_16x16x32_bf16 v[20:23], v[104:107], a[36:39], v[20:23]
    ds_read_b64_tr_b16 v[104:105], v238 offset:8192
    buffer_load_dwordx4 a[4:7], v254, s[24:27], s77 offen offset:1024 sc1
    v_mfma_f32_16x16x32_bf16 v[24:27], v[108:111], a[32:35], v[24:27]
    ds_read_b64_tr_b16 v[106:107], v238 offset:12288
    s_add_u32 m0, s40, 24576
    v_mfma_f32_16x16x32_bf16 v[28:31], v[108:111], a[36:39], v[28:31]
    ds_read_b64_tr_b16 v[108:109], v239 offset:8192
    s_waitcnt lgkmcnt(7)
    v_mfma_f32_16x16x32_bf16 v[32:35], v[112:115], a[32:35], v[32:35]
    ds_read_b64_tr_b16 v[110:111], v239 offset:12288
    buffer_load_dwordx4 v227, s[8:11], s65 offen offset:0 lds
    v_mfma_f32_16x16x32_bf16 v[36:39], v[112:115], a[36:39], v[36:39]
    ds_read_b64_tr_b16 v[112:113], v236 offset:9216
    buffer_load_dwordx4 v225, s[8:11], s65 offen offset:1024 lds
    v_mfma_f32_16x16x32_bf16 v[40:43], v[116:119], a[32:35], v[40:43]
    ds_read_b64_tr_b16 v[114:115], v236 offset:13312
    v_accvgpr_read_b32 v77, a237
    v_mfma_f32_16x16x32_bf16 v[44:47], v[116:119], a[36:39], v[44:47]
    ds_read_b64_tr_b16 v[116:117], v237 offset:9216
    v_accvgpr_read_b32 v78, a238
    v_mfma_f32_16x16x32_bf16 v[48:51], v[120:123], a[32:35], v[48:51]
    ds_read_b64_tr_b16 v[118:119], v237 offset:13312
    v_accvgpr_read_b32 v79, a239
    v_mfma_f32_16x16x32_bf16 v[52:55], v[120:123], a[36:39], v[52:55]
    ds_read_b64_tr_b16 v[120:121], v238 offset:9216
    v_accvgpr_read_b32 v80, a240
    v_mfma_f32_16x16x32_bf16 v[56:59], v[124:127], a[32:35], v[56:59]
    ds_read_b64_tr_b16 v[122:123], v238 offset:13312
    v_accvgpr_read_b32 v81, a241
    v_mfma_f32_16x16x32_bf16 v[60:63], v[124:127], a[36:39], v[60:63]
    ds_read_b64_tr_b16 v[124:125], v239 offset:9216
    ds_read_b64_tr_b16 v[126:127], v239 offset:13312
    s_waitcnt vmcnt(14) lgkmcnt(8)
    v_mfma_f32_16x16x32_bf16 v[0:3], v[96:99], a[40:43], v[0:3]
    v_readlane_b32 s67, v244, 45
    buffer_load_dwordx4 a[8:11], v254, s[24:27], s59 offen offset:0 sc1
    v_mfma_f32_16x16x32_bf16 v[4:7], v[96:99], a[44:47], v[4:7]
    ds_read_b64_tr_b16 v[96:97], v236 offset:16384
    buffer_load_dwordx4 a[12:15], v254, s[24:27], s59 offen offset:1024 sc1
    v_mfma_f32_16x16x32_bf16 v[8:11], v[100:103], a[40:43], v[8:11]
    ds_read_b64_tr_b16 v[98:99], v236 offset:20480
    s_add_u32 m0, s40, 32768
    v_mfma_f32_16x16x32_bf16 v[12:15], v[100:103], a[44:47], v[12:15]
    ds_read_b64_tr_b16 v[100:101], v237 offset:16384
    buffer_load_dwordx4 v227, s[8:11], s66 offen offset:0 lds
    v_mfma_f32_16x16x32_bf16 v[16:19], v[104:107], a[40:43], v[16:19]
    ds_read_b64_tr_b16 v[102:103], v237 offset:20480
    buffer_load_dwordx4 v225, s[8:11], s66 offen offset:1024 lds
    v_mfma_f32_16x16x32_bf16 v[20:23], v[104:107], a[44:47], v[20:23]
    ds_read_b64_tr_b16 v[104:105], v238 offset:16384
    v_accvgpr_read_b32 v82, a242
    v_mfma_f32_16x16x32_bf16 v[24:27], v[108:111], a[40:43], v[24:27]
    ds_read_b64_tr_b16 v[106:107], v238 offset:20480
    v_accvgpr_read_b32 v83, a243
    v_mfma_f32_16x16x32_bf16 v[28:31], v[108:111], a[44:47], v[28:31]
    ds_read_b64_tr_b16 v[108:109], v239 offset:16384
    s_waitcnt lgkmcnt(7)
    v_mfma_f32_16x16x32_bf16 v[32:35], v[112:115], a[40:43], v[32:35]
    ds_read_b64_tr_b16 v[110:111], v239 offset:20480
    v_accvgpr_read_b32 v84, a244
    v_mfma_f32_16x16x32_bf16 v[36:39], v[112:115], a[44:47], v[36:39]
    ds_read_b64_tr_b16 v[112:113], v236 offset:17408
    v_accvgpr_read_b32 v85, a245
    v_mfma_f32_16x16x32_bf16 v[40:43], v[116:119], a[40:43], v[40:43]
    ds_read_b64_tr_b16 v[114:115], v236 offset:21504
    v_accvgpr_read_b32 v86, a246
    v_mfma_f32_16x16x32_bf16 v[44:47], v[116:119], a[44:47], v[44:47]
    ds_read_b64_tr_b16 v[116:117], v237 offset:17408
    v_accvgpr_read_b32 v87, a247
    v_mfma_f32_16x16x32_bf16 v[48:51], v[120:123], a[40:43], v[48:51]
    ds_read_b64_tr_b16 v[118:119], v237 offset:21504
    v_accvgpr_read_b32 v88, a248
    v_mfma_f32_16x16x32_bf16 v[52:55], v[120:123], a[44:47], v[52:55]
    ds_read_b64_tr_b16 v[120:121], v238 offset:17408
    v_accvgpr_read_b32 v89, a249
    v_mfma_f32_16x16x32_bf16 v[56:59], v[124:127], a[40:43], v[56:59]
    ds_read_b64_tr_b16 v[122:123], v238 offset:21504
    v_accvgpr_read_b32 v90, a250
    v_mfma_f32_16x16x32_bf16 v[60:63], v[124:127], a[44:47], v[60:63]
    ds_read_b64_tr_b16 v[124:125], v239 offset:17408
    ds_read_b64_tr_b16 v[126:127], v239 offset:21504
    s_waitcnt vmcnt(14) lgkmcnt(8)
    v_mfma_f32_16x16x32_bf16 v[0:3], v[96:99], a[48:51], v[0:3]
    v_readlane_b32 s68, v244, 46
    buffer_load_dwordx4 a[16:19], v254, s[24:27], s64 offen offset:0 sc1
    v_mfma_f32_16x16x32_bf16 v[4:7], v[96:99], a[52:55], v[4:7]
    ds_read_b64_tr_b16 v[96:97], v236 offset:24576
    buffer_load_dwordx4 a[20:23], v254, s[24:27], s64 offen offset:1024 sc1
    v_mfma_f32_16x16x32_bf16 v[8:11], v[100:103], a[48:51], v[8:11]
    ds_read_b64_tr_b16 v[98:99], v236 offset:28672
    s_add_u32 m0, s40, 40960
    v_mfma_f32_16x16x32_bf16 v[12:15], v[100:103], a[52:55], v[12:15]
    ds_read_b64_tr_b16 v[100:101], v237 offset:24576
    buffer_load_dwordx4 v227, s[8:11], s67 offen offset:0 lds
    v_mfma_f32_16x16x32_bf16 v[16:19], v[104:107], a[48:51], v[16:19]
    ds_read_b64_tr_b16 v[102:103], v237 offset:28672
    buffer_load_dwordx4 v225, s[8:11], s67 offen offset:1024 lds
    v_mfma_f32_16x16x32_bf16 v[20:23], v[104:107], a[52:55], v[20:23]
    ds_read_b64_tr_b16 v[104:105], v238 offset:24576
    v_accvgpr_read_b32 v91, a251
    v_mfma_f32_16x16x32_bf16 v[24:27], v[108:111], a[48:51], v[24:27]
    ds_read_b64_tr_b16 v[106:107], v238 offset:28672
    v_accvgpr_read_b32 v92, a252
    v_mfma_f32_16x16x32_bf16 v[28:31], v[108:111], a[52:55], v[28:31]
    ds_read_b64_tr_b16 v[108:109], v239 offset:24576
    s_waitcnt lgkmcnt(7)
    v_mfma_f32_16x16x32_bf16 v[32:35], v[112:115], a[48:51], v[32:35]
    ds_read_b64_tr_b16 v[110:111], v239 offset:28672
    v_accvgpr_read_b32 v93, a253
    v_mfma_f32_16x16x32_bf16 v[36:39], v[112:115], a[52:55], v[36:39]
    ds_read_b64_tr_b16 v[112:113], v236 offset:25600
    v_accvgpr_read_b32 v94, a254
    v_mfma_f32_16x16x32_bf16 v[40:43], v[116:119], a[48:51], v[40:43]
    ds_read_b64_tr_b16 v[114:115], v236 offset:29696
    v_accvgpr_read_b32 v95, a255
    v_mfma_f32_16x16x32_bf16 v[44:47], v[116:119], a[52:55], v[44:47]
    ds_read_b64_tr_b16 v[116:117], v237 offset:25600
    v_mfma_f32_16x16x32_bf16 v[48:51], v[120:123], a[48:51], v[48:51]
    ds_read_b64_tr_b16 v[118:119], v237 offset:29696
    v_mfma_f32_16x16x32_bf16 v[52:55], v[120:123], a[52:55], v[52:55]
    ds_read_b64_tr_b16 v[120:121], v238 offset:25600
    v_mfma_f32_16x16x32_bf16 v[56:59], v[124:127], a[48:51], v[56:59]
    ds_read_b64_tr_b16 v[122:123], v238 offset:29696
    v_mfma_f32_16x16x32_bf16 v[60:63], v[124:127], a[52:55], v[60:63]
    ds_read_b64_tr_b16 v[124:125], v239 offset:25600
    ds_read_b64_tr_b16 v[126:127], v239 offset:29696
    s_waitcnt vmcnt(14) lgkmcnt(8)
    v_mfma_f32_16x16x32_bf16 v[0:3], v[96:99], a[56:59], v[0:3]
    v_readlane_b32 s69, v244, 47
    buffer_load_dwordx4 a[24:27], v254, s[24:27], s65 offen offset:0 sc1
    v_mfma_f32_16x16x32_bf16 v[4:7], v[96:99], a[60:63], v[4:7]
    s_waitcnt vmcnt(9)
    s_barrier
    ds_read_b64_tr_b16 v[96:97], v232 offset:0
    v_mfma_f32_16x16x32_bf16 v[8:11], v[100:103], a[56:59], v[8:11]
    ds_read_b64_tr_b16 v[98:99], v232 offset:4096
    buffer_load_dwordx4 a[28:31], v254, s[24:27], s65 offen offset:1024 sc1
    v_mfma_f32_16x16x32_bf16 v[12:15], v[100:103], a[60:63], v[12:15]
    ds_read_b64_tr_b16 v[100:101], v233 offset:0
    s_add_u32 m0, s40, 49152
    v_mfma_f32_16x16x32_bf16 v[16:19], v[104:107], a[56:59], v[16:19]
    ds_read_b64_tr_b16 v[102:103], v233 offset:4096
    buffer_load_dwordx4 v227, s[8:11], s68 offen offset:0 lds
    v_mfma_f32_16x16x32_bf16 v[20:23], v[104:107], a[60:63], v[20:23]
    ds_read_b64_tr_b16 v[104:105], v234 offset:0
    buffer_load_dwordx4 v225, s[8:11], s68 offen offset:1024 lds
    v_mfma_f32_16x16x32_bf16 v[24:27], v[108:111], a[56:59], v[24:27]
    ds_read_b64_tr_b16 v[106:107], v234 offset:4096
    v_mfma_f32_16x16x32_bf16 v[28:31], v[108:111], a[60:63], v[28:31]
    ds_read_b64_tr_b16 v[108:109], v235 offset:0
    s_waitcnt lgkmcnt(7)
    v_mfma_f32_16x16x32_bf16 v[32:35], v[112:115], a[56:59], v[32:35]
    ds_read_b64_tr_b16 v[110:111], v235 offset:4096
    v_mfma_f32_16x16x32_bf16 v[36:39], v[112:115], a[60:63], v[36:39]
    ds_read_b64_tr_b16 v[112:113], v232 offset:1024
    v_mfma_f32_16x16x32_bf16 v[40:43], v[116:119], a[56:59], v[40:43]
    ds_read_b64_tr_b16 v[114:115], v232 offset:5120
    v_mfma_f32_16x16x32_bf16 v[44:47], v[116:119], a[60:63], v[44:47]
    ds_read_b64_tr_b16 v[116:117], v233 offset:1024
    v_mfma_f32_16x16x32_bf16 v[48:51], v[120:123], a[56:59], v[48:51]
    ds_read_b64_tr_b16 v[118:119], v233 offset:5120
    v_mfma_f32_16x16x32_bf16 v[52:55], v[120:123], a[60:63], v[52:55]
    ds_read_b64_tr_b16 v[120:121], v234 offset:1024
    v_mfma_f32_16x16x32_bf16 v[56:59], v[124:127], a[56:59], v[56:59]
    ds_read_b64_tr_b16 v[122:123], v234 offset:5120
    v_mfma_f32_16x16x32_bf16 v[60:63], v[124:127], a[60:63], v[60:63]
    ds_read_b64_tr_b16 v[124:125], v235 offset:1024
    ds_read_b64_tr_b16 v[126:127], v235 offset:5120
    s_waitcnt lgkmcnt(8)
    v_mfma_f32_16x16x32_bf16 v[0:3], v[96:99], a[0:3], v[0:3]
    v_add_u32 v236, 32768, v248
    v_add_u32 v237, 32768, v249
    v_mfma_f32_16x16x32_bf16 v[4:7], v[96:99], a[4:7], v[4:7]
    ds_read_b64_tr_b16 v[96:97], v232 offset:8192
    v_add_u32 v238, 32768, v250
    v_mfma_f32_16x16x32_bf16 v[8:11], v[100:103], a[0:3], v[8:11]
    ds_read_b64_tr_b16 v[98:99], v232 offset:12288
    v_add_u32 v239, 32768, v251
    v_mfma_f32_16x16x32_bf16 v[12:15], v[100:103], a[4:7], v[12:15]
    ds_read_b64_tr_b16 v[100:101], v233 offset:8192
    v_readlane_b32 s71, v244, 48
    v_mfma_f32_16x16x32_bf16 v[16:19], v[104:107], a[0:3], v[16:19]
    ds_read_b64_tr_b16 v[102:103], v233 offset:12288
    buffer_load_dwordx4 a[32:35], v254, s[24:27], s66 offen offset:0 sc1
    v_mfma_f32_16x16x32_bf16 v[20:23], v[104:107], a[4:7], v[20:23]
    ds_read_b64_tr_b16 v[104:105], v234 offset:8192
    buffer_load_dwordx4 a[36:39], v254, s[24:27], s66 offen offset:1024 sc1
    v_mfma_f32_16x16x32_bf16 v[24:27], v[108:111], a[0:3], v[24:27]
    ds_read_b64_tr_b16 v[106:107], v234 offset:12288
    s_add_u32 m0, s40, 57344
    v_mfma_f32_16x16x32_bf16 v[28:31], v[108:111], a[4:7], v[28:31]
    ds_read_b64_tr_b16 v[108:109], v235 offset:8192
    s_waitcnt lgkmcnt(7)
    v_mfma_f32_16x16x32_bf16 v[32:35], v[112:115], a[0:3], v[32:35]
    ds_read_b64_tr_b16 v[110:111], v235 offset:12288
    buffer_load_dwordx4 v227, s[8:11], s69 offen offset:0 lds
    v_mfma_f32_16x16x32_bf16 v[36:39], v[112:115], a[4:7], v[36:39]
    ds_read_b64_tr_b16 v[112:113], v232 offset:9216
    buffer_load_dwordx4 v225, s[8:11], s69 offen offset:1024 lds
    v_mfma_f32_16x16x32_bf16 v[40:43], v[116:119], a[0:3], v[40:43]
    ds_read_b64_tr_b16 v[114:115], v232 offset:13312
    v_mfma_f32_16x16x32_bf16 v[44:47], v[116:119], a[4:7], v[44:47]
    ds_read_b64_tr_b16 v[116:117], v233 offset:9216
    v_mfma_f32_16x16x32_bf16 v[48:51], v[120:123], a[0:3], v[48:51]
    ds_read_b64_tr_b16 v[118:119], v233 offset:13312
    v_mfma_f32_16x16x32_bf16 v[52:55], v[120:123], a[4:7], v[52:55]
    ds_read_b64_tr_b16 v[120:121], v234 offset:9216
    v_mfma_f32_16x16x32_bf16 v[56:59], v[124:127], a[0:3], v[56:59]
    ds_read_b64_tr_b16 v[122:123], v234 offset:13312
    v_mfma_f32_16x16x32_bf16 v[60:63], v[124:127], a[4:7], v[60:63]
    ds_read_b64_tr_b16 v[124:125], v235 offset:9216
    ds_read_b64_tr_b16 v[126:127], v235 offset:13312
    s_waitcnt vmcnt(14) lgkmcnt(8)
    v_mfma_f32_16x16x32_bf16 v[0:3], v[96:99], a[8:11], v[0:3]
    v_readlane_b32 s72, v228, 0
    v_readlane_b32 s73, v228, 1
    v_mfma_f32_16x16x32_bf16 v[4:7], v[96:99], a[12:15], v[4:7]
    ds_read_b64_tr_b16 v[96:97], v232 offset:16384
    buffer_load_dwordx4 a[40:43], v254, s[24:27], s67 offen offset:0 sc1
    v_mfma_f32_16x16x32_bf16 v[8:11], v[100:103], a[8:11], v[8:11]
    ds_read_b64_tr_b16 v[98:99], v232 offset:20480
    buffer_load_dwordx4 a[44:47], v254, s[24:27], s67 offen offset:1024 sc1
    v_mfma_f32_16x16x32_bf16 v[12:15], v[100:103], a[12:15], v[12:15]
    ds_read_b64_tr_b16 v[100:101], v233 offset:16384
    s_add_u32 m0, s40, 65536
    v_mfma_f32_16x16x32_bf16 v[16:19], v[104:107], a[8:11], v[16:19]
    ds_read_b64_tr_b16 v[102:103], v233 offset:20480
    buffer_load_dwordx4 v227, s[8:11], s71 offen offset:0 lds
    v_mfma_f32_16x16x32_bf16 v[20:23], v[104:107], a[12:15], v[20:23]
    ds_read_b64_tr_b16 v[104:105], v234 offset:16384
    buffer_load_dwordx4 v225, s[8:11], s71 offen offset:1024 lds
    v_mfma_f32_16x16x32_bf16 v[24:27], v[108:111], a[8:11], v[24:27]
    ds_read_b64_tr_b16 v[106:107], v234 offset:20480
    v_mfma_f32_16x16x32_bf16 v[28:31], v[108:111], a[12:15], v[28:31]
    ds_read_b64_tr_b16 v[108:109], v235 offset:16384
    s_waitcnt lgkmcnt(7)
    v_mfma_f32_16x16x32_bf16 v[32:35], v[112:115], a[8:11], v[32:35]
    ds_read_b64_tr_b16 v[110:111], v235 offset:20480
    v_mfma_f32_16x16x32_bf16 v[36:39], v[112:115], a[12:15], v[36:39]
    ds_read_b64_tr_b16 v[112:113], v232 offset:17408
    v_mfma_f32_16x16x32_bf16 v[40:43], v[116:119], a[8:11], v[40:43]
    ds_read_b64_tr_b16 v[114:115], v232 offset:21504
    v_mfma_f32_16x16x32_bf16 v[44:47], v[116:119], a[12:15], v[44:47]
    ds_read_b64_tr_b16 v[116:117], v233 offset:17408
    v_mfma_f32_16x16x32_bf16 v[48:51], v[120:123], a[8:11], v[48:51]
    ds_read_b64_tr_b16 v[118:119], v233 offset:21504
    v_mfma_f32_16x16x32_bf16 v[52:55], v[120:123], a[12:15], v[52:55]
    ds_read_b64_tr_b16 v[120:121], v234 offset:17408
    v_mfma_f32_16x16x32_bf16 v[56:59], v[124:127], a[8:11], v[56:59]
    ds_read_b64_tr_b16 v[122:123], v234 offset:21504
    v_mfma_f32_16x16x32_bf16 v[60:63], v[124:127], a[12:15], v[60:63]
    ds_read_b64_tr_b16 v[124:125], v235 offset:17408
    ds_read_b64_tr_b16 v[126:127], v235 offset:21504
    s_waitcnt vmcnt(14) lgkmcnt(8)
    v_mfma_f32_16x16x32_bf16 v[0:3], v[96:99], a[16:19], v[0:3]
    v_readlane_b32 s74, v228, 2
    v_readlane_b32 s75, v228, 3
    v_mfma_f32_16x16x32_bf16 v[4:7], v[96:99], a[20:23], v[4:7]
    ds_read_b64_tr_b16 v[96:97], v232 offset:24576
    buffer_load_dwordx4 a[48:51], v254, s[24:27], s68 offen offset:0 sc1
    v_mfma_f32_16x16x32_bf16 v[8:11], v[100:103], a[16:19], v[8:11]
    ds_read_b64_tr_b16 v[98:99], v232 offset:28672
    buffer_load_dwordx4 a[52:55], v254, s[24:27], s68 offen offset:1024 sc1
    v_mfma_f32_16x16x32_bf16 v[12:15], v[100:103], a[20:23], v[12:15]
    ds_read_b64_tr_b16 v[100:101], v233 offset:24576
    s_add_u32 m0, s40, 73728
    v_mfma_f32_16x16x32_bf16 v[16:19], v[104:107], a[16:19], v[16:19]
    ds_read_b64_tr_b16 v[102:103], v233 offset:28672
    buffer_load_dwordx4 v247, s[8:11], s72 offen offset:0 lds
    v_mfma_f32_16x16x32_bf16 v[20:23], v[104:107], a[20:23], v[20:23]
    ds_read_b64_tr_b16 v[104:105], v234 offset:24576
    buffer_load_dwordx4 v246, s[8:11], s73 offen offset:1024 lds
    v_mfma_f32_16x16x32_bf16 v[24:27], v[108:111], a[16:19], v[24:27]
    ds_read_b64_tr_b16 v[106:107], v234 offset:28672
    v_mfma_f32_16x16x32_bf16 v[28:31], v[108:111], a[20:23], v[28:31]
    ds_read_b64_tr_b16 v[108:109], v235 offset:24576
    s_waitcnt lgkmcnt(7)
    v_mfma_f32_16x16x32_bf16 v[32:35], v[112:115], a[16:19], v[32:35]
    ds_read_b64_tr_b16 v[110:111], v235 offset:28672
    v_mfma_f32_16x16x32_bf16 v[36:39], v[112:115], a[20:23], v[36:39]
    ds_read_b64_tr_b16 v[112:113], v232 offset:25600
    v_mfma_f32_16x16x32_bf16 v[40:43], v[116:119], a[16:19], v[40:43]
    ds_read_b64_tr_b16 v[114:115], v232 offset:29696
    v_mfma_f32_16x16x32_bf16 v[44:47], v[116:119], a[20:23], v[44:47]
    ds_read_b64_tr_b16 v[116:117], v233 offset:25600
    v_mfma_f32_16x16x32_bf16 v[48:51], v[120:123], a[16:19], v[48:51]
    ds_read_b64_tr_b16 v[118:119], v233 offset:29696
    v_mfma_f32_16x16x32_bf16 v[52:55], v[120:123], a[20:23], v[52:55]
    ds_read_b64_tr_b16 v[120:121], v234 offset:25600
    v_mfma_f32_16x16x32_bf16 v[56:59], v[124:127], a[16:19], v[56:59]
    ds_read_b64_tr_b16 v[122:123], v234 offset:29696
    v_mfma_f32_16x16x32_bf16 v[60:63], v[124:127], a[20:23], v[60:63]
    ds_read_b64_tr_b16 v[124:125], v235 offset:25600
    ds_read_b64_tr_b16 v[126:127], v235 offset:29696
    s_waitcnt vmcnt(14) lgkmcnt(8)
    v_mfma_f32_16x16x32_bf16 v[0:3], v[96:99], a[24:27], v[0:3]
    v_readlane_b32 s76, v228, 4
    v_readlane_b32 s77, v228, 5
    v_mfma_f32_16x16x32_bf16 v[4:7], v[96:99], a[28:31], v[4:7]
    s_waitcnt vmcnt(8)
    s_barrier
    ds_read_b64_tr_b16 v[96:97], v236 offset:0
    v_mfma_f32_16x16x32_bf16 v[8:11], v[100:103], a[24:27], v[8:11]
    ds_read_b64_tr_b16 v[98:99], v236 offset:4096
    buffer_load_dwordx4 a[56:59], v254, s[24:27], s69 offen offset:0 sc1
    v_mfma_f32_16x16x32_bf16 v[12:15], v[100:103], a[28:31], v[12:15]
    ds_read_b64_tr_b16 v[100:101], v237 offset:0
    buffer_load_dwordx4 a[60:63], v254, s[24:27], s69 offen offset:1024 sc1
    v_mfma_f32_16x16x32_bf16 v[16:19], v[104:107], a[24:27], v[16:19]
    ds_read_b64_tr_b16 v[102:103], v237 offset:4096
    s_add_u32 m0, s40, 81920
    v_mfma_f32_16x16x32_bf16 v[20:23], v[104:107], a[28:31], v[20:23]
    ds_read_b64_tr_b16 v[104:105], v238 offset:0
    buffer_load_dwordx4 v247, s[8:11], s74 offen offset:0 lds
    v_mfma_f32_16x16x32_bf16 v[24:27], v[108:111], a[24:27], v[24:27]
    ds_read_b64_tr_b16 v[106:107], v238 offset:4096
    buffer_load_dwordx4 v246, s[8:11], s75 offen offset:1024 lds
    v_mfma_f32_16x16x32_bf16 v[28:31], v[108:111], a[28:31], v[28:31]
    ds_read_b64_tr_b16 v[108:109], v239 offset:0
    s_waitcnt lgkmcnt(7)
    v_mfma_f32_16x16x32_bf16 v[32:35], v[112:115], a[24:27], v[32:35]
    ds_read_b64_tr_b16 v[110:111], v239 offset:4096
    v_mfma_f32_16x16x32_bf16 v[36:39], v[112:115], a[28:31], v[36:39]
    ds_read_b64_tr_b16 v[112:113], v236 offset:1024
    v_mfma_f32_16x16x32_bf16 v[40:43], v[116:119], a[24:27], v[40:43]
    ds_read_b64_tr_b16 v[114:115], v236 offset:5120
    v_mfma_f32_16x16x32_bf16 v[44:47], v[116:119], a[28:31], v[44:47]
    ds_read_b64_tr_b16 v[116:117], v237 offset:1024
    v_mfma_f32_16x16x32_bf16 v[48:51], v[120:123], a[24:27], v[48:51]
    ds_read_b64_tr_b16 v[118:119], v237 offset:5120
    v_mfma_f32_16x16x32_bf16 v[52:55], v[120:123], a[28:31], v[52:55]
    ds_read_b64_tr_b16 v[120:121], v238 offset:1024
    v_mfma_f32_16x16x32_bf16 v[56:59], v[124:127], a[24:27], v[56:59]
    ds_read_b64_tr_b16 v[122:123], v238 offset:5120
    v_mfma_f32_16x16x32_bf16 v[60:63], v[124:127], a[28:31], v[60:63]
    ds_read_b64_tr_b16 v[124:125], v239 offset:1024
    ds_read_b64_tr_b16 v[126:127], v239 offset:5120
    s_waitcnt lgkmcnt(8)
    v_mfma_f32_16x16x32_bf16 v[0:3], v[96:99], a[32:35], v[0:3]
    v_add_u32 v232, 65536, v248
    v_add_u32 v233, 65536, v249
    v_mfma_f32_16x16x32_bf16 v[4:7], v[96:99], a[36:39], v[4:7]
    ds_read_b64_tr_b16 v[96:97], v236 offset:8192
    v_add_u32 v234, 65536, v250
    v_mfma_f32_16x16x32_bf16 v[8:11], v[100:103], a[32:35], v[8:11]
    ds_read_b64_tr_b16 v[98:99], v236 offset:12288
    v_add_u32 v235, 65536, v251
    v_mfma_f32_16x16x32_bf16 v[12:15], v[100:103], a[36:39], v[12:15]
    ds_read_b64_tr_b16 v[100:101], v237 offset:8192
    v_readlane_b32 s59, v228, 6
    v_mfma_f32_16x16x32_bf16 v[16:19], v[104:107], a[32:35], v[16:19]
    ds_read_b64_tr_b16 v[102:103], v237 offset:12288
    v_readlane_b32 s64, v228, 7
    v_mfma_f32_16x16x32_bf16 v[20:23], v[104:107], a[36:39], v[20:23]
    ds_read_b64_tr_b16 v[104:105], v238 offset:8192
    buffer_load_dwordx4 a[0:3], v254, s[24:27], s71 offen offset:0 sc1
    v_mfma_f32_16x16x32_bf16 v[24:27], v[108:111], a[32:35], v[24:27]
    ds_read_b64_tr_b16 v[106:107], v238 offset:12288
    buffer_load_dwordx4 a[4:7], v254, s[24:27], s71 offen offset:1024 sc1
    v_mfma_f32_16x16x32_bf16 v[28:31], v[108:111], a[36:39], v[28:31]
    ds_read_b64_tr_b16 v[108:109], v239 offset:8192
    s_waitcnt lgkmcnt(7)
    v_mfma_f32_16x16x32_bf16 v[32:35], v[112:115], a[32:35], v[32:35]
    ds_read_b64_tr_b16 v[110:111], v239 offset:12288
    s_add_u32 m0, s40, 90112
    v_mfma_f32_16x16x32_bf16 v[36:39], v[112:115], a[36:39], v[36:39]
    ds_read_b64_tr_b16 v[112:113], v236 offset:9216
    buffer_load_dwordx4 v247, s[8:11], s76 offen offset:0 lds
    v_mfma_f32_16x16x32_bf16 v[40:43], v[116:119], a[32:35], v[40:43]
    ds_read_b64_tr_b16 v[114:115], v236 offset:13312
    buffer_load_dwordx4 v246, s[8:11], s77 offen offset:1024 lds
    v_mfma_f32_16x16x32_bf16 v[44:47], v[116:119], a[36:39], v[44:47]
    ds_read_b64_tr_b16 v[116:117], v237 offset:9216
    v_mfma_f32_16x16x32_bf16 v[48:51], v[120:123], a[32:35], v[48:51]
    ds_read_b64_tr_b16 v[118:119], v237 offset:13312
    v_mfma_f32_16x16x32_bf16 v[52:55], v[120:123], a[36:39], v[52:55]
    ds_read_b64_tr_b16 v[120:121], v238 offset:9216
    v_mfma_f32_16x16x32_bf16 v[56:59], v[124:127], a[32:35], v[56:59]
    ds_read_b64_tr_b16 v[122:123], v238 offset:13312
    v_mfma_f32_16x16x32_bf16 v[60:63], v[124:127], a[36:39], v[60:63]
    ds_read_b64_tr_b16 v[124:125], v239 offset:9216
    ds_read_b64_tr_b16 v[126:127], v239 offset:13312
    s_waitcnt vmcnt(14) lgkmcnt(8)
    v_mfma_f32_16x16x32_bf16 v[0:3], v[96:99], a[40:43], v[0:3]
    v_readlane_b32 s65, v228, 8
    v_readlane_b32 s66, v228, 9
    v_mfma_f32_16x16x32_bf16 v[4:7], v[96:99], a[44:47], v[4:7]
    ds_read_b64_tr_b16 v[96:97], v236 offset:16384
    buffer_load_dwordx4 a[8:11], v254, s[24:27], s72 offen offset:0 sc1
    v_mfma_f32_16x16x32_bf16 v[8:11], v[100:103], a[40:43], v[8:11]
    ds_read_b64_tr_b16 v[98:99], v236 offset:20480
    buffer_load_dwordx4 a[12:15], v254, s[24:27], s72 offen offset:1024 sc1
    v_mfma_f32_16x16x32_bf16 v[12:15], v[100:103], a[44:47], v[12:15]
    ds_read_b64_tr_b16 v[100:101], v237 offset:16384
    s_add_u32 m0, s40, 98304
    v_mfma_f32_16x16x32_bf16 v[16:19], v[104:107], a[40:43], v[16:19]
    ds_read_b64_tr_b16 v[102:103], v237 offset:20480
    buffer_load_dwordx4 v247, s[8:11], s59 offen offset:0 lds
    v_mfma_f32_16x16x32_bf16 v[20:23], v[104:107], a[44:47], v[20:23]
    ds_read_b64_tr_b16 v[104:105], v238 offset:16384
    buffer_load_dwordx4 v246, s[8:11], s64 offen offset:1024 lds
    v_mfma_f32_16x16x32_bf16 v[24:27], v[108:111], a[40:43], v[24:27]
    ds_read_b64_tr_b16 v[106:107], v238 offset:20480
    v_mfma_f32_16x16x32_bf16 v[28:31], v[108:111], a[44:47], v[28:31]
    ds_read_b64_tr_b16 v[108:109], v239 offset:16384
    s_waitcnt lgkmcnt(7)
    v_mfma_f32_16x16x32_bf16 v[32:35], v[112:115], a[40:43], v[32:35]
    ds_read_b64_tr_b16 v[110:111], v239 offset:20480
    v_mfma_f32_16x16x32_bf16 v[36:39], v[112:115], a[44:47], v[36:39]
    ds_read_b64_tr_b16 v[112:113], v236 offset:17408
    v_mfma_f32_16x16x32_bf16 v[40:43], v[116:119], a[40:43], v[40:43]
    ds_read_b64_tr_b16 v[114:115], v236 offset:21504
    v_mfma_f32_16x16x32_bf16 v[44:47], v[116:119], a[44:47], v[44:47]
    ds_read_b64_tr_b16 v[116:117], v237 offset:17408
    v_mfma_f32_16x16x32_bf16 v[48:51], v[120:123], a[40:43], v[48:51]
    ds_read_b64_tr_b16 v[118:119], v237 offset:21504
    v_mfma_f32_16x16x32_bf16 v[52:55], v[120:123], a[44:47], v[52:55]
    ds_read_b64_tr_b16 v[120:121], v238 offset:17408
    v_mfma_f32_16x16x32_bf16 v[56:59], v[124:127], a[40:43], v[56:59]
    ds_read_b64_tr_b16 v[122:123], v238 offset:21504
    v_mfma_f32_16x16x32_bf16 v[60:63], v[124:127], a[44:47], v[60:63]
    ds_read_b64_tr_b16 v[124:125], v239 offset:17408
    ds_read_b64_tr_b16 v[126:127], v239 offset:21504
    s_waitcnt vmcnt(14) lgkmcnt(8)
    v_mfma_f32_16x16x32_bf16 v[0:3], v[96:99], a[48:51], v[0:3]
    v_readlane_b32 s67, v228, 10
    v_readlane_b32 s68, v228, 11
    v_mfma_f32_16x16x32_bf16 v[4:7], v[96:99], a[52:55], v[4:7]
    ds_read_b64_tr_b16 v[96:97], v236 offset:24576
    buffer_load_dwordx4 a[16:19], v254, s[24:27], s73 offen offset:0 sc1
    v_mfma_f32_16x16x32_bf16 v[8:11], v[100:103], a[48:51], v[8:11]
    ds_read_b64_tr_b16 v[98:99], v236 offset:28672
    buffer_load_dwordx4 a[20:23], v254, s[24:27], s73 offen offset:1024 sc1
    v_mfma_f32_16x16x32_bf16 v[12:15], v[100:103], a[52:55], v[12:15]
    ds_read_b64_tr_b16 v[100:101], v237 offset:24576
    s_add_u32 m0, s40, 106496
    v_mfma_f32_16x16x32_bf16 v[16:19], v[104:107], a[48:51], v[16:19]
    ds_read_b64_tr_b16 v[102:103], v237 offset:28672
    buffer_load_dwordx4 v247, s[8:11], s65 offen offset:0 lds
    v_mfma_f32_16x16x32_bf16 v[20:23], v[104:107], a[52:55], v[20:23]
    ds_read_b64_tr_b16 v[104:105], v238 offset:24576
    buffer_load_dwordx4 v246, s[8:11], s66 offen offset:1024 lds
    v_mfma_f32_16x16x32_bf16 v[24:27], v[108:111], a[48:51], v[24:27]
    ds_read_b64_tr_b16 v[106:107], v238 offset:28672
    v_mfma_f32_16x16x32_bf16 v[28:31], v[108:111], a[52:55], v[28:31]
    ds_read_b64_tr_b16 v[108:109], v239 offset:24576
    s_waitcnt lgkmcnt(7)
    v_mfma_f32_16x16x32_bf16 v[32:35], v[112:115], a[48:51], v[32:35]
    ds_read_b64_tr_b16 v[110:111], v239 offset:28672
    v_mfma_f32_16x16x32_bf16 v[36:39], v[112:115], a[52:55], v[36:39]
    ds_read_b64_tr_b16 v[112:113], v236 offset:25600
    v_mfma_f32_16x16x32_bf16 v[40:43], v[116:119], a[48:51], v[40:43]
    ds_read_b64_tr_b16 v[114:115], v236 offset:29696
    v_mfma_f32_16x16x32_bf16 v[44:47], v[116:119], a[52:55], v[44:47]
    ds_read_b64_tr_b16 v[116:117], v237 offset:25600
    v_mfma_f32_16x16x32_bf16 v[48:51], v[120:123], a[48:51], v[48:51]
    ds_read_b64_tr_b16 v[118:119], v237 offset:29696
    v_mfma_f32_16x16x32_bf16 v[52:55], v[120:123], a[52:55], v[52:55]
    ds_read_b64_tr_b16 v[120:121], v238 offset:25600
    v_mfma_f32_16x16x32_bf16 v[56:59], v[124:127], a[48:51], v[56:59]
    ds_read_b64_tr_b16 v[122:123], v238 offset:29696
    v_mfma_f32_16x16x32_bf16 v[60:63], v[124:127], a[52:55], v[60:63]
    ds_read_b64_tr_b16 v[124:125], v239 offset:25600
    ds_read_b64_tr_b16 v[126:127], v239 offset:29696
    s_waitcnt vmcnt(14) lgkmcnt(8)
    v_mfma_f32_16x16x32_bf16 v[0:3], v[96:99], a[56:59], v[0:3]
    v_readlane_b32 s69, v228, 12
    v_readlane_b32 s71, v228, 13
    v_mfma_f32_16x16x32_bf16 v[4:7], v[96:99], a[60:63], v[4:7]
    s_waitcnt vmcnt(8)
    s_barrier
    ds_read_b64_tr_b16 v[96:97], v232 offset:0
    v_mfma_f32_16x16x32_bf16 v[8:11], v[100:103], a[56:59], v[8:11]
    ds_read_b64_tr_b16 v[98:99], v232 offset:4096
    buffer_load_dwordx4 a[24:27], v254, s[24:27], s74 offen offset:0 sc1
    v_mfma_f32_16x16x32_bf16 v[12:15], v[100:103], a[60:63], v[12:15]
    ds_read_b64_tr_b16 v[100:101], v233 offset:0
    buffer_load_dwordx4 a[28:31], v254, s[24:27], s74 offen offset:1024 sc1
    v_mfma_f32_16x16x32_bf16 v[16:19], v[104:107], a[56:59], v[16:19]
    ds_read_b64_tr_b16 v[102:103], v233 offset:4096
    buffer_load_dwordx4 a[32:35], v254, s[24:27], s75 offen offset:0 sc1
    v_mfma_f32_16x16x32_bf16 v[20:23], v[104:107], a[60:63], v[20:23]
    ds_read_b64_tr_b16 v[104:105], v234 offset:0
    buffer_load_dwordx4 a[36:39], v254, s[24:27], s75 offen offset:1024 sc1
    v_mfma_f32_16x16x32_bf16 v[24:27], v[108:111], a[56:59], v[24:27]
    ds_read_b64_tr_b16 v[106:107], v234 offset:4096
    s_add_u32 m0, s40, 114688
    v_mfma_f32_16x16x32_bf16 v[28:31], v[108:111], a[60:63], v[28:31]
    ds_read_b64_tr_b16 v[108:109], v235 offset:0
    s_waitcnt lgkmcnt(7)
    v_mfma_f32_16x16x32_bf16 v[32:35], v[112:115], a[56:59], v[32:35]
    ds_read_b64_tr_b16 v[110:111], v235 offset:4096
    buffer_load_dwordx4 v247, s[8:11], s67 offen offset:0 lds
    v_mfma_f32_16x16x32_bf16 v[36:39], v[112:115], a[60:63], v[36:39]
    ds_read_b64_tr_b16 v[112:113], v232 offset:1024
    buffer_load_dwordx4 v246, s[8:11], s68 offen offset:1024 lds
    v_mfma_f32_16x16x32_bf16 v[40:43], v[116:119], a[56:59], v[40:43]
    ds_read_b64_tr_b16 v[114:115], v232 offset:5120
    v_mfma_f32_16x16x32_bf16 v[44:47], v[116:119], a[60:63], v[44:47]
    ds_read_b64_tr_b16 v[116:117], v233 offset:1024
    v_mfma_f32_16x16x32_bf16 v[48:51], v[120:123], a[56:59], v[48:51]
    ds_read_b64_tr_b16 v[118:119], v233 offset:5120
    v_mfma_f32_16x16x32_bf16 v[52:55], v[120:123], a[60:63], v[52:55]
    ds_read_b64_tr_b16 v[120:121], v234 offset:1024
    v_mfma_f32_16x16x32_bf16 v[56:59], v[124:127], a[56:59], v[56:59]
    ds_read_b64_tr_b16 v[122:123], v234 offset:5120
    v_mfma_f32_16x16x32_bf16 v[60:63], v[124:127], a[60:63], v[60:63]
    ds_read_b64_tr_b16 v[124:125], v235 offset:1024
    ds_read_b64_tr_b16 v[126:127], v235 offset:5120
    s_waitcnt lgkmcnt(8)
    v_mfma_f32_16x16x32_bf16 v[0:3], v[96:99], a[0:3], v[0:3]
    v_add_u32 v236, 98304, v248
    v_add_u32 v237, 98304, v249
    v_mfma_f32_16x16x32_bf16 v[4:7], v[96:99], a[4:7], v[4:7]
    ds_read_b64_tr_b16 v[96:97], v232 offset:8192
    v_add_u32 v238, 98304, v250
    v_mfma_f32_16x16x32_bf16 v[8:11], v[100:103], a[0:3], v[8:11]
    ds_read_b64_tr_b16 v[98:99], v232 offset:12288
    v_add_u32 v239, 98304, v251
    v_mfma_f32_16x16x32_bf16 v[12:15], v[100:103], a[4:7], v[12:15]
    ds_read_b64_tr_b16 v[100:101], v233 offset:8192
    buffer_load_dwordx4 a[40:43], v254, s[24:27], s76 offen offset:0 sc1
    v_mfma_f32_16x16x32_bf16 v[16:19], v[104:107], a[0:3], v[16:19]
    ds_read_b64_tr_b16 v[102:103], v233 offset:12288
    buffer_load_dwordx4 a[44:47], v254, s[24:27], s76 offen offset:1024 sc1
    v_mfma_f32_16x16x32_bf16 v[20:23], v[104:107], a[4:7], v[20:23]
    ds_read_b64_tr_b16 v[104:105], v234 offset:8192
    buffer_load_dwordx4 a[48:51], v254, s[24:27], s77 offen offset:0 sc1
    v_mfma_f32_16x16x32_bf16 v[24:27], v[108:111], a[0:3], v[24:27]
    ds_read_b64_tr_b16 v[106:107], v234 offset:12288
    buffer_load_dwordx4 a[52:55], v254, s[24:27], s77 offen offset:1024 sc1
    v_mfma_f32_16x16x32_bf16 v[28:31], v[108:111], a[4:7], v[28:31]
    ds_read_b64_tr_b16 v[108:109], v235 offset:8192
    s_waitcnt lgkmcnt(7)
    v_mfma_f32_16x16x32_bf16 v[32:35], v[112:115], a[0:3], v[32:35]
    ds_read_b64_tr_b16 v[110:111], v235 offset:12288
    s_add_u32 m0, s40, 122880
    v_mfma_f32_16x16x32_bf16 v[36:39], v[112:115], a[4:7], v[36:39]
    buffer_load_dwordx4 v227, s[8:11], s69 offen offset:0 lds
    buffer_load_dwordx4 v226, s[8:11], s71 offen offset:1024 lds
    v_mfma_f32_16x16x32_bf16 v[40:43], v[116:119], a[0:3], v[40:43]
    v_mfma_f32_16x16x32_bf16 v[44:47], v[116:119], a[4:7], v[44:47]
    v_mfma_f32_16x16x32_bf16 v[48:51], v[120:123], a[0:3], v[48:51]
    v_mfma_f32_16x16x32_bf16 v[52:55], v[120:123], a[4:7], v[52:55]
    v_mfma_f32_16x16x32_bf16 v[56:59], v[124:127], a[0:3], v[56:59]
    v_mfma_f32_16x16x32_bf16 v[60:63], v[124:127], a[4:7], v[60:63]
    s_waitcnt vmcnt(18) lgkmcnt(4)
    v_mfma_f32_16x16x32_bf16 v[0:3], v[96:99], a[8:11], v[0:3]
    ds_read_b64_tr_b16 v[112:113], v232 offset:9216
    v_cvt_pk_bf16_f32 v160, v32, v33
    v_cvt_pk_bf16_f32 v161, v34, v35
    v_mfma_f32_16x16x32_bf16 v[4:7], v[96:99], a[12:15], v[4:7]
    ds_read_b64_tr_b16 v[114:115], v232 offset:13312
    v_cvt_pk_bf16_f32 v162, v36, v37
    v_cvt_pk_bf16_f32 v163, v38, v39
    v_mfma_f32_16x16x32_bf16 v[8:11], v[100:103], a[8:11], v[8:11]
    ds_read_b64_tr_b16 v[116:117], v233 offset:9216
    buffer_store_dwordx4 v[160:163], v254, s[16:19], 0 offen offset:0 sc1
    v_cvt_pk_bf16_f32 v164, v40, v41
    v_mfma_f32_16x16x32_bf16 v[12:15], v[100:103], a[12:15], v[12:15]
    ds_read_b64_tr_b16 v[118:119], v233 offset:13312
    v_cvt_pk_bf16_f32 v165, v42, v43
    s_waitcnt lgkmcnt(4)
    v_mfma_f32_16x16x32_bf16 v[16:19], v[104:107], a[8:11], v[16:19]
    ds_read_b64_tr_b16 v[120:121], v234 offset:9216
    v_cvt_pk_bf16_f32 v166, v44, v45
    v_cvt_pk_bf16_f32 v167, v46, v47
    v_mfma_f32_16x16x32_bf16 v[20:23], v[104:107], a[12:15], v[20:23]
    ds_read_b64_tr_b16 v[122:123], v234 offset:13312
    buffer_store_dwordx4 v[164:167], v254, s[16:19], 0 offen offset:1024 sc1
    v_cvt_pk_bf16_f32 v168, v48, v49
    v_mfma_f32_16x16x32_bf16 v[24:27], v[108:111], a[8:11], v[24:27]
    ds_read_b64_tr_b16 v[124:125], v235 offset:9216
    v_cvt_pk_bf16_f32 v169, v50, v51
    v_cvt_pk_bf16_f32 v170, v52, v53
    v_mfma_f32_16x16x32_bf16 v[28:31], v[108:111], a[12:15], v[28:31]
    ds_read_b64_tr_b16 v[126:127], v235 offset:13312
    v_cvt_pk_bf16_f32 v171, v54, v55
    s_waitcnt vmcnt(16) lgkmcnt(4)
    v_mfma_f32_16x16x32_bf16 v[0:3], v[112:115], a[16:19], v[0:3]
    ds_read_b64_tr_b16 v[96:97], v232 offset:16384
    buffer_store_dwordx4 v[168:171], v254, s[16:19], 0 offen offset:2048 sc1
    v_cvt_pk_bf16_f32 v172, v56, v57
    v_mfma_f32_16x16x32_bf16 v[4:7], v[112:115], a[20:23], v[4:7]
    ds_read_b64_tr_b16 v[98:99], v232 offset:20480
    v_cvt_pk_bf16_f32 v173, v58, v59
    v_cvt_pk_bf16_f32 v174, v60, v61
    v_mfma_f32_16x16x32_bf16 v[8:11], v[116:119], a[16:19], v[8:11]
    ds_read_b64_tr_b16 v[100:101], v233 offset:16384
    v_cvt_pk_bf16_f32 v175, v62, v63
    buffer_store_dwordx4 v[172:175], v254, s[16:19], 0 offen offset:3072 sc1
    v_mfma_f32_16x16x32_bf16 v[12:15], v[116:119], a[20:23], v[12:15]
    ds_read_b64_tr_b16 v[102:103], v233 offset:20480
    buffer_load_dwordx4 a[56:59], v254, s[24:27], s59 offen offset:0 sc1
    s_waitcnt lgkmcnt(4)
    v_mfma_f32_16x16x32_bf16 v[16:19], v[120:123], a[16:19], v[16:19]
    ds_read_b64_tr_b16 v[104:105], v234 offset:16384
    buffer_load_dwordx4 a[60:63], v254, s[24:27], s59 offen offset:1024 sc1
    buffer_load_dwordx4 a[0:3], v254, s[24:27], s64 offen offset:0 sc1
    v_mfma_f32_16x16x32_bf16 v[20:23], v[120:123], a[20:23], v[20:23]
    ds_read_b64_tr_b16 v[106:107], v234 offset:20480
    buffer_load_dwordx4 a[4:7], v254, s[24:27], s64 offen offset:1024 sc1
    buffer_load_dwordx4 a[8:11], v254, s[24:27], s65 offen offset:0 sc1
    v_mfma_f32_16x16x32_bf16 v[24:27], v[124:127], a[16:19], v[24:27]
    ds_read_b64_tr_b16 v[108:109], v235 offset:16384
    buffer_load_dwordx4 a[12:15], v254, s[24:27], s65 offen offset:1024 sc1
    v_mfma_f32_16x16x32_bf16 v[28:31], v[124:127], a[20:23], v[28:31]
    ds_read_b64_tr_b16 v[110:111], v235 offset:20480
    s_waitcnt vmcnt(20) lgkmcnt(4)
    v_mfma_f32_16x16x32_bf16 v[0:3], v[96:99], a[24:27], v[0:3]
    ds_read_b64_tr_b16 v[112:113], v232 offset:17408
    buffer_load_dwordx4 a[16:19], v254, s[24:27], s66 offen offset:0 sc1
    buffer_load_dwordx4 a[20:23], v254, s[24:27], s66 offen offset:1024 sc1
    v_mfma_f32_16x16x32_bf16 v[4:7], v[96:99], a[28:31], v[4:7]
    ds_read_b64_tr_b16 v[114:115], v232 offset:21504
    v_mfma_f32_16x16x32_bf16 v[8:11], v[100:103], a[24:27], v[8:11]
    ds_read_b64_tr_b16 v[116:117], v233 offset:17408
    v_mfma_f32_16x16x32_bf16 v[12:15], v[100:103], a[28:31], v[12:15]
    ds_read_b64_tr_b16 v[118:119], v233 offset:21504
    s_waitcnt lgkmcnt(4)
    v_mfma_f32_16x16x32_bf16 v[16:19], v[104:107], a[24:27], v[16:19]
    ds_read_b64_tr_b16 v[120:121], v234 offset:17408
    v_mfma_f32_16x16x32_bf16 v[20:23], v[104:107], a[28:31], v[20:23]
    ds_read_b64_tr_b16 v[122:123], v234 offset:21504
    v_mfma_f32_16x16x32_bf16 v[24:27], v[108:111], a[24:27], v[24:27]
    ds_read_b64_tr_b16 v[124:125], v235 offset:17408
    v_mfma_f32_16x16x32_bf16 v[28:31], v[108:111], a[28:31], v[28:31]
    ds_read_b64_tr_b16 v[126:127], v235 offset:21504
    s_waitcnt vmcnt(20) lgkmcnt(4)
    v_mfma_f32_16x16x32_bf16 v[0:3], v[112:115], a[32:35], v[0:3]
    ds_read_b64_tr_b16 v[96:97], v232 offset:24576
    buffer_load_dwordx4 a[24:27], v254, s[24:27], s67 offen offset:0 sc1
    buffer_load_dwordx4 a[28:31], v254, s[24:27], s67 offen offset:1024 sc1
    v_mfma_f32_16x16x32_bf16 v[4:7], v[112:115], a[36:39], v[4:7]
    ds_read_b64_tr_b16 v[98:99], v232 offset:28672
    v_mfma_f32_16x16x32_bf16 v[8:11], v[116:119], a[32:35], v[8:11]
    ds_read_b64_tr_b16 v[100:101], v233 offset:24576
    v_mfma_f32_16x16x32_bf16 v[12:15], v[116:119], a[36:39], v[12:15]
    ds_read_b64_tr_b16 v[102:103], v233 offset:28672
    s_waitcnt lgkmcnt(4)
    v_mfma_f32_16x16x32_bf16 v[16:19], v[120:123], a[32:35], v[16:19]
    ds_read_b64_tr_b16 v[104:105], v234 offset:24576
    v_mfma_f32_16x16x32_bf16 v[20:23], v[120:123], a[36:39], v[20:23]
    ds_read_b64_tr_b16 v[106:107], v234 offset:28672
    v_mfma_f32_16x16x32_bf16 v[24:27], v[124:127], a[32:35], v[24:27]
    ds_read_b64_tr_b16 v[108:109], v235 offset:24576
    v_mfma_f32_16x16x32_bf16 v[28:31], v[124:127], a[36:39], v[28:31]
    ds_read_b64_tr_b16 v[110:111], v235 offset:28672
    s_waitcnt vmcnt(18) lgkmcnt(4)
    v_mfma_f32_16x16x32_bf16 v[0:3], v[96:99], a[40:43], v[0:3]
    ds_read_b64_tr_b16 v[112:113], v232 offset:25600
    buffer_load_dwordx4 a[32:35], v254, s[24:27], s68 offen offset:0 sc1
    buffer_load_dwordx4 a[36:39], v254, s[24:27], s68 offen offset:1024 sc1
    v_mfma_f32_16x16x32_bf16 v[4:7], v[96:99], a[44:47], v[4:7]
    ds_read_b64_tr_b16 v[114:115], v232 offset:29696
    v_mfma_f32_16x16x32_bf16 v[8:11], v[100:103], a[40:43], v[8:11]
    ds_read_b64_tr_b16 v[116:117], v233 offset:25600
    v_mfma_f32_16x16x32_bf16 v[12:15], v[100:103], a[44:47], v[12:15]
    ds_read_b64_tr_b16 v[118:119], v233 offset:29696
    s_waitcnt lgkmcnt(4)
    v_mfma_f32_16x16x32_bf16 v[16:19], v[104:107], a[40:43], v[16:19]
    ds_read_b64_tr_b16 v[120:121], v234 offset:25600
    v_mfma_f32_16x16x32_bf16 v[20:23], v[104:107], a[44:47], v[20:23]
    ds_read_b64_tr_b16 v[122:123], v234 offset:29696
    v_mfma_f32_16x16x32_bf16 v[24:27], v[108:111], a[40:43], v[24:27]
    ds_read_b64_tr_b16 v[124:125], v235 offset:25600
    v_mfma_f32_16x16x32_bf16 v[28:31], v[108:111], a[44:47], v[28:31]
    ds_read_b64_tr_b16 v[126:127], v235 offset:29696
    s_waitcnt vmcnt(18) lgkmcnt(4)
    v_mfma_f32_16x16x32_bf16 v[0:3], v[112:115], a[48:51], v[0:3]
    buffer_load_dwordx4 a[40:43], v254, s[24:27], s69 offen offset:0 sc1
    buffer_load_dwordx4 a[44:47], v254, s[24:27], s69 offen offset:1024 sc1
    s_waitcnt vmcnt(14)
    s_barrier
    s_cmp_ge_u32 s28, 1
    s_cbranch_scc1 L_sig45
    s_mov_b64 exec, 1
    buffer_atomic_add v253, v252, s[20:23], s46 offen sc1
    s_mov_b64 exec, -1
L_sig45:
    ds_read_b64_tr_b16 v[96:97], v236 offset:0
    v_mfma_f32_16x16x32_bf16 v[4:7], v[112:115], a[52:55], v[4:7]
    ds_read_b64_tr_b16 v[98:99], v236 offset:4096
    v_mfma_f32_16x16x32_bf16 v[8:11], v[116:119], a[48:51], v[8:11]
    ds_read_b64_tr_b16 v[100:101], v237 offset:0
    v_mfma_f32_16x16x32_bf16 v[12:15], v[116:119], a[52:55], v[12:15]
    ds_read_b64_tr_b16 v[102:103], v237 offset:4096
    s_waitcnt lgkmcnt(4)
    v_mfma_f32_16x16x32_bf16 v[16:19], v[120:123], a[48:51], v[16:19]
    ds_read_b64_tr_b16 v[104:105], v238 offset:0
    v_mfma_f32_16x16x32_bf16 v[20:23], v[120:123], a[52:55], v[20:23]
    ds_read_b64_tr_b16 v[106:107], v238 offset:4096
    v_mfma_f32_16x16x32_bf16 v[24:27], v[124:127], a[48:51], v[24:27]
    ds_read_b64_tr_b16 v[108:109], v239 offset:0
    v_mfma_f32_16x16x32_bf16 v[28:31], v[124:127], a[52:55], v[28:31]
    ds_read_b64_tr_b16 v[110:111], v239 offset:4096
    s_waitcnt vmcnt(12) lgkmcnt(4)
    v_mfma_f32_16x16x32_bf16 v[0:3], v[96:99], a[56:59], v[0:3]
    ds_read_b64_tr_b16 v[112:113], v236 offset:1024
    buffer_load_dwordx4 a[48:51], v254, s[24:27], s71 offen offset:0 sc1
    buffer_load_dwordx4 a[52:55], v254, s[24:27], s71 offen offset:1024 sc1
    v_mfma_f32_16x16x32_bf16 v[4:7], v[96:99], a[60:63], v[4:7]
    ds_read_b64_tr_b16 v[114:115], v236 offset:5120
    v_mfma_f32_16x16x32_bf16 v[8:11], v[100:103], a[56:59], v[8:11]
    ds_read_b64_tr_b16 v[116:117], v237 offset:1024
    v_mfma_f32_16x16x32_bf16 v[12:15], v[100:103], a[60:63], v[12:15]
    ds_read_b64_tr_b16 v[118:119], v237 offset:5120
    s_waitcnt lgkmcnt(4)
    v_mfma_f32_16x16x32_bf16 v[16:19], v[104:107], a[56:59], v[16:19]
    ds_read_b64_tr_b16 v[120:121], v238 offset:1024
    v_mfma_f32_16x16x32_bf16 v[20:23], v[104:107], a[60:63], v[20:23]
    ds_read_b64_tr_b16 v[122:123], v238 offset:5120
    v_mfma_f32_16x16x32_bf16 v[24:27], v[108:111], a[56:59], v[24:27]
    ds_read_b64_tr_b16 v[124:125], v239 offset:1024
    v_mfma_f32_16x16x32_bf16 v[28:31], v[108:111], a[60:63], v[28:31]
    ds_read_b64_tr_b16 v[126:127], v239 offset:5120
    s_waitcnt vmcnt(12) lgkmcnt(4)
    v_mfma_f32_16x16x32_bf16 v[0:3], v[112:115], a[0:3], v[0:3]
    ds_read_b64_tr_b16 v[96:97], v236 offset:8192
    v_mfma_f32_16x16x32_bf16 v[4:7], v[112:115], a[4:7], v[4:7]
    ds_read_b64_tr_b16 v[98:99], v236 offset:12288
    v_mfma_f32_16x16x32_bf16 v[8:11], v[116:119], a[0:3], v[8:11]
    ds_read_b64_tr_b16 v[100:101], v237 offset:8192
    v_mfma_f32_16x16x32_bf16 v[12:15], v[116:119], a[4:7], v[12:15]
    ds_read_b64_tr_b16 v[102:103], v237 offset:12288
    s_waitcnt lgkmcnt(4)
    v_mfma_f32_16x16x32_bf16 v[16:19], v[120:123], a[0:3], v[16:19]
    ds_read_b64_tr_b16 v[104:105], v238 offset:8192
    v_mfma_f32_16x16x32_bf16 v[20:23], v[120:123], a[4:7], v[20:23]
    ds_read_b64_tr_b16 v[106:107], v238 offset:12288
    v_mfma_f32_16x16x32_bf16 v[24:27], v[124:127], a[0:3], v[24:27]
    ds_read_b64_tr_b16 v[108:109], v239 offset:8192
    v_mfma_f32_16x16x32_bf16 v[28:31], v[124:127], a[4:7], v[28:31]
    ds_read_b64_tr_b16 v[110:111], v239 offset:12288
    s_waitcnt vmcnt(10) lgkmcnt(4)
    v_mfma_f32_16x16x32_bf16 v[0:3], v[96:99], a[8:11], v[0:3]
    ds_read_b64_tr_b16 v[112:113], v236 offset:9216
    v_mfma_f32_16x16x32_bf16 v[4:7], v[96:99], a[12:15], v[4:7]
    ds_read_b64_tr_b16 v[114:115], v236 offset:13312
    v_mfma_f32_16x16x32_bf16 v[8:11], v[100:103], a[8:11], v[8:11]
    ds_read_b64_tr_b16 v[116:117], v237 offset:9216
    v_mfma_f32_16x16x32_bf16 v[12:15], v[100:103], a[12:15], v[12:15]
    ds_read_b64_tr_b16 v[118:119], v237 offset:13312
    s_waitcnt lgkmcnt(4)
    v_mfma_f32_16x16x32_bf16 v[16:19], v[104:107], a[8:11], v[16:19]
    ds_read_b64_tr_b16 v[120:121], v238 offset:9216
    v_mfma_f32_16x16x32_bf16 v[20:23], v[104:107], a[12:15], v[20:23]
    ds_read_b64_tr_b16 v[122:123], v238 offset:13312
    v_mfma_f32_16x16x32_bf16 v[24:27], v[108:111], a[8:11], v[24:27]
    ds_read_b64_tr_b16 v[124:125], v239 offset:9216
    v_mfma_f32_16x16x32_bf16 v[28:31], v[108:111], a[12:15], v[28:31]
    ds_read_b64_tr_b16 v[126:127], v239 offset:13312
    s_waitcnt vmcnt(8) lgkmcnt(4)
    v_mfma_f32_16x16x32_bf16 v[0:3], v[112:115], a[16:19], v[0:3]
    ds_read_b64_tr_b16 v[96:97], v236 offset:16384
    buffer_load_dword v243, v252, s[20:23], s47 offen sc1
    v_mfma_f32_16x16x32_bf16 v[4:7], v[112:115], a[20:23], v[4:7]
    ds_read_b64_tr_b16 v[98:99], v236 offset:20480
    v_mfma_f32_16x16x32_bf16 v[8:11], v[116:119], a[16:19], v[8:11]
    ds_read_b64_tr_b16 v[100:101], v237 offset:16384
    v_mfma_f32_16x16x32_bf16 v[12:15], v[116:119], a[20:23], v[12:15]
    ds_read_b64_tr_b16 v[102:103], v237 offset:20480
    s_waitcnt lgkmcnt(4)
    v_mfma_f32_16x16x32_bf16 v[16:19], v[120:123], a[16:19], v[16:19]
    ds_read_b64_tr_b16 v[104:105], v238 offset:16384
    v_mfma_f32_16x16x32_bf16 v[20:23], v[120:123], a[20:23], v[20:23]
    ds_read_b64_tr_b16 v[106:107], v238 offset:20480
    v_mfma_f32_16x16x32_bf16 v[24:27], v[124:127], a[16:19], v[24:27]
    ds_read_b64_tr_b16 v[108:109], v239 offset:16384
    v_mfma_f32_16x16x32_bf16 v[28:31], v[124:127], a[20:23], v[28:31]
    ds_read_b64_tr_b16 v[110:111], v239 offset:20480
    s_waitcnt vmcnt(7) lgkmcnt(4)
    v_mfma_f32_16x16x32_bf16 v[0:3], v[96:99], a[24:27], v[0:3]
    ds_read_b64_tr_b16 v[112:113], v236 offset:17408
    v_mfma_f32_16x16x32_bf16 v[4:7], v[96:99], a[28:31], v[4:7]
    ds_read_b64_tr_b16 v[114:115], v236 offset:21504
    v_mfma_f32_16x16x32_bf16 v[8:11], v[100:103], a[24:27], v[8:11]
    ds_read_b64_tr_b16 v[116:117], v237 offset:17408
    v_mfma_f32_16x16x32_bf16 v[12:15], v[100:103], a[28:31], v[12:15]
    ds_read_b64_tr_b16 v[118:119], v237 offset:21504
    s_waitcnt lgkmcnt(4)
    v_mfma_f32_16x16x32_bf16 v[16:19], v[104:107], a[24:27], v[16:19]
    ds_read_b64_tr_b16 v[120:121], v238 offset:17408
    v_mfma_f32_16x16x32_bf16 v[20:23], v[104:107], a[28:31], v[20:23]
    ds_read_b64_tr_b16 v[122:123], v238 offset:21504
    v_mfma_f32_16x16x32_bf16 v[24:27], v[108:111], a[24:27], v[24:27]
    ds_read_b64_tr_b16 v[124:125], v239 offset:17408
    v_mfma_f32_16x16x32_bf16 v[28:31], v[108:111], a[28:31], v[28:31]
    ds_read_b64_tr_b16 v[126:127], v239 offset:21504
    s_waitcnt vmcnt(0)
    v_cmp_gt_u32 vcc, 1, v243
    s_cbranch_vccz L_chk46
    s_mov_b64 exec, 1
    s_mov_b32 s3, 0x40000
L_poll47:
    buffer_load_dword v243, v252, s[20:23], s47 offen sc1
    s_sub_u32 s3, s3, 1
    s_cbranch_scc1 L_poll47_y
    s_waitcnt vmcnt(0)
    v_cmp_gt_u32 vcc, 1, v243
    s_cbranch_vccz L_poll47_y
    s_sleep 1
    s_branch L_poll47
L_poll47_y:
    s_waitcnt vmcnt(0)
    s_mov_b64 exec, -1
L_poll47_x:
L_chk46:
    s_waitcnt lgkmcnt(4)
    v_mfma_f32_16x16x32_bf16 v[0:3], v[112:115], a[32:35], v[0:3]
    ds_read_b64_tr_b16 v[96:97], v236 offset:24576
    buffer_load_dwordx4 v[160:163], v254, s[12:15], 0 offen offset:0 sc1
    buffer_load_dwordx4 v[164:167], v254, s[12:15], 0 offen offset:1024 sc1
    v_mfma_f32_16x16x32_bf16 v[4:7], v[112:115], a[36:39], v[4:7]
    ds_read_b64_tr_b16 v[98:99], v236 offset:28672
    buffer_load_dwordx4 v[168:171], v254, s[12:15], 0 offen offset:2048 sc1
    buffer_load_dwordx4 v[172:175], v254, s[12:15], 0 offen offset:3072 sc1
    v_mfma_f32_16x16x32_bf16 v[8:11], v[116:119], a[32:35], v[8:11]
    ds_read_b64_tr_b16 v[100:101], v237 offset:24576
    v_mfma_f32_16x16x32_bf16 v[12:15], v[116:119], a[36:39], v[12:15]
    ds_read_b64_tr_b16 v[102:103], v237 offset:28672
    s_waitcnt lgkmcnt(4)
    v_mfma_f32_16x16x32_bf16 v[16:19], v[120:123], a[32:35], v[16:19]
    ds_read_b64_tr_b16 v[104:105], v238 offset:24576
    v_mfma_f32_16x16x32_bf16 v[20:23], v[120:123], a[36:39], v[20:23]
    ds_read_b64_tr_b16 v[106:107], v238 offset:28672
    v_mfma_f32_16x16x32_bf16 v[24:27], v[124:127], a[32:35], v[24:27]
    ds_read_b64_tr_b16 v[108:109], v239 offset:24576
    v_mfma_f32_16x16x32_bf16 v[28:31], v[124:127], a[36:39], v[28:31]
    ds_read_b64_tr_b16 v[110:111], v239 offset:28672
    s_waitcnt lgkmcnt(4)
    v_mfma_f32_16x16x32_bf16 v[0:3], v[96:99], a[40:43], v[0:3]
    ds_read_b64_tr_b16 v[112:113], v236 offset:25600
    v_mfma_f32_16x16x32_bf16 v[4:7], v[96:99], a[44:47], v[4:7]
    ds_read_b64_tr_b16 v[114:115], v236 offset:29696
    v_mfma_f32_16x16x32_bf16 v[8:11], v[100:103], a[40:43], v[8:11]
    ds_read_b64_tr_b16 v[116:117], v237 offset:25600
    v_mfma_f32_16x16x32_bf16 v[12:15], v[100:103], a[44:47], v[12:15]
    ds_read_b64_tr_b16 v[118:119], v237 offset:29696
    s_waitcnt lgkmcnt(4)
    v_mfma_f32_16x16x32_bf16 v[16:19], v[104:107], a[40:43], v[16:19]
    ds_read_b64_tr_b16 v[120:121], v238 offset:25600
    v_mfma_f32_16x16x32_bf16 v[20:23], v[104:107], a[44:47], v[20:23]
    ds_read_b64_tr_b16 v[122:123], v238 offset:29696
    v_mfma_f32_16x16x32_bf16 v[24:27], v[108:111], a[40:43], v[24:27]
    ds_read_b64_tr_b16 v[124:125], v239 offset:25600
    v_mfma_f32_16x16x32_bf16 v[28:31], v[108:111], a[44:47], v[28:31]
    ds_read_b64_tr_b16 v[126:127], v239 offset:29696
    s_waitcnt lgkmcnt(4)
    v_mfma_f32_16x16x32_bf16 v[0:3], v[112:115], a[48:51], v[0:3]
    v_mfma_f32_16x16x32_bf16 v[4:7], v[112:115], a[52:55], v[4:7]
    v_mfma_f32_16x16x32_bf16 v[8:11], v[116:119], a[48:51], v[8:11]
    v_mfma_f32_16x16x32_bf16 v[12:15], v[116:119], a[52:55], v[12:15]
    s_waitcnt lgkmcnt(0)
    v_mfma_f32_16x16x32_bf16 v[16:19], v[120:123], a[48:51], v[16:19]
    v_mfma_f32_16x16x32_bf16 v[20:23], v[120:123], a[52:55], v[20:23]
    v_mfma_f32_16x16x32_bf16 v[24:27], v[124:127], a[48:51], v[24:27]
    v_mfma_f32_16x16x32_bf16 v[28:31], v[124:127], a[52:55], v[28:31]
    s_mov_b32 s45, 0xffff0000
    s_waitcnt vmcnt(3)
    v_lshlrev_b32 v128, 16, v160
    v_and_b32 v129, s45, v160
    v_pk_fma_f32 v[64:65], v[128:129], v[240:241], v[64:65] op_sel:[0,0,0] op_sel_hi:[1,0,1]
    v_lshlrev_b32 v130, 16, v161
    v_and_b32 v131, s45, v161
    v_pk_fma_f32 v[66:67], v[130:131], v[240:241], v[66:67] op_sel:[0,0,0] op_sel_hi:[1,0,1]
    v_lshlrev_b32 v132, 16, v162
    v_and_b32 v133, s45, v162
    v_pk_fma_f32 v[68:69], v[132:133], v[240:241], v[68:69] op_sel:[0,1,0] op_sel_hi:[1,1,1]
    v_lshlrev_b32 v134, 16, v163
    v_and_b32 v135, s45, v163
    v_pk_fma_f32 v[70:71], v[134:135], v[240:241], v[70:71] op_sel:[0,1,0] op_sel_hi:[1,1,1]
    s_waitcnt vmcnt(2)
    v_lshlrev_b32 v136, 16, v164
    v_and_b32 v137, s45, v164
    v_pk_fma_f32 v[72:73], v[136:137], v[240:241], v[72:73] op_sel:[0,0,0] op_sel_hi:[1,0,1]
    v_lshlrev_b32 v138, 16, v165
    v_and_b32 v139, s45, v165
    v_pk_fma_f32 v[74:75], v[138:139], v[240:241], v[74:75] op_sel:[0,0,0] op_sel_hi:[1,0,1]
    v_lshlrev_b32 v140, 16, v166
    v_and_b32 v141, s45, v166
    v_pk_fma_f32 v[76:77], v[140:141], v[240:241], v[76:77] op_sel:[0,1,0] op_sel_hi:[1,1,1]
    v_lshlrev_b32 v142, 16, v167
    v_and_b32 v143, s45, v167
    v_pk_fma_f32 v[78:79], v[142:143], v[240:241], v[78:79] op_sel:[0,1,0] op_sel_hi:[1,1,1]
    s_waitcnt vmcnt(1)
    v_lshlrev_b32 v144, 16, v168
    v_and_b32 v145, s45, v168
    v_pk_fma_f32 v[80:81], v[144:145], v[240:241], v[80:81] op_sel:[0,0,0] op_sel_hi:[1,0,1]
    v_lshlrev_b32 v146, 16, v169
    v_and_b32 v147, s45, v169
    v_pk_fma_f32 v[82:83], v[146:147], v[240:241], v[82:83] op_sel:[0,0,0] op_sel_hi:[1,0,1]
    v_lshlrev_b32 v148, 16, v170
    v_and_b32 v149, s45, v170
    v_pk_fma_f32 v[84:85], v[148:149], v[240:241], v[84:85] op_sel:[0,1,0] op_sel_hi:[1,1,1]
    v_lshlrev_b32 v150, 16, v171
    v_and_b32 v151, s45, v171
    v_pk_fma_f32 v[86:87], v[150:151], v[240:241], v[86:87] op_sel:[0,1,0] op_sel_hi:[1,1,1]
    s_waitcnt vmcnt(0)
    v_lshlrev_b32 v152, 16, v172
    v_and_b32 v153, s45, v172
    v_pk_fma_f32 v[88:89], v[152:153], v[240:241], v[88:89] op_sel:[0,0,0] op_sel_hi:[1,0,1]
    v_lshlrev_b32 v154, 16, v173
    v_and_b32 v155, s45, v173
    v_pk_fma_f32 v[90:91], v[154:155], v[240:241], v[90:91] op_sel:[0,0,0] op_sel_hi:[1,0,1]
    v_lshlrev_b32 v156, 16, v174
    v_and_b32 v157, s45, v174
    v_pk_fma_f32 v[92:93], v[156:157], v[240:241], v[92:93] op_sel:[0,1,0] op_sel_hi:[1,1,1]
    v_lshlrev_b32 v158, 16, v175
    v_and_b32 v159, s45, v175
    v_pk_fma_f32 v[94:95], v[158:159], v[240:241], v[94:95] op_sel:[0,1,0] op_sel_hi:[1,1,1]
    v_pk_fma_f32 v[64:65], v[0:1], v[240:241], v[64:65] op_sel:[0,0,0] op_sel_hi:[1,0,1]
    v_cvt_pk_bf16_f32 v96, v64, v65
    v_pk_fma_f32 v[66:67], v[2:3], v[240:241], v[66:67] op_sel:[0,0,0] op_sel_hi:[1,0,1]
    v_cvt_pk_bf16_f32 v97, v66, v67
    v_pk_fma_f32 v[72:73], v[8:9], v[240:241], v[72:73] op_sel:[0,0,0] op_sel_hi:[1,0,1]
    v_cvt_pk_bf16_f32 v98, v72, v73
    v_pk_fma_f32 v[74:75], v[10:11], v[240:241], v[74:75] op_sel:[0,0,0] op_sel_hi:[1,0,1]
    v_cvt_pk_bf16_f32 v99, v74, v75
    v_permlane16_swap_b32 v96, v98
    s_nop 0
    v_permlane16_swap_b32 v97, v99
    ds_write_b128 v229, v[96:99] offset:0
    v_pk_fma_f32 v[80:81], v[16:17], v[240:241], v[80:81] op_sel:[0,0,0] op_sel_hi:[1,0,1]
    v_cvt_pk_bf16_f32 v100, v80, v81
    v_pk_fma_f32 v[82:83], v[18:19], v[240:241], v[82:83] op_sel:[0,0,0] op_sel_hi:[1,0,1]
    v_cvt_pk_bf16_f32 v101, v82, v83
    v_pk_fma_f32 v[88:89], v[24:25], v[240:241], v[88:89] op_sel:[0,0,0] op_sel_hi:[1,0,1]
    v_cvt_pk_bf16_f32 v102, v88, v89
    v_pk_fma_f32 v[90:91], v[26:27], v[240:241], v[90:91] op_sel:[0,0,0] op_sel_hi:[1,0,1]
    v_cvt_pk_bf16_f32 v103, v90, v91
    v_permlane16_swap_b32 v100, v102
    s_nop 0
    v_permlane16_swap_b32 v101, v103
    ds_write_b128 v230, v[100:103] offset:0
    s_waitcnt lgkmcnt(0)
    ds_read_b128 v[112:115], v224 offset:0
    ds_read_b128 v[116:119], v231 offset:1024
    v_pk_fma_f32 v[68:69], v[4:5], v[240:241], v[68:69] op_sel:[0,1,0] op_sel_hi:[1,1,1]
    v_cvt_pk_bf16_f32 v104, v68, v69
    v_pk_fma_f32 v[70:71], v[6:7], v[240:241], v[70:71] op_sel:[0,1,0] op_sel_hi:[1,1,1]
    v_cvt_pk_bf16_f32 v105, v70, v71
    v_pk_fma_f32 v[76:77], v[12:13], v[240:241], v[76:77] op_sel:[0,1,0] op_sel_hi:[1,1,1]
    v_cvt_pk_bf16_f32 v106, v76, v77
    v_pk_fma_f32 v[78:79], v[14:15], v[240:241], v[78:79] op_sel:[0,1,0] op_sel_hi:[1,1,1]
    v_cvt_pk_bf16_f32 v107, v78, v79
    v_permlane16_swap_b32 v104, v106
    s_nop 0
    v_permlane16_swap_b32 v105, v107
    ds_write_b128 v229, v[104:107] offset:2048
    v_pk_fma_f32 v[84:85], v[20:21], v[240:241], v[84:85] op_sel:[0,1,0] op_sel_hi:[1,1,1]
    v_cvt_pk_bf16_f32 v108, v84, v85
    v_pk_fma_f32 v[86:87], v[22:23], v[240:241], v[86:87] op_sel:[0,1,0] op_sel_hi:[1,1,1]
    v_cvt_pk_bf16_f32 v109, v86, v87
    v_pk_fma_f32 v[92:93], v[28:29], v[240:241], v[92:93] op_sel:[0,1,0] op_sel_hi:[1,1,1]
    v_cvt_pk_bf16_f32 v110, v92, v93
    v_pk_fma_f32 v[94:95], v[30:31], v[240:241], v[94:95] op_sel:[0,1,0] op_sel_hi:[1,1,1]
    v_cvt_pk_bf16_f32 v111, v94, v95
    v_permlane16_swap_b32 v108, v110
    s_nop 0
    v_permlane16_swap_b32 v109, v111
    ds_write_b128 v230, v[108:111] offset:2048
    s_waitcnt lgkmcnt(0)
    ds_read_b128 v[120:123], v224 offset:2048
    ds_read_b128 v[124:127], v231 offset:3072
    buffer_store_dwordx4 v[112:115], v242, s[4:7], 0 offen sc1
    s_mul_i32 s3, s44, 1
    buffer_store_dwordx4 v[116:119], v242, s[4:7], s3 offen sc1
    s_mul_i32 s3, s44, 2
    s_waitcnt lgkmcnt(1)
    buffer_store_dwordx4 v[120:123], v242, s[4:7], s3 offen sc1
    s_mul_i32 s3, s44, 3
    s_waitcnt lgkmcnt(0)
    buffer_store_dwordx4 v[124:127], v242, s[4:7], s3 offen sc1
L_done:
    s_endpgm
L_end:

.section .rodata,"a"
.p2align 6
.amdhsa_kernel sequential_preLN__sliding_block__glu_gated_glu__prompt_kernel
  .amdhsa_next_free_vgpr 512
  .amdhsa_next_free_sgpr 102
  .amdhsa_accum_offset 256
  .amdhsa_group_segment_fixed_size 0
  .amdhsa_kernarg_size 80
  .amdhsa_user_sgpr_count 2
  .amdhsa_user_sgpr_kernarg_segment_ptr 1
  .amdhsa_system_sgpr_workgroup_id_x 1
  .amdhsa_float_denorm_mode_32 3
.end_amdhsa_kernel
```
